```python
import torch

def _softmax(x, axis=-1):
    return torch.softmax(x, dim=axis)

def _gelu(x):
    return torch.nn.functional.gelu(x, approximate='tanh')

def _silu(x):
    return torch.nn.functional.silu(x)

def _sigmoid(x):
    return torch.sigmoid(x)

def _layernorm(x, axis=-1, eps=1e-05):
    m = x.mean(dim=axis, keepdim=True)
    v = x.var(dim=axis, keepdim=True, unbiased=False)
    return (x - m) / torch.sqrt(v + eps)

def _scatter_add(tgt, idx, src, axis=0):
    return tgt.clone().index_add_(axis, idx, src)

def _segment_sum(src, seg, n):
    out = torch.zeros((n,) + src.shape[1:], dtype=src.dtype)
    return out.index_add_(0, seg, src)

def _pad(x, pw):
    flat = tuple((v for pair in reversed(pw) for v in pair))
    return torch.nn.functional.pad(x, flat)
kernel_name = 'adaLN_cond__compressed_kv_cla__dense_activation_squared_relu__prompt'

def setup_inputs():

    _w = lambda a: (lambda t: t.to(torch.bfloat16) if t.is_floating_point() else t)(torch.as_tensor(a))

    def _A_setup():
        B, H, Sq, Sk, D, M = (1, 32, 2048, 2048, 128, 640)
        Dc = 4 * D
        return {'x': _w((lambda *s: torch.randn(*s, dtype=torch.bfloat16) * 0.05)(B, Sq, M)), 'c_kv': _w((lambda *s: torch.randn(*s, dtype=torch.bfloat16) * 1.6)(B, Sk, Dc)), 'w_q': _w((lambda *s: torch.randn(*s, dtype=torch.bfloat16) * 0.8)(M, H, D) * M ** (-0.5)), 'w_uk': _w((lambda *s: torch.randn(*s, dtype=torch.bfloat16) * 0.8)(Dc, H, D) * Dc ** (-0.5)), 'w_uv': _w((lambda *s: torch.randn(*s, dtype=torch.bfloat16) * 1.6)(Dc, H, D) * Dc ** (-0.5)), 'w_o': _w((lambda *s: torch.randn(*s, dtype=torch.bfloat16) * 1.6)(H, D, M) * (H * D) ** (-0.5))}
    _A_in = _A_setup()

    def _B_setup():
        B, S, D, F = (1, 2048, 640, 1728)
        return {'x': _w((lambda *s: torch.randn(*s, dtype=torch.bfloat16) * 0.05)(B, S, D)), 'w1': _w((lambda *s: torch.randn(*s, dtype=torch.bfloat16) * 0.05)(D, F)), 'b1': _w((lambda *s: torch.randn(*s, dtype=torch.bfloat16) * 0.4)(F)), 'w2': _w((lambda *s: torch.randn(*s, dtype=torch.bfloat16) * 0.05)(F, D)), 'b2': _w((lambda *s: torch.randn(*s, dtype=torch.bfloat16) * 3.2)(D))}
    _B_in = _B_setup()
    return {'A_x': _A_in['x'], 'A_c_kv': _A_in['c_kv'], 'A_w_q': _A_in['w_q'], 'A_w_uk': _A_in['w_uk'], 'A_w_uv': _A_in['w_uv'], 'A_w_o': _A_in['w_o'], 'B_x': _B_in['x'], 'B_w1': _B_in['w1'], 'B_b1': _B_in['b1'], 'B_w2': _B_in['w2'], 'B_b2': _B_in['b2'], 'c': _w((lambda *s: torch.randn(*s, dtype=torch.bfloat16) * 0.1)(1, 640) * 8.0), 'w_mod': _w((lambda *s: torch.randn(*s, dtype=torch.bfloat16) * 0.1)(640, 6 * 640) * 640 ** (-0.5) * 8.0)}

def reference(A_x, A_c_kv, A_w_q, A_w_uk, A_w_uv, A_w_o, B_x, B_w1, B_b1, B_w2, B_b2, c, w_mod):

    def _A_ref(x, c_kv, w_q, w_uk, w_uv, w_o):
        B, Sq, M = (x.shape[0], x.shape[1], x.shape[2])
        Sk = c_kv.shape[1]
        H, D = (w_q.shape[1], w_q.shape[2])
        q = torch.einsum('bqm,mhd->bhqd', x, w_q)
        k = torch.einsum('bkc,chd->bhkd', c_kv, w_uk)
        v = torch.einsum('bkc,chd->bhkd', c_kv, w_uv)
        scores = torch.einsum('bhqd,bhkd->bhqk', q, k) * D ** (-0.5)
        off = Sk - Sq
        qi = torch.arange(Sq)[:, None]
        kj = torch.arange(Sk)[None, :]
        cmask = kj <= qi + off
        scores = torch.where(cmask[None, None], scores, -1000000000.0)
        p = _softmax(scores, axis=-1)
        ctx = torch.einsum('bhqk,bhkd->bhqd', p, v)
        return torch.einsum('bhqd,hdm->bqm', ctx, w_o)

    def _B_ref(x, w1, b1, w2, b2):
        h = torch.einsum('bsd,df->bsf', x, w1) + b1
        zero = torch.zeros_like(h)
        r = torch.where(h > zero, h, zero)
        h = r * r
        out = torch.einsum('bsf,fd->bsd', h, w2) + b2
        return out
    x = A_x
    mod = (_silu(c) @ w_mod).reshape(c.shape[0], 6, 1, -1)
    sa, ca, ga, sb, cb, gb = (mod[:, 0].clone(), mod[:, 1].clone(), mod[:, 2].clone(), mod[:, 3].clone(), mod[:, 4].clone(), mod[:, 5].clone())
    h = _layernorm(x, axis=-1) * (1 + ca) + sa
    x = x + ga * _A_ref(h, A_c_kv, A_w_q, A_w_uk, A_w_uv, A_w_o)
    h = _layernorm(x, axis=-1) * (1 + cb) + sb
    x = x + gb * _B_ref(h, B_w1, B_b1, B_w2, B_b2)
    return x
```

```asm
; @launch grid=(256,1,1) block=(256,1,1) lds=163840
.amdgcn_target "amdgcn-amd-amdhsa--gfx950"
.text
.globl adaLN_cond__compressed_kv_cla__dense_activation_squared_relu__prompt_kernel
.p2align 8
.type adaLN_cond__compressed_kv_cla__dense_activation_squared_relu__prompt_kernel,@function
adaLN_cond__compressed_kv_cla__dense_activation_squared_relu__prompt_kernel:
s_cmp_ge_u32 s2, 256
s_cbranch_scc1 L_fr_end
s_load_dwordx16 s[16:31], s[0:1], 0
s_load_dwordx16 s[32:47], s[0:1], 64
v_and_b32 v2, 63, v0
v_lshlrev_b32 v1, 4, v2
v_lshrrev_b32 v4, 6, v0
s_nop 0
v_readfirstlane_b32 s3, v4
s_and_b32 s6, s2, 7
s_lshl_b32 s4, s6, 2
s_lshr_b32 s7, s2, 3
s_and_b32 s7, s7, 3
s_add_u32 s4, s4, s7
s_lshr_b32 s5, s2, 5
s_xor_b32 s8, s5, s7
s_and_b32 s8, s8, 1
v_lshrrev_b32 v7, 3, v2
v_lshlrev_b32 v4, 10, v7
v_and_b32 v8, 7, v2
v_lshrrev_b32 v6, 4, v2
v_xor_b32 v5, v8, v6
v_lshl_add_u32 v92, v5, 4, v4
v_xor_b32 v93, 64, v92
v_add_u32 v93, 7168, v93
v_add_u32 v94, 14336, v92
v_add_u32 v95, 14336, v93
v_and_b32 v10, 15, v2
v_lshlrev_b32 v4, 1, v6
v_xor_b32 v5, v10, v4
v_lshlrev_b32 v4, 13, v6
v_lshl_add_u32 v88, v5, 4, v4
v_add_u32 v89, 31744, v88
v_xor_b32 v90, 128, v88
v_add_u32 v90, 63488, v90
v_add_u32 v91, 31744, v90
s_lshl_b32 s10, s5, 18
s_lshl_b32 s6, s3, 16
s_add_u32 s10, s10, s6
s_lshl_b32 s6, s8, 7
s_add_u32 s10, s10, s6
s_lshl_b32 s15, s4, 8
s_lshl_b32 s6, s3, 17
s_add_u32 s15, s15, s6
s_lshl_b32 s6, s8, 19
s_add_u32 s11, s15, s6
s_lshl_b32 s12, s3, 14
s_add_u32 s12, s12, 65536
s_lshl_b32 s13, s3, 12
s_getpc_b64 s[84:85]
L_fr_pc:
s_lshr_b32 s6, s2, 3
s_and_b32 s6, s6, 7
s_lshl_b32 s6, s6, 2
s_add_u32 s6, s6, s3
s_lshl_b32 s6, s6, 11
v_lshl_add_u32 v18, v10, 7, s6
v_min_u32 v18, L_fr_codeend-L_fr_pc-4, v18
global_load_dword a255, v18, s[84:85]
s_waitcnt lgkmcnt(0)
s_mov_b32 s48, s18
s_mov_b32 s49, s19
s_mov_b32 s50, 2097152
s_mov_b32 s51, 0x20000
s_mov_b32 s52, s22
s_mov_b32 s53, s23
s_mov_b32 s54, 4194304
s_mov_b32 s55, 0x20000
s_add_u32 m0, s13, 32768
s_xor_b32 s7, s11, 0
buffer_load_dwordx4 v88, s[52:55], s7 offen offset:0  lds
buffer_load_dwordx4 v89, s[52:55], s7 offen offset:1024  lds
buffer_load_dwordx4 v90, s[52:55], s7 offen offset:2048  lds
buffer_load_dwordx4 v91, s[52:55], s7 offen offset:3072  lds
s_add_u32 m0, s12, 0
s_xor_b32 s8, s10, 0
buffer_load_dwordx4 v92, s[48:51], s8 offen offset:0 lds
buffer_load_dwordx4 v93, s[48:51], s8 offen offset:1024 lds
buffer_load_dwordx4 v94, s[48:51], s8 offen offset:2048 lds
buffer_load_dwordx4 v95, s[48:51], s8 offen offset:3072 lds
s_add_u32 m0, s12, 4096
s_xor_b32 s9, s10, 32768
buffer_load_dwordx4 v92, s[48:51], s9 offen offset:0 lds
buffer_load_dwordx4 v93, s[48:51], s9 offen offset:1024 lds
buffer_load_dwordx4 v94, s[48:51], s9 offen offset:2048 lds
buffer_load_dwordx4 v95, s[48:51], s9 offen offset:3072 lds
s_mov_b32 s68, s40
s_mov_b32 s69, s41
s_mov_b32 s70, 4915200
s_mov_b32 s71, 0x20000
s_mov_b32 s56, s38
s_mov_b32 s57, s39
s_mov_b32 s58, 1280
s_mov_b32 s59, 0x20000
s_mov_b32 s38, 0
s_sub_u32 s101, s2, 0
s_and_b32 s101, s101, 255
s_and_b32 s28, s101, 3
s_lshr_b32 s29, s101, 2
s_cmp_lt_u32 s101, 80
s_cselect_b32 s70, s70, 0
s_mul_i32 s6, s28, 320
v_lshlrev_b32 v12, 3, v2
buffer_load_dwordx2 v[16:17], v12, s[56:59], s6 offen
s_lshl_b32 s6, s28, 2
s_add_u32 s6, s6, s3
s_mul_i32 s6, s6, 307200
s_lshl_b32 s7, s29, 7
s_add_u32 s6, s6, s7
v_mul_u32_u24 v13, 7680, v7
v_lshl_add_u32 v13, v8, 4, v13
s_mul_i32 s7, s3, 5120
s_add_u32 s7, s7, 131072
s_mov_b32 s37, s6
s_mov_b32 s42, s7
s_barrier
s_add_u32 m0, s7, 0
s_add_u32 s8, s6, 0
buffer_load_dwordx4 v13, s[68:71], s8 offen nt lds
s_add_u32 m0, s7, 1024
s_add_u32 s8, s6, 61440
buffer_load_dwordx4 v13, s[68:71], s8 offen nt lds
s_add_u32 m0, s7, 2048
s_add_u32 s8, s6, 122880
buffer_load_dwordx4 v13, s[68:71], s8 offen nt lds
s_add_u32 m0, s7, 3072
s_add_u32 s8, s6, 184320
buffer_load_dwordx4 v13, s[68:71], s8 offen nt lds
s_add_u32 m0, s7, 4096
s_add_u32 s8, s6, 245760
buffer_load_dwordx4 v13, s[68:71], s8 offen nt lds
v_lshrrev_b32 v4, 2, v2
v_and_b32 v4, 3, v4
v_and_b32 v5, 1, v6
v_lshl_or_b32 v5, v5, 2, v4
v_lshl_add_u32 v7, v6, 3, v4
v_lshlrev_b32 v8, 8, v7
v_and_b32 v9, 3, v2
v_lshl_add_u32 v8, v9, 3, v8
v_lshl_add_u32 v80, v5, 5, v8
v_xor_b32 v81, 32, v80
v_xor_b32 v82, 64, v80
v_xor_b32 v83, 96, v80
v_xor_b32 v84, 128, v80
v_xor_b32 v85, 160, v80
v_xor_b32 v86, 192, v80
v_xor_b32 v87, 224, v80
v_lshrrev_b32 v11, 1, v10
v_xor_b32 v11, v11, v6
v_lshlrev_b32 v11, 4, v11
v_lshl_add_u32 v11, v10, 7, v11
v_add_u32 v120, s12, v11
v_xor_b32 v11, 64, v11
v_add_u32 v121, s12, v11
s_lshl_b32 s6, s3, 5
s_add_u32 s6, s6, 131072
v_lshlrev_b32 v14, 7, v7
v_lshl_add_u32 v14, v9, 3, v14
v_add_u32 v14, s6, v14
s_lshl_b32 s6, s3, 9
s_add_u32 s6, s6, 151552
v_lshl_add_u32 v15, v6, 4, s6
v_add_u32 v12, s6, v12
s_mov_b32 s60, s46
s_mov_b32 s61, s47
s_mov_b32 s62, 268435456
s_mov_b32 s63, 0x20000
s_mov_b32 s72, s44
s_mov_b32 s73, s45
s_mov_b32 s74, 256
s_mov_b32 s75, 0x20000
s_mov_b32 s64, s16
s_mov_b32 s65, s17
s_mov_b32 s66, 2621440
s_mov_b32 s67, 0x20000
s_waitcnt vmcnt(14)
s_barrier
ds_read_b64_tr_b16 v[96:97], v80 offset:32768
ds_read_b64_tr_b16 v[98:99], v80 offset:33792
ds_read_b64_tr_b16 v[100:101], v80 offset:40960
ds_read_b64_tr_b16 v[102:103], v80 offset:41984
ds_read_b64_tr_b16 v[104:105], v81 offset:32768
ds_read_b64_tr_b16 v[106:107], v81 offset:33792
s_waitcnt vmcnt(6)
ds_read_b128 a[0:3], v120 offset:0
ds_read_b128 a[4:7], v120 offset:2048
ds_read_b128 a[8:11], v120 offset:4096
ds_read_b128 a[12:15], v120 offset:6144
ds_read_b128 a[16:19], v121 offset:0
ds_read_b128 a[20:23], v121 offset:2048
ds_read_b128 a[24:27], v121 offset:4096
ds_read_b128 a[28:31], v121 offset:6144
s_add_u32 m0, s13, 49152
s_xor_b32 s7, s11, 524288
buffer_load_dwordx4 v88, s[52:55], s7 offen offset:0  lds
buffer_load_dwordx4 v89, s[52:55], s7 offen offset:1024  lds
buffer_load_dwordx4 v90, s[52:55], s7 offen offset:2048  lds
buffer_load_dwordx4 v91, s[52:55], s7 offen offset:3072  lds
s_add_u32 m0, s12, 8192
s_xor_b32 s8, s10, 128
buffer_load_dwordx4 v92, s[48:51], s8 offen offset:0 lds
buffer_load_dwordx4 v93, s[48:51], s8 offen offset:1024 lds
buffer_load_dwordx4 v94, s[48:51], s8 offen offset:2048 lds
buffer_load_dwordx4 v95, s[48:51], s8 offen offset:3072 lds
s_add_u32 m0, s12, 12288
s_xor_b32 s9, s10, 32896
buffer_load_dwordx4 v92, s[48:51], s9 offen offset:0 lds
buffer_load_dwordx4 v93, s[48:51], s9 offen offset:1024 lds
buffer_load_dwordx4 v94, s[48:51], s9 offen offset:2048 lds
buffer_load_dwordx4 v95, s[48:51], s9 offen offset:3072 lds
s_waitcnt lgkmcnt(7)
v_mfma_f32_16x16x32_bf16 v[128:131], v[96:99], a[0:3], 0
s_waitcnt lgkmcnt(3)
s_add_u32 m0, s13, 0
ds_read_b64_tr_b16 v[108:109], v81 offset:40960
v_mfma_f32_16x16x32_bf16 v[128:131], v[100:103], a[16:19], v[128:131]
s_xor_b32 s7, s11, 1048576
ds_read_b64_tr_b16 v[110:111], v81 offset:41984
v_mfma_f32_16x16x32_bf16 v[132:135], v[96:99], a[4:7], 0
s_waitcnt vmcnt(17) lgkmcnt(4)
buffer_load_dwordx4 v88, s[52:55], s7 offen offset:0  lds
v_lshlrev_b32 v20, 16, v16
v_mfma_f32_16x16x32_bf16 v[132:135], v[100:103], a[20:23], v[132:135]
v_and_b32 v21, 0xffff0000, v16
v_lshlrev_b32 v22, 16, v17
v_and_b32 v23, 0xffff0000, v17
v_mfma_f32_16x16x32_bf16 v[136:139], v[96:99], a[8:11], 0
s_waitcnt lgkmcnt(3)
ds_read_b64_tr_b16 v[112:113], v82 offset:32768
v_mul_f32 v24, 0xbfb8aa3b, v20
v_mul_f32 v25, 0xbfb8aa3b, v21
v_mfma_f32_16x16x32_bf16 v[136:139], v[100:103], a[24:27], v[136:139]
ds_read_b64_tr_b16 v[114:115], v82 offset:33792
v_mul_f32 v26, 0xbfb8aa3b, v22
v_mul_f32 v27, 0xbfb8aa3b, v23
v_mfma_f32_16x16x32_bf16 v[140:143], v[96:99], a[12:15], 0
s_waitcnt lgkmcnt(4)
s_lshl_b32 s32, s29, 10
s_lshl_b32 s6, s3, 8
buffer_load_dwordx4 v89, s[52:55], s7 offen offset:1024  lds
v_mfma_f32_16x16x32_bf16 v[140:143], v[100:103], a[28:31], v[140:143]
s_waitcnt lgkmcnt(2)
s_add_u32 s32, s32, s6
s_lshl_b32 s6, s28, 2
s_add_u32 s32, s32, s6
v_exp_f32 v24, v24
v_mfma_f32_16x16x32_bf16 v[156:159], v[104:107], a[12:15], 0
s_add_u32 s32, s32, 262144
s_mov_b32 s36, s32
ds_read_b64_tr_b16 v[116:117], v82 offset:40960
v_exp_f32 v25, v25
v_mfma_f32_16x16x32_bf16 v[156:159], v[108:111], a[28:31], v[156:159]
s_cmp_lt_u32 s101, 80
s_cselect_b32 s32, s32, 268435456
ds_read_b64_tr_b16 v[118:119], v82 offset:41984
v_exp_f32 v26, v26
v_mfma_f32_16x16x32_bf16 v[152:155], v[104:107], a[8:11], 0
v_exp_f32 v27, v27
v_add_f32 v24, 1.0, v24
v_mfma_f32_16x16x32_bf16 v[152:155], v[108:111], a[24:27], v[152:155]
buffer_load_dwordx4 v90, s[52:55], s7 offen offset:2048  lds
v_add_f32 v25, 1.0, v25
v_mfma_f32_16x16x32_bf16 v[148:151], v[104:107], a[4:7], 0
ds_read_b64_tr_b16 v[96:97], v83 offset:32768
v_add_f32 v26, 1.0, v26
v_add_f32 v27, 1.0, v27
v_mfma_f32_16x16x32_bf16 v[148:151], v[108:111], a[20:23], v[148:151]
ds_read_b64_tr_b16 v[98:99], v83 offset:33792
v_rcp_f32 v24, v24
v_mfma_f32_16x16x32_bf16 v[144:147], v[104:107], a[0:3], 0
s_or_b32 s6, s101, s3
s_cselect_b32 s28, 268435456, 0
v_rcp_f32 v25, v25
v_mfma_f32_16x16x32_bf16 v[144:147], v[108:111], a[16:19], v[144:147]
s_waitcnt lgkmcnt(2)
s_add_u32 s28, s28, 393216
buffer_load_dwordx4 v91, s[52:55], s7 offen offset:3072  lds
v_mfma_f32_16x16x32_bf16 v[160:163], v[112:115], a[0:3], 0
ds_read_b64_tr_b16 v[100:101], v83 offset:40960
v_rcp_f32 v26, v26
v_mfma_f32_16x16x32_bf16 v[160:163], v[116:119], a[16:19], v[160:163]
s_add_u32 m0, s12, 0
ds_read_b64_tr_b16 v[102:103], v83 offset:41984
v_rcp_f32 v27, v27
v_mfma_f32_16x16x32_bf16 v[164:167], v[112:115], a[4:7], 0
s_xor_b32 s8, s10, 256
v_mul_f32 v20, v20, v24
v_mul_f32 v21, v21, v25
v_mul_f32 v22, v22, v26
v_mfma_f32_16x16x32_bf16 v[164:167], v[116:119], a[20:23], v[164:167]
v_mul_f32 v23, v23, v27
v_cvt_pk_bf16_f32 v20, v20, v21
v_cvt_pk_bf16_f32 v21, v22, v23
v_mfma_f32_16x16x32_bf16 v[168:171], v[112:115], a[8:11], 0
ds_read_b64_tr_b16 v[104:105], v84 offset:32768
ds_write_b64 v12, v[20:21]
v_mfma_f32_16x16x32_bf16 v[168:171], v[116:119], a[24:27], v[168:171]
ds_read_b64_tr_b16 v[106:107], v84 offset:33792
v_mfma_f32_16x16x32_bf16 v[172:175], v[112:115], a[12:15], 0
buffer_load_dwordx4 v92, s[48:51], s8 offen offset:0 lds
v_mfma_f32_16x16x32_bf16 v[172:175], v[116:119], a[28:31], v[172:175]
s_waitcnt lgkmcnt(3)
v_mfma_f32_16x16x32_bf16 v[188:191], v[96:99], a[12:15], 0
ds_read_b64_tr_b16 v[108:109], v84 offset:40960
v_mfma_f32_16x16x32_bf16 v[188:191], v[100:103], a[28:31], v[188:191]
ds_read_b64_tr_b16 v[110:111], v84 offset:41984
v_mfma_f32_16x16x32_bf16 v[184:187], v[96:99], a[8:11], 0
s_waitcnt vmcnt(17)
buffer_load_dwordx4 v93, s[48:51], s8 offen offset:1024 lds
v_mfma_f32_16x16x32_bf16 v[184:187], v[100:103], a[24:27], v[184:187]
v_mfma_f32_16x16x32_bf16 v[180:183], v[96:99], a[4:7], 0
s_barrier
ds_read_b64_tr_b16 v[112:113], v85 offset:32768
v_mfma_f32_16x16x32_bf16 v[180:183], v[100:103], a[20:23], v[180:183]
ds_read_b64_tr_b16 v[114:115], v85 offset:33792
ds_read_b128 v[24:27], v15 offset:0
v_mfma_f32_16x16x32_bf16 v[176:179], v[96:99], a[0:3], 0
buffer_load_dwordx4 v94, s[48:51], s8 offen offset:2048 lds
v_mfma_f32_16x16x32_bf16 v[176:179], v[100:103], a[16:19], v[176:179]
s_waitcnt lgkmcnt(3)
ds_read_b64_tr_b16 v[28:29], v14 offset:0
ds_read_b64_tr_b16 v[30:31], v14 offset:512
v_mfma_f32_16x16x32_bf16 v[192:195], v[104:107], a[0:3], 0
ds_read_b64_tr_b16 v[116:117], v85 offset:40960
ds_read_b128 v[32:35], v15 offset:64
v_mfma_f32_16x16x32_bf16 v[192:195], v[108:111], a[16:19], v[192:195]
ds_read_b64_tr_b16 v[118:119], v85 offset:41984
ds_read_b64_tr_b16 v[36:37], v14 offset:4096
v_mfma_f32_16x16x32_bf16 v[196:199], v[104:107], a[4:7], 0
buffer_load_dwordx4 v95, s[48:51], s8 offen offset:3072 lds
v_mfma_f32_16x16x32_bf16 v[196:199], v[108:111], a[20:23], v[196:199]
s_add_u32 m0, s12, 4096
ds_read_b64_tr_b16 v[38:39], v14 offset:4608
ds_read_b128 v[40:43], v15 offset:128
v_mfma_f32_16x16x32_bf16 v[200:203], v[104:107], a[8:11], 0
s_xor_b32 s9, s10, 33024
ds_read_b64_tr_b16 v[96:97], v86 offset:32768
ds_read_b64_tr_b16 v[44:45], v14 offset:8192
v_mfma_f32_16x16x32_bf16 v[200:203], v[108:111], a[24:27], v[200:203]
ds_read_b64_tr_b16 v[98:99], v86 offset:33792
ds_read_b64_tr_b16 v[46:47], v14 offset:8704
v_mfma_f32_16x16x32_bf16 v[204:207], v[104:107], a[12:15], 0
buffer_load_dwordx4 v92, s[48:51], s9 offen offset:0 lds
v_mfma_f32_16x16x32_bf16 v[204:207], v[108:111], a[28:31], v[204:207]
s_waitcnt lgkmcnt(7)
ds_read_b128 v[48:51], v15 offset:192
ds_read_b64_tr_b16 v[52:53], v14 offset:12288
v_mfma_f32_16x16x32_bf16 v[220:223], v[112:115], a[12:15], 0
ds_read_b64_tr_b16 v[100:101], v86 offset:40960
ds_read_b64_tr_b16 v[54:55], v14 offset:12800
v_mfma_f32_16x16x32_bf16 v[220:223], v[116:119], a[28:31], v[220:223]
ds_read_b64_tr_b16 v[102:103], v86 offset:41984
ds_read_b128 v[56:59], v15 offset:256
v_mfma_f32_16x16x32_bf16 v[216:219], v[112:115], a[8:11], 0
buffer_load_dwordx4 v93, s[48:51], s9 offen offset:1024 lds
v_mfma_f32_16x16x32_bf16 v[216:219], v[116:119], a[24:27], v[216:219]
ds_read_b64_tr_b16 v[60:61], v14 offset:16384
ds_read_b64_tr_b16 v[62:63], v14 offset:16896
v_mfma_f32_16x16x32_bf16 v[212:215], v[112:115], a[4:7], 0
ds_read_b64_tr_b16 v[104:105], v87 offset:32768
v_mfma_f32_16x16x32_bf16 v[212:215], v[116:119], a[20:23], v[212:215]
ds_read_b64_tr_b16 v[106:107], v87 offset:33792
v_mfma_f32_16x16x32_bf16 v[208:211], v[112:115], a[0:3], 0
v_mfma_f32_16x16x32_bf16 v[208:211], v[116:119], a[16:19], v[208:211]
s_waitcnt lgkmcnt(5)
buffer_load_dwordx4 v94, s[48:51], s9 offen offset:2048 lds
v_mfma_f32_16x16x32_bf16 v[224:227], v[96:99], a[0:3], 0
ds_read_b64_tr_b16 v[108:109], v87 offset:40960
v_mfma_f32_16x16x32_bf16 v[16:19], v[24:27], v[28:31], 0
v_mfma_f32_16x16x32_bf16 v[224:227], v[100:103], a[16:19], v[224:227]
ds_read_b64_tr_b16 v[110:111], v87 offset:41984
v_mfma_f32_16x16x32_bf16 v[16:19], v[32:35], v[36:39], v[16:19]
v_mfma_f32_16x16x32_bf16 v[228:231], v[96:99], a[4:7], 0
s_waitcnt vmcnt(19)
v_mfma_f32_16x16x32_bf16 v[16:19], v[40:43], v[44:47], v[16:19]
v_mfma_f32_16x16x32_bf16 v[228:231], v[100:103], a[20:23], v[228:231]
s_barrier
buffer_load_dwordx4 v95, s[48:51], s9 offen offset:3072 lds
v_mfma_f32_16x16x32_bf16 v[16:19], v[48:51], v[52:55], v[16:19]
v_mfma_f32_16x16x32_bf16 v[232:235], v[96:99], a[8:11], 0
s_waitcnt vmcnt(12) lgkmcnt(4)
ds_read_b64_tr_b16 v[112:113], v80 offset:49152
ds_read_b128 a[32:35], v120 offset:8192
v_mfma_f32_16x16x32_bf16 v[16:19], v[56:59], v[60:63], v[16:19]
v_mfma_f32_16x16x32_bf16 v[232:235], v[100:103], a[24:27], v[232:235]
ds_read_b64_tr_b16 v[114:115], v80 offset:50176
ds_read_b128 a[36:39], v120 offset:10240
v_mfma_f32_16x16x32_bf16 v[236:239], v[96:99], a[12:15], 0
ds_read_b128 a[40:43], v120 offset:12288
ds_read_b128 a[44:47], v120 offset:14336
v_mfma_f32_16x16x32_bf16 v[236:239], v[100:103], a[28:31], v[236:239]
s_waitcnt lgkmcnt(6)
ds_read_b128 a[48:51], v121 offset:8192
ds_read_b128 a[52:55], v121 offset:10240
v_mfma_f32_16x16x32_bf16 v[252:255], v[104:107], a[12:15], 0
ds_read_b64_tr_b16 v[116:117], v80 offset:57344
ds_read_b128 a[56:59], v121 offset:12288
v_mfma_f32_16x16x32_bf16 v[252:255], v[108:111], a[28:31], v[252:255]
ds_read_b64_tr_b16 v[118:119], v80 offset:58368
ds_read_b128 a[60:63], v121 offset:14336
v_mfma_f32_16x16x32_bf16 v[248:251], v[104:107], a[8:11], 0
v_mfma_f32_16x16x32_bf16 v[248:251], v[108:111], a[24:27], v[248:251]
v_mfma_f32_16x16x32_bf16 v[244:247], v[104:107], a[4:7], 0
ds_read_b64_tr_b16 v[96:97], v81 offset:49152
v_mfma_f32_16x16x32_bf16 v[244:247], v[108:111], a[20:23], v[244:247]
ds_read_b64_tr_b16 v[98:99], v81 offset:50176
v_mfma_f32_16x16x32_bf16 v[240:243], v[104:107], a[0:3], 0
v_lshl_add_u32 v20, v6, 28, v1
v_lshlrev_b32 v21, 7, v2
v_mfma_f32_16x16x32_bf16 v[240:243], v[108:111], a[16:19], v[240:243]
s_waitcnt lgkmcnt(3)
v_mov_b32 v22, 0
v_mov_b32 v23, 0
v_mfma_f32_16x16x32_bf16 v[128:131], v[112:115], a[32:35], v[128:131]
s_add_u32 m0, s13, 16384
ds_read_b64_tr_b16 v[100:101], v81 offset:57344
v_mfma_f32_16x16x32_bf16 v[128:131], v[116:119], a[48:51], v[128:131]
s_xor_b32 s7, s11, 1572864
ds_read_b64_tr_b16 v[102:103], v81 offset:58368
v_mfma_f32_16x16x32_bf16 v[132:135], v[116:119], a[52:55], v[132:135]
s_mul_i32 s43, s2, 10240
buffer_load_dwordx4 v88, s[52:55], s7 offen offset:0  lds
v_mfma_f32_16x16x32_bf16 v[132:135], v[112:115], a[36:39], v[132:135]
s_mul_i32 s44, s3, 320
buffer_store_dword v16, v20, s[60:63], s32 offen sc1
v_mfma_f32_16x16x32_bf16 v[136:139], v[112:115], a[40:43], v[136:139]
s_add_u32 s43, s43, s44
ds_read_b64_tr_b16 v[104:105], v82 offset:49152
v_add_u32 v68, 0, v2
v_mfma_f32_16x16x32_bf16 v[136:139], v[116:119], a[56:59], v[136:139]
s_waitcnt lgkmcnt(5)
ds_read_b64_tr_b16 v[106:107], v82 offset:50176
v_mul_u32_u24 v69, 3277, v68
v_mfma_f32_16x16x32_bf16 v[140:143], v[116:119], a[60:63], v[140:143]
buffer_load_dwordx4 v89, s[52:55], s7 offen offset:1024  lds
v_mfma_f32_16x16x32_bf16 v[140:143], v[112:115], a[44:47], v[140:143]
s_waitcnt lgkmcnt(2)
buffer_store_dwordx2 v[22:23], v21, s[60:63], s28 offen sc1
v_mfma_f32_16x16x32_bf16 v[156:159], v[96:99], a[44:47], v[156:159]
ds_read_b64_tr_b16 v[108:109], v82 offset:57344
v_add_u32 v23, 8192, v21
v_mfma_f32_16x16x32_bf16 v[156:159], v[100:103], a[60:63], v[156:159]
ds_read_b64_tr_b16 v[110:111], v82 offset:58368
v_lshrrev_b32 v69, 16, v69
v_mul_u32_u24 v69, 960, v69
v_mfma_f32_16x16x32_bf16 v[152:155], v[100:103], a[56:59], v[152:155]
buffer_load_dwordx4 v90, s[52:55], s7 offen offset:2048  lds
v_lshl_add_u32 v122, v2, 4, v69
v_mfma_f32_16x16x32_bf16 v[152:155], v[96:99], a[40:43], v[152:155]
buffer_store_dword v22, v23, s[60:63], s28 offen sc1
v_add_u32 v68, 64, v2
v_mfma_f32_16x16x32_bf16 v[148:151], v[96:99], a[36:39], v[148:151]
ds_read_b64_tr_b16 v[112:113], v83 offset:49152
v_add_u32 v21, 16384, v21
v_mul_u32_u24 v69, 3277, v68
v_mfma_f32_16x16x32_bf16 v[148:151], v[100:103], a[52:55], v[148:151]
ds_read_b64_tr_b16 v[114:115], v83 offset:50176
v_mov_b32 v64, 0
v_mfma_f32_16x16x32_bf16 v[144:147], v[100:103], a[48:51], v[144:147]
buffer_load_dwordx4 v91, s[52:55], s7 offen offset:3072  lds
v_mfma_f32_16x16x32_bf16 v[144:147], v[96:99], a[32:35], v[144:147]
s_waitcnt lgkmcnt(2)
v_mov_b32 v65, 0
v_mov_b32 v66, 0
v_mfma_f32_16x16x32_bf16 v[160:163], v[104:107], a[32:35], v[160:163]
ds_read_b64_tr_b16 v[116:117], v83 offset:57344
v_mov_b32 v67, 0
v_mfma_f32_16x16x32_bf16 v[160:163], v[108:111], a[48:51], v[160:163]
s_add_u32 m0, s12, 8192
ds_read_b64_tr_b16 v[118:119], v83 offset:58368
v_lshrrev_b32 v69, 16, v69
v_mfma_f32_16x16x32_bf16 v[164:167], v[108:111], a[52:55], v[164:167]
s_xor_b32 s8, s10, 384
buffer_store_dwordx4 v[64:67], v21, s[60:63], s28 offen sc1
v_mfma_f32_16x16x32_bf16 v[164:167], v[104:107], a[36:39], v[164:167]
buffer_load_dwordx4 v92, s[48:51], s8 offen offset:0 lds
v_mfma_f32_16x16x32_bf16 v[168:171], v[104:107], a[40:43], v[168:171]
ds_read_b64_tr_b16 v[96:97], v84 offset:49152
v_add_u32 v23, 8192, v21
v_mfma_f32_16x16x32_bf16 v[168:171], v[108:111], a[56:59], v[168:171]
ds_read_b64_tr_b16 v[98:99], v84 offset:50176
v_mul_u32_u24 v69, 960, v69
v_lshl_add_u32 v123, v2, 4, v69
v_mfma_f32_16x16x32_bf16 v[172:175], v[108:111], a[60:63], v[172:175]
buffer_load_dwordx4 v93, s[48:51], s8 offen offset:1024 lds
v_add_u32 v68, 128, v2
v_mfma_f32_16x16x32_bf16 v[172:175], v[104:107], a[44:47], v[172:175]
s_waitcnt lgkmcnt(2)
buffer_store_dwordx4 v[64:67], v23, s[60:63], s28 offen sc1
v_mfma_f32_16x16x32_bf16 v[188:191], v[112:115], a[44:47], v[188:191]
ds_read_b64_tr_b16 v[100:101], v84 offset:57344
v_lshlrev_b32 v126, 12, v2
v_mfma_f32_16x16x32_bf16 v[188:191], v[116:119], a[60:63], v[188:191]
ds_read_b64_tr_b16 v[102:103], v84 offset:58368
v_mov_b32 v127, 1
v_mfma_f32_16x16x32_bf16 v[184:187], v[116:119], a[56:59], v[184:187]
buffer_load_dwordx4 v94, s[48:51], s8 offen offset:2048 lds
v_mfma_f32_16x16x32_bf16 v[184:187], v[112:115], a[40:43], v[184:187]
s_cmp_eq_u32 s3, 0
s_cselect_b32 s6, 80, 0
v_mul_u32_u24 v69, 3277, v68
v_mfma_f32_16x16x32_bf16 v[180:183], v[112:115], a[36:39], v[180:183]
s_cmp_lt_u32 s101, s6
s_cselect_b32 s29, 0, 4096
ds_read_b64_tr_b16 v[104:105], v85 offset:49152
v_mfma_f32_16x16x32_bf16 v[180:183], v[116:119], a[52:55], v[180:183]
ds_read_b64_tr_b16 v[106:107], v85 offset:50176
v_lshrrev_b32 v69, 16, v69
v_mfma_f32_16x16x32_bf16 v[176:179], v[116:119], a[48:51], v[176:179]
s_mov_b32 s56, s24
buffer_load_dwordx4 v95, s[48:51], s8 offen offset:3072 lds
v_mfma_f32_16x16x32_bf16 v[176:179], v[112:115], a[32:35], v[176:179]
s_waitcnt lgkmcnt(2)
v_mul_u32_u24 v69, 960, v69
v_lshl_add_u32 v124, v2, 4, v69
v_mfma_f32_16x16x32_bf16 v[192:195], v[96:99], a[32:35], v[192:195]
s_add_u32 m0, s12, 12288
ds_read_b64_tr_b16 v[108:109], v85 offset:57344
v_lshrrev_b32 v68, 5, v2
v_mfma_f32_16x16x32_bf16 v[192:195], v[100:103], a[48:51], v[192:195]
s_xor_b32 s9, s10, 33152
ds_read_b64_tr_b16 v[110:111], v85 offset:58368
v_lshl_add_u32 v124, v68, 28, v124
v_mfma_f32_16x16x32_bf16 v[196:199], v[100:103], a[52:55], v[196:199]
s_mov_b32 s57, s25
buffer_load_dwordx4 v92, s[48:51], s9 offen offset:0 lds
v_mfma_f32_16x16x32_bf16 v[196:199], v[96:99], a[36:39], v[196:199]
s_mov_b32 s58, 4194304
v_mfma_f32_16x16x32_bf16 v[200:203], v[96:99], a[40:43], v[200:203]
s_mov_b32 s59, 0x20000
ds_read_b64_tr_b16 v[112:113], v86 offset:49152
v_mfma_f32_16x16x32_bf16 v[200:203], v[100:103], a[56:59], v[200:203]
ds_read_b64_tr_b16 v[114:115], v86 offset:50176
v_mfma_f32_16x16x32_bf16 v[204:207], v[100:103], a[60:63], v[204:207]
buffer_load_dwordx4 v93, s[48:51], s9 offen offset:1024 lds
v_mfma_f32_16x16x32_bf16 v[204:207], v[96:99], a[44:47], v[204:207]
s_waitcnt lgkmcnt(2)
v_mfma_f32_16x16x32_bf16 v[220:223], v[104:107], a[44:47], v[220:223]
ds_read_b64_tr_b16 v[116:117], v86 offset:57344
v_and_b32 v20, 7, v2
v_mfma_f32_16x16x32_bf16 v[220:223], v[108:111], a[60:63], v[220:223]
ds_read_b64_tr_b16 v[118:119], v86 offset:58368
v_lshrrev_b32 v21, 3, v2
v_mfma_f32_16x16x32_bf16 v[216:219], v[108:111], a[56:59], v[216:219]
buffer_load_dwordx4 v94, s[48:51], s9 offen offset:2048 lds
v_mfma_f32_16x16x32_bf16 v[216:219], v[104:107], a[40:43], v[216:219]
v_mul_u32_u24 v22, 320, v20
v_lshl_add_u32 v22, v21, 4, v22
v_mfma_f32_16x16x32_bf16 v[212:215], v[104:107], a[36:39], v[212:215]
ds_read_b64_tr_b16 v[96:97], v87 offset:49152
v_add_u32 v22, s42, v22
v_mfma_f32_16x16x32_bf16 v[212:215], v[108:111], a[52:55], v[212:215]
ds_read_b64_tr_b16 v[98:99], v87 offset:50176
v_cmp_gt_u32 s[84:85], 32, v2
v_mfma_f32_16x16x32_bf16 v[208:211], v[108:111], a[48:51], v[208:211]
s_add_u32 s44, s42, 2304
buffer_load_dwordx4 v95, s[48:51], s9 offen offset:3072 lds
v_mfma_f32_16x16x32_bf16 v[208:211], v[104:107], a[32:35], v[208:211]
s_waitcnt lgkmcnt(2)
v_mov_b32 v23, s44
v_cndmask_b32 v23, v23, v22, s[84:85]
v_mfma_f32_16x16x32_bf16 v[224:227], v[112:115], a[32:35], v[224:227]
ds_read_b64_tr_b16 v[100:101], v87 offset:57344
v_mfma_f32_16x16x32_bf16 v[224:227], v[116:119], a[48:51], v[224:227]
ds_read_b64_tr_b16 v[102:103], v87 offset:58368
v_mfma_f32_16x16x32_bf16 v[228:231], v[116:119], a[52:55], v[228:231]
s_waitcnt vmcnt(6)
v_mfma_f32_16x16x32_bf16 v[228:231], v[112:115], a[36:39], v[228:231]
s_barrier
v_mfma_f32_16x16x32_bf16 v[232:235], v[112:115], a[40:43], v[232:235]
s_mov_b32 m0, s42
ds_read_b64_tr_b16 v[104:105], v80 offset:0
ds_read_b128 a[64:67], v120 offset:0
buffer_load_dwordx4 v122, s[64:67], s43 offen offset:0 lds
v_mfma_f32_16x16x32_bf16 v[232:235], v[116:119], a[56:59], v[232:235]
ds_read_b64_tr_b16 v[106:107], v80 offset:1024
ds_read_b128 a[68:71], v120 offset:2048
buffer_load_dwordx4 v123, s[64:67], s43 offen offset:1024 lds
v_mfma_f32_16x16x32_bf16 v[236:239], v[116:119], a[60:63], v[236:239]
ds_read_b128 a[72:75], v120 offset:4096
ds_read_b128 a[76:79], v120 offset:6144
buffer_load_dwordx4 v124, s[64:67], s43 offen offset:2048 lds
v_mfma_f32_16x16x32_bf16 v[236:239], v[112:115], a[44:47], v[236:239]
s_waitcnt lgkmcnt(6)
ds_read_b128 a[80:83], v121 offset:0
ds_read_b128 a[84:87], v121 offset:2048
v_mfma_f32_16x16x32_bf16 v[252:255], v[96:99], a[44:47], v[252:255]
ds_read_b64_tr_b16 v[108:109], v80 offset:8192
ds_read_b128 a[88:91], v121 offset:4096
v_mfma_f32_16x16x32_bf16 v[252:255], v[100:103], a[60:63], v[252:255]
ds_read_b64_tr_b16 v[110:111], v80 offset:9216
ds_read_b128 a[92:95], v121 offset:6144
v_mfma_f32_16x16x32_bf16 v[248:251], v[100:103], a[56:59], v[248:251]
buffer_atomic_add v127, v126, s[72:75], s29 offen sc1
v_mfma_f32_16x16x32_bf16 v[248:251], v[96:99], a[40:43], v[248:251]
v_mfma_f32_16x16x32_bf16 v[244:247], v[96:99], a[36:39], v[244:247]
ds_read_b64_tr_b16 v[112:113], v81 offset:0
v_mfma_f32_16x16x32_bf16 v[244:247], v[100:103], a[52:55], v[244:247]
ds_read_b64_tr_b16 v[114:115], v81 offset:1024
v_mfma_f32_16x16x32_bf16 v[240:243], v[100:103], a[48:51], v[240:243]
v_mfma_f32_16x16x32_bf16 v[240:243], v[96:99], a[32:35], v[240:243]
s_waitcnt lgkmcnt(3)
v_mfma_f32_16x16x32_bf16 v[128:131], v[104:107], a[64:67], v[128:131]
s_add_u32 m0, s13, 32768
ds_read_b64_tr_b16 v[116:117], v81 offset:8192
v_mfma_f32_16x16x32_bf16 v[128:131], v[108:111], a[80:83], v[128:131]
s_xor_b32 s7, s11, 2097152
ds_read_b64_tr_b16 v[118:119], v81 offset:9216
v_mfma_f32_16x16x32_bf16 v[132:135], v[108:111], a[84:87], v[132:135]
buffer_load_dwordx4 v88, s[52:55], s7 offen offset:0  lds
v_mfma_f32_16x16x32_bf16 v[132:135], v[104:107], a[68:71], v[132:135]
v_mfma_f32_16x16x32_bf16 v[136:139], v[104:107], a[72:75], v[136:139]
ds_read_b64_tr_b16 v[96:97], v82 offset:0
v_mfma_f32_16x16x32_bf16 v[136:139], v[108:111], a[88:91], v[136:139]
s_waitcnt lgkmcnt(5)
ds_read_b64_tr_b16 v[98:99], v82 offset:1024
v_mfma_f32_16x16x32_bf16 v[140:143], v[108:111], a[92:95], v[140:143]
buffer_load_dwordx4 v89, s[52:55], s7 offen offset:1024  lds
v_mfma_f32_16x16x32_bf16 v[140:143], v[104:107], a[76:79], v[140:143]
s_waitcnt lgkmcnt(2)
v_mfma_f32_16x16x32_bf16 v[156:159], v[112:115], a[76:79], v[156:159]
ds_read_b64_tr_b16 v[100:101], v82 offset:8192
v_mfma_f32_16x16x32_bf16 v[156:159], v[116:119], a[92:95], v[156:159]
ds_read_b64_tr_b16 v[102:103], v82 offset:9216
v_mfma_f32_16x16x32_bf16 v[152:155], v[116:119], a[88:91], v[152:155]
s_mul_i32 s6, s3, 640
v_mfma_f32_16x16x32_bf16 v[152:155], v[112:115], a[72:75], v[152:155]
s_add_u32 s6, s6, 153600
buffer_load_dwordx4 v90, s[52:55], s7 offen offset:2048  lds
v_mfma_f32_16x16x32_bf16 v[148:151], v[112:115], a[68:71], v[148:151]
ds_read_b64_tr_b16 v[104:105], v83 offset:0
v_lshl_add_u32 v127, v21, 5, s6
v_mfma_f32_16x16x32_bf16 v[148:151], v[116:119], a[84:87], v[148:151]
ds_read_b64_tr_b16 v[106:107], v83 offset:1024
v_lshrrev_b32 v126, 5, v2
v_mfma_f32_16x16x32_bf16 v[144:147], v[116:119], a[80:83], v[144:147]
v_lshlrev_b32 v126, 11, v126
v_and_b32 v125, 3, v21
v_mfma_f32_16x16x32_bf16 v[144:147], v[112:115], a[64:67], v[144:147]
s_waitcnt lgkmcnt(2)
buffer_load_dwordx4 v91, s[52:55], s7 offen offset:3072  lds
v_mfma_f32_16x16x32_bf16 v[160:163], v[96:99], a[64:67], v[160:163]
ds_read_b64_tr_b16 v[108:109], v83 offset:8192
v_lshl_add_u32 v126, v125, 8, v126
v_mfma_f32_16x16x32_bf16 v[160:163], v[100:103], a[80:83], v[160:163]
s_add_u32 m0, s12, 0
ds_read_b64_tr_b16 v[110:111], v83 offset:9216
v_lshl_add_u32 v126, v20, 4, v126
v_mfma_f32_16x16x32_bf16 v[164:167], v[100:103], a[84:87], v[164:167]
s_xor_b32 s8, s10, 512
v_lshrrev_b32 v125, 5, v2
v_lshl_add_u32 v125, v125, 28, v126
v_mfma_f32_16x16x32_bf16 v[164:167], v[96:99], a[68:71], v[164:167]
s_lshr_b32 s33, s2, 2
v_mfma_f32_16x16x32_bf16 v[168:171], v[96:99], a[72:75], v[168:171]
s_mul_i32 s33, s33, 40960
ds_read_b64_tr_b16 v[112:113], v84 offset:0
v_mfma_f32_16x16x32_bf16 v[168:171], v[100:103], a[88:91], v[168:171]
s_lshl_b32 s6, s2, 9
ds_read_b64_tr_b16 v[114:115], v84 offset:1024
v_mfma_f32_16x16x32_bf16 v[172:175], v[100:103], a[92:95], v[172:175]
s_and_b32 s6, s6, 1024
buffer_load_dwordx4 v92, s[48:51], s8 offen offset:0 lds
v_mfma_f32_16x16x32_bf16 v[172:175], v[96:99], a[76:79], v[172:175]
s_waitcnt lgkmcnt(2)
v_mfma_f32_16x16x32_bf16 v[188:191], v[104:107], a[76:79], v[188:191]
s_add_u32 s33, s33, s6
ds_read_b64_tr_b16 v[116:117], v84 offset:8192
v_mfma_f32_16x16x32_bf16 v[188:191], v[108:111], a[92:95], v[188:191]
s_lshl_b32 s6, s2, 7
ds_read_b64_tr_b16 v[118:119], v84 offset:9216
v_mfma_f32_16x16x32_bf16 v[184:187], v[108:111], a[88:91], v[184:187]
s_and_b32 s6, s6, 128
buffer_load_dwordx4 v93, s[48:51], s8 offen offset:1024 lds
v_mfma_f32_16x16x32_bf16 v[184:187], v[104:107], a[72:75], v[184:187]
s_add_u32 s33, s33, s6
v_mfma_f32_16x16x32_bf16 v[180:183], v[104:107], a[68:71], v[180:183]
s_mul_i32 s6, s3, 10240
ds_read_b64_tr_b16 v[96:97], v85 offset:0
v_mfma_f32_16x16x32_bf16 v[180:183], v[108:111], a[84:87], v[180:183]
s_add_u32 s33, s33, s6
ds_read_b64_tr_b16 v[98:99], v85 offset:1024
v_mfma_f32_16x16x32_bf16 v[176:179], v[108:111], a[80:83], v[176:179]
buffer_load_dwordx4 v94, s[48:51], s8 offen offset:2048 lds
v_mfma_f32_16x16x32_bf16 v[176:179], v[104:107], a[64:67], v[176:179]
s_waitcnt lgkmcnt(2)
v_mfma_f32_16x16x32_bf16 v[192:195], v[112:115], a[64:67], v[192:195]
ds_read_b64_tr_b16 v[100:101], v85 offset:8192
v_mfma_f32_16x16x32_bf16 v[192:195], v[116:119], a[80:83], v[192:195]
ds_read_b64_tr_b16 v[102:103], v85 offset:9216
v_mfma_f32_16x16x32_bf16 v[196:199], v[116:119], a[84:87], v[196:199]
buffer_load_dwordx4 v95, s[48:51], s8 offen offset:3072 lds
v_mfma_f32_16x16x32_bf16 v[196:199], v[112:115], a[68:71], v[196:199]
s_add_u32 m0, s12, 4096
v_mfma_f32_16x16x32_bf16 v[200:203], v[112:115], a[72:75], v[200:203]
s_xor_b32 s9, s10, 33280
ds_read_b64_tr_b16 v[104:105], v86 offset:0
v_mfma_f32_16x16x32_bf16 v[200:203], v[116:119], a[88:91], v[200:203]
ds_read_b64_tr_b16 v[106:107], v86 offset:1024
v_mfma_f32_16x16x32_bf16 v[204:207], v[116:119], a[92:95], v[204:207]
buffer_load_dwordx4 v92, s[48:51], s9 offen offset:0 lds
v_mfma_f32_16x16x32_bf16 v[204:207], v[112:115], a[76:79], v[204:207]
s_waitcnt lgkmcnt(2)
v_mfma_f32_16x16x32_bf16 v[220:223], v[96:99], a[76:79], v[220:223]
ds_read_b64_tr_b16 v[108:109], v86 offset:8192
v_mfma_f32_16x16x32_bf16 v[220:223], v[100:103], a[92:95], v[220:223]
ds_read_b64_tr_b16 v[110:111], v86 offset:9216
v_mfma_f32_16x16x32_bf16 v[216:219], v[100:103], a[88:91], v[216:219]
buffer_load_dwordx4 v93, s[48:51], s9 offen offset:1024 lds
v_mfma_f32_16x16x32_bf16 v[216:219], v[96:99], a[72:75], v[216:219]
v_mfma_f32_16x16x32_bf16 v[212:215], v[96:99], a[68:71], v[212:215]
ds_read_b64_tr_b16 v[112:113], v87 offset:0
v_mfma_f32_16x16x32_bf16 v[212:215], v[100:103], a[84:87], v[212:215]
ds_read_b64_tr_b16 v[114:115], v87 offset:1024
v_mfma_f32_16x16x32_bf16 v[208:211], v[100:103], a[80:83], v[208:211]
v_mfma_f32_16x16x32_bf16 v[208:211], v[96:99], a[64:67], v[208:211]
s_waitcnt lgkmcnt(2)
buffer_load_dwordx4 v94, s[48:51], s9 offen offset:2048 lds
v_mfma_f32_16x16x32_bf16 v[224:227], v[104:107], a[64:67], v[224:227]
ds_read_b64_tr_b16 v[116:117], v87 offset:8192
v_mfma_f32_16x16x32_bf16 v[224:227], v[108:111], a[80:83], v[224:227]
ds_read_b64_tr_b16 v[118:119], v87 offset:9216
v_mfma_f32_16x16x32_bf16 v[228:231], v[108:111], a[84:87], v[228:231]
v_mfma_f32_16x16x32_bf16 v[228:231], v[104:107], a[68:71], v[228:231]
s_barrier
buffer_load_dwordx4 v95, s[48:51], s9 offen offset:3072 lds
v_mfma_f32_16x16x32_bf16 v[232:235], v[104:107], a[72:75], v[232:235]
s_waitcnt vmcnt(16)
ds_read_b64_tr_b16 v[96:97], v80 offset:16384
ds_read_b128 a[96:99], v120 offset:8192
v_mfma_f32_16x16x32_bf16 v[232:235], v[108:111], a[88:91], v[232:235]
ds_read_b64_tr_b16 v[98:99], v80 offset:17408
ds_read_b128 a[100:103], v120 offset:10240
v_mfma_f32_16x16x32_bf16 v[236:239], v[108:111], a[92:95], v[236:239]
ds_read_b128 a[104:107], v120 offset:12288
ds_read_b128 a[108:111], v120 offset:14336
v_mfma_f32_16x16x32_bf16 v[236:239], v[104:107], a[76:79], v[236:239]
s_waitcnt lgkmcnt(6)
ds_read_b128 a[112:115], v121 offset:8192
ds_read_b128 a[116:119], v121 offset:10240
v_mfma_f32_16x16x32_bf16 v[252:255], v[112:115], a[76:79], v[252:255]
ds_read_b64_tr_b16 v[100:101], v80 offset:24576
ds_read_b128 a[120:123], v121 offset:12288
v_mfma_f32_16x16x32_bf16 v[252:255], v[116:119], a[92:95], v[252:255]
ds_read_b64_tr_b16 v[102:103], v80 offset:25600
ds_read_b128 a[124:127], v121 offset:14336
v_mfma_f32_16x16x32_bf16 v[248:251], v[116:119], a[88:91], v[248:251]
s_waitcnt vmcnt(13)
ds_read_b128 v[68:71], v22 offset:0
ds_read_b128 v[72:75], v22 offset:128
v_mfma_f32_16x16x32_bf16 v[248:251], v[112:115], a[72:75], v[248:251]
ds_read_b128 v[76:79], v23 offset:256
v_mfma_f32_16x16x32_bf16 v[244:247], v[112:115], a[68:71], v[244:247]
ds_read_b64_tr_b16 v[104:105], v81 offset:16384
v_mfma_f32_16x16x32_bf16 v[244:247], v[116:119], a[84:87], v[244:247]
ds_read_b64_tr_b16 v[106:107], v81 offset:17408
v_mfma_f32_16x16x32_bf16 v[240:243], v[116:119], a[80:83], v[240:243]
v_mfma_f32_16x16x32_bf16 v[240:243], v[112:115], a[64:67], v[240:243]
s_waitcnt lgkmcnt(6)
v_mfma_f32_16x16x32_bf16 v[128:131], v[96:99], a[96:99], v[128:131]
s_add_u32 m0, s13, 49152
ds_read_b64_tr_b16 v[108:109], v81 offset:24576
v_mfma_f32_16x16x32_bf16 v[128:131], v[100:103], a[112:115], v[128:131]
s_waitcnt lgkmcnt(5)
s_xor_b32 s7, s11, 2621440
ds_read_b64_tr_b16 v[110:111], v81 offset:25600
v_lshlrev_b32 v24, 16, v68
v_mfma_f32_16x16x32_bf16 v[132:135], v[100:103], a[116:119], v[132:135]
buffer_load_dwordx4 v88, s[52:55], s7 offen offset:0  lds
v_mfma_f32_16x16x32_bf16 v[132:135], v[96:99], a[100:103], v[132:135]
v_and_b32 v25, 0xffff0000, v68
v_lshlrev_b32 v26, 16, v69
v_mfma_f32_16x16x32_bf16 v[136:139], v[96:99], a[104:107], v[136:139]
s_cmp_eq_u32 s3, 0
s_cselect_b32 s39, 80, 0
ds_read_b64_tr_b16 v[112:113], v82 offset:16384
v_and_b32 v27, 0xffff0000, v69
v_mfma_f32_16x16x32_bf16 v[136:139], v[100:103], a[120:123], v[136:139]
ds_read_b64_tr_b16 v[114:115], v82 offset:17408
v_lshlrev_b32 v28, 16, v70
v_mov_b32 v123, s13
v_mfma_f32_16x16x32_bf16 v[140:143], v[100:103], a[124:127], v[140:143]
buffer_load_dwordx4 v89, s[52:55], s7 offen offset:1024  lds
v_mfma_f32_16x16x32_bf16 v[140:143], v[96:99], a[108:111], v[140:143]
s_waitcnt lgkmcnt(2)
v_and_b32 v29, 0xffff0000, v70
v_lshlrev_b32 v30, 16, v71
v_mfma_f32_16x16x32_bf16 v[156:159], v[104:107], a[108:111], v[156:159]
ds_read_b64_tr_b16 v[116:117], v82 offset:24576
v_and_b32 v31, 0xffff0000, v71
v_mfma_f32_16x16x32_bf16 v[156:159], v[108:111], a[124:127], v[156:159]
ds_read_b64_tr_b16 v[118:119], v82 offset:25600
v_lshlrev_b32 v32, 16, v72
v_mfma_f32_16x16x32_bf16 v[152:155], v[108:111], a[120:123], v[152:155]
v_and_b32 v33, 0xffff0000, v72
v_lshlrev_b32 v34, 16, v73
v_mfma_f32_16x16x32_bf16 v[152:155], v[104:107], a[104:107], v[152:155]
buffer_load_dwordx4 v90, s[52:55], s7 offen offset:2048  lds
v_mfma_f32_16x16x32_bf16 v[148:151], v[104:107], a[100:103], v[148:151]
ds_read_b64_tr_b16 v[96:97], v83 offset:16384
v_and_b32 v35, 0xffff0000, v73
v_mfma_f32_16x16x32_bf16 v[148:151], v[108:111], a[116:119], v[148:151]
ds_read_b64_tr_b16 v[98:99], v83 offset:17408
v_lshlrev_b32 v36, 16, v74
v_mfma_f32_16x16x32_bf16 v[144:147], v[108:111], a[112:115], v[144:147]
v_and_b32 v37, 0xffff0000, v74
v_lshlrev_b32 v38, 16, v75
v_mfma_f32_16x16x32_bf16 v[144:147], v[104:107], a[96:99], v[144:147]
s_waitcnt lgkmcnt(2)
buffer_load_dwordx4 v91, s[52:55], s7 offen offset:3072  lds
v_mfma_f32_16x16x32_bf16 v[160:163], v[112:115], a[96:99], v[160:163]
ds_read_b64_tr_b16 v[100:101], v83 offset:24576
v_and_b32 v39, 0xffff0000, v75
v_mfma_f32_16x16x32_bf16 v[160:163], v[116:119], a[112:115], v[160:163]
s_add_u32 m0, s12, 8192
ds_read_b64_tr_b16 v[102:103], v83 offset:25600
v_lshlrev_b32 v40, 16, v76
v_mfma_f32_16x16x32_bf16 v[164:167], v[116:119], a[116:119], v[164:167]
s_xor_b32 s8, s10, 640
v_and_b32 v41, 0xffff0000, v76
v_lshlrev_b32 v42, 16, v77
v_mfma_f32_16x16x32_bf16 v[164:167], v[112:115], a[100:103], v[164:167]
v_and_b32 v43, 0xffff0000, v77
v_lshlrev_b32 v44, 16, v78
v_mfma_f32_16x16x32_bf16 v[168:171], v[112:115], a[104:107], v[168:171]
ds_read_b64_tr_b16 v[104:105], v84 offset:16384
v_and_b32 v45, 0xffff0000, v78
v_mfma_f32_16x16x32_bf16 v[168:171], v[116:119], a[120:123], v[168:171]
ds_read_b64_tr_b16 v[106:107], v84 offset:17408
v_lshlrev_b32 v46, 16, v79
v_mfma_f32_16x16x32_bf16 v[172:175], v[116:119], a[124:127], v[172:175]
buffer_load_dwordx4 v92, s[48:51], s8 offen offset:0 lds
v_mfma_f32_16x16x32_bf16 v[172:175], v[112:115], a[108:111], v[172:175]
s_waitcnt lgkmcnt(2)
v_and_b32 v47, 0xffff0000, v79
v_add_f32 v16, v24, v25
v_mfma_f32_16x16x32_bf16 v[188:191], v[96:99], a[108:111], v[188:191]
ds_read_b64_tr_b16 v[108:109], v84 offset:24576
v_add_f32 v17, v26, v27
v_mfma_f32_16x16x32_bf16 v[188:191], v[100:103], a[124:127], v[188:191]
ds_read_b64_tr_b16 v[110:111], v84 offset:25600
v_add_f32 v16, v16, v28
v_mfma_f32_16x16x32_bf16 v[184:187], v[100:103], a[120:123], v[184:187]
buffer_load_dwordx4 v93, s[48:51], s8 offen offset:1024 lds
v_mfma_f32_16x16x32_bf16 v[184:187], v[96:99], a[104:107], v[184:187]
v_add_f32 v17, v17, v29
v_add_f32 v16, v16, v30
v_mfma_f32_16x16x32_bf16 v[180:183], v[96:99], a[100:103], v[180:183]
ds_read_b64_tr_b16 v[112:113], v85 offset:16384
v_add_f32 v17, v17, v31
v_mfma_f32_16x16x32_bf16 v[180:183], v[100:103], a[116:119], v[180:183]
ds_read_b64_tr_b16 v[114:115], v85 offset:17408
v_add_f32 v16, v16, v32
v_mfma_f32_16x16x32_bf16 v[176:179], v[100:103], a[112:115], v[176:179]
buffer_load_dwordx4 v94, s[48:51], s8 offen offset:2048 lds
v_mfma_f32_16x16x32_bf16 v[176:179], v[96:99], a[96:99], v[176:179]
s_waitcnt lgkmcnt(2)
v_add_f32 v17, v17, v33
v_add_f32 v16, v16, v34
v_mfma_f32_16x16x32_bf16 v[192:195], v[104:107], a[96:99], v[192:195]
ds_read_b64_tr_b16 v[116:117], v85 offset:24576
v_add_f32 v17, v17, v35
v_mfma_f32_16x16x32_bf16 v[192:195], v[108:111], a[112:115], v[192:195]
ds_read_b64_tr_b16 v[118:119], v85 offset:25600
v_add_f32 v16, v16, v36
v_mfma_f32_16x16x32_bf16 v[196:199], v[108:111], a[116:119], v[196:199]
buffer_load_dwordx4 v95, s[48:51], s8 offen offset:3072 lds
v_mfma_f32_16x16x32_bf16 v[196:199], v[104:107], a[100:103], v[196:199]
s_add_u32 m0, s12, 12288
v_add_f32 v17, v17, v37
v_add_f32 v16, v16, v38
v_mfma_f32_16x16x32_bf16 v[200:203], v[104:107], a[104:107], v[200:203]
s_xor_b32 s9, s10, 33408
ds_read_b64_tr_b16 v[96:97], v86 offset:16384
v_add_f32 v17, v17, v39
v_mfma_f32_16x16x32_bf16 v[200:203], v[108:111], a[120:123], v[200:203]
ds_read_b64_tr_b16 v[98:99], v86 offset:17408
v_add_f32 v16, v16, v40
v_mfma_f32_16x16x32_bf16 v[204:207], v[108:111], a[124:127], v[204:207]
buffer_load_dwordx4 v92, s[48:51], s9 offen offset:0 lds
v_mfma_f32_16x16x32_bf16 v[204:207], v[104:107], a[108:111], v[204:207]
s_waitcnt lgkmcnt(2)
v_add_f32 v17, v17, v41
v_add_f32 v16, v16, v42
v_mfma_f32_16x16x32_bf16 v[220:223], v[112:115], a[108:111], v[220:223]
ds_read_b64_tr_b16 v[100:101], v86 offset:24576
v_add_f32 v17, v17, v43
v_mfma_f32_16x16x32_bf16 v[220:223], v[116:119], a[124:127], v[220:223]
ds_read_b64_tr_b16 v[102:103], v86 offset:25600
v_add_f32 v16, v16, v44
v_mfma_f32_16x16x32_bf16 v[216:219], v[116:119], a[120:123], v[216:219]
buffer_load_dwordx4 v93, s[48:51], s9 offen offset:1024 lds
v_mfma_f32_16x16x32_bf16 v[216:219], v[112:115], a[104:107], v[216:219]
v_add_f32 v17, v17, v45
v_add_f32 v16, v16, v46
v_mfma_f32_16x16x32_bf16 v[212:215], v[112:115], a[100:103], v[212:215]
ds_read_b64_tr_b16 v[104:105], v87 offset:16384
v_add_f32 v17, v17, v47
v_mfma_f32_16x16x32_bf16 v[212:215], v[116:119], a[116:119], v[212:215]
ds_read_b64_tr_b16 v[106:107], v87 offset:17408
v_add_f32 v16, v16, v17
v_mfma_f32_16x16x32_bf16 v[208:211], v[116:119], a[112:115], v[208:211]
v_mfma_f32_16x16x32_bf16 v[208:211], v[112:115], a[96:99], v[208:211]
s_waitcnt lgkmcnt(2)
buffer_load_dwordx4 v94, s[48:51], s9 offen offset:2048 lds
v_mfma_f32_16x16x32_bf16 v[224:227], v[96:99], a[96:99], v[224:227]
ds_read_b64_tr_b16 v[108:109], v87 offset:24576
v_add_f32_dpp v16, v16, v16 row_ror:8 row_mask:0xf bank_mask:0xf
v_mfma_f32_16x16x32_bf16 v[224:227], v[100:103], a[112:115], v[224:227]
ds_read_b64_tr_b16 v[110:111], v87 offset:25600
v_mfma_f32_16x16x32_bf16 v[228:231], v[100:103], a[116:119], v[228:231]
s_waitcnt vmcnt(19)
v_mov_b32 v18, v16
v_mfma_f32_16x16x32_bf16 v[228:231], v[96:99], a[100:103], v[228:231]
s_barrier
buffer_load_dwordx4 v95, s[48:51], s9 offen offset:3072 lds
v_mfma_f32_16x16x32_bf16 v[232:235], v[96:99], a[104:107], v[232:235]
s_waitcnt vmcnt(12)
ds_read_b64_tr_b16 v[112:113], v80 offset:32768
ds_read_b128 a[128:131], v120 offset:0
v_permlane16_swap_b32 v16, v18
v_mfma_f32_16x16x32_bf16 v[232:235], v[100:103], a[120:123], v[232:235]
ds_read_b64_tr_b16 v[114:115], v80 offset:33792
ds_read_b128 a[132:135], v120 offset:2048
v_mfma_f32_16x16x32_bf16 v[236:239], v[100:103], a[124:127], v[236:239]
ds_read_b128 a[136:139], v120 offset:4096
ds_read_b128 a[140:143], v120 offset:6144
v_mfma_f32_16x16x32_bf16 v[236:239], v[96:99], a[108:111], v[236:239]
s_waitcnt lgkmcnt(6)
ds_read_b128 a[144:147], v121 offset:0
ds_read_b128 a[148:151], v121 offset:2048
v_mfma_f32_16x16x32_bf16 v[252:255], v[104:107], a[108:111], v[252:255]
ds_read_b64_tr_b16 v[116:117], v80 offset:40960
ds_read_b128 a[152:155], v121 offset:4096
v_mfma_f32_16x16x32_bf16 v[252:255], v[108:111], a[124:127], v[252:255]
ds_read_b64_tr_b16 v[118:119], v80 offset:41984
ds_read_b128 a[156:159], v121 offset:6144
v_mfma_f32_16x16x32_bf16 v[248:251], v[108:111], a[120:123], v[248:251]
v_add_f32 v16, v16, v18
v_mfma_f32_16x16x32_bf16 v[248:251], v[104:107], a[104:107], v[248:251]
buffer_load_dword v122, v123, s[72:75], 0 offen sc1
v_mfma_f32_16x16x32_bf16 v[244:247], v[104:107], a[100:103], v[244:247]
ds_read_b64_tr_b16 v[96:97], v81 offset:32768
v_mov_b32 v18, v16
v_mfma_f32_16x16x32_bf16 v[244:247], v[108:111], a[116:119], v[244:247]
ds_read_b64_tr_b16 v[98:99], v81 offset:33792
v_mfma_f32_16x16x32_bf16 v[240:243], v[108:111], a[112:115], v[240:243]
v_permlane32_swap_b32 v16, v18
v_mfma_f32_16x16x32_bf16 v[240:243], v[104:107], a[96:99], v[240:243]
s_waitcnt lgkmcnt(3)
v_mfma_f32_16x16x32_bf16 v[128:131], v[112:115], a[128:131], v[128:131]
s_add_u32 m0, s13, 0
ds_read_b64_tr_b16 v[100:101], v81 offset:40960
v_add_f32 v16, v16, v18
v_mfma_f32_16x16x32_bf16 v[128:131], v[116:119], a[144:147], v[128:131]
s_xor_b32 s7, s11, 3145728
ds_read_b64_tr_b16 v[102:103], v81 offset:41984
v_mul_f32 v16, 0x3bcccccd, v16
v_mfma_f32_16x16x32_bf16 v[132:135], v[116:119], a[148:151], v[132:135]
s_mul_i32 s14, s4, 1148928
buffer_load_dwordx4 v88, s[52:55], s7 offen offset:0  lds
v_mfma_f32_16x16x32_bf16 v[132:135], v[112:115], a[132:135], v[132:135]
s_mul_i32 s6, s5, 139264
v_sub_f32 v24, v24, v16
v_sub_f32 v25, v25, v16
v_mfma_f32_16x16x32_bf16 v[136:139], v[112:115], a[136:139], v[136:139]
s_add_u32 s14, s14, s6
ds_read_b64_tr_b16 v[104:105], v82 offset:32768
v_sub_f32 v26, v26, v16
v_mfma_f32_16x16x32_bf16 v[136:139], v[116:119], a[152:155], v[136:139]
s_waitcnt lgkmcnt(5)
s_mul_i32 s6, s3, 34816
ds_read_b64_tr_b16 v[106:107], v82 offset:33792
v_sub_f32 v27, v27, v16
v_mfma_f32_16x16x32_bf16 v[140:143], v[116:119], a[156:159], v[140:143]
s_add_u32 s14, s14, s6
buffer_load_dwordx4 v89, s[52:55], s7 offen offset:1024  lds
v_mfma_f32_16x16x32_bf16 v[140:143], v[112:115], a[140:143], v[140:143]
s_waitcnt lgkmcnt(2)
v_sub_f32 v28, v28, v16
v_sub_f32 v29, v29, v16
v_mfma_f32_16x16x32_bf16 v[156:159], v[96:99], a[140:143], v[156:159]
s_add_u32 s14, s14, 52428800
ds_read_b64_tr_b16 v[108:109], v82 offset:40960
v_sub_f32 v30, v30, v16
v_mfma_f32_16x16x32_bf16 v[156:159], v[100:103], a[156:159], v[156:159]
ds_read_b64_tr_b16 v[110:111], v82 offset:41984
v_sub_f32 v31, v31, v16
v_mfma_f32_16x16x32_bf16 v[152:155], v[100:103], a[152:155], v[152:155]
v_sub_f32 v32, v32, v16
v_sub_f32 v33, v33, v16
v_mfma_f32_16x16x32_bf16 v[152:155], v[96:99], a[136:139], v[152:155]
buffer_load_dwordx4 v90, s[52:55], s7 offen offset:2048  lds
v_mfma_f32_16x16x32_bf16 v[148:151], v[96:99], a[132:135], v[148:151]
ds_read_b64_tr_b16 v[112:113], v83 offset:32768
v_sub_f32 v34, v34, v16
v_mfma_f32_16x16x32_bf16 v[148:151], v[100:103], a[148:151], v[148:151]
ds_read_b64_tr_b16 v[114:115], v83 offset:33792
v_sub_f32 v35, v35, v16
v_mfma_f32_16x16x32_bf16 v[144:147], v[100:103], a[144:147], v[144:147]
v_sub_f32 v36, v36, v16
v_sub_f32 v37, v37, v16
v_mfma_f32_16x16x32_bf16 v[144:147], v[96:99], a[128:131], v[144:147]
s_waitcnt lgkmcnt(2)
buffer_load_dwordx4 v91, s[52:55], s7 offen offset:3072  lds
v_mfma_f32_16x16x32_bf16 v[160:163], v[104:107], a[128:131], v[160:163]
ds_read_b64_tr_b16 v[116:117], v83 offset:40960
v_sub_f32 v38, v38, v16
v_mfma_f32_16x16x32_bf16 v[160:163], v[108:111], a[144:147], v[160:163]
s_add_u32 m0, s12, 0
ds_read_b64_tr_b16 v[118:119], v83 offset:41984
v_sub_f32 v39, v39, v16
v_mfma_f32_16x16x32_bf16 v[164:167], v[108:111], a[148:151], v[164:167]
s_xor_b32 s8, s10, 768
v_sub_f32 v40, v40, v16
v_sub_f32 v41, v41, v16
v_mfma_f32_16x16x32_bf16 v[164:167], v[104:107], a[132:135], v[164:167]
v_sub_f32 v42, v42, v16
v_sub_f32 v43, v43, v16
v_mfma_f32_16x16x32_bf16 v[168:171], v[104:107], a[136:139], v[168:171]
ds_read_b64_tr_b16 v[96:97], v84 offset:32768
v_sub_f32 v44, v44, v16
v_mfma_f32_16x16x32_bf16 v[168:171], v[108:111], a[152:155], v[168:171]
ds_read_b64_tr_b16 v[98:99], v84 offset:33792
v_sub_f32 v45, v45, v16
v_mfma_f32_16x16x32_bf16 v[172:175], v[108:111], a[156:159], v[172:175]
buffer_load_dwordx4 v92, s[48:51], s8 offen offset:0 lds
v_mfma_f32_16x16x32_bf16 v[172:175], v[104:107], a[140:143], v[172:175]
s_waitcnt lgkmcnt(2)
v_sub_f32 v46, v46, v16
v_sub_f32 v47, v47, v16
v_mfma_f32_16x16x32_bf16 v[188:191], v[112:115], a[140:143], v[188:191]
ds_read_b64_tr_b16 v[100:101], v84 offset:40960
v_mul_f32 v17, v40, v40
v_mfma_f32_16x16x32_bf16 v[188:191], v[116:119], a[156:159], v[188:191]
ds_read_b64_tr_b16 v[102:103], v84 offset:41984
v_fmac_f32 v17, v41, v41
v_mfma_f32_16x16x32_bf16 v[184:187], v[116:119], a[152:155], v[184:187]
buffer_load_dwordx4 v93, s[48:51], s8 offen offset:1024 lds
v_mfma_f32_16x16x32_bf16 v[184:187], v[112:115], a[136:139], v[184:187]
v_fmac_f32 v17, v42, v42
v_fmac_f32 v17, v43, v43
v_mfma_f32_16x16x32_bf16 v[180:183], v[112:115], a[132:135], v[180:183]
ds_read_b64_tr_b16 v[104:105], v85 offset:32768
v_fmac_f32 v17, v44, v44
v_mfma_f32_16x16x32_bf16 v[180:183], v[116:119], a[148:151], v[180:183]
ds_read_b64_tr_b16 v[106:107], v85 offset:33792
v_fmac_f32 v17, v45, v45
v_mfma_f32_16x16x32_bf16 v[176:179], v[116:119], a[144:147], v[176:179]
buffer_load_dwordx4 v94, s[48:51], s8 offen offset:2048 lds
v_mfma_f32_16x16x32_bf16 v[176:179], v[112:115], a[128:131], v[176:179]
s_waitcnt lgkmcnt(2)
v_fmac_f32 v17, v46, v46
v_fmac_f32 v17, v47, v47
v_mfma_f32_16x16x32_bf16 v[192:195], v[96:99], a[128:131], v[192:195]
ds_read_b64_tr_b16 v[108:109], v85 offset:40960
v_mul_f32 v19, v24, v24
v_mfma_f32_16x16x32_bf16 v[192:195], v[100:103], a[144:147], v[192:195]
ds_read_b64_tr_b16 v[110:111], v85 offset:41984
v_fmac_f32 v19, v25, v25
v_mfma_f32_16x16x32_bf16 v[196:199], v[100:103], a[148:151], v[196:199]
buffer_load_dwordx4 v95, s[48:51], s8 offen offset:3072 lds
v_mfma_f32_16x16x32_bf16 v[196:199], v[96:99], a[132:135], v[196:199]
s_add_u32 m0, s12, 4096
v_cndmask_b32 v17, 0, v17, s[84:85]
v_fmac_f32 v17, v26, v26
v_mfma_f32_16x16x32_bf16 v[200:203], v[96:99], a[136:139], v[200:203]
s_xor_b32 s9, s10, 33536
ds_read_b64_tr_b16 v[112:113], v86 offset:32768
v_fmac_f32 v19, v27, v27
v_mfma_f32_16x16x32_bf16 v[200:203], v[100:103], a[152:155], v[200:203]
ds_read_b64_tr_b16 v[114:115], v86 offset:33792
v_fmac_f32 v17, v28, v28
v_mfma_f32_16x16x32_bf16 v[204:207], v[100:103], a[156:159], v[204:207]
buffer_load_dwordx4 v92, s[48:51], s9 offen offset:0 lds
v_mfma_f32_16x16x32_bf16 v[204:207], v[96:99], a[140:143], v[204:207]
s_waitcnt lgkmcnt(2)
v_fmac_f32 v19, v29, v29
v_fmac_f32 v17, v30, v30
v_mfma_f32_16x16x32_bf16 v[220:223], v[104:107], a[140:143], v[220:223]
ds_read_b64_tr_b16 v[116:117], v86 offset:40960
v_fmac_f32 v19, v31, v31
v_mfma_f32_16x16x32_bf16 v[220:223], v[108:111], a[156:159], v[220:223]
ds_read_b64_tr_b16 v[118:119], v86 offset:41984
v_fmac_f32 v17, v32, v32
v_mfma_f32_16x16x32_bf16 v[216:219], v[108:111], a[152:155], v[216:219]
buffer_load_dwordx4 v93, s[48:51], s9 offen offset:1024 lds
v_mfma_f32_16x16x32_bf16 v[216:219], v[104:107], a[136:139], v[216:219]
v_fmac_f32 v19, v33, v33
v_fmac_f32 v17, v34, v34
v_mfma_f32_16x16x32_bf16 v[212:215], v[104:107], a[132:135], v[212:215]
ds_read_b64_tr_b16 v[96:97], v87 offset:32768
v_fmac_f32 v19, v35, v35
v_mfma_f32_16x16x32_bf16 v[212:215], v[108:111], a[148:151], v[212:215]
ds_read_b64_tr_b16 v[98:99], v87 offset:33792
v_fmac_f32 v17, v36, v36
v_mfma_f32_16x16x32_bf16 v[208:211], v[108:111], a[144:147], v[208:211]
v_fmac_f32 v19, v37, v37
v_fmac_f32 v17, v38, v38
v_mfma_f32_16x16x32_bf16 v[208:211], v[104:107], a[128:131], v[208:211]
s_waitcnt lgkmcnt(2)
buffer_load_dwordx4 v94, s[48:51], s9 offen offset:2048 lds
v_mfma_f32_16x16x32_bf16 v[224:227], v[112:115], a[128:131], v[224:227]
ds_read_b64_tr_b16 v[100:101], v87 offset:40960
v_fmac_f32 v19, v39, v39
v_mfma_f32_16x16x32_bf16 v[224:227], v[116:119], a[144:147], v[224:227]
s_waitcnt vmcnt(11)
ds_read_b64_tr_b16 v[102:103], v87 offset:41984
v_add_f32 v17, v17, v19
v_cmp_gt_u32 vcc, s39, v122
s_nop 1
s_cbranch_vccnz L_fr_spinm
L_fr_gom:
v_mfma_f32_16x16x32_bf16 v[228:231], v[116:119], a[148:151], v[228:231]
v_mfma_f32_16x16x32_bf16 v[228:231], v[112:115], a[132:135], v[228:231]
s_barrier
buffer_load_dwordx4 v95, s[48:51], s9 offen offset:3072 lds
v_add_f32_dpp v17, v17, v17 row_ror:8 row_mask:0xf bank_mask:0xf
v_mfma_f32_16x16x32_bf16 v[232:235], v[112:115], a[136:139], v[232:235]
ds_read_b64_tr_b16 v[104:105], v80 offset:49152
ds_read_b128 a[160:163], v120 offset:8192
v_lshlrev_b32 v123, 4, v0
v_mfma_f32_16x16x32_bf16 v[232:235], v[116:119], a[152:155], v[232:235]
ds_read_b64_tr_b16 v[106:107], v80 offset:50176
ds_read_b128 a[164:167], v120 offset:10240
v_mov_b32 v18, v17
v_mfma_f32_16x16x32_bf16 v[236:239], v[116:119], a[156:159], v[236:239]
s_mov_b32 s32, 262144
ds_read_b128 a[168:171], v120 offset:12288
ds_read_b128 a[172:175], v120 offset:14336
v_mfma_f32_16x16x32_bf16 v[236:239], v[112:115], a[140:143], v[236:239]
s_waitcnt lgkmcnt(6)
ds_read_b128 a[176:179], v121 offset:8192
ds_read_b128 a[180:183], v121 offset:10240
v_mfma_f32_16x16x32_bf16 v[252:255], v[96:99], a[140:143], v[252:255]
ds_read_b64_tr_b16 v[108:109], v80 offset:57344
ds_read_b128 a[184:187], v121 offset:12288
v_mfma_f32_16x16x32_bf16 v[252:255], v[100:103], a[156:159], v[252:255]
ds_read_b64_tr_b16 v[110:111], v80 offset:58368
ds_read_b128 a[188:191], v121 offset:14336
v_mfma_f32_16x16x32_bf16 v[248:251], v[100:103], a[152:155], v[248:251]
v_permlane16_swap_b32 v17, v18
v_mfma_f32_16x16x32_bf16 v[248:251], v[96:99], a[136:139], v[248:251]
buffer_load_dwordx4 v[56:59], v123, s[60:63], s32 offen sc1
v_mfma_f32_16x16x32_bf16 v[244:247], v[96:99], a[132:135], v[244:247]
ds_read_b64_tr_b16 v[112:113], v81 offset:49152
v_add_f32 v17, v17, v18
v_mfma_f32_16x16x32_bf16 v[244:247], v[100:103], a[148:151], v[244:247]
ds_read_b64_tr_b16 v[114:115], v81 offset:50176
v_mfma_f32_16x16x32_bf16 v[240:243], v[100:103], a[144:147], v[240:243]
v_mov_b32 v18, v17
v_mfma_f32_16x16x32_bf16 v[240:243], v[96:99], a[128:131], v[240:243]
s_waitcnt lgkmcnt(3)
v_mfma_f32_16x16x32_bf16 v[128:131], v[104:107], a[160:163], v[128:131]
s_add_u32 m0, s13, 16384
ds_read_b64_tr_b16 v[116:117], v81 offset:57344
v_permlane32_swap_b32 v17, v18
v_mfma_f32_16x16x32_bf16 v[128:131], v[108:111], a[176:179], v[128:131]
s_xor_b32 s7, s11, 3670016
ds_read_b64_tr_b16 v[118:119], v81 offset:58368
v_mfma_f32_16x16x32_bf16 v[132:135], v[108:111], a[180:183], v[132:135]
s_mov_b32 s32, 266240
buffer_load_dwordx4 v88, s[52:55], s7 offen offset:0  lds
v_mfma_f32_16x16x32_bf16 v[132:135], v[104:107], a[164:167], v[132:135]
buffer_load_dwordx4 v[60:63], v123, s[60:63], s32 offen sc1
v_add_f32 v17, v17, v18
v_mfma_f32_16x16x32_bf16 v[136:139], v[104:107], a[168:171], v[136:139]
s_lshl_b32 s44, s3, 3
ds_read_b64_tr_b16 v[96:97], v82 offset:49152
v_lshlrev_b32 v19, 5, v20
v_mfma_f32_16x16x32_bf16 v[136:139], v[108:111], a[184:187], v[136:139]
s_waitcnt lgkmcnt(5)
ds_read_b64_tr_b16 v[98:99], v82 offset:50176
v_add_u32 v19, 159744, v19
v_mfma_f32_16x16x32_bf16 v[140:143], v[108:111], a[188:191], v[140:143]
buffer_load_dwordx4 v89, s[52:55], s7 offen offset:1024  lds
v_mfma_f32_16x16x32_bf16 v[140:143], v[104:107], a[172:175], v[140:143]
s_waitcnt lgkmcnt(2)
v_add_u32 v18, s44, v19
v_mfma_f32_16x16x32_bf16 v[156:159], v[112:115], a[172:175], v[156:159]
ds_read_b64_tr_b16 v[100:101], v82 offset:57344
ds_write_b64 v18, v[16:17]
v_mfma_f32_16x16x32_bf16 v[156:159], v[116:119], a[188:191], v[156:159]
ds_read_b64_tr_b16 v[102:103], v82 offset:58368
v_mfma_f32_16x16x32_bf16 v[152:155], v[116:119], a[184:187], v[152:155]
s_mov_b32 s32, 270336
buffer_load_dwordx4 v[64:67], v123, s[60:63], s32 offen sc1
v_mfma_f32_16x16x32_bf16 v[152:155], v[112:115], a[168:171], v[152:155]
buffer_load_dwordx4 v90, s[52:55], s7 offen offset:2048  lds
v_mfma_f32_16x16x32_bf16 v[148:151], v[112:115], a[164:167], v[148:151]
ds_read_b64_tr_b16 v[104:105], v83 offset:49152
v_mfma_f32_16x16x32_bf16 v[148:151], v[116:119], a[180:183], v[148:151]
ds_read_b64_tr_b16 v[106:107], v83 offset:50176
v_mfma_f32_16x16x32_bf16 v[144:147], v[116:119], a[176:179], v[144:147]
v_mfma_f32_16x16x32_bf16 v[144:147], v[112:115], a[160:163], v[144:147]
s_waitcnt lgkmcnt(2)
buffer_load_dwordx4 v91, s[52:55], s7 offen offset:3072  lds
v_mfma_f32_16x16x32_bf16 v[160:163], v[96:99], a[160:163], v[160:163]
ds_read_b64_tr_b16 v[108:109], v83 offset:57344
v_mfma_f32_16x16x32_bf16 v[160:163], v[100:103], a[176:179], v[160:163]
s_add_u32 m0, s12, 8192
ds_read_b64_tr_b16 v[110:111], v83 offset:58368
v_mfma_f32_16x16x32_bf16 v[164:167], v[100:103], a[180:183], v[164:167]
s_xor_b32 s8, s10, 896
v_mfma_f32_16x16x32_bf16 v[164:167], v[96:99], a[164:167], v[164:167]
s_mov_b32 s32, 274432
buffer_load_dwordx4 v[68:71], v123, s[60:63], s32 offen sc1
v_mfma_f32_16x16x32_bf16 v[168:171], v[96:99], a[168:171], v[168:171]
ds_read_b64_tr_b16 v[112:113], v84 offset:49152
v_mfma_f32_16x16x32_bf16 v[168:171], v[100:103], a[184:187], v[168:171]
ds_read_b64_tr_b16 v[114:115], v84 offset:50176
v_mfma_f32_16x16x32_bf16 v[172:175], v[100:103], a[188:191], v[172:175]
buffer_load_dwordx4 v92, s[48:51], s8 offen offset:0 lds
v_mfma_f32_16x16x32_bf16 v[172:175], v[96:99], a[172:175], v[172:175]
s_waitcnt lgkmcnt(2)
v_mfma_f32_16x16x32_bf16 v[188:191], v[104:107], a[172:175], v[188:191]
ds_read_b64_tr_b16 v[116:117], v84 offset:57344
v_mfma_f32_16x16x32_bf16 v[188:191], v[108:111], a[188:191], v[188:191]
ds_read_b64_tr_b16 v[118:119], v84 offset:58368
v_mfma_f32_16x16x32_bf16 v[184:187], v[108:111], a[184:187], v[184:187]
s_mov_b32 s32, 278528
buffer_load_dwordx4 v93, s[48:51], s8 offen offset:1024 lds
v_mfma_f32_16x16x32_bf16 v[184:187], v[104:107], a[168:171], v[184:187]
buffer_load_dwordx4 v[72:75], v123, s[60:63], s32 offen sc1
v_mfma_f32_16x16x32_bf16 v[180:183], v[104:107], a[164:167], v[180:183]
ds_read_b64_tr_b16 v[96:97], v85 offset:49152
v_mfma_f32_16x16x32_bf16 v[180:183], v[108:111], a[180:183], v[180:183]
ds_read_b64_tr_b16 v[98:99], v85 offset:50176
v_mfma_f32_16x16x32_bf16 v[176:179], v[108:111], a[176:179], v[176:179]
buffer_load_dwordx4 v94, s[48:51], s8 offen offset:2048 lds
v_mfma_f32_16x16x32_bf16 v[176:179], v[104:107], a[160:163], v[176:179]
s_waitcnt lgkmcnt(2)
v_mfma_f32_16x16x32_bf16 v[192:195], v[112:115], a[160:163], v[192:195]
ds_read_b64_tr_b16 v[100:101], v85 offset:57344
v_mfma_f32_16x16x32_bf16 v[192:195], v[116:119], a[176:179], v[192:195]
ds_read_b64_tr_b16 v[102:103], v85 offset:58368
v_mfma_f32_16x16x32_bf16 v[196:199], v[116:119], a[180:183], v[196:199]
buffer_load_dwordx4 v95, s[48:51], s8 offen offset:3072 lds
v_mfma_f32_16x16x32_bf16 v[196:199], v[112:115], a[164:167], v[196:199]
s_add_u32 m0, s12, 12288
v_mfma_f32_16x16x32_bf16 v[200:203], v[112:115], a[168:171], v[200:203]
s_xor_b32 s9, s10, 33664
ds_read_b64_tr_b16 v[104:105], v86 offset:49152
v_mfma_f32_16x16x32_bf16 v[200:203], v[116:119], a[184:187], v[200:203]
ds_read_b64_tr_b16 v[106:107], v86 offset:50176
v_mfma_f32_16x16x32_bf16 v[204:207], v[116:119], a[188:191], v[204:207]
buffer_load_dwordx4 v92, s[48:51], s9 offen offset:0 lds
v_mfma_f32_16x16x32_bf16 v[204:207], v[112:115], a[172:175], v[204:207]
s_waitcnt lgkmcnt(2)
v_mfma_f32_16x16x32_bf16 v[220:223], v[96:99], a[172:175], v[220:223]
ds_read_b64_tr_b16 v[108:109], v86 offset:57344
v_mfma_f32_16x16x32_bf16 v[220:223], v[100:103], a[188:191], v[220:223]
ds_read_b64_tr_b16 v[110:111], v86 offset:58368
v_mfma_f32_16x16x32_bf16 v[216:219], v[100:103], a[184:187], v[216:219]
buffer_load_dwordx4 v93, s[48:51], s9 offen offset:1024 lds
v_mfma_f32_16x16x32_bf16 v[216:219], v[96:99], a[168:171], v[216:219]
v_mfma_f32_16x16x32_bf16 v[212:215], v[96:99], a[164:167], v[212:215]
ds_read_b64_tr_b16 v[112:113], v87 offset:49152
v_mfma_f32_16x16x32_bf16 v[212:215], v[100:103], a[180:183], v[212:215]
ds_read_b64_tr_b16 v[114:115], v87 offset:50176
v_mfma_f32_16x16x32_bf16 v[208:211], v[100:103], a[176:179], v[208:211]
v_mfma_f32_16x16x32_bf16 v[208:211], v[96:99], a[160:163], v[208:211]
s_waitcnt lgkmcnt(2)
buffer_load_dwordx4 v94, s[48:51], s9 offen offset:2048 lds
v_mfma_f32_16x16x32_bf16 v[224:227], v[104:107], a[160:163], v[224:227]
ds_read_b64_tr_b16 v[116:117], v87 offset:57344
v_mfma_f32_16x16x32_bf16 v[224:227], v[108:111], a[176:179], v[224:227]
ds_read_b64_tr_b16 v[118:119], v87 offset:58368
v_mfma_f32_16x16x32_bf16 v[228:231], v[108:111], a[180:183], v[228:231]
s_waitcnt vmcnt(24)
v_mfma_f32_16x16x32_bf16 v[228:231], v[104:107], a[164:167], v[228:231]
s_barrier
buffer_load_dwordx4 v95, s[48:51], s9 offen offset:3072 lds
v_mfma_f32_16x16x32_bf16 v[232:235], v[104:107], a[168:171], v[232:235]
s_waitcnt vmcnt(17)
ds_read_b64_tr_b16 v[96:97], v80 offset:0
ds_read_b128 a[192:195], v120 offset:0
ds_read_b128 v[4:7], v19
v_mfma_f32_16x16x32_bf16 v[232:235], v[108:111], a[184:187], v[232:235]
ds_read_b64_tr_b16 v[98:99], v80 offset:1024
ds_read_b128 a[196:199], v120 offset:2048
ds_read_b128 v[8:11], v19 offset:16
v_mfma_f32_16x16x32_bf16 v[236:239], v[108:111], a[188:191], v[236:239]
ds_read_b128 a[200:203], v120 offset:4096
ds_read_b128 a[204:207], v120 offset:6144
v_mfma_f32_16x16x32_bf16 v[236:239], v[104:107], a[172:175], v[236:239]
s_waitcnt lgkmcnt(8)
ds_read_b128 a[208:211], v121 offset:0
ds_read_b128 a[212:215], v121 offset:2048
v_mfma_f32_16x16x32_bf16 v[252:255], v[112:115], a[172:175], v[252:255]
ds_read_b64_tr_b16 v[100:101], v80 offset:8192
ds_read_b128 a[216:219], v121 offset:4096
v_mfma_f32_16x16x32_bf16 v[252:255], v[116:119], a[188:191], v[252:255]
ds_read_b64_tr_b16 v[102:103], v80 offset:9216
ds_read_b128 a[220:223], v121 offset:6144
v_mfma_f32_16x16x32_bf16 v[248:251], v[116:119], a[184:187], v[248:251]
v_mfma_f32_16x16x32_bf16 v[248:251], v[112:115], a[168:171], v[248:251]
s_waitcnt lgkmcnt(8)
v_add_f32 v12, v4, v6
v_add_f32 v13, v8, v10
v_mfma_f32_16x16x32_bf16 v[244:247], v[112:115], a[164:167], v[244:247]
ds_read_b64_tr_b16 v[104:105], v81 offset:0
v_add_f32 v12, v12, v13
v_mfma_f32_16x16x32_bf16 v[244:247], v[116:119], a[180:183], v[244:247]
ds_read_b64_tr_b16 v[106:107], v81 offset:1024
v_mul_f32 v12, 0x3e800000, v12
v_mfma_f32_16x16x32_bf16 v[240:243], v[116:119], a[176:179], v[240:243]
v_add_f32 v13, v5, v7
v_add_f32 v14, v9, v11
v_mfma_f32_16x16x32_bf16 v[240:243], v[112:115], a[160:163], v[240:243]
s_waitcnt lgkmcnt(3)
v_add_f32 v13, v13, v14
v_sub_f32 v4, v4, v12
v_mfma_f32_16x16x32_bf16 v[128:131], v[96:99], a[192:195], v[128:131]
s_add_u32 m0, s13, 32768
s_mov_b32 s52, s20
ds_read_b64_tr_b16 v[108:109], v81 offset:8192
v_sub_f32 v6, v6, v12
v_mfma_f32_16x16x32_bf16 v[128:131], v[100:103], a[208:211], v[128:131]
s_xor_b32 s7, s11, 0
s_mov_b32 s53, s21
s_mov_b32 s54, 5242880
ds_read_b64_tr_b16 v[110:111], v81 offset:9216
v_sub_f32 v8, v8, v12
v_mfma_f32_16x16x32_bf16 v[132:135], v[100:103], a[212:215], v[132:135]
s_sub_u32 s43, s101, 80
s_cmp_lt_u32 s43, 160
s_cselect_b32 s70, 4915200, 0
s_cselect_b32 s36, s36, 268435456
buffer_load_dwordx4 v88, s[56:59], s7 offen offset:0  lds
v_mfma_f32_16x16x32_bf16 v[132:135], v[96:99], a[196:199], v[132:135]
v_sub_f32 v10, v10, v12
v_mul_f32 v14, v4, v4
v_lshrrev_b32 v92, 3, v2
v_mfma_f32_16x16x32_bf16 v[136:139], v[96:99], a[200:203], v[136:139]
ds_read_b64_tr_b16 v[112:113], v82 offset:0
v_fmac_f32 v14, v6, v6
v_mul_u32_u24 v92, 7680, v92
v_mfma_f32_16x16x32_bf16 v[136:139], v[100:103], a[216:219], v[136:139]
s_waitcnt lgkmcnt(5)
ds_read_b64_tr_b16 v[114:115], v82 offset:1024
v_fmac_f32 v14, v8, v8
v_and_b32 v93, 7, v2
v_mfma_f32_16x16x32_bf16 v[140:143], v[100:103], a[220:223], v[140:143]
buffer_load_dwordx4 v89, s[56:59], s7 offen offset:1024  lds
v_lshl_add_u32 v92, v93, 4, v92
v_mfma_f32_16x16x32_bf16 v[140:143], v[96:99], a[204:207], v[140:143]
s_waitcnt lgkmcnt(2)
v_fmac_f32 v14, v10, v10
v_fmac_f32 v13, 0x43200000, v14
v_mov_b32 v14, 0x3727c5ac
v_mfma_f32_16x16x32_bf16 v[156:159], v[104:107], a[204:207], v[156:159]
s_cmp_ge_u32 s3, 2
s_cselect_b32 s28, 1.0, 0
ds_read_b64_tr_b16 v[116:117], v82 offset:8192
v_fmac_f32 v14, 0x3acccccd, v13
v_mfma_f32_16x16x32_bf16 v[156:159], v[108:111], a[220:223], v[156:159]
s_mov_b32 s29, 0x3e0293ee
ds_read_b64_tr_b16 v[118:119], v82 offset:9216
v_lshlrev_b32 v122, 2, v0
v_rsq_f32 v17, v14
v_mfma_f32_16x16x32_bf16 v[152:155], v[108:111], a[216:219], v[152:155]
buffer_load_dwordx4 v90, s[56:59], s7 offen offset:2048  lds
v_sub_f32 v16, v16, v12
v_mfma_f32_16x16x32_bf16 v[152:155], v[104:107], a[200:203], v[152:155]
s_waitcnt vmcnt(19)
v_add_u32 v122, 153600, v122
v_add_f32 v56, v56, v57
v_mul_f32 v16, v16, v17
v_mfma_f32_16x16x32_bf16 v[148:151], v[104:107], a[196:199], v[148:151]
ds_read_b64_tr_b16 v[96:97], v83 offset:0
v_add_f32 v58, v58, v59
v_fma_f32 v24, v24, v17, v16
v_mfma_f32_16x16x32_bf16 v[148:151], v[108:111], a[212:215], v[148:151]
ds_read_b64_tr_b16 v[98:99], v83 offset:1024
v_add_f32 v56, v56, v58
v_fma_f32 v25, v25, v17, v16
v_mfma_f32_16x16x32_bf16 v[144:147], v[108:111], a[208:211], v[144:147]
buffer_load_dwordx4 v91, s[56:59], s7 offen offset:3072  lds
v_fma_f32 v26, v26, v17, v16
v_mfma_f32_16x16x32_bf16 v[144:147], v[104:107], a[192:195], v[144:147]
s_waitcnt lgkmcnt(2)
s_add_u32 m0, s42, 0
s_add_u32 s43, s37, 0
v_cvt_pk_bf16_f32 v56, v56, v56
v_lshlrev_b32 v56, 16, v56
v_fma_f32 v27, v27, v17, v16
v_mfma_f32_16x16x32_bf16 v[160:163], v[112:115], a[192:195], v[160:163]
ds_read_b64_tr_b16 v[100:101], v83 offset:8192
buffer_load_dwordx4 v92, s[68:71], s43 offen lds
v_mul_f32 v56, s29, v56
v_fma_f32 v28, v28, v17, v16
v_mfma_f32_16x16x32_bf16 v[160:163], v[116:119], a[208:211], v[160:163]
s_waitcnt vmcnt(19)
s_add_u32 m0, s42, 1024
s_add_u32 s43, s37, 61440
ds_read_b64_tr_b16 v[102:103], v83 offset:9216
v_add_f32 v60, v60, v61
v_fma_f32 v29, v29, v17, v16
v_mfma_f32_16x16x32_bf16 v[164:167], v[116:119], a[212:215], v[164:167]
buffer_load_dwordx4 v92, s[68:71], s43 offen lds
v_add_f32 v62, v62, v63
v_add_f32 v60, v60, v62
v_fma_f32 v30, v30, v17, v16
v_mfma_f32_16x16x32_bf16 v[164:167], v[112:115], a[196:199], v[164:167]
s_add_u32 m0, s42, 2048
s_add_u32 s43, s37, 122880
v_cvt_pk_bf16_f32 v60, v60, v60
v_lshlrev_b32 v60, 16, v60
v_fma_f32 v31, v31, v17, v16
v_mfma_f32_16x16x32_bf16 v[168:171], v[112:115], a[200:203], v[168:171]
ds_read_b64_tr_b16 v[104:105], v84 offset:0
buffer_load_dwordx4 v92, s[68:71], s43 offen lds
v_mul_f32 v60, s29, v60
v_fma_f32 v32, v32, v17, v16
v_mfma_f32_16x16x32_bf16 v[168:171], v[116:119], a[216:219], v[168:171]
s_waitcnt vmcnt(19)
s_add_u32 m0, s42, 3072
s_add_u32 s43, s37, 184320
ds_read_b64_tr_b16 v[106:107], v84 offset:1024
v_add_f32 v64, v64, v65
v_fma_f32 v33, v33, v17, v16
v_mfma_f32_16x16x32_bf16 v[172:175], v[116:119], a[220:223], v[172:175]
buffer_load_dwordx4 v92, s[68:71], s43 offen lds
v_add_f32 v66, v66, v67
v_add_f32 v64, v64, v66
v_fma_f32 v34, v34, v17, v16
v_mfma_f32_16x16x32_bf16 v[172:175], v[112:115], a[204:207], v[172:175]
s_waitcnt lgkmcnt(2)
s_add_u32 m0, s42, 4096
s_add_u32 s43, s37, 245760
v_cvt_pk_bf16_f32 v64, v64, v64
v_lshlrev_b32 v64, 16, v64
v_fma_f32 v35, v35, v17, v16
v_mfma_f32_16x16x32_bf16 v[188:191], v[96:99], a[204:207], v[188:191]
ds_read_b64_tr_b16 v[108:109], v84 offset:8192
buffer_load_dwordx4 v92, s[68:71], s43 offen lds
v_add_f32 v64, s28, v64
v_fma_f32 v36, v36, v17, v16
v_mfma_f32_16x16x32_bf16 v[188:191], v[100:103], a[220:223], v[188:191]
ds_read_b64_tr_b16 v[110:111], v84 offset:9216
v_cvt_pk_bf16_f32 v64, v64, v64
v_fma_f32 v37, v37, v17, v16
v_mfma_f32_16x16x32_bf16 v[184:187], v[100:103], a[216:219], v[184:187]
v_lshlrev_b32 v64, 16, v64
v_mul_f32 v64, s29, v64
v_fma_f32 v38, v38, v17, v16
v_mfma_f32_16x16x32_bf16 v[184:187], v[96:99], a[200:203], v[184:187]
s_waitcnt vmcnt(18)
v_add_f32 v68, v68, v69
v_add_f32 v70, v70, v71
v_fma_f32 v39, v39, v17, v16
v_mfma_f32_16x16x32_bf16 v[180:183], v[96:99], a[196:199], v[180:183]
ds_read_b64_tr_b16 v[112:113], v85 offset:0
v_add_f32 v68, v68, v70
v_fma_f32 v40, v40, v17, v16
v_mfma_f32_16x16x32_bf16 v[180:183], v[100:103], a[212:215], v[180:183]
ds_read_b64_tr_b16 v[114:115], v85 offset:1024
v_cvt_pk_bf16_f32 v68, v68, v68
v_fma_f32 v41, v41, v17, v16
v_mfma_f32_16x16x32_bf16 v[176:179], v[100:103], a[208:211], v[176:179]
v_lshlrev_b32 v68, 16, v68
v_add_f32 v68, 1.0, v68
v_fma_f32 v42, v42, v17, v16
v_mfma_f32_16x16x32_bf16 v[176:179], v[96:99], a[192:195], v[176:179]
s_waitcnt lgkmcnt(2)
v_cvt_pk_bf16_f32 v68, v68, v68
v_lshlrev_b32 v68, 16, v68
v_fma_f32 v43, v43, v17, v16
v_mfma_f32_16x16x32_bf16 v[192:195], v[104:107], a[192:195], v[192:195]
ds_read_b64_tr_b16 v[116:117], v85 offset:8192
v_mul_f32 v68, s29, v68
v_fma_f32 v44, v44, v17, v16
v_mfma_f32_16x16x32_bf16 v[192:195], v[108:111], a[208:211], v[192:195]
s_waitcnt vmcnt(15)
ds_read_b64_tr_b16 v[118:119], v85 offset:9216
v_add_f32 v72, v72, v73
v_fma_f32 v45, v45, v17, v16
v_mfma_f32_16x16x32_bf16 v[196:199], v[108:111], a[212:215], v[196:199]
v_add_f32 v74, v74, v75
v_add_f32 v72, v72, v74
v_fma_f32 v46, v46, v17, v16
v_mfma_f32_16x16x32_bf16 v[196:199], v[104:107], a[196:199], v[196:199]
v_cvt_pk_bf16_f32 v72, v72, v72
v_lshlrev_b32 v72, 16, v72
v_fma_f32 v47, v47, v17, v16
v_mfma_f32_16x16x32_bf16 v[200:203], v[104:107], a[200:203], v[200:203]
ds_read_b64_tr_b16 v[96:97], v86 offset:0
v_add_f32 v72, 1.0, v72
v_mfma_f32_16x16x32_bf16 v[200:203], v[108:111], a[216:219], v[200:203]
ds_read_b64_tr_b16 v[98:99], v86 offset:1024
v_cvt_pk_bf16_f32 v72, v72, v72
v_mfma_f32_16x16x32_bf16 v[204:207], v[108:111], a[220:223], v[204:207]
v_lshlrev_b32 v72, 16, v72
v_mul_f32 v72, s29, v72
v_mfma_f32_16x16x32_bf16 v[204:207], v[104:107], a[204:207], v[204:207]
s_waitcnt lgkmcnt(2)
ds_write_b32 v122, v56 offset:0
ds_write_b32 v122, v60 offset:1024
v_mfma_f32_16x16x32_bf16 v[220:223], v[112:115], a[204:207], v[220:223]
ds_read_b64_tr_b16 v[100:101], v86 offset:8192
ds_write_b32 v122, v64 offset:2048
v_mfma_f32_16x16x32_bf16 v[220:223], v[116:119], a[220:223], v[220:223]
ds_read_b64_tr_b16 v[102:103], v86 offset:9216
ds_write_b32 v122, v68 offset:3072
v_mfma_f32_16x16x32_bf16 v[216:219], v[116:119], a[216:219], v[216:219]
ds_write_b32 v122, v72 offset:4096
v_mfma_f32_16x16x32_bf16 v[216:219], v[112:115], a[200:203], v[216:219]
v_mfma_f32_16x16x32_bf16 v[212:215], v[112:115], a[196:199], v[212:215]
ds_read_b64_tr_b16 v[104:105], v87 offset:0
v_mfma_f32_16x16x32_bf16 v[212:215], v[116:119], a[212:215], v[212:215]
ds_read_b64_tr_b16 v[106:107], v87 offset:1024
v_mfma_f32_16x16x32_bf16 v[208:211], v[116:119], a[208:211], v[208:211]
v_mfma_f32_16x16x32_bf16 v[208:211], v[112:115], a[192:195], v[208:211]
s_waitcnt lgkmcnt(4)
v_mfma_f32_16x16x32_bf16 v[224:227], v[96:99], a[192:195], v[224:227]
ds_read_b64_tr_b16 v[108:109], v87 offset:8192
v_mfma_f32_16x16x32_bf16 v[224:227], v[100:103], a[208:211], v[224:227]
ds_read_b64_tr_b16 v[110:111], v87 offset:9216
v_mfma_f32_16x16x32_bf16 v[228:231], v[100:103], a[212:215], v[228:231]
s_waitcnt lgkmcnt(4)
v_mfma_f32_16x16x32_bf16 v[228:231], v[96:99], a[196:199], v[228:231]
s_barrier
v_mfma_f32_16x16x32_bf16 v[232:235], v[96:99], a[200:203], v[232:235]
s_waitcnt vmcnt(9)
ds_read_b64_tr_b16 v[112:113], v80 offset:16384
ds_read_b128 a[224:227], v120 offset:8192
ds_read_b128 v[48:51], v127 offset:2560
v_mfma_f32_16x16x32_bf16 v[232:235], v[100:103], a[216:219], v[232:235]
ds_read_b64_tr_b16 v[114:115], v80 offset:17408
ds_read_b128 a[228:231], v120 offset:10240
ds_read_b128 v[52:55], v127 offset:2576
v_mfma_f32_16x16x32_bf16 v[236:239], v[100:103], a[220:223], v[236:239]
ds_read_b128 a[232:235], v120 offset:12288
ds_read_b128 a[236:239], v120 offset:14336
v_mfma_f32_16x16x32_bf16 v[236:239], v[96:99], a[204:207], v[236:239]
s_waitcnt lgkmcnt(8)
ds_read_b128 a[240:243], v121 offset:8192
ds_read_b128 a[244:247], v121 offset:10240
v_mfma_f32_16x16x32_bf16 v[252:255], v[104:107], a[204:207], v[252:255]
ds_read_b64_tr_b16 v[116:117], v80 offset:24576
ds_read_b128 a[248:251], v121 offset:12288
v_mfma_f32_16x16x32_bf16 v[252:255], v[108:111], a[220:223], v[252:255]
ds_read_b64_tr_b16 v[118:119], v80 offset:25600
ds_read_b128 a[252:255], v121 offset:14336
v_mfma_f32_16x16x32_bf16 v[248:251], v[108:111], a[216:219], v[248:251]
ds_read_b128 v[56:59], v127 offset:0
ds_read_b128 v[60:63], v127 offset:16
v_mfma_f32_16x16x32_bf16 v[248:251], v[104:107], a[200:203], v[248:251]
ds_read_b128 v[64:67], v127 offset:2816
ds_read_b128 v[68:71], v127 offset:2832
v_mfma_f32_16x16x32_bf16 v[244:247], v[104:107], a[196:199], v[244:247]
ds_read_b64_tr_b16 v[96:97], v81 offset:16384
ds_read_b128 v[72:75], v127 offset:256
v_mfma_f32_16x16x32_bf16 v[244:247], v[108:111], a[212:215], v[244:247]
ds_read_b64_tr_b16 v[98:99], v81 offset:17408
ds_read_b128 v[76:79], v127 offset:272
v_mfma_f32_16x16x32_bf16 v[240:243], v[108:111], a[208:211], v[240:243]
v_mfma_f32_16x16x32_bf16 v[240:243], v[104:107], a[192:195], v[240:243]
s_waitcnt lgkmcnt(9)
v_mfma_f32_16x16x32_bf16 v[140:143], v[112:115], a[236:239], v[140:143]
s_waitcnt lgkmcnt(8)
s_add_u32 m0, s13, 49152
ds_read_b64_tr_b16 v[100:101], v81 offset:24576
v_mfma_f32_16x16x32_bf16 v[140:143], v[116:119], a[252:255], v[140:143]
s_xor_b32 s7, s11, 524288
ds_read_b64_tr_b16 v[102:103], v81 offset:25600
v_mfma_f32_16x16x32_bf16 v[136:139], v[116:119], a[248:251], v[136:139]
buffer_load_dwordx4 v88, s[56:59], s7 offen offset:0  lds
v_mfma_f32_16x16x32_bf16 v[136:139], v[112:115], a[232:235], v[136:139]
s_waitcnt lgkmcnt(9)
v_fma_f32 v24, v24, v48, v56
v_fma_f32 v25, v25, v49, v57
v_mfma_f32_16x16x32_bf16 v[132:135], v[112:115], a[228:231], v[132:135]
ds_read_b64_tr_b16 v[104:105], v82 offset:16384
v_fma_f32 v26, v26, v50, v58
v_mfma_f32_16x16x32_bf16 v[132:135], v[116:119], a[244:247], v[132:135]
ds_read_b64_tr_b16 v[106:107], v82 offset:17408
v_fma_f32 v27, v27, v51, v59
v_mfma_f32_16x16x32_bf16 v[128:131], v[116:119], a[240:243], v[128:131]
buffer_load_dwordx4 v89, s[56:59], s7 offen offset:1024  lds
v_mfma_f32_16x16x32_bf16 v[128:131], v[112:115], a[224:227], v[128:131]
s_waitcnt lgkmcnt(2)
v_fma_f32 v28, v28, v52, v60
v_fma_f32 v29, v29, v53, v61
v_mfma_f32_16x16x32_bf16 v[156:159], v[96:99], a[236:239], v[156:159]
ds_read_b64_tr_b16 v[108:109], v82 offset:24576
v_fma_f32 v30, v30, v54, v62
v_mfma_f32_16x16x32_bf16 v[156:159], v[100:103], a[252:255], v[156:159]
ds_read_b64_tr_b16 v[110:111], v82 offset:25600
v_fma_f32 v31, v31, v55, v63
v_mfma_f32_16x16x32_bf16 v[152:155], v[100:103], a[248:251], v[152:155]
buffer_load_dwordx4 v90, s[56:59], s7 offen offset:2048  lds
v_mfma_f32_16x16x32_bf16 v[152:155], v[96:99], a[232:235], v[152:155]
ds_read_b128 v[48:51], v127 offset:3072
ds_read_b128 v[52:55], v127 offset:3088
v_mfma_f32_16x16x32_bf16 v[148:151], v[96:99], a[228:231], v[148:151]
ds_read_b64_tr_b16 v[112:113], v83 offset:16384
ds_read_b128 v[56:59], v127 offset:512
v_mfma_f32_16x16x32_bf16 v[148:151], v[100:103], a[244:247], v[148:151]
ds_read_b64_tr_b16 v[114:115], v83 offset:17408
ds_read_b128 v[60:63], v127 offset:528
v_mfma_f32_16x16x32_bf16 v[144:147], v[100:103], a[240:243], v[144:147]
buffer_load_dwordx4 v91, s[56:59], s7 offen offset:3072  lds
v_mfma_f32_16x16x32_bf16 v[144:147], v[96:99], a[224:227], v[144:147]
s_waitcnt lgkmcnt(6)
v_cvt_pk_bf16_f32 v4, v24, v25
v_cvt_pk_bf16_f32 v5, v26, v27
v_mfma_f32_16x16x32_bf16 v[172:175], v[104:107], a[236:239], v[172:175]
ds_read_b64_tr_b16 v[116:117], v83 offset:24576
v_cvt_pk_bf16_f32 v6, v28, v29
v_mfma_f32_16x16x32_bf16 v[172:175], v[108:111], a[252:255], v[172:175]
ds_read_b64_tr_b16 v[118:119], v83 offset:25600
v_cvt_pk_bf16_f32 v7, v30, v31
v_mfma_f32_16x16x32_bf16 v[168:171], v[108:111], a[248:251], v[168:171]
s_add_u32 s28, s33, 1048576
buffer_store_dwordx4 v[4:7], v126, s[60:63], s28 offen sc1
v_mfma_f32_16x16x32_bf16 v[168:171], v[104:107], a[232:235], v[168:171]
v_fma_f32 v32, v32, v64, v72
v_fma_f32 v33, v33, v65, v73
v_mfma_f32_16x16x32_bf16 v[164:167], v[104:107], a[228:231], v[164:167]
ds_read_b64_tr_b16 v[96:97], v84 offset:16384
v_fma_f32 v34, v34, v66, v74
v_mfma_f32_16x16x32_bf16 v[164:167], v[108:111], a[244:247], v[164:167]
ds_read_b64_tr_b16 v[98:99], v84 offset:17408
v_fma_f32 v35, v35, v67, v75
v_mfma_f32_16x16x32_bf16 v[160:163], v[108:111], a[240:243], v[160:163]
v_fma_f32 v36, v36, v68, v76
v_fma_f32 v37, v37, v69, v77
v_mfma_f32_16x16x32_bf16 v[160:163], v[104:107], a[224:227], v[160:163]
s_waitcnt lgkmcnt(2)
v_fma_f32 v38, v38, v70, v78
v_fma_f32 v39, v39, v71, v79
v_mfma_f32_16x16x32_bf16 v[188:191], v[112:115], a[236:239], v[188:191]
ds_read_b64_tr_b16 v[100:101], v84 offset:24576
v_cvt_pk_bf16_f32 v8, v32, v33
v_mfma_f32_16x16x32_bf16 v[188:191], v[116:119], a[252:255], v[188:191]
ds_read_b64_tr_b16 v[102:103], v84 offset:25600
v_cvt_pk_bf16_f32 v9, v34, v35
v_mfma_f32_16x16x32_bf16 v[184:187], v[116:119], a[248:251], v[184:187]
v_cvt_pk_bf16_f32 v10, v36, v37
v_cvt_pk_bf16_f32 v11, v38, v39
v_mfma_f32_16x16x32_bf16 v[184:187], v[112:115], a[232:235], v[184:187]
s_add_u32 s28, s33, 1052672
buffer_store_dwordx4 v[8:11], v126, s[60:63], s28 offen sc1
v_mfma_f32_16x16x32_bf16 v[180:183], v[112:115], a[228:231], v[180:183]
ds_read_b64_tr_b16 v[104:105], v85 offset:16384
v_fma_f32 v40, v40, v48, v56
v_mfma_f32_16x16x32_bf16 v[180:183], v[116:119], a[244:247], v[180:183]
ds_read_b64_tr_b16 v[106:107], v85 offset:17408
v_fma_f32 v41, v41, v49, v57
v_mfma_f32_16x16x32_bf16 v[176:179], v[116:119], a[240:243], v[176:179]
v_fma_f32 v42, v42, v50, v58
v_fma_f32 v43, v43, v51, v59
v_mfma_f32_16x16x32_bf16 v[176:179], v[112:115], a[224:227], v[176:179]
s_waitcnt lgkmcnt(2)
v_fma_f32 v44, v44, v52, v60
v_fma_f32 v45, v45, v53, v61
v_mfma_f32_16x16x32_bf16 v[204:207], v[96:99], a[236:239], v[204:207]
ds_read_b64_tr_b16 v[108:109], v85 offset:24576
v_fma_f32 v46, v46, v54, v62
v_mfma_f32_16x16x32_bf16 v[204:207], v[100:103], a[252:255], v[204:207]
ds_read_b64_tr_b16 v[110:111], v85 offset:25600
v_fma_f32 v47, v47, v55, v63
v_mfma_f32_16x16x32_bf16 v[200:203], v[100:103], a[248:251], v[200:203]
v_cvt_pk_bf16_f32 v12, v40, v41
v_cvt_pk_bf16_f32 v13, v42, v43
v_mfma_f32_16x16x32_bf16 v[200:203], v[96:99], a[232:235], v[200:203]
v_cvt_pk_bf16_f32 v14, v44, v45
v_cvt_pk_bf16_f32 v15, v46, v47
v_mfma_f32_16x16x32_bf16 v[196:199], v[96:99], a[228:231], v[196:199]
s_add_u32 s28, s33, 1056768
ds_read_b64_tr_b16 v[112:113], v86 offset:16384
v_mfma_f32_16x16x32_bf16 v[196:199], v[100:103], a[244:247], v[196:199]
ds_read_b64_tr_b16 v[114:115], v86 offset:17408
v_mfma_f32_16x16x32_bf16 v[192:195], v[100:103], a[240:243], v[192:195]
buffer_store_dwordx4 v[12:15], v125, s[60:63], s28 offen sc1
v_mfma_f32_16x16x32_bf16 v[192:195], v[96:99], a[224:227], v[192:195]
s_waitcnt lgkmcnt(2)
v_cvt_pk_bf16_f32 v64, v128, v129
v_cvt_pk_bf16_f32 v65, v130, v131
v_mfma_f32_16x16x32_bf16 v[220:223], v[104:107], a[236:239], v[220:223]
ds_read_b64_tr_b16 v[116:117], v86 offset:24576
v_cvt_pk_bf16_f32 v68, v132, v133
v_mfma_f32_16x16x32_bf16 v[220:223], v[108:111], a[252:255], v[220:223]
ds_read_b64_tr_b16 v[118:119], v86 offset:25600
v_cvt_pk_bf16_f32 v69, v134, v135
v_mfma_f32_16x16x32_bf16 v[216:219], v[108:111], a[248:251], v[216:219]
v_cvt_pk_bf16_f32 v72, v136, v137
v_cvt_pk_bf16_f32 v73, v138, v139
v_mfma_f32_16x16x32_bf16 v[216:219], v[104:107], a[232:235], v[216:219]
v_cvt_pk_bf16_f32 v76, v140, v141
v_cvt_pk_bf16_f32 v77, v142, v143
v_mfma_f32_16x16x32_bf16 v[212:215], v[104:107], a[228:231], v[212:215]
ds_read_b64_tr_b16 v[96:97], v87 offset:16384
v_cvt_pk_bf16_f32 v78, v156, v157
v_mfma_f32_16x16x32_bf16 v[212:215], v[108:111], a[244:247], v[212:215]
ds_read_b64_tr_b16 v[98:99], v87 offset:17408
v_cvt_pk_bf16_f32 v79, v158, v159
v_mfma_f32_16x16x32_bf16 v[208:211], v[108:111], a[240:243], v[208:211]
v_cvt_pk_bf16_f32 v74, v152, v153
v_cvt_pk_bf16_f32 v75, v154, v155
v_mfma_f32_16x16x32_bf16 v[208:211], v[104:107], a[224:227], v[208:211]
s_waitcnt lgkmcnt(2)
v_cvt_pk_bf16_f32 v70, v148, v149
v_cvt_pk_bf16_f32 v71, v150, v151
v_mfma_f32_16x16x32_bf16 v[236:239], v[112:115], a[236:239], v[236:239]
ds_read_b64_tr_b16 v[100:101], v87 offset:24576
v_cvt_pk_bf16_f32 v66, v144, v145
v_mfma_f32_16x16x32_bf16 v[236:239], v[116:119], a[252:255], v[236:239]
ds_read_b64_tr_b16 v[102:103], v87 offset:25600
v_cvt_pk_bf16_f32 v67, v146, v147
v_mfma_f32_16x16x32_bf16 v[232:235], v[116:119], a[248:251], v[232:235]
s_waitcnt vmcnt(12)
v_cvt_pk_bf16_f32 v16, v160, v161
v_cvt_pk_bf16_f32 v17, v162, v163
v_mfma_f32_16x16x32_bf16 v[232:235], v[112:115], a[232:235], v[232:235]
s_barrier
v_cvt_pk_bf16_f32 v20, v164, v165
v_cvt_pk_bf16_f32 v21, v166, v167
v_mfma_f32_16x16x32_bf16 v[228:231], v[112:115], a[228:231], v[228:231]
s_add_u32 m0, s13, 65536
ds_read_b64_tr_b16 v[104:105], v80 offset:32768
v_cvt_pk_bf16_f32 v24, v168, v169
v_mfma_f32_16x16x32_bf16 v[228:231], v[116:119], a[244:247], v[228:231]
s_xor_b32 s7, s11, 1048576
ds_read_b64_tr_b16 v[106:107], v80 offset:33792
v_cvt_pk_bf16_f32 v25, v170, v171
v_mfma_f32_16x16x32_bf16 v[224:227], v[116:119], a[240:243], v[224:227]
buffer_load_dwordx4 v88, s[56:59], s7 offen offset:0  lds
v_cvt_pk_bf16_f32 v28, v172, v173
v_cvt_pk_bf16_f32 v29, v174, v175
v_mfma_f32_16x16x32_bf16 v[224:227], v[112:115], a[224:227], v[224:227]
s_waitcnt lgkmcnt(2)
v_cvt_pk_bf16_f32 v30, v188, v189
v_cvt_pk_bf16_f32 v31, v190, v191
v_mfma_f32_16x16x32_bf16 v[252:255], v[96:99], a[236:239], v[252:255]
ds_read_b64_tr_b16 v[108:109], v80 offset:40960
v_cvt_pk_bf16_f32 v26, v184, v185
v_mfma_f32_16x16x32_bf16 v[252:255], v[100:103], a[252:255], v[252:255]
ds_read_b64_tr_b16 v[110:111], v80 offset:41984
v_cvt_pk_bf16_f32 v27, v186, v187
v_mfma_f32_16x16x32_bf16 v[248:251], v[100:103], a[248:251], v[248:251]
buffer_load_dwordx4 v89, s[56:59], s7 offen offset:1024  lds
v_cvt_pk_bf16_f32 v22, v180, v181
v_cvt_pk_bf16_f32 v23, v182, v183
v_mfma_f32_16x16x32_bf16 v[248:251], v[96:99], a[232:235], v[248:251]
v_cvt_pk_bf16_f32 v18, v176, v177
v_cvt_pk_bf16_f32 v19, v178, v179
v_mfma_f32_16x16x32_bf16 v[244:247], v[96:99], a[228:231], v[244:247]
ds_read_b64_tr_b16 v[112:113], v81 offset:32768
v_cvt_pk_bf16_f32 v32, v192, v193
v_mfma_f32_16x16x32_bf16 v[244:247], v[100:103], a[244:247], v[244:247]
ds_read_b64_tr_b16 v[114:115], v81 offset:33792
v_cvt_pk_bf16_f32 v33, v194, v195
v_mfma_f32_16x16x32_bf16 v[240:243], v[100:103], a[240:243], v[240:243]
v_cvt_pk_bf16_f32 v36, v196, v197
v_cvt_pk_bf16_f32 v37, v198, v199
v_mfma_f32_16x16x32_bf16 v[240:243], v[96:99], a[224:227], v[240:243]
s_waitcnt lgkmcnt(2)
v_cvt_pk_bf16_f32 v40, v200, v201
v_cvt_pk_bf16_f32 v41, v202, v203
v_mfma_f32_16x16x32_bf16 v[128:131], a[0:3], v[104:107], 0
ds_read_b64_tr_b16 v[116:117], v81 offset:40960
buffer_load_dwordx4 v90, s[56:59], s7 offen offset:2048  lds
v_cvt_pk_bf16_f32 v44, v204, v205
v_mfma_f32_16x16x32_bf16 v[128:131], a[16:19], v[108:111], v[128:131]
ds_read_b64_tr_b16 v[118:119], v81 offset:41984
v_cvt_pk_bf16_f32 v45, v206, v207
v_mfma_f32_16x16x32_bf16 v[132:135], a[4:7], v[104:107], 0
v_cvt_pk_bf16_f32 v46, v220, v221
v_cvt_pk_bf16_f32 v47, v222, v223
v_mfma_f32_16x16x32_bf16 v[132:135], a[20:23], v[108:111], v[132:135]
v_cvt_pk_bf16_f32 v42, v216, v217
v_cvt_pk_bf16_f32 v43, v218, v219
v_mfma_f32_16x16x32_bf16 v[136:139], a[8:11], v[104:107], 0
ds_read_b64_tr_b16 v[96:97], v82 offset:32768
v_cvt_pk_bf16_f32 v38, v212, v213
v_mfma_f32_16x16x32_bf16 v[136:139], a[24:27], v[108:111], v[136:139]
ds_read_b64_tr_b16 v[98:99], v82 offset:33792
v_cvt_pk_bf16_f32 v39, v214, v215
v_mfma_f32_16x16x32_bf16 v[140:143], a[12:15], v[104:107], 0
buffer_load_dwordx4 v91, s[56:59], s7 offen offset:3072  lds
v_cvt_pk_bf16_f32 v34, v208, v209
v_cvt_pk_bf16_f32 v35, v210, v211
v_mfma_f32_16x16x32_bf16 v[140:143], a[28:31], v[108:111], v[140:143]
s_waitcnt lgkmcnt(2)
v_cvt_pk_bf16_f32 v48, v224, v225
v_cvt_pk_bf16_f32 v49, v226, v227
v_mfma_f32_16x16x32_bf16 v[156:159], a[12:15], v[112:115], 0
s_add_u32 m0, s13, 81920
ds_read_b64_tr_b16 v[100:101], v82 offset:40960
v_cvt_pk_bf16_f32 v52, v228, v229
v_mfma_f32_16x16x32_bf16 v[156:159], a[28:31], v[116:119], v[156:159]
s_xor_b32 s7, s11, 1572864
ds_read_b64_tr_b16 v[102:103], v82 offset:41984
v_cvt_pk_bf16_f32 v53, v230, v231
v_mfma_f32_16x16x32_bf16 v[152:155], a[8:11], v[112:115], 0
v_cvt_pk_bf16_f32 v56, v232, v233
v_cvt_pk_bf16_f32 v57, v234, v235
v_mfma_f32_16x16x32_bf16 v[152:155], a[24:27], v[116:119], v[152:155]
v_cvt_pk_bf16_f32 v60, v236, v237
v_cvt_pk_bf16_f32 v61, v238, v239
v_mfma_f32_16x16x32_bf16 v[148:151], a[4:7], v[112:115], 0
ds_read_b64_tr_b16 v[104:105], v83 offset:32768
buffer_load_dwordx4 v88, s[56:59], s7 offen offset:0  lds
v_cvt_pk_bf16_f32 v62, v252, v253
v_mfma_f32_16x16x32_bf16 v[148:151], a[20:23], v[116:119], v[148:151]
ds_read_b64_tr_b16 v[106:107], v83 offset:33792
v_cvt_pk_bf16_f32 v63, v254, v255
v_mfma_f32_16x16x32_bf16 v[144:147], a[0:3], v[112:115], 0
v_cvt_pk_bf16_f32 v58, v248, v249
v_cvt_pk_bf16_f32 v59, v250, v251
v_mfma_f32_16x16x32_bf16 v[144:147], a[16:19], v[116:119], v[144:147]
s_waitcnt lgkmcnt(2)
v_cvt_pk_bf16_f32 v54, v244, v245
v_cvt_pk_bf16_f32 v55, v246, v247
v_mfma_f32_16x16x32_bf16 v[160:163], a[0:3], v[96:99], 0
ds_read_b64_tr_b16 v[108:109], v83 offset:40960
v_cvt_pk_bf16_f32 v50, v240, v241
v_mfma_f32_16x16x32_bf16 v[160:163], a[16:19], v[100:103], v[160:163]
ds_read_b64_tr_b16 v[110:111], v83 offset:41984
v_cvt_pk_bf16_f32 v51, v242, v243
v_mfma_f32_16x16x32_bf16 v[164:167], a[4:7], v[96:99], 0
buffer_load_dwordx4 v89, s[56:59], s7 offen offset:1024  lds
v_mfma_f32_16x16x32_bf16 v[164:167], a[20:23], v[100:103], v[164:167]
v_mfma_f32_16x16x32_bf16 v[168:171], a[8:11], v[96:99], 0
ds_read_b64_tr_b16 v[112:113], v84 offset:32768
v_mfma_f32_16x16x32_bf16 v[168:171], a[24:27], v[100:103], v[168:171]
ds_read_b64_tr_b16 v[114:115], v84 offset:33792
v_mfma_f32_16x16x32_bf16 v[172:175], a[12:15], v[96:99], 0
v_mfma_f32_16x16x32_bf16 v[172:175], a[28:31], v[100:103], v[172:175]
s_waitcnt lgkmcnt(2)
v_mfma_f32_16x16x32_bf16 v[188:191], a[12:15], v[104:107], 0
ds_read_b64_tr_b16 v[116:117], v84 offset:40960
buffer_load_dwordx4 v90, s[56:59], s7 offen offset:2048  lds
v_mfma_f32_16x16x32_bf16 v[188:191], a[28:31], v[108:111], v[188:191]
ds_read_b64_tr_b16 v[118:119], v84 offset:41984
v_mfma_f32_16x16x32_bf16 v[184:187], a[8:11], v[104:107], 0
s_lshl_b32 s87, s5, 2
v_lshrrev_b32 v4, 2, v2
v_and_b32 v4, 3, v4
v_mfma_f32_16x16x32_bf16 v[184:187], a[24:27], v[108:111], v[184:187]
s_add_u32 s87, s87, s3
v_lshrrev_b32 v5, 4, v2
v_lshl_add_u32 v4, v5, 3, v4
v_mfma_f32_16x16x32_bf16 v[180:183], a[4:7], v[104:107], 0
s_mul_i32 s86, s87, 32768
ds_read_b64_tr_b16 v[96:97], v85 offset:32768
v_min_u32 v126, 1, v2
v_mfma_f32_16x16x32_bf16 v[180:183], a[20:23], v[108:111], v[180:183]
s_mul_i32 s87, s87, 163840
ds_read_b64_tr_b16 v[98:99], v85 offset:33792
v_lshlrev_b32 v126, 28, v126
v_mfma_f32_16x16x32_bf16 v[176:179], a[0:3], v[104:107], 0
s_lshl_b32 s88, s4, 8
v_mov_b32 v127, 1
v_lshlrev_b32 v4, 7, v4
v_mfma_f32_16x16x32_bf16 v[176:179], a[16:19], v[108:111], v[176:179]
s_waitcnt lgkmcnt(2)
v_and_b32 v6, 3, v2
v_lshl_add_u32 v4, v6, 3, v4
v_mfma_f32_16x16x32_bf16 v[192:195], a[0:3], v[112:115], 0
s_lshr_b32 s28, s2, 4
ds_read_b64_tr_b16 v[100:101], v85 offset:40960
buffer_load_dwordx4 v91, s[56:59], s7 offen offset:3072  lds
v_mfma_f32_16x16x32_bf16 v[192:195], a[16:19], v[116:119], v[192:195]
s_lshl_b32 s28, s28, 7
s_add_u32 m0, s13, 98304
ds_read_b64_tr_b16 v[102:103], v85 offset:41984
v_mfma_f32_16x16x32_bf16 v[196:199], a[4:7], v[112:115], 0
s_add_u32 s28, s28, 393216
s_add_u32 s86, s86, s88
s_xor_b32 s7, s11, 2097152
v_mfma_f32_16x16x32_bf16 v[196:199], a[20:23], v[116:119], v[196:199]
s_cmp_eq_u32 s3, 0
s_cselect_b32 s28, s28, 268435456
v_mfma_f32_16x16x32_bf16 v[200:203], a[8:11], v[112:115], 0
s_lshl_b32 s43, s3, 5
ds_read_b64_tr_b16 v[104:105], v86 offset:32768
v_mfma_f32_16x16x32_bf16 v[200:203], a[24:27], v[116:119], v[200:203]
s_add_u32 s43, s43, 131072
ds_read_b64_tr_b16 v[106:107], v86 offset:33792
v_add_u32 v120, s43, v4
v_mfma_f32_16x16x32_bf16 v[204:207], a[12:15], v[112:115], 0
s_lshl_b32 s43, s3, 9
s_add_u32 s87, s87, s88
v_mfma_f32_16x16x32_bf16 v[204:207], a[28:31], v[116:119], v[204:207]
s_waitcnt lgkmcnt(2)
buffer_load_dwordx4 v88, s[56:59], s7 offen offset:0  lds
v_mfma_f32_16x16x32_bf16 v[220:223], a[12:15], v[96:99], 0
s_add_u32 s43, s43, 151552
ds_read_b64_tr_b16 v[108:109], v86 offset:40960
v_lshl_add_u32 v121, v5, 4, s43
v_mfma_f32_16x16x32_bf16 v[220:223], a[28:31], v[100:103], v[220:223]
s_add_u32 s86, s86, 3145728
ds_read_b64_tr_b16 v[110:111], v86 offset:41984
v_lshl_add_u32 v125, v5, 28, v1
v_mfma_f32_16x16x32_bf16 v[216:219], a[8:11], v[96:99], 0
v_lshrrev_b32 v124, 1, v2
v_lshlrev_b32 v124, 13, v124
v_mfma_f32_16x16x32_bf16 v[216:219], a[24:27], v[100:103], v[216:219]
v_and_b32 v94, 1, v2
v_lshl_add_u32 v124, v94, 7, v124
v_mfma_f32_16x16x32_bf16 v[212:215], a[4:7], v[96:99], 0
ds_read_b64_tr_b16 v[112:113], v87 offset:32768
v_mov_b32 v95, 268435456
v_mfma_f32_16x16x32_bf16 v[212:215], a[20:23], v[100:103], v[212:215]
ds_read_b64_tr_b16 v[114:115], v87 offset:33792
v_cmp_gt_u32 s[88:89], 8, v2
v_mfma_f32_16x16x32_bf16 v[208:211], a[0:3], v[96:99], 0
v_cmp_gt_u32 s[90:91], 40, v2
v_cndmask_b32 v94, v95, v124, s[88:89]
v_mfma_f32_16x16x32_bf16 v[208:211], a[16:19], v[100:103], v[208:211]
s_waitcnt lgkmcnt(2)
buffer_load_dwordx4 v89, s[56:59], s7 offen offset:1024  lds
v_cndmask_b32 v95, v95, v124, s[90:91]
v_mfma_f32_16x16x32_bf16 v[224:227], a[0:3], v[104:107], 0
ds_read_b64_tr_b16 v[116:117], v87 offset:40960
v_mfma_f32_16x16x32_bf16 v[224:227], a[16:19], v[108:111], v[224:227]
ds_read_b64_tr_b16 v[118:119], v87 offset:41984
v_mfma_f32_16x16x32_bf16 v[228:231], a[4:7], v[104:107], 0
s_waitcnt vmcnt(10)
buffer_load_dwordx4 v90, s[56:59], s7 offen offset:2048  lds
v_mfma_f32_16x16x32_bf16 v[228:231], a[20:23], v[108:111], v[228:231]
s_barrier
v_mfma_f32_16x16x32_bf16 v[232:235], a[8:11], v[104:107], 0
ds_read_b64_tr_b16 v[96:97], v80 offset:49152
ds_read_b128 v[4:7], v121 offset:0
v_mfma_f32_16x16x32_bf16 v[232:235], a[24:27], v[108:111], v[232:235]
ds_read_b64_tr_b16 v[98:99], v80 offset:50176
ds_read_b64_tr_b16 v[8:9], v120 offset:0
v_mfma_f32_16x16x32_bf16 v[236:239], a[12:15], v[104:107], 0
buffer_atomic_add v127, v126, s[60:63], s28 offen sc1
v_mfma_f32_16x16x32_bf16 v[236:239], a[28:31], v[108:111], v[236:239]
s_waitcnt lgkmcnt(4)
ds_read_b64_tr_b16 v[10:11], v120 offset:512
v_mfma_f32_16x16x32_bf16 v[252:255], a[12:15], v[112:115], 0
ds_read_b64_tr_b16 v[100:101], v80 offset:57344
v_mfma_f32_16x16x32_bf16 v[252:255], a[28:31], v[116:119], v[252:255]
ds_read_b64_tr_b16 v[102:103], v80 offset:58368
v_add_u32 v80, 65536, v80
v_mfma_f32_16x16x32_bf16 v[248:251], a[8:11], v[112:115], 0
buffer_load_dwordx4 v91, s[56:59], s7 offen offset:3072  lds
v_mfma_f32_16x16x32_bf16 v[248:251], a[24:27], v[116:119], v[248:251]
s_add_u32 m0, s13, 114688
v_mfma_f32_16x16x32_bf16 v[244:247], a[4:7], v[112:115], 0
s_xor_b32 s7, s11, 2621440
ds_read_b64_tr_b16 v[104:105], v81 offset:49152
v_mfma_f32_16x16x32_bf16 v[244:247], a[20:23], v[116:119], v[244:247]
ds_read_b64_tr_b16 v[106:107], v81 offset:50176
buffer_load_dwordx4 v88, s[56:59], s7 offen offset:0  lds
v_mfma_f32_16x16x32_bf16 v[240:243], a[0:3], v[112:115], 0
s_waitcnt lgkmcnt(4)
buffer_load_dword v124, v94, s[56:59], s86 offen
v_mfma_f32_16x16x32_bf16 v[12:15], v[4:7], v[8:11], 0
v_mfma_f32_16x16x32_bf16 v[240:243], a[16:19], v[116:119], v[240:243]
s_waitcnt lgkmcnt(2)
ds_read_b128 v[4:7], v121 offset:64
ds_read_b64_tr_b16 v[8:9], v120 offset:4096
v_mfma_f32_16x16x32_bf16 v[128:131], a[32:35], v[96:99], v[128:131]
ds_read_b64_tr_b16 v[108:109], v81 offset:57344
ds_read_b64_tr_b16 v[10:11], v120 offset:4608
v_mfma_f32_16x16x32_bf16 v[128:131], a[48:51], v[100:103], v[128:131]
ds_read_b64_tr_b16 v[110:111], v81 offset:58368
v_add_u32 v81, 65536, v81
v_mfma_f32_16x16x32_bf16 v[132:135], a[52:55], v[100:103], v[132:135]
buffer_load_dword v124, v95, s[52:55], s87 offen
v_mfma_f32_16x16x32_bf16 v[132:135], a[36:39], v[96:99], v[132:135]
v_mfma_f32_16x16x32_bf16 v[136:139], a[40:43], v[96:99], v[136:139]
ds_read_b64_tr_b16 v[112:113], v82 offset:49152
v_mfma_f32_16x16x32_bf16 v[136:139], a[56:59], v[100:103], v[136:139]
ds_read_b64_tr_b16 v[114:115], v82 offset:50176
v_mfma_f32_16x16x32_bf16 v[140:143], a[60:63], v[100:103], v[140:143]
v_mfma_f32_16x16x32_bf16 v[140:143], a[44:47], v[96:99], v[140:143]
s_waitcnt lgkmcnt(2)
v_mfma_f32_16x16x32_bf16 v[12:15], v[4:7], v[8:11], v[12:15]
v_mfma_f32_16x16x32_bf16 v[156:159], a[44:47], v[104:107], v[156:159]
s_lshl_b32 s6, s5, 2
ds_read_b64_tr_b16 v[116:117], v82 offset:57344
ds_read_b128 v[4:7], v121 offset:128
v_mfma_f32_16x16x32_bf16 v[156:159], a[60:63], v[108:111], v[156:159]
s_sub_u32 s88, s6, s3
ds_read_b64_tr_b16 v[118:119], v82 offset:58368
v_add_u32 v82, 65536, v82
v_mfma_f32_16x16x32_bf16 v[152:155], a[56:59], v[108:111], v[152:155]
s_add_u32 s88, s88, 4
ds_read_b64_tr_b16 v[8:9], v120 offset:8192
ds_read_b64_tr_b16 v[10:11], v120 offset:8704
v_mfma_f32_16x16x32_bf16 v[152:155], a[40:43], v[104:107], v[152:155]
s_sub_u32 s98, 65, s88
v_mfma_f32_16x16x32_bf16 v[148:151], a[36:39], v[104:107], v[148:151]
s_mul_i32 s100, s88, 40960
ds_read_b64_tr_b16 v[96:97], v83 offset:49152
v_mfma_f32_16x16x32_bf16 v[148:151], a[52:55], v[108:111], v[148:151]
s_add_u32 s100, s100, 1007616
ds_read_b64_tr_b16 v[98:99], v83 offset:50176
v_mfma_f32_16x16x32_bf16 v[144:147], a[48:51], v[108:111], v[144:147]
s_mul_i32 s99, s98, 40960
v_and_b32 v123, 1, v2
v_mul_u32_u24 v123, 15, v123
v_mfma_f32_16x16x32_bf16 v[144:147], a[32:35], v[104:107], v[144:147]
s_waitcnt lgkmcnt(4)
v_xor_b32 v123, s5, v123
v_lshlrev_b32 v123, 7, v123
v_mfma_f32_16x16x32_bf16 v[160:163], a[32:35], v[112:115], v[160:163]
s_add_u32 s99, s99, 1007616
s_mov_b32 s29, 268435456
ds_read_b64_tr_b16 v[100:101], v83 offset:57344
v_mfma_f32_16x16x32_bf16 v[160:163], a[48:51], v[116:119], v[160:163]
s_waitcnt lgkmcnt(3)
s_mul_i32 s6, s4, 1148928
ds_read_b64_tr_b16 v[102:103], v83 offset:58368
v_add_u32 v83, 65536, v83
v_mfma_f32_16x16x32_bf16 v[12:15], v[4:7], v[8:11], v[12:15]
v_mfma_f32_16x16x32_bf16 v[164:167], a[52:55], v[116:119], v[164:167]
s_add_u32 s6, s6, 52428800
ds_read_b128 v[4:7], v121 offset:192
ds_read_b64_tr_b16 v[8:9], v120 offset:12288
v_mfma_f32_16x16x32_bf16 v[164:167], a[36:39], v[112:115], v[164:167]
s_add_u32 s48, s46, s6
s_addc_u32 s49, s47, 0
ds_read_b64_tr_b16 v[10:11], v120 offset:12800
v_mfma_f32_16x16x32_bf16 v[168:171], a[40:43], v[112:115], v[168:171]
s_mul_i32 s6, s5, 69632
s_cmp_eq_u32 s3, 0
s_cselect_b32 s39, 16, 0
s_cmov_b32 s29, 393216
ds_read_b64_tr_b16 v[104:105], v84 offset:49152
v_mfma_f32_16x16x32_bf16 v[168:171], a[56:59], v[116:119], v[168:171]
s_sub_u32 s50, 1148928, s6
ds_read_b64_tr_b16 v[106:107], v84 offset:50176
v_mfma_f32_16x16x32_bf16 v[172:175], a[60:63], v[116:119], v[172:175]
s_cmp_lt_u32 s3, 2
s_cselect_b32 s6, 34816, 0
v_mfma_f32_16x16x32_bf16 v[172:175], a[44:47], v[112:115], v[172:175]
s_waitcnt lgkmcnt(5)
v_mfma_f32_16x16x32_bf16 v[188:191], a[44:47], v[96:99], v[188:191]
s_sub_u32 s50, s50, s6
ds_read_b64_tr_b16 v[108:109], v84 offset:57344
v_mfma_f32_16x16x32_bf16 v[188:191], a[60:63], v[100:103], v[188:191]
s_sub_u32 s90, s98, s88
ds_read_b64_tr_b16 v[110:111], v84 offset:58368
v_add_u32 v84, 65536, v84
v_mfma_f32_16x16x32_bf16 v[184:187], a[56:59], v[100:103], v[184:187]
s_waitcnt lgkmcnt(4)
s_mov_b32 s97, 0
v_mfma_f32_16x16x32_bf16 v[12:15], v[4:7], v[8:11], v[12:15]
v_mfma_f32_16x16x32_bf16 v[184:187], a[40:43], v[96:99], v[184:187]
s_sub_u32 s6, s98, 1
ds_read_b128 v[4:7], v121 offset:256
ds_read_b64_tr_b16 v[8:9], v120 offset:16384
v_mfma_f32_16x16x32_bf16 v[180:183], a[36:39], v[96:99], v[180:183]
s_lshr_b32 s91, s6, 1
ds_read_b64_tr_b16 v[112:113], v85 offset:49152
ds_read_b64_tr_b16 v[10:11], v120 offset:16896
v_mfma_f32_16x16x32_bf16 v[180:183], a[52:55], v[100:103], v[180:183]
s_lshl_b32 s91, s91, 19
ds_read_b64_tr_b16 v[114:115], v85 offset:50176
v_mfma_f32_16x16x32_bf16 v[176:179], a[48:51], v[100:103], v[176:179]
s_and_b32 s6, s6, 1
v_mfma_f32_16x16x32_bf16 v[176:179], a[32:35], v[96:99], v[176:179]
s_waitcnt lgkmcnt(5)
v_mfma_f32_16x16x32_bf16 v[192:195], a[32:35], v[104:107], v[192:195]
s_lshl_b32 s6, s6, 11
ds_read_b64_tr_b16 v[116:117], v85 offset:57344
v_mfma_f32_16x16x32_bf16 v[192:195], a[48:51], v[108:111], v[192:195]
s_add_u32 s91, s91, s6
ds_read_b64_tr_b16 v[118:119], v85 offset:58368
v_add_u32 v85, 65536, v85
v_mfma_f32_16x16x32_bf16 v[196:199], a[52:55], v[108:111], v[196:199]
s_lshl_b32 s6, s4, 14
v_mfma_f32_16x16x32_bf16 v[196:199], a[36:39], v[104:107], v[196:199]
s_waitcnt lgkmcnt(3)
s_add_u32 s91, s91, s6
v_mfma_f32_16x16x32_bf16 v[12:15], v[4:7], v[8:11], v[12:15]
v_mfma_f32_16x16x32_bf16 v[200:203], a[40:43], v[104:107], v[200:203]
s_add_u32 s91, s91, 34603008
ds_read_b64_tr_b16 v[96:97], v86 offset:49152
v_mfma_f32_16x16x32_bf16 v[200:203], a[56:59], v[108:111], v[200:203]
s_sub_u32 s6, s88, 1
ds_read_b64_tr_b16 v[98:99], v86 offset:50176
v_mfma_f32_16x16x32_bf16 v[204:207], a[60:63], v[108:111], v[204:207]
s_lshr_b32 s96, s6, 1
v_mfma_f32_16x16x32_bf16 v[204:207], a[44:47], v[104:107], v[204:207]
s_waitcnt lgkmcnt(2)
v_mfma_f32_16x16x32_bf16 v[220:223], a[44:47], v[112:115], v[220:223]
s_lshl_b32 s96, s96, 19
ds_read_b64_tr_b16 v[100:101], v86 offset:57344
v_mfma_f32_16x16x32_bf16 v[220:223], a[60:63], v[116:119], v[220:223]
s_and_b32 s6, s6, 1
ds_read_b64_tr_b16 v[102:103], v86 offset:58368
v_add_u32 v86, 65536, v86
v_mfma_f32_16x16x32_bf16 v[216:219], a[56:59], v[116:119], v[216:219]
s_lshl_b32 s6, s6, 11
v_mfma_f32_16x16x32_bf16 v[216:219], a[40:43], v[112:115], v[216:219]
s_add_u32 s96, s96, s6
v_mfma_f32_16x16x32_bf16 v[212:215], a[36:39], v[112:115], v[212:215]
s_lshl_b32 s6, s4, 14
ds_read_b64_tr_b16 v[104:105], v87 offset:49152
v_mfma_f32_16x16x32_bf16 v[212:215], a[52:55], v[116:119], v[212:215]
s_add_u32 s96, s96, s6
ds_read_b64_tr_b16 v[106:107], v87 offset:50176
v_mfma_f32_16x16x32_bf16 v[208:211], a[48:51], v[116:119], v[208:211]
s_add_u32 s96, s96, 34603008
buffer_store_dword v12, v125, s[60:63], s36 offen sc1
v_mfma_f32_16x16x32_bf16 v[208:211], a[32:35], v[112:115], v[208:211]
s_waitcnt lgkmcnt(2)
v_mfma_f32_16x16x32_bf16 v[224:227], a[32:35], v[96:99], v[224:227]
ds_read_b64_tr_b16 v[108:109], v87 offset:57344
v_mfma_f32_16x16x32_bf16 v[224:227], a[48:51], v[100:103], v[224:227]
ds_read_b64_tr_b16 v[110:111], v87 offset:58368
v_add_u32 v87, 65536, v87
v_mfma_f32_16x16x32_bf16 v[228:231], a[52:55], v[100:103], v[228:231]
s_waitcnt vmcnt(13)
v_mfma_f32_16x16x32_bf16 v[228:231], a[36:39], v[96:99], v[228:231]
s_barrier
v_mfma_f32_16x16x32_bf16 v[232:235], a[40:43], v[96:99], v[232:235]
ds_read_b64_tr_b16 v[112:113], v80 offset:0
v_mfma_f32_16x16x32_bf16 v[232:235], a[56:59], v[100:103], v[232:235]
ds_read_b64_tr_b16 v[114:115], v80 offset:1024
v_mfma_f32_16x16x32_bf16 v[236:239], a[60:63], v[100:103], v[236:239]
v_mfma_f32_16x16x32_bf16 v[236:239], a[44:47], v[96:99], v[236:239]
s_waitcnt lgkmcnt(2)
v_mfma_f32_16x16x32_bf16 v[252:255], a[44:47], v[104:107], v[252:255]
ds_read_b64_tr_b16 v[116:117], v80 offset:8192
v_mfma_f32_16x16x32_bf16 v[252:255], a[60:63], v[108:111], v[252:255]
ds_read_b64_tr_b16 v[118:119], v80 offset:9216
v_mfma_f32_16x16x32_bf16 v[248:251], a[56:59], v[108:111], v[248:251]
v_mfma_f32_16x16x32_bf16 v[248:251], a[40:43], v[104:107], v[248:251]
v_mfma_f32_16x16x32_bf16 v[244:247], a[36:39], v[104:107], v[244:247]
ds_read_b64_tr_b16 v[96:97], v81 offset:0
v_mfma_f32_16x16x32_bf16 v[244:247], a[52:55], v[108:111], v[244:247]
ds_read_b64_tr_b16 v[98:99], v81 offset:1024
v_mfma_f32_16x16x32_bf16 v[240:243], a[48:51], v[108:111], v[240:243]
buffer_load_dwordx4 v89, s[56:59], s7 offen offset:1024  lds
v_mfma_f32_16x16x32_bf16 v[240:243], a[32:35], v[104:107], v[240:243]
s_waitcnt lgkmcnt(2)
v_mfma_f32_16x16x32_bf16 v[128:131], a[64:67], v[112:115], v[128:131]
s_getpc_b64 s[84:85]
L_fr_pcx0:
ds_read_b64_tr_b16 v[100:101], v81 offset:8192
v_mfma_f32_16x16x32_bf16 v[128:131], a[80:83], v[116:119], v[128:131]
s_add_u32 s84, s84, L_fr_goh-L_fr_pcx0
s_addc_u32 s85, s85, 0
ds_read_b64_tr_b16 v[102:103], v81 offset:9216
v_mfma_f32_16x16x32_bf16 v[132:135], a[84:87], v[116:119], v[132:135]
s_lshr_b32 s86, s2, 3
v_mfma_f32_16x16x32_bf16 v[132:135], a[68:71], v[112:115], v[132:135]
s_and_b32 s86, s86, 3
buffer_load_dwordx4 v90, s[56:59], s7 offen offset:2048  lds
v_mfma_f32_16x16x32_bf16 v[136:139], a[72:75], v[112:115], v[136:139]
s_lshl_b32 s86, s86, 13
ds_read_b64_tr_b16 v[104:105], v82 offset:0
v_mfma_f32_16x16x32_bf16 v[136:139], a[88:91], v[116:119], v[136:139]
s_lshr_b32 s87, s13, 1
ds_read_b64_tr_b16 v[106:107], v82 offset:1024
v_mfma_f32_16x16x32_bf16 v[140:143], a[92:95], v[116:119], v[140:143]
s_add_u32 s86, s86, s87
v_and_b32 v125, 15, v2
v_lshl_add_u32 v125, v125, 7, s86
v_mfma_f32_16x16x32_bf16 v[140:143], a[76:79], v[112:115], v[140:143]
s_waitcnt lgkmcnt(2)
global_load_dword v125, v125, s[84:85]
v_mfma_f32_16x16x32_bf16 v[156:159], a[76:79], v[96:99], v[156:159]
ds_read_b64_tr_b16 v[108:109], v82 offset:8192
v_mfma_f32_16x16x32_bf16 v[156:159], a[92:95], v[100:103], v[156:159]
ds_read_b64_tr_b16 v[110:111], v82 offset:9216
v_mfma_f32_16x16x32_bf16 v[152:155], a[88:91], v[100:103], v[152:155]
buffer_load_dwordx4 v91, s[56:59], s7 offen offset:3072  lds
v_mfma_f32_16x16x32_bf16 v[152:155], a[72:75], v[96:99], v[152:155]
s_add_u32 m0, s13, 131072
v_mfma_f32_16x16x32_bf16 v[148:151], a[68:71], v[96:99], v[148:151]
s_xor_b32 s7, s11, 3145728
ds_read_b64_tr_b16 v[112:113], v83 offset:0
v_mfma_f32_16x16x32_bf16 v[148:151], a[84:87], v[100:103], v[148:151]
ds_read_b64_tr_b16 v[114:115], v83 offset:1024
v_mfma_f32_16x16x32_bf16 v[144:147], a[80:83], v[100:103], v[144:147]
buffer_load_dwordx4 v88, s[56:59], s7 offen offset:0  lds
v_mfma_f32_16x16x32_bf16 v[144:147], a[64:67], v[96:99], v[144:147]
s_waitcnt lgkmcnt(2)
v_mfma_f32_16x16x32_bf16 v[160:163], a[64:67], v[104:107], v[160:163]
ds_read_b64_tr_b16 v[116:117], v83 offset:8192
v_mfma_f32_16x16x32_bf16 v[160:163], a[80:83], v[108:111], v[160:163]
ds_read_b64_tr_b16 v[118:119], v83 offset:9216
v_mfma_f32_16x16x32_bf16 v[164:167], a[84:87], v[108:111], v[164:167]
buffer_load_dwordx4 v89, s[56:59], s7 offen offset:1024  lds
v_mfma_f32_16x16x32_bf16 v[164:167], a[68:71], v[104:107], v[164:167]
v_mfma_f32_16x16x32_bf16 v[168:171], a[72:75], v[104:107], v[168:171]
ds_read_b64_tr_b16 v[96:97], v84 offset:0
v_mfma_f32_16x16x32_bf16 v[168:171], a[88:91], v[108:111], v[168:171]
ds_read_b64_tr_b16 v[98:99], v84 offset:1024
v_mfma_f32_16x16x32_bf16 v[172:175], a[92:95], v[108:111], v[172:175]
buffer_load_dword v122, v123, s[60:63], s29 offen sc1
v_mfma_f32_16x16x32_bf16 v[172:175], a[76:79], v[104:107], v[172:175]
s_waitcnt lgkmcnt(2)
v_mfma_f32_16x16x32_bf16 v[188:191], a[76:79], v[112:115], v[188:191]
ds_read_b64_tr_b16 v[100:101], v84 offset:8192
v_mfma_f32_16x16x32_bf16 v[188:191], a[92:95], v[116:119], v[188:191]
ds_read_b64_tr_b16 v[102:103], v84 offset:9216
v_mfma_f32_16x16x32_bf16 v[184:187], a[88:91], v[116:119], v[184:187]
buffer_load_dwordx4 v90, s[56:59], s7 offen offset:2048  lds
v_mfma_f32_16x16x32_bf16 v[184:187], a[72:75], v[112:115], v[184:187]
v_mfma_f32_16x16x32_bf16 v[180:183], a[68:71], v[112:115], v[180:183]
ds_read_b64_tr_b16 v[104:105], v85 offset:0
v_mfma_f32_16x16x32_bf16 v[180:183], a[84:87], v[116:119], v[180:183]
ds_read_b64_tr_b16 v[106:107], v85 offset:1024
v_mfma_f32_16x16x32_bf16 v[176:179], a[80:83], v[116:119], v[176:179]
buffer_load_dwordx4 v91, s[56:59], s7 offen offset:3072  lds
v_mfma_f32_16x16x32_bf16 v[176:179], a[64:67], v[112:115], v[176:179]
s_waitcnt lgkmcnt(2)
v_mfma_f32_16x16x32_bf16 v[192:195], a[64:67], v[96:99], v[192:195]
s_add_u32 m0, s13, 147456
ds_read_b64_tr_b16 v[108:109], v85 offset:8192
v_mfma_f32_16x16x32_bf16 v[192:195], a[80:83], v[100:103], v[192:195]
s_xor_b32 s7, s11, 3670016
ds_read_b64_tr_b16 v[110:111], v85 offset:9216
v_mfma_f32_16x16x32_bf16 v[196:199], a[84:87], v[100:103], v[196:199]
buffer_load_dwordx4 v88, s[56:59], s7 offen offset:0  lds
v_mfma_f32_16x16x32_bf16 v[196:199], a[68:71], v[96:99], v[196:199]
v_mfma_f32_16x16x32_bf16 v[200:203], a[72:75], v[96:99], v[200:203]
ds_read_b64_tr_b16 v[112:113], v86 offset:0
v_mfma_f32_16x16x32_bf16 v[200:203], a[88:91], v[100:103], v[200:203]
ds_read_b64_tr_b16 v[114:115], v86 offset:1024
v_mfma_f32_16x16x32_bf16 v[204:207], a[92:95], v[100:103], v[204:207]
v_mfma_f32_16x16x32_bf16 v[204:207], a[76:79], v[96:99], v[204:207]
s_waitcnt lgkmcnt(2)
v_mfma_f32_16x16x32_bf16 v[220:223], a[76:79], v[104:107], v[220:223]
ds_read_b64_tr_b16 v[116:117], v86 offset:8192
v_mfma_f32_16x16x32_bf16 v[220:223], a[92:95], v[108:111], v[220:223]
ds_read_b64_tr_b16 v[118:119], v86 offset:9216
v_mfma_f32_16x16x32_bf16 v[216:219], a[88:91], v[108:111], v[216:219]
buffer_load_dwordx4 v89, s[56:59], s7 offen offset:1024  lds
v_mfma_f32_16x16x32_bf16 v[216:219], a[72:75], v[104:107], v[216:219]
v_mfma_f32_16x16x32_bf16 v[212:215], a[68:71], v[104:107], v[212:215]
ds_read_b64_tr_b16 v[96:97], v87 offset:0
v_mfma_f32_16x16x32_bf16 v[212:215], a[84:87], v[108:111], v[212:215]
ds_read_b64_tr_b16 v[98:99], v87 offset:1024
v_mfma_f32_16x16x32_bf16 v[208:211], a[80:83], v[108:111], v[208:211]
buffer_load_dwordx4 v90, s[56:59], s7 offen offset:2048  lds
v_mfma_f32_16x16x32_bf16 v[208:211], a[64:67], v[104:107], v[208:211]
s_waitcnt lgkmcnt(2)
v_mfma_f32_16x16x32_bf16 v[224:227], a[64:67], v[112:115], v[224:227]
ds_read_b64_tr_b16 v[100:101], v87 offset:8192
v_mfma_f32_16x16x32_bf16 v[224:227], a[80:83], v[116:119], v[224:227]
s_waitcnt vmcnt(5)
ds_read_b64_tr_b16 v[102:103], v87 offset:9216
v_cmp_gt_u32 vcc, s39, v122
s_nop 1
s_cbranch_vccnz L_fr_spinh
L_fr_goh:
v_mfma_f32_16x16x32_bf16 v[228:231], a[84:87], v[116:119], v[228:231]
buffer_load_dwordx4 v91, s[56:59], s7 offen offset:3072  lds
v_mfma_f32_16x16x32_bf16 v[228:231], a[68:71], v[112:115], v[228:231]
s_add_u32 m0, s13, 0
s_barrier
v_mfma_f32_16x16x32_bf16 v[232:235], a[72:75], v[112:115], v[232:235]
s_add_u32 s7, s15, 0
ds_read_b64_tr_b16 v[104:105], v80 offset:16384
v_mfma_f32_16x16x32_bf16 v[232:235], a[88:91], v[116:119], v[232:235]
ds_read_b64_tr_b16 v[106:107], v80 offset:17408
v_mfma_f32_16x16x32_bf16 v[236:239], a[92:95], v[116:119], v[236:239]
v_mfma_f32_16x16x32_bf16 v[236:239], a[76:79], v[112:115], v[236:239]
s_waitcnt lgkmcnt(2)
buffer_load_dwordx4 v88, s[52:55], s7 offen offset:0  lds
v_mfma_f32_16x16x32_bf16 v[252:255], a[76:79], v[96:99], v[252:255]
ds_read_b64_tr_b16 v[108:109], v80 offset:24576
v_mfma_f32_16x16x32_bf16 v[252:255], a[92:95], v[100:103], v[252:255]
ds_read_b64_tr_b16 v[110:111], v80 offset:25600
v_mfma_f32_16x16x32_bf16 v[248:251], a[88:91], v[100:103], v[248:251]
v_mfma_f32_16x16x32_bf16 v[248:251], a[72:75], v[96:99], v[248:251]
v_mfma_f32_16x16x32_bf16 v[244:247], a[68:71], v[96:99], v[244:247]
ds_read_b64_tr_b16 v[112:113], v81 offset:16384
v_mfma_f32_16x16x32_bf16 v[244:247], a[84:87], v[100:103], v[244:247]
ds_read_b64_tr_b16 v[114:115], v81 offset:17408
v_mfma_f32_16x16x32_bf16 v[240:243], a[80:83], v[100:103], v[240:243]
buffer_load_dwordx4 v89, s[52:55], s7 offen offset:1024  lds
v_mfma_f32_16x16x32_bf16 v[240:243], a[64:67], v[96:99], v[240:243]
s_waitcnt lgkmcnt(2)
v_mfma_f32_16x16x32_bf16 v[128:131], a[96:99], v[104:107], v[128:131]
s_add_u32 s32, s14, 0
ds_read_b64_tr_b16 v[116:117], v81 offset:24576
v_mfma_f32_16x16x32_bf16 v[128:131], a[112:115], v[108:111], v[128:131]
ds_read_b64_tr_b16 v[118:119], v81 offset:25600
v_mfma_f32_16x16x32_bf16 v[132:135], a[116:119], v[108:111], v[132:135]
s_and_b32 s43, s2, 3
buffer_store_dwordx4 v[64:67], v1, s[60:63], s32 offen offset:0 sc1
v_mfma_f32_16x16x32_bf16 v[132:135], a[100:103], v[104:107], v[132:135]
s_lshl_b32 s43, s43, 7
v_mfma_f32_16x16x32_bf16 v[136:139], a[104:107], v[104:107], v[136:139]
s_add_u32 s43, s43, 401920
ds_read_b64_tr_b16 v[96:97], v82 offset:16384
v_mfma_f32_16x16x32_bf16 v[136:139], a[120:123], v[108:111], v[136:139]
s_cmp_eq_u32 s3, 0
s_cselect_b32 s43, s43, 268435456
ds_read_b64_tr_b16 v[98:99], v82 offset:17408
v_mfma_f32_16x16x32_bf16 v[140:143], a[124:127], v[108:111], v[140:143]
v_mfma_f32_16x16x32_bf16 v[140:143], a[108:111], v[104:107], v[140:143]
s_waitcnt lgkmcnt(2)
buffer_load_dwordx4 v90, s[52:55], s7 offen offset:2048  lds
v_mfma_f32_16x16x32_bf16 v[156:159], a[108:111], v[112:115], v[156:159]
ds_read_b64_tr_b16 v[100:101], v82 offset:24576
v_mfma_f32_16x16x32_bf16 v[156:159], a[124:127], v[116:119], v[156:159]
ds_read_b64_tr_b16 v[102:103], v82 offset:25600
v_mfma_f32_16x16x32_bf16 v[152:155], a[120:123], v[116:119], v[152:155]
v_mfma_f32_16x16x32_bf16 v[152:155], a[104:107], v[112:115], v[152:155]
v_mfma_f32_16x16x32_bf16 v[148:151], a[100:103], v[112:115], v[148:151]
ds_read_b64_tr_b16 v[104:105], v83 offset:16384
v_mfma_f32_16x16x32_bf16 v[148:151], a[116:119], v[116:119], v[148:151]
ds_read_b64_tr_b16 v[106:107], v83 offset:17408
v_mfma_f32_16x16x32_bf16 v[144:147], a[112:115], v[116:119], v[144:147]
buffer_load_dwordx4 v91, s[52:55], s7 offen offset:3072  lds
v_mfma_f32_16x16x32_bf16 v[144:147], a[96:99], v[112:115], v[144:147]
s_waitcnt lgkmcnt(2)
v_mfma_f32_16x16x32_bf16 v[160:163], a[96:99], v[96:99], v[160:163]
ds_read_b64_tr_b16 v[108:109], v83 offset:24576
v_mfma_f32_16x16x32_bf16 v[160:163], a[112:115], v[100:103], v[160:163]
s_add_u32 s32, s14, 4096
ds_read_b64_tr_b16 v[110:111], v83 offset:25600
v_mfma_f32_16x16x32_bf16 v[164:167], a[116:119], v[100:103], v[164:167]
buffer_store_dwordx4 v[68:71], v1, s[60:63], s32 offen offset:0 sc1
v_mfma_f32_16x16x32_bf16 v[164:167], a[100:103], v[96:99], v[164:167]
s_add_u32 s8, s99, 0
v_mfma_f32_16x16x32_bf16 v[168:171], a[104:107], v[96:99], v[168:171]
s_add_u32 s9, s100, 0
ds_read_b64_tr_b16 v[112:113], v84 offset:16384
v_mfma_f32_16x16x32_bf16 v[168:171], a[120:123], v[100:103], v[168:171]
ds_read_b64_tr_b16 v[114:115], v84 offset:17408
v_mfma_f32_16x16x32_bf16 v[172:175], a[124:127], v[100:103], v[172:175]
v_mfma_f32_16x16x32_bf16 v[172:175], a[108:111], v[96:99], v[172:175]
s_waitcnt lgkmcnt(2)
buffer_load_dwordx4 a[0:3], v1, s[60:63], s8 offen offset:0 sc1
v_mfma_f32_16x16x32_bf16 v[188:191], a[108:111], v[104:107], v[188:191]
ds_read_b64_tr_b16 v[116:117], v84 offset:24576
v_mfma_f32_16x16x32_bf16 v[188:191], a[124:127], v[108:111], v[188:191]
ds_read_b64_tr_b16 v[118:119], v84 offset:25600
v_mfma_f32_16x16x32_bf16 v[184:187], a[120:123], v[108:111], v[184:187]
v_mfma_f32_16x16x32_bf16 v[184:187], a[104:107], v[104:107], v[184:187]
v_mfma_f32_16x16x32_bf16 v[180:183], a[100:103], v[104:107], v[180:183]
ds_read_b64_tr_b16 v[96:97], v85 offset:16384
v_mfma_f32_16x16x32_bf16 v[180:183], a[116:119], v[108:111], v[180:183]
ds_read_b64_tr_b16 v[98:99], v85 offset:17408
v_mfma_f32_16x16x32_bf16 v[176:179], a[112:115], v[108:111], v[176:179]
buffer_load_dwordx4 a[4:7], v1, s[60:63], s8 offen offset:1024 sc1
v_mfma_f32_16x16x32_bf16 v[176:179], a[96:99], v[104:107], v[176:179]
s_waitcnt lgkmcnt(2)
v_mfma_f32_16x16x32_bf16 v[192:195], a[96:99], v[112:115], v[192:195]
ds_read_b64_tr_b16 v[100:101], v85 offset:24576
v_mfma_f32_16x16x32_bf16 v[192:195], a[112:115], v[116:119], v[192:195]
ds_read_b64_tr_b16 v[102:103], v85 offset:25600
v_mfma_f32_16x16x32_bf16 v[196:199], a[116:119], v[116:119], v[196:199]
buffer_load_dwordx4 a[8:11], v1, s[60:63], s9 offen offset:0 sc1
v_mfma_f32_16x16x32_bf16 v[196:199], a[100:103], v[112:115], v[196:199]
v_mfma_f32_16x16x32_bf16 v[200:203], a[104:107], v[112:115], v[200:203]
ds_read_b64_tr_b16 v[104:105], v86 offset:16384
v_mfma_f32_16x16x32_bf16 v[200:203], a[120:123], v[116:119], v[200:203]
s_add_u32 s32, s14, 17408
ds_read_b64_tr_b16 v[106:107], v86 offset:17408
v_mfma_f32_16x16x32_bf16 v[204:207], a[124:127], v[116:119], v[204:207]
v_mfma_f32_16x16x32_bf16 v[204:207], a[108:111], v[112:115], v[204:207]
s_waitcnt lgkmcnt(2)
buffer_store_dwordx4 v[72:75], v1, s[60:63], s32 offen offset:0 sc1
v_mfma_f32_16x16x32_bf16 v[220:223], a[108:111], v[96:99], v[220:223]
ds_read_b64_tr_b16 v[108:109], v86 offset:24576
v_mfma_f32_16x16x32_bf16 v[220:223], a[124:127], v[100:103], v[220:223]
ds_read_b64_tr_b16 v[110:111], v86 offset:25600
v_mfma_f32_16x16x32_bf16 v[216:219], a[120:123], v[100:103], v[216:219]
v_mfma_f32_16x16x32_bf16 v[216:219], a[104:107], v[96:99], v[216:219]
v_mfma_f32_16x16x32_bf16 v[212:215], a[100:103], v[96:99], v[212:215]
ds_read_b64_tr_b16 v[112:113], v87 offset:16384
v_mfma_f32_16x16x32_bf16 v[212:215], a[116:119], v[100:103], v[212:215]
ds_read_b64_tr_b16 v[114:115], v87 offset:17408
v_mfma_f32_16x16x32_bf16 v[208:211], a[112:115], v[100:103], v[208:211]
buffer_load_dwordx4 a[12:15], v1, s[60:63], s9 offen offset:1024 sc1
v_mfma_f32_16x16x32_bf16 v[208:211], a[96:99], v[96:99], v[208:211]
s_waitcnt lgkmcnt(2)
v_mfma_f32_16x16x32_bf16 v[224:227], a[96:99], v[104:107], v[224:227]
ds_read_b64_tr_b16 v[116:117], v87 offset:24576
v_mfma_f32_16x16x32_bf16 v[224:227], a[112:115], v[108:111], v[224:227]
ds_read_b64_tr_b16 v[118:119], v87 offset:25600
v_mfma_f32_16x16x32_bf16 v[228:231], a[116:119], v[108:111], v[228:231]
buffer_load_dwordx4 a[16:19], v1, s[60:63], s8 offen offset:2048 sc1
v_mfma_f32_16x16x32_bf16 v[228:231], a[100:103], v[104:107], v[228:231]
s_barrier
v_mfma_f32_16x16x32_bf16 v[232:235], a[104:107], v[104:107], v[232:235]
ds_read_b64_tr_b16 v[96:97], v80 offset:32768
v_mfma_f32_16x16x32_bf16 v[232:235], a[120:123], v[108:111], v[232:235]
s_add_u32 s32, s14, 21504
ds_read_b64_tr_b16 v[98:99], v80 offset:33792
v_mfma_f32_16x16x32_bf16 v[236:239], a[124:127], v[108:111], v[236:239]
buffer_atomic_add v127, v126, s[60:63], s43 offen sc1
v_mfma_f32_16x16x32_bf16 v[236:239], a[108:111], v[104:107], v[236:239]
s_waitcnt lgkmcnt(2)
buffer_store_dwordx4 v[76:79], v1, s[60:63], s32 offen offset:0 sc1
v_mfma_f32_16x16x32_bf16 v[252:255], a[108:111], v[112:115], v[252:255]
ds_read_b64_tr_b16 v[100:101], v80 offset:40960
v_mfma_f32_16x16x32_bf16 v[252:255], a[124:127], v[116:119], v[252:255]
ds_read_b64_tr_b16 v[102:103], v80 offset:41984
v_mfma_f32_16x16x32_bf16 v[248:251], a[120:123], v[116:119], v[248:251]
v_mfma_f32_16x16x32_bf16 v[248:251], a[104:107], v[112:115], v[248:251]
v_mfma_f32_16x16x32_bf16 v[244:247], a[100:103], v[112:115], v[244:247]
ds_read_b64_tr_b16 v[104:105], v81 offset:32768
v_mfma_f32_16x16x32_bf16 v[244:247], a[116:119], v[116:119], v[244:247]
ds_read_b64_tr_b16 v[106:107], v81 offset:33792
v_mfma_f32_16x16x32_bf16 v[240:243], a[112:115], v[116:119], v[240:243]
buffer_load_dwordx4 a[20:23], v1, s[60:63], s8 offen offset:3072 sc1
v_mfma_f32_16x16x32_bf16 v[240:243], a[96:99], v[112:115], v[240:243]
s_waitcnt lgkmcnt(2)
v_mfma_f32_16x16x32_bf16 v[128:131], a[128:131], v[96:99], v[128:131]
ds_read_b64_tr_b16 v[108:109], v81 offset:40960
v_mfma_f32_16x16x32_bf16 v[128:131], a[144:147], v[100:103], v[128:131]
ds_read_b64_tr_b16 v[110:111], v81 offset:41984
v_mfma_f32_16x16x32_bf16 v[132:135], a[148:151], v[100:103], v[132:135]
buffer_load_dwordx4 a[24:27], v1, s[60:63], s9 offen offset:2048 sc1
v_mfma_f32_16x16x32_bf16 v[132:135], a[132:135], v[96:99], v[132:135]
v_mfma_f32_16x16x32_bf16 v[136:139], a[136:139], v[96:99], v[136:139]
ds_read_b64_tr_b16 v[112:113], v82 offset:32768
v_mfma_f32_16x16x32_bf16 v[136:139], a[152:155], v[100:103], v[136:139]
ds_read_b64_tr_b16 v[114:115], v82 offset:33792
v_mfma_f32_16x16x32_bf16 v[140:143], a[156:159], v[100:103], v[140:143]
s_add_u32 s32, s14, 0
v_mfma_f32_16x16x32_bf16 v[140:143], a[140:143], v[96:99], v[140:143]
s_waitcnt lgkmcnt(2)
buffer_store_dwordx4 v[16:19], v1, s[60:63], s32 offen offset:1024 sc1
v_mfma_f32_16x16x32_bf16 v[156:159], a[140:143], v[104:107], v[156:159]
ds_read_b64_tr_b16 v[116:117], v82 offset:40960
v_mfma_f32_16x16x32_bf16 v[156:159], a[156:159], v[108:111], v[156:159]
ds_read_b64_tr_b16 v[118:119], v82 offset:41984
v_mfma_f32_16x16x32_bf16 v[152:155], a[152:155], v[108:111], v[152:155]
v_mfma_f32_16x16x32_bf16 v[152:155], a[136:139], v[104:107], v[152:155]
v_mfma_f32_16x16x32_bf16 v[148:151], a[132:135], v[104:107], v[148:151]
ds_read_b64_tr_b16 v[96:97], v83 offset:32768
v_mfma_f32_16x16x32_bf16 v[148:151], a[148:151], v[108:111], v[148:151]
ds_read_b64_tr_b16 v[98:99], v83 offset:33792
v_mfma_f32_16x16x32_bf16 v[144:147], a[144:147], v[108:111], v[144:147]
s_sub_u32 s33, s2, 96
buffer_load_dwordx4 a[28:31], v1, s[60:63], s9 offen offset:3072 sc1
v_mfma_f32_16x16x32_bf16 v[144:147], a[128:131], v[104:107], v[144:147]
s_waitcnt lgkmcnt(2)
s_add_u32 m0, s13, 16384
s_add_u32 s7, s15, 524288
v_mfma_f32_16x16x32_bf16 v[160:163], a[128:131], v[112:115], v[160:163]
s_lshl_b32 s29, s2, 31
ds_read_b64_tr_b16 v[100:101], v83 offset:40960
v_mfma_f32_16x16x32_bf16 v[160:163], a[144:147], v[116:119], v[160:163]
s_lshr_b32 s33, s33, 1
ds_read_b64_tr_b16 v[102:103], v83 offset:41984
v_mfma_f32_16x16x32_bf16 v[164:167], a[148:151], v[116:119], v[164:167]
s_or_b32 s33, s33, s29
buffer_load_dwordx4 v88, s[52:55], s7 offen offset:0  lds
v_mfma_f32_16x16x32_bf16 v[164:167], a[132:135], v[112:115], v[164:167]
s_lshl_b32 s29, s3, 4
v_mfma_f32_16x16x32_bf16 v[168:171], a[136:139], v[112:115], v[168:171]
s_or_b32 s29, s29, s33
ds_read_b64_tr_b16 v[104:105], v84 offset:32768
v_and_b32 v123, 3, v2
v_mfma_f32_16x16x32_bf16 v[168:171], a[152:155], v[116:119], v[168:171]
ds_read_b64_tr_b16 v[106:107], v84 offset:33792
v_lshlrev_b32 v123, 7, v123
v_mfma_f32_16x16x32_bf16 v[172:175], a[156:159], v[116:119], v[172:175]
s_cmp_lt_u32 s29, 10
s_cselect_b32 s39, 64, 0
s_cselect_b32 s29, 0, 268435456
v_mfma_f32_16x16x32_bf16 v[172:175], a[140:143], v[112:115], v[172:175]
s_waitcnt lgkmcnt(2)
buffer_load_dwordx4 v89, s[52:55], s7 offen offset:1024  lds
v_mfma_f32_16x16x32_bf16 v[188:191], a[140:143], v[96:99], v[188:191]
s_add_u32 s29, s29, 401920
ds_read_b64_tr_b16 v[108:109], v84 offset:40960
v_mfma_f32_16x16x32_bf16 v[188:191], a[156:159], v[100:103], v[188:191]
ds_read_b64_tr_b16 v[110:111], v84 offset:41984
v_mfma_f32_16x16x32_bf16 v[184:187], a[152:155], v[100:103], v[184:187]
s_add_u32 s32, s14, 4096
v_mfma_f32_16x16x32_bf16 v[184:187], a[136:139], v[96:99], v[184:187]
v_mfma_f32_16x16x32_bf16 v[180:183], a[132:135], v[96:99], v[180:183]
ds_read_b64_tr_b16 v[112:113], v85 offset:32768
v_mfma_f32_16x16x32_bf16 v[180:183], a[148:151], v[100:103], v[180:183]
ds_read_b64_tr_b16 v[114:115], v85 offset:33792
v_mfma_f32_16x16x32_bf16 v[176:179], a[144:147], v[100:103], v[176:179]
buffer_store_dwordx4 v[20:23], v1, s[60:63], s32 offen offset:1024 sc1
v_mfma_f32_16x16x32_bf16 v[176:179], a[128:131], v[96:99], v[176:179]
s_waitcnt lgkmcnt(2)
v_mfma_f32_16x16x32_bf16 v[192:195], a[128:131], v[104:107], v[192:195]
ds_read_b64_tr_b16 v[116:117], v85 offset:40960
v_mfma_f32_16x16x32_bf16 v[192:195], a[144:147], v[108:111], v[192:195]
ds_read_b64_tr_b16 v[118:119], v85 offset:41984
v_mfma_f32_16x16x32_bf16 v[196:199], a[148:151], v[108:111], v[196:199]
buffer_load_dwordx4 v90, s[52:55], s7 offen offset:2048  lds
v_mfma_f32_16x16x32_bf16 v[196:199], a[132:135], v[104:107], v[196:199]
v_mfma_f32_16x16x32_bf16 v[200:203], a[136:139], v[104:107], v[200:203]
ds_read_b64_tr_b16 v[96:97], v86 offset:32768
v_mfma_f32_16x16x32_bf16 v[200:203], a[152:155], v[108:111], v[200:203]
ds_read_b64_tr_b16 v[98:99], v86 offset:33792
v_mfma_f32_16x16x32_bf16 v[204:207], a[156:159], v[108:111], v[204:207]
v_mfma_f32_16x16x32_bf16 v[204:207], a[140:143], v[104:107], v[204:207]
s_waitcnt lgkmcnt(2)
buffer_load_dwordx4 v91, s[52:55], s7 offen offset:3072  lds
v_mfma_f32_16x16x32_bf16 v[220:223], a[140:143], v[112:115], v[220:223]
ds_read_b64_tr_b16 v[100:101], v86 offset:40960
v_mfma_f32_16x16x32_bf16 v[220:223], a[156:159], v[116:119], v[220:223]
ds_read_b64_tr_b16 v[102:103], v86 offset:41984
v_mfma_f32_16x16x32_bf16 v[216:219], a[152:155], v[116:119], v[216:219]
s_add_u32 s32, s14, 17408
v_mfma_f32_16x16x32_bf16 v[216:219], a[136:139], v[112:115], v[216:219]
v_mfma_f32_16x16x32_bf16 v[212:215], a[132:135], v[112:115], v[212:215]
ds_read_b64_tr_b16 v[104:105], v87 offset:32768
v_mfma_f32_16x16x32_bf16 v[212:215], a[148:151], v[116:119], v[212:215]
s_add_u32 s8, s99, 4096
ds_read_b64_tr_b16 v[106:107], v87 offset:33792
v_mfma_f32_16x16x32_bf16 v[208:211], a[144:147], v[116:119], v[208:211]
buffer_store_dwordx4 v[24:27], v1, s[60:63], s32 offen offset:1024 sc1
v_mfma_f32_16x16x32_bf16 v[208:211], a[128:131], v[112:115], v[208:211]
s_waitcnt lgkmcnt(2)
v_mfma_f32_16x16x32_bf16 v[224:227], a[128:131], v[96:99], v[224:227]
s_add_u32 s9, s100, 4096
ds_read_b64_tr_b16 v[108:109], v87 offset:40960
v_mfma_f32_16x16x32_bf16 v[224:227], a[144:147], v[100:103], v[224:227]
ds_read_b64_tr_b16 v[110:111], v87 offset:41984
v_mfma_f32_16x16x32_bf16 v[228:231], a[148:151], v[100:103], v[228:231]
buffer_load_dwordx4 a[32:35], v1, s[60:63], s8 offen offset:0 sc1
v_mfma_f32_16x16x32_bf16 v[228:231], a[132:135], v[96:99], v[228:231]
s_barrier
v_mfma_f32_16x16x32_bf16 v[232:235], a[136:139], v[96:99], v[232:235]
ds_read_b64_tr_b16 v[112:113], v80 offset:49152
v_mfma_f32_16x16x32_bf16 v[232:235], a[152:155], v[100:103], v[232:235]
ds_read_b64_tr_b16 v[114:115], v80 offset:50176
v_mfma_f32_16x16x32_bf16 v[236:239], a[156:159], v[100:103], v[236:239]
v_mfma_f32_16x16x32_bf16 v[236:239], a[140:143], v[96:99], v[236:239]
s_waitcnt lgkmcnt(2)
buffer_load_dwordx4 a[36:39], v1, s[60:63], s8 offen offset:1024 sc1
v_mfma_f32_16x16x32_bf16 v[252:255], a[140:143], v[104:107], v[252:255]
ds_read_b64_tr_b16 v[116:117], v80 offset:57344
v_mfma_f32_16x16x32_bf16 v[252:255], a[156:159], v[108:111], v[252:255]
ds_read_b64_tr_b16 v[118:119], v80 offset:58368
v_add_u32 v80, 65536, v80
v_mfma_f32_16x16x32_bf16 v[248:251], a[152:155], v[108:111], v[248:251]
buffer_load_dword v122, v123, s[60:63], s29 offen sc1
v_mfma_f32_16x16x32_bf16 v[248:251], a[136:139], v[104:107], v[248:251]
s_add_u32 s32, s14, 21504
v_mfma_f32_16x16x32_bf16 v[244:247], a[132:135], v[104:107], v[244:247]
ds_read_b64_tr_b16 v[96:97], v81 offset:49152
v_mfma_f32_16x16x32_bf16 v[244:247], a[148:151], v[108:111], v[244:247]
ds_read_b64_tr_b16 v[98:99], v81 offset:50176
v_mfma_f32_16x16x32_bf16 v[240:243], a[144:147], v[108:111], v[240:243]
buffer_store_dwordx4 v[28:31], v1, s[60:63], s32 offen offset:1024 sc1
v_mfma_f32_16x16x32_bf16 v[240:243], a[128:131], v[104:107], v[240:243]
s_waitcnt lgkmcnt(2)
v_mfma_f32_16x16x32_bf16 v[128:131], a[160:163], v[112:115], v[128:131]
ds_read_b64_tr_b16 v[100:101], v81 offset:57344
v_mfma_f32_16x16x32_bf16 v[128:131], a[176:179], v[116:119], v[128:131]
ds_read_b64_tr_b16 v[102:103], v81 offset:58368
v_add_u32 v81, 65536, v81
v_mfma_f32_16x16x32_bf16 v[132:135], a[180:183], v[116:119], v[132:135]
buffer_load_dwordx4 a[40:43], v1, s[60:63], s9 offen offset:0 sc1
v_mfma_f32_16x16x32_bf16 v[132:135], a[164:167], v[112:115], v[132:135]
v_mfma_f32_16x16x32_bf16 v[136:139], a[168:171], v[112:115], v[136:139]
ds_read_b64_tr_b16 v[104:105], v82 offset:49152
v_mfma_f32_16x16x32_bf16 v[136:139], a[184:187], v[116:119], v[136:139]
ds_read_b64_tr_b16 v[106:107], v82 offset:50176
v_mfma_f32_16x16x32_bf16 v[140:143], a[188:191], v[116:119], v[140:143]
v_mfma_f32_16x16x32_bf16 v[140:143], a[172:175], v[112:115], v[140:143]
s_waitcnt lgkmcnt(2)
buffer_load_dwordx4 a[44:47], v1, s[60:63], s9 offen offset:1024 sc1
v_mfma_f32_16x16x32_bf16 v[156:159], a[172:175], v[96:99], v[156:159]
ds_read_b64_tr_b16 v[108:109], v82 offset:57344
v_mfma_f32_16x16x32_bf16 v[156:159], a[188:191], v[100:103], v[156:159]
ds_read_b64_tr_b16 v[110:111], v82 offset:58368
v_add_u32 v82, 65536, v82
v_mfma_f32_16x16x32_bf16 v[152:155], a[184:187], v[100:103], v[152:155]
v_mfma_f32_16x16x32_bf16 v[152:155], a[168:171], v[96:99], v[152:155]
v_mfma_f32_16x16x32_bf16 v[148:151], a[164:167], v[96:99], v[148:151]
s_add_u32 s32, s14, 0
ds_read_b64_tr_b16 v[112:113], v83 offset:49152
v_mfma_f32_16x16x32_bf16 v[148:151], a[180:183], v[100:103], v[148:151]
ds_read_b64_tr_b16 v[114:115], v83 offset:50176
v_mfma_f32_16x16x32_bf16 v[144:147], a[176:179], v[100:103], v[144:147]
buffer_store_dwordx4 v[32:35], v1, s[60:63], s32 offen offset:2048 sc1
v_mfma_f32_16x16x32_bf16 v[144:147], a[160:163], v[96:99], v[144:147]
s_waitcnt lgkmcnt(2)
v_mfma_f32_16x16x32_bf16 v[160:163], a[160:163], v[104:107], v[160:163]
ds_read_b64_tr_b16 v[116:117], v83 offset:57344
v_mfma_f32_16x16x32_bf16 v[160:163], a[176:179], v[108:111], v[160:163]
ds_read_b64_tr_b16 v[118:119], v83 offset:58368
v_add_u32 v83, 65536, v83
v_mfma_f32_16x16x32_bf16 v[164:167], a[180:183], v[108:111], v[164:167]
buffer_load_dwordx4 a[48:51], v1, s[60:63], s8 offen offset:2048 sc1
v_mfma_f32_16x16x32_bf16 v[164:167], a[164:167], v[104:107], v[164:167]
v_mfma_f32_16x16x32_bf16 v[168:171], a[168:171], v[104:107], v[168:171]
ds_read_b64_tr_b16 v[96:97], v84 offset:49152
v_mfma_f32_16x16x32_bf16 v[168:171], a[184:187], v[108:111], v[168:171]
ds_read_b64_tr_b16 v[98:99], v84 offset:50176
v_mfma_f32_16x16x32_bf16 v[172:175], a[188:191], v[108:111], v[172:175]
buffer_load_dwordx4 a[52:55], v1, s[60:63], s8 offen offset:3072 sc1
v_mfma_f32_16x16x32_bf16 v[172:175], a[172:175], v[104:107], v[172:175]
s_waitcnt lgkmcnt(2)
v_mfma_f32_16x16x32_bf16 v[188:191], a[172:175], v[112:115], v[188:191]
ds_read_b64_tr_b16 v[100:101], v84 offset:57344
v_mfma_f32_16x16x32_bf16 v[188:191], a[188:191], v[116:119], v[188:191]
ds_read_b64_tr_b16 v[102:103], v84 offset:58368
v_add_u32 v84, 65536, v84
v_mfma_f32_16x16x32_bf16 v[184:187], a[184:187], v[116:119], v[184:187]
v_mfma_f32_16x16x32_bf16 v[184:187], a[168:171], v[112:115], v[184:187]
v_mfma_f32_16x16x32_bf16 v[180:183], a[164:167], v[112:115], v[180:183]
ds_read_b64_tr_b16 v[104:105], v85 offset:49152
v_mfma_f32_16x16x32_bf16 v[180:183], a[180:183], v[116:119], v[180:183]
ds_read_b64_tr_b16 v[106:107], v85 offset:50176
v_mfma_f32_16x16x32_bf16 v[176:179], a[176:179], v[116:119], v[176:179]
buffer_load_dwordx4 a[56:59], v1, s[60:63], s9 offen offset:2048 sc1
v_mfma_f32_16x16x32_bf16 v[176:179], a[160:163], v[112:115], v[176:179]
s_waitcnt lgkmcnt(2)
v_mfma_f32_16x16x32_bf16 v[192:195], a[160:163], v[96:99], v[192:195]
s_add_u32 s32, s14, 4096
ds_read_b64_tr_b16 v[108:109], v85 offset:57344
v_mfma_f32_16x16x32_bf16 v[192:195], a[176:179], v[100:103], v[192:195]
ds_read_b64_tr_b16 v[110:111], v85 offset:58368
v_add_u32 v85, 65536, v85
v_mfma_f32_16x16x32_bf16 v[196:199], a[180:183], v[100:103], v[196:199]
buffer_store_dwordx4 v[36:39], v1, s[60:63], s32 offen offset:2048 sc1
v_mfma_f32_16x16x32_bf16 v[196:199], a[164:167], v[96:99], v[196:199]
v_mfma_f32_16x16x32_bf16 v[200:203], a[168:171], v[96:99], v[200:203]
ds_read_b64_tr_b16 v[112:113], v86 offset:49152
v_mfma_f32_16x16x32_bf16 v[200:203], a[184:187], v[100:103], v[200:203]
ds_read_b64_tr_b16 v[114:115], v86 offset:50176
v_mfma_f32_16x16x32_bf16 v[204:207], a[188:191], v[100:103], v[204:207]
buffer_load_dwordx4 a[60:63], v1, s[60:63], s9 offen offset:3072 sc1
v_mfma_f32_16x16x32_bf16 v[204:207], a[172:175], v[96:99], v[204:207]
s_waitcnt lgkmcnt(2)
v_mfma_f32_16x16x32_bf16 v[220:223], a[172:175], v[104:107], v[220:223]
s_add_u32 m0, s13, 32768
ds_read_b64_tr_b16 v[116:117], v86 offset:57344
v_mfma_f32_16x16x32_bf16 v[220:223], a[188:191], v[108:111], v[220:223]
s_add_u32 s7, s15, 1048576
ds_read_b64_tr_b16 v[118:119], v86 offset:58368
v_add_u32 v86, 65536, v86
v_mfma_f32_16x16x32_bf16 v[216:219], a[184:187], v[108:111], v[216:219]
v_mfma_f32_16x16x32_bf16 v[216:219], a[168:171], v[104:107], v[216:219]
v_mfma_f32_16x16x32_bf16 v[212:215], a[164:167], v[104:107], v[212:215]
ds_read_b64_tr_b16 v[96:97], v87 offset:49152
v_mfma_f32_16x16x32_bf16 v[212:215], a[180:183], v[108:111], v[212:215]
ds_read_b64_tr_b16 v[98:99], v87 offset:50176
v_mfma_f32_16x16x32_bf16 v[208:211], a[176:179], v[108:111], v[208:211]
buffer_load_dwordx4 v88, s[52:55], s7 offen offset:0  lds
v_mfma_f32_16x16x32_bf16 v[208:211], a[160:163], v[104:107], v[208:211]
s_waitcnt lgkmcnt(2)
v_mfma_f32_16x16x32_bf16 v[224:227], a[160:163], v[112:115], v[224:227]
s_add_u32 s32, s14, 17408
ds_read_b64_tr_b16 v[100:101], v87 offset:57344
v_mfma_f32_16x16x32_bf16 v[224:227], a[176:179], v[116:119], v[224:227]
ds_read_b64_tr_b16 v[102:103], v87 offset:58368
v_add_u32 v87, 65536, v87
s_cmp_lg_u32 s39, 0
s_cbranch_scc1 L_fr_chkf
L_fr_gof:
v_mfma_f32_16x16x32_bf16 v[228:231], a[180:183], v[116:119], v[228:231]
s_waitcnt vmcnt(41)
buffer_store_dwordx4 v[40:43], v1, s[60:63], s32 offen offset:2048 sc1
v_mfma_f32_16x16x32_bf16 v[228:231], a[164:167], v[112:115], v[228:231]
s_barrier
v_mfma_f32_16x16x32_bf16 v[232:235], a[168:171], v[112:115], v[232:235]
s_lshl_b32 s6, s33, 2
ds_read_b64_tr_b16 v[104:105], v80 offset:0
v_mfma_f32_16x16x32_bf16 v[232:235], a[184:187], v[116:119], v[232:235]
s_add_u32 s6, s6, s3
ds_read_b64_tr_b16 v[106:107], v80 offset:1024
v_mfma_f32_16x16x32_bf16 v[236:239], a[188:191], v[116:119], v[236:239]
s_sub_u32 s6, s6, 20
buffer_load_dwordx4 v89, s[52:55], s7 offen offset:1024  lds
v_mfma_f32_16x16x32_bf16 v[236:239], a[172:175], v[112:115], v[236:239]
s_waitcnt lgkmcnt(2)
v_mfma_f32_16x16x32_bf16 v[252:255], a[172:175], v[96:99], v[252:255]
s_cmp_lt_u32 s6, 10
s_cselect_b32 s28, 1.0, 0
ds_read_b64_tr_b16 v[108:109], v80 offset:8192
v_mfma_f32_16x16x32_bf16 v[252:255], a[188:191], v[100:103], v[252:255]
s_lshl_b32 s29, s33, 12
ds_read_b64_tr_b16 v[110:111], v80 offset:9216
v_mfma_f32_16x16x32_bf16 v[248:251], a[184:187], v[100:103], v[248:251]
s_add_u32 s29, s29, 282624
v_mfma_f32_16x16x32_bf16 v[248:251], a[168:171], v[96:99], v[248:251]
s_cmp_lt_u32 s33, 10
s_cselect_b32 s29, s29, 268435456
v_lshlrev_b32 v123, 4, v0
v_mfma_f32_16x16x32_bf16 v[244:247], a[164:167], v[96:99], v[244:247]
ds_read_b64_tr_b16 v[112:113], v81 offset:0
v_mfma_f32_16x16x32_bf16 v[244:247], a[180:183], v[100:103], v[244:247]
ds_read_b64_tr_b16 v[114:115], v81 offset:1024
v_mfma_f32_16x16x32_bf16 v[240:243], a[176:179], v[100:103], v[240:243]
buffer_load_dwordx4 v[4:7], v123, s[60:63], s29 offen sc1
v_mfma_f32_16x16x32_bf16 v[240:243], a[160:163], v[96:99], v[240:243]
s_waitcnt lgkmcnt(2)
buffer_load_dwordx4 v90, s[52:55], s7 offen offset:2048  lds
v_mfma_f32_16x16x32_bf16 v[128:131], a[192:195], v[104:107], v[128:131]
ds_read_b64_tr_b16 v[116:117], v81 offset:8192
v_mfma_f32_16x16x32_bf16 v[128:131], a[208:211], v[108:111], v[128:131]
s_add_u32 s32, s14, 21504
ds_read_b64_tr_b16 v[118:119], v81 offset:9216
v_mfma_f32_16x16x32_bf16 v[132:135], a[212:215], v[108:111], v[132:135]
buffer_store_dwordx4 v[44:47], v1, s[60:63], s32 offen offset:2048 sc1
v_mfma_f32_16x16x32_bf16 v[132:135], a[196:199], v[104:107], v[132:135]
v_mfma_f32_16x16x32_bf16 v[136:139], a[200:203], v[104:107], v[136:139]
ds_read_b64_tr_b16 v[96:97], v82 offset:0
v_mfma_f32_16x16x32_bf16 v[136:139], a[216:219], v[108:111], v[136:139]
ds_read_b64_tr_b16 v[98:99], v82 offset:1024
v_mfma_f32_16x16x32_bf16 v[140:143], a[220:223], v[108:111], v[140:143]
buffer_load_dwordx4 v91, s[52:55], s7 offen offset:3072  lds
v_mfma_f32_16x16x32_bf16 v[140:143], a[204:207], v[104:107], v[140:143]
s_waitcnt lgkmcnt(2)
v_mfma_f32_16x16x32_bf16 v[156:159], a[204:207], v[112:115], v[156:159]
s_add_u32 s8, s99, 8192
ds_read_b64_tr_b16 v[100:101], v82 offset:8192
v_mfma_f32_16x16x32_bf16 v[156:159], a[220:223], v[116:119], v[156:159]
s_add_u32 s9, s100, 8192
ds_read_b64_tr_b16 v[102:103], v82 offset:9216
v_mfma_f32_16x16x32_bf16 v[152:155], a[216:219], v[116:119], v[152:155]
v_mfma_f32_16x16x32_bf16 v[152:155], a[200:203], v[112:115], v[152:155]
buffer_load_dwordx4 a[64:67], v1, s[60:63], s8 offen offset:0 sc1
v_mfma_f32_16x16x32_bf16 v[148:151], a[196:199], v[112:115], v[148:151]
ds_read_b64_tr_b16 v[104:105], v83 offset:0
v_mfma_f32_16x16x32_bf16 v[148:151], a[212:215], v[116:119], v[148:151]
ds_read_b64_tr_b16 v[106:107], v83 offset:1024
v_mfma_f32_16x16x32_bf16 v[144:147], a[208:211], v[116:119], v[144:147]
v_mfma_f32_16x16x32_bf16 v[144:147], a[192:195], v[112:115], v[144:147]
s_waitcnt lgkmcnt(2)
v_mfma_f32_16x16x32_bf16 v[160:163], a[192:195], v[96:99], v[160:163]
ds_read_b64_tr_b16 v[108:109], v83 offset:8192
v_mfma_f32_16x16x32_bf16 v[160:163], a[208:211], v[100:103], v[160:163]
ds_read_b64_tr_b16 v[110:111], v83 offset:9216
v_mfma_f32_16x16x32_bf16 v[164:167], a[212:215], v[100:103], v[164:167]
buffer_load_dwordx4 a[68:71], v1, s[60:63], s8 offen offset:1024 sc1
v_mfma_f32_16x16x32_bf16 v[164:167], a[196:199], v[96:99], v[164:167]
v_mfma_f32_16x16x32_bf16 v[168:171], a[200:203], v[96:99], v[168:171]
s_add_u32 s32, s14, 0
ds_read_b64_tr_b16 v[112:113], v84 offset:0
v_mfma_f32_16x16x32_bf16 v[168:171], a[216:219], v[100:103], v[168:171]
ds_read_b64_tr_b16 v[114:115], v84 offset:1024
v_mfma_f32_16x16x32_bf16 v[172:175], a[220:223], v[100:103], v[172:175]
buffer_store_dwordx4 v[48:51], v1, s[60:63], s32 offen offset:3072 sc1
v_mfma_f32_16x16x32_bf16 v[172:175], a[204:207], v[96:99], v[172:175]
s_waitcnt lgkmcnt(2)
v_mfma_f32_16x16x32_bf16 v[188:191], a[204:207], v[104:107], v[188:191]
ds_read_b64_tr_b16 v[116:117], v84 offset:8192
v_mfma_f32_16x16x32_bf16 v[188:191], a[220:223], v[108:111], v[188:191]
ds_read_b64_tr_b16 v[118:119], v84 offset:9216
v_mfma_f32_16x16x32_bf16 v[184:187], a[216:219], v[108:111], v[184:187]
v_mfma_f32_16x16x32_bf16 v[184:187], a[200:203], v[104:107], v[184:187]
buffer_load_dwordx4 a[72:75], v1, s[60:63], s9 offen offset:0 sc1
v_mfma_f32_16x16x32_bf16 v[180:183], a[196:199], v[104:107], v[180:183]
ds_read_b64_tr_b16 v[96:97], v85 offset:0
v_mfma_f32_16x16x32_bf16 v[180:183], a[212:215], v[108:111], v[180:183]
ds_read_b64_tr_b16 v[98:99], v85 offset:1024
v_mfma_f32_16x16x32_bf16 v[176:179], a[208:211], v[108:111], v[176:179]
v_mfma_f32_16x16x32_bf16 v[176:179], a[192:195], v[104:107], v[176:179]
s_waitcnt lgkmcnt(2)
v_mfma_f32_16x16x32_bf16 v[192:195], a[192:195], v[112:115], v[192:195]
ds_read_b64_tr_b16 v[100:101], v85 offset:8192
v_mfma_f32_16x16x32_bf16 v[192:195], a[208:211], v[116:119], v[192:195]
ds_read_b64_tr_b16 v[102:103], v85 offset:9216
v_mfma_f32_16x16x32_bf16 v[196:199], a[212:215], v[116:119], v[196:199]
buffer_load_dwordx4 a[76:79], v1, s[60:63], s9 offen offset:1024 sc1
v_mfma_f32_16x16x32_bf16 v[196:199], a[196:199], v[112:115], v[196:199]
v_mfma_f32_16x16x32_bf16 v[200:203], a[200:203], v[112:115], v[200:203]
s_add_u32 s32, s14, 4096
ds_read_b64_tr_b16 v[104:105], v86 offset:0
v_mfma_f32_16x16x32_bf16 v[200:203], a[216:219], v[116:119], v[200:203]
ds_read_b64_tr_b16 v[106:107], v86 offset:1024
v_mfma_f32_16x16x32_bf16 v[204:207], a[220:223], v[116:119], v[204:207]
buffer_store_dwordx4 v[52:55], v1, s[60:63], s32 offen offset:3072 sc1
v_mfma_f32_16x16x32_bf16 v[204:207], a[204:207], v[112:115], v[204:207]
s_waitcnt lgkmcnt(2)
v_mfma_f32_16x16x32_bf16 v[220:223], a[204:207], v[96:99], v[220:223]
ds_read_b64_tr_b16 v[108:109], v86 offset:8192
v_mfma_f32_16x16x32_bf16 v[220:223], a[220:223], v[100:103], v[220:223]
ds_read_b64_tr_b16 v[110:111], v86 offset:9216
v_mfma_f32_16x16x32_bf16 v[216:219], a[216:219], v[100:103], v[216:219]
v_mfma_f32_16x16x32_bf16 v[216:219], a[200:203], v[96:99], v[216:219]
buffer_load_dwordx4 a[80:83], v1, s[60:63], s8 offen offset:2048 sc1
v_mfma_f32_16x16x32_bf16 v[212:215], a[196:199], v[96:99], v[212:215]
ds_read_b64_tr_b16 v[112:113], v87 offset:0
v_mfma_f32_16x16x32_bf16 v[212:215], a[212:215], v[100:103], v[212:215]
ds_read_b64_tr_b16 v[114:115], v87 offset:1024
v_mfma_f32_16x16x32_bf16 v[208:211], a[208:211], v[100:103], v[208:211]
v_mfma_f32_16x16x32_bf16 v[208:211], a[192:195], v[96:99], v[208:211]
s_waitcnt lgkmcnt(2)
v_mfma_f32_16x16x32_bf16 v[224:227], a[192:195], v[104:107], v[224:227]
ds_read_b64_tr_b16 v[116:117], v87 offset:8192
v_mfma_f32_16x16x32_bf16 v[224:227], a[208:211], v[108:111], v[224:227]
ds_read_b64_tr_b16 v[118:119], v87 offset:9216
v_mfma_f32_16x16x32_bf16 v[228:231], a[212:215], v[108:111], v[228:231]
s_waitcnt vmcnt(50)
buffer_load_dwordx4 a[84:87], v1, s[60:63], s8 offen offset:3072 sc1
v_mfma_f32_16x16x32_bf16 v[228:231], a[196:199], v[104:107], v[228:231]
s_barrier
v_mfma_f32_16x16x32_bf16 v[232:235], a[200:203], v[104:107], v[232:235]
ds_read_b64_tr_b16 v[96:97], v80 offset:16384
v_mfma_f32_16x16x32_bf16 v[232:235], a[216:219], v[108:111], v[232:235]
ds_read_b64_tr_b16 v[98:99], v80 offset:17408
v_mfma_f32_16x16x32_bf16 v[236:239], a[220:223], v[108:111], v[236:239]
s_add_u32 s32, s14, 17408
v_mfma_f32_16x16x32_bf16 v[236:239], a[204:207], v[104:107], v[236:239]
s_waitcnt lgkmcnt(2)
buffer_store_dwordx4 v[56:59], v1, s[60:63], s32 offen offset:3072 sc1
v_mfma_f32_16x16x32_bf16 v[252:255], a[204:207], v[112:115], v[252:255]
ds_read_b64_tr_b16 v[100:101], v80 offset:24576
v_mfma_f32_16x16x32_bf16 v[252:255], a[220:223], v[116:119], v[252:255]
ds_read_b64_tr_b16 v[102:103], v80 offset:25600
v_add_u32 v80, 4294836224, v80
v_mfma_f32_16x16x32_bf16 v[248:251], a[216:219], v[116:119], v[248:251]
v_mfma_f32_16x16x32_bf16 v[248:251], a[200:203], v[112:115], v[248:251]
buffer_load_dwordx4 a[88:91], v1, s[60:63], s9 offen offset:2048 sc1
v_mfma_f32_16x16x32_bf16 v[244:247], a[196:199], v[112:115], v[244:247]
ds_read_b64_tr_b16 v[104:105], v81 offset:16384
v_mfma_f32_16x16x32_bf16 v[244:247], a[212:215], v[116:119], v[244:247]
ds_read_b64_tr_b16 v[106:107], v81 offset:17408
v_mfma_f32_16x16x32_bf16 v[240:243], a[208:211], v[116:119], v[240:243]
v_mfma_f32_16x16x32_bf16 v[240:243], a[192:195], v[112:115], v[240:243]
s_waitcnt lgkmcnt(2)
v_mfma_f32_16x16x32_bf16 v[140:143], a[236:239], v[96:99], v[140:143]
ds_read_b64_tr_b16 v[108:109], v81 offset:24576
v_mfma_f32_16x16x32_bf16 v[140:143], a[252:255], v[100:103], v[140:143]
ds_read_b64_tr_b16 v[110:111], v81 offset:25600
v_add_u32 v81, 4294836224, v81
v_mfma_f32_16x16x32_bf16 v[136:139], a[248:251], v[100:103], v[136:139]
s_add_u32 m0, s13, 49152
buffer_load_dwordx4 a[92:95], v1, s[60:63], s9 offen offset:3072 sc1
v_mfma_f32_16x16x32_bf16 v[136:139], a[232:235], v[96:99], v[136:139]
s_add_u32 s7, s15, 1572864
v_mfma_f32_16x16x32_bf16 v[132:135], a[228:231], v[96:99], v[132:135]
ds_read_b64_tr_b16 v[112:113], v82 offset:16384
v_mfma_f32_16x16x32_bf16 v[132:135], a[244:247], v[100:103], v[132:135]
ds_read_b64_tr_b16 v[114:115], v82 offset:17408
v_mfma_f32_16x16x32_bf16 v[128:131], a[240:243], v[100:103], v[128:131]
buffer_load_dwordx4 v88, s[52:55], s7 offen offset:0  lds
v_mfma_f32_16x16x32_bf16 v[128:131], a[224:227], v[96:99], v[128:131]
s_waitcnt lgkmcnt(2)
v_mfma_f32_16x16x32_bf16 v[156:159], a[236:239], v[104:107], v[156:159]
ds_read_b64_tr_b16 v[116:117], v82 offset:24576
v_mfma_f32_16x16x32_bf16 v[156:159], a[252:255], v[108:111], v[156:159]
s_add_u32 s32, s14, 21504
ds_read_b64_tr_b16 v[118:119], v82 offset:25600
v_add_u32 v82, 4294836224, v82
v_mfma_f32_16x16x32_bf16 v[152:155], a[248:251], v[108:111], v[152:155]
s_lshl_b32 s29, s33, 10
v_mfma_f32_16x16x32_bf16 v[152:155], a[232:235], v[104:107], v[152:155]
s_add_u32 s29, s29, 5120
buffer_store_dwordx4 v[60:63], v1, s[60:63], s32 offen offset:3072 sc1
v_mfma_f32_16x16x32_bf16 v[148:151], a[228:231], v[104:107], v[148:151]
s_cmp_lt_u32 s33, 10
s_cselect_b32 s29, s29, 268435456
ds_read_b64_tr_b16 v[96:97], v83 offset:16384
v_mfma_f32_16x16x32_bf16 v[148:151], a[244:247], v[108:111], v[148:151]
ds_read_b64_tr_b16 v[98:99], v83 offset:17408
v_lshlrev_b32 v123, 2, v0
v_mfma_f32_16x16x32_bf16 v[144:147], a[240:243], v[108:111], v[144:147]
s_waitcnt vmcnt(16)
v_add_f32 v4, v4, v5
v_add_f32 v6, v6, v7
v_mfma_f32_16x16x32_bf16 v[144:147], a[224:227], v[104:107], v[144:147]
s_waitcnt lgkmcnt(2)
v_add_f32 v4, v4, v6
v_cvt_pk_bf16_f32 v4, v4, v4
v_mfma_f32_16x16x32_bf16 v[172:175], a[236:239], v[112:115], v[172:175]
ds_read_b64_tr_b16 v[100:101], v83 offset:24576
v_lshlrev_b32 v4, 16, v4
v_mfma_f32_16x16x32_bf16 v[172:175], a[252:255], v[116:119], v[172:175]
ds_read_b64_tr_b16 v[102:103], v83 offset:25600
v_add_u32 v83, 4294836224, v83
v_mfma_f32_16x16x32_bf16 v[168:171], a[248:251], v[116:119], v[168:171]
v_add_f32 v4, s28, v4
v_cvt_pk_bf16_f32 v4, v4, v4
v_mfma_f32_16x16x32_bf16 v[168:171], a[232:235], v[112:115], v[168:171]
buffer_load_dwordx4 v89, s[52:55], s7 offen offset:1024  lds
v_lshlrev_b32 v4, 16, v4
v_mfma_f32_16x16x32_bf16 v[164:167], a[228:231], v[112:115], v[164:167]
ds_read_b64_tr_b16 v[104:105], v84 offset:16384
v_mfma_f32_16x16x32_bf16 v[164:167], a[244:247], v[116:119], v[164:167]
ds_read_b64_tr_b16 v[106:107], v84 offset:17408
v_mfma_f32_16x16x32_bf16 v[160:163], a[240:243], v[116:119], v[160:163]
buffer_store_dword v4, v123, s[60:63], s29 offen sc1
v_mfma_f32_16x16x32_bf16 v[160:163], a[224:227], v[112:115], v[160:163]
s_waitcnt lgkmcnt(2)
buffer_load_dwordx4 v90, s[52:55], s7 offen offset:2048  lds
v_mfma_f32_16x16x32_bf16 v[188:191], a[236:239], v[96:99], v[188:191]
ds_read_b64_tr_b16 v[108:109], v84 offset:24576
v_mfma_f32_16x16x32_bf16 v[188:191], a[252:255], v[100:103], v[188:191]
ds_read_b64_tr_b16 v[110:111], v84 offset:25600
v_add_u32 v84, 4294836224, v84
v_mfma_f32_16x16x32_bf16 v[184:187], a[248:251], v[100:103], v[184:187]
v_mfma_f32_16x16x32_bf16 v[184:187], a[232:235], v[96:99], v[184:187]
buffer_load_dwordx4 v91, s[52:55], s7 offen offset:3072  lds
v_mfma_f32_16x16x32_bf16 v[180:183], a[228:231], v[96:99], v[180:183]
s_add_u32 s8, s99, 12288
ds_read_b64_tr_b16 v[112:113], v85 offset:16384
v_mfma_f32_16x16x32_bf16 v[180:183], a[244:247], v[100:103], v[180:183]
s_add_u32 s9, s100, 12288
ds_read_b64_tr_b16 v[114:115], v85 offset:17408
v_mfma_f32_16x16x32_bf16 v[176:179], a[240:243], v[100:103], v[176:179]
v_mfma_f32_16x16x32_bf16 v[176:179], a[224:227], v[96:99], v[176:179]
s_waitcnt lgkmcnt(2)
v_mfma_f32_16x16x32_bf16 v[204:207], a[236:239], v[104:107], v[204:207]
ds_read_b64_tr_b16 v[116:117], v85 offset:24576
buffer_load_dwordx4 a[96:99], v1, s[60:63], s8 offen offset:0 sc1
v_mfma_f32_16x16x32_bf16 v[204:207], a[252:255], v[108:111], v[204:207]
ds_read_b64_tr_b16 v[118:119], v85 offset:25600
v_add_u32 v85, 4294836224, v85
v_mfma_f32_16x16x32_bf16 v[200:203], a[248:251], v[108:111], v[200:203]
v_cvt_pk_bf16_f32 v20, v136, v137
v_cvt_pk_bf16_f32 v21, v138, v139
v_mfma_f32_16x16x32_bf16 v[200:203], a[232:235], v[104:107], v[200:203]
v_cvt_pk_bf16_f32 v22, v140, v141
v_cvt_pk_bf16_f32 v23, v142, v143
v_mfma_f32_16x16x32_bf16 v[196:199], a[228:231], v[104:107], v[196:199]
ds_read_b64_tr_b16 v[96:97], v86 offset:16384
v_cvt_pk_bf16_f32 v16, v128, v129
v_mfma_f32_16x16x32_bf16 v[196:199], a[244:247], v[108:111], v[196:199]
ds_read_b64_tr_b16 v[98:99], v86 offset:17408
v_cvt_pk_bf16_f32 v17, v130, v131
v_mfma_f32_16x16x32_bf16 v[192:195], a[240:243], v[108:111], v[192:195]
buffer_load_dwordx4 a[100:103], v1, s[60:63], s8 offen offset:1024 sc1
v_cvt_pk_bf16_f32 v18, v132, v133
v_cvt_pk_bf16_f32 v19, v134, v135
v_mfma_f32_16x16x32_bf16 v[192:195], a[224:227], v[104:107], v[192:195]
s_waitcnt lgkmcnt(2)
v_cvt_pk_bf16_f32 v28, v152, v153
v_cvt_pk_bf16_f32 v29, v154, v155
v_mfma_f32_16x16x32_bf16 v[220:223], a[236:239], v[112:115], v[220:223]
ds_read_b64_tr_b16 v[100:101], v86 offset:24576
v_cvt_pk_bf16_f32 v30, v156, v157
v_mfma_f32_16x16x32_bf16 v[220:223], a[252:255], v[116:119], v[220:223]
ds_read_b64_tr_b16 v[102:103], v86 offset:25600
v_add_u32 v86, 4294836224, v86
v_mfma_f32_16x16x32_bf16 v[216:219], a[248:251], v[116:119], v[216:219]
v_cvt_pk_bf16_f32 v31, v158, v159
v_cvt_pk_bf16_f32 v24, v144, v145
v_mfma_f32_16x16x32_bf16 v[216:219], a[232:235], v[112:115], v[216:219]
buffer_load_dwordx4 a[104:107], v1, s[60:63], s9 offen offset:0 sc1
v_cvt_pk_bf16_f32 v25, v146, v147
v_cvt_pk_bf16_f32 v26, v148, v149
v_mfma_f32_16x16x32_bf16 v[212:215], a[228:231], v[112:115], v[212:215]
ds_read_b64_tr_b16 v[104:105], v87 offset:16384
v_cvt_pk_bf16_f32 v27, v150, v151
v_mfma_f32_16x16x32_bf16 v[212:215], a[244:247], v[116:119], v[212:215]
ds_read_b64_tr_b16 v[106:107], v87 offset:17408
v_cvt_pk_bf16_f32 v36, v168, v169
v_mfma_f32_16x16x32_bf16 v[208:211], a[240:243], v[116:119], v[208:211]
v_cvt_pk_bf16_f32 v37, v170, v171
v_cvt_pk_bf16_f32 v38, v172, v173
v_mfma_f32_16x16x32_bf16 v[208:211], a[224:227], v[112:115], v[208:211]
s_waitcnt lgkmcnt(2)
v_cvt_pk_bf16_f32 v39, v174, v175
v_cvt_pk_bf16_f32 v32, v160, v161
v_mfma_f32_16x16x32_bf16 v[236:239], a[236:239], v[96:99], v[236:239]
ds_read_b64_tr_b16 v[108:109], v87 offset:24576
buffer_load_dwordx4 a[108:111], v1, s[60:63], s9 offen offset:1024 sc1
v_cvt_pk_bf16_f32 v33, v162, v163
v_mfma_f32_16x16x32_bf16 v[236:239], a[252:255], v[100:103], v[236:239]
ds_read_b64_tr_b16 v[110:111], v87 offset:25600
v_add_u32 v87, 4294836224, v87
v_mfma_f32_16x16x32_bf16 v[232:235], a[248:251], v[100:103], v[232:235]
v_cvt_pk_bf16_f32 v34, v164, v165
v_cvt_pk_bf16_f32 v35, v166, v167
v_mfma_f32_16x16x32_bf16 v[232:235], a[232:235], v[96:99], v[232:235]
s_barrier
v_cvt_pk_bf16_f32 v44, v184, v185
v_cvt_pk_bf16_f32 v45, v186, v187
v_mfma_f32_16x16x32_bf16 v[228:231], a[228:231], v[96:99], v[228:231]
ds_read_b64_tr_b16 v[112:113], v80 offset:0
v_cvt_pk_bf16_f32 v46, v188, v189
v_mfma_f32_16x16x32_bf16 v[228:231], a[244:247], v[100:103], v[228:231]
ds_read_b64_tr_b16 v[114:115], v80 offset:1024
buffer_load_dwordx4 a[112:115], v1, s[60:63], s8 offen offset:2048 sc1
v_cvt_pk_bf16_f32 v47, v190, v191
v_mfma_f32_16x16x32_bf16 v[224:227], a[240:243], v[100:103], v[224:227]
v_cvt_pk_bf16_f32 v40, v176, v177
v_cvt_pk_bf16_f32 v41, v178, v179
v_mfma_f32_16x16x32_bf16 v[224:227], a[224:227], v[96:99], v[224:227]
s_waitcnt lgkmcnt(2)
v_cvt_pk_bf16_f32 v42, v180, v181
v_cvt_pk_bf16_f32 v43, v182, v183
v_mfma_f32_16x16x32_bf16 v[252:255], a[236:239], v[104:107], v[252:255]
ds_read_b64_tr_b16 v[116:117], v80 offset:8192
v_cvt_pk_bf16_f32 v52, v200, v201
v_mfma_f32_16x16x32_bf16 v[252:255], a[252:255], v[108:111], v[252:255]
ds_read_b64_tr_b16 v[118:119], v80 offset:9216
v_cvt_pk_bf16_f32 v53, v202, v203
v_mfma_f32_16x16x32_bf16 v[248:251], a[248:251], v[108:111], v[248:251]
v_cvt_pk_bf16_f32 v54, v204, v205
v_cvt_pk_bf16_f32 v55, v206, v207
v_mfma_f32_16x16x32_bf16 v[248:251], a[232:235], v[104:107], v[248:251]
buffer_load_dwordx4 a[116:119], v1, s[60:63], s8 offen offset:3072 sc1
v_cvt_pk_bf16_f32 v48, v192, v193
v_cvt_pk_bf16_f32 v49, v194, v195
v_mfma_f32_16x16x32_bf16 v[244:247], a[228:231], v[104:107], v[244:247]
ds_read_b64_tr_b16 v[96:97], v81 offset:0
v_cvt_pk_bf16_f32 v50, v196, v197
v_mfma_f32_16x16x32_bf16 v[244:247], a[244:247], v[108:111], v[244:247]
ds_read_b64_tr_b16 v[98:99], v81 offset:1024
v_cvt_pk_bf16_f32 v51, v198, v199
v_mfma_f32_16x16x32_bf16 v[240:243], a[240:243], v[108:111], v[240:243]
v_cvt_pk_bf16_f32 v60, v216, v217
v_cvt_pk_bf16_f32 v61, v218, v219
v_mfma_f32_16x16x32_bf16 v[240:243], a[224:227], v[104:107], v[240:243]
s_waitcnt lgkmcnt(2)
v_cvt_pk_bf16_f32 v62, v220, v221
v_cvt_pk_bf16_f32 v63, v222, v223
v_mfma_f32_16x16x32_bf16 v[128:131], v[112:115], a[0:3], 0
ds_read_b64_tr_b16 v[100:101], v81 offset:8192
buffer_load_dwordx4 a[120:123], v1, s[60:63], s9 offen offset:2048 sc1
v_cvt_pk_bf16_f32 v56, v208, v209
v_mfma_f32_16x16x32_bf16 v[128:131], v[116:119], a[16:19], v[128:131]
ds_read_b64_tr_b16 v[102:103], v81 offset:9216
v_cvt_pk_bf16_f32 v57, v210, v211
v_mfma_f32_16x16x32_bf16 v[132:135], v[112:115], a[4:7], 0
s_lshl_b32 s10, s2, 2
v_cvt_pk_bf16_f32 v58, v212, v213
v_cvt_pk_bf16_f32 v59, v214, v215
v_mfma_f32_16x16x32_bf16 v[132:135], v[116:119], a[20:23], v[132:135]
s_add_u32 s32, s14, 43008
v_cvt_pk_bf16_f32 v68, v232, v233
v_cvt_pk_bf16_f32 v69, v234, v235
v_mfma_f32_16x16x32_bf16 v[136:139], v[112:115], a[8:11], 0
s_add_u32 s10, s10, s3
ds_read_b64_tr_b16 v[104:105], v82 offset:0
v_cvt_pk_bf16_f32 v70, v236, v237
v_mfma_f32_16x16x32_bf16 v[136:139], v[116:119], a[24:27], v[136:139]
ds_read_b64_tr_b16 v[106:107], v82 offset:1024
buffer_store_dwordx4 v[16:19], v1, s[60:63], s32 offen offset:0 sc1
v_cvt_pk_bf16_f32 v71, v238, v239
v_mfma_f32_16x16x32_bf16 v[140:143], v[112:115], a[12:15], 0
s_sub_u32 s10, s10, 384
v_cvt_pk_bf16_f32 v64, v224, v225
v_cvt_pk_bf16_f32 v65, v226, v227
v_mfma_f32_16x16x32_bf16 v[140:143], v[116:119], a[28:31], v[140:143]
s_waitcnt lgkmcnt(2)
v_cvt_pk_bf16_f32 v66, v228, v229
v_cvt_pk_bf16_f32 v67, v230, v231
v_mfma_f32_16x16x32_bf16 v[156:159], v[96:99], a[12:15], 0
s_max_i32 s10, s10, 0
ds_read_b64_tr_b16 v[108:109], v82 offset:8192
v_cvt_pk_bf16_f32 v76, v248, v249
v_mfma_f32_16x16x32_bf16 v[156:159], v[100:103], a[28:31], v[156:159]
s_mul_hi_u32 s36, s10, 429496730
ds_read_b64_tr_b16 v[110:111], v82 offset:9216
v_cvt_pk_bf16_f32 v77, v250, v251
v_mfma_f32_16x16x32_bf16 v[152:155], v[96:99], a[8:11], 0
s_mul_i32 s37, s36, 10
v_cvt_pk_bf16_f32 v78, v252, v253
v_cvt_pk_bf16_f32 v79, v254, v255
v_mfma_f32_16x16x32_bf16 v[152:155], v[100:103], a[24:27], v[152:155]
s_sub_u32 s37, s10, s37
v_cvt_pk_bf16_f32 v72, v240, v241
v_cvt_pk_bf16_f32 v73, v242, v243
v_mfma_f32_16x16x32_bf16 v[148:151], v[96:99], a[4:7], 0
s_add_u32 m0, s13, 65536
ds_read_b64_tr_b16 v[112:113], v83 offset:0
v_cvt_pk_bf16_f32 v74, v244, v245
v_mfma_f32_16x16x32_bf16 v[148:151], v[100:103], a[20:23], v[148:151]
s_add_u32 s7, s15, 2097152
ds_read_b64_tr_b16 v[114:115], v83 offset:1024
v_cvt_pk_bf16_f32 v75, v246, v247
v_mfma_f32_16x16x32_bf16 v[144:147], v[96:99], a[0:3], 0
s_mul_i32 s44, s36, 40960
buffer_load_dwordx4 a[124:127], v1, s[60:63], s9 offen offset:3072 sc1
v_mfma_f32_16x16x32_bf16 v[144:147], v[100:103], a[16:19], v[144:147]
s_waitcnt lgkmcnt(2)
v_mfma_f32_16x16x32_bf16 v[160:163], v[104:107], a[0:3], 0
s_lshl_b32 s28, s37, 7
ds_read_b64_tr_b16 v[116:117], v83 offset:8192
v_mfma_f32_16x16x32_bf16 v[160:163], v[108:111], a[16:19], v[160:163]
s_add_u32 s44, s44, s28
ds_read_b64_tr_b16 v[118:119], v83 offset:9216
v_mfma_f32_16x16x32_bf16 v[164:167], v[104:107], a[4:7], 0
buffer_load_dwordx4 v88, s[52:55], s7 offen offset:0  lds
v_mfma_f32_16x16x32_bf16 v[164:167], v[108:111], a[20:23], v[164:167]
s_add_u32 s32, s14, 60416
v_mfma_f32_16x16x32_bf16 v[168:171], v[104:107], a[8:11], 0
s_add_u32 s56, s26, s44
s_addc_u32 s57, s27, 0
ds_read_b64_tr_b16 v[96:97], v84 offset:0
v_mfma_f32_16x16x32_bf16 v[168:171], v[108:111], a[24:27], v[168:171]
s_mov_b32 s58, 39808
ds_read_b64_tr_b16 v[98:99], v84 offset:1024
v_mfma_f32_16x16x32_bf16 v[172:175], v[104:107], a[12:15], 0
buffer_store_dwordx4 v[20:23], v1, s[60:63], s32 offen offset:0 sc1
v_mfma_f32_16x16x32_bf16 v[172:175], v[108:111], a[28:31], v[172:175]
s_waitcnt lgkmcnt(2)
v_mfma_f32_16x16x32_bf16 v[188:191], v[112:115], a[12:15], 0
s_mul_i32 s36, s36, 5120
ds_read_b64_tr_b16 v[100:101], v84 offset:8192
v_mfma_f32_16x16x32_bf16 v[188:191], v[116:119], a[28:31], v[188:191]
s_add_u32 s36, s36, 13631488
ds_read_b64_tr_b16 v[102:103], v84 offset:9216
v_mfma_f32_16x16x32_bf16 v[184:187], v[112:115], a[8:11], 0
s_lshl_b32 s44, s37, 2
v_mfma_f32_16x16x32_bf16 v[184:187], v[116:119], a[24:27], v[184:187]
s_add_u32 s44, s44, 0
buffer_load_dwordx4 v89, s[52:55], s7 offen offset:1024  lds
v_mfma_f32_16x16x32_bf16 v[180:183], v[112:115], a[4:7], 0
s_mul_hi_u32 s28, s44, 858993460
ds_read_b64_tr_b16 v[104:105], v85 offset:0
v_mfma_f32_16x16x32_bf16 v[180:183], v[116:119], a[20:23], v[180:183]
s_mul_i32 s6, s28, 5
ds_read_b64_tr_b16 v[106:107], v85 offset:1024
v_mfma_f32_16x16x32_bf16 v[176:179], v[112:115], a[0:3], 0
s_sub_u32 s6, s44, s6
v_mfma_f32_16x16x32_bf16 v[176:179], v[116:119], a[16:19], v[176:179]
s_waitcnt lgkmcnt(2)
v_mfma_f32_16x16x32_bf16 v[192:195], v[96:99], a[0:3], 0
s_add_u32 s32, s14, 43008
ds_read_b64_tr_b16 v[108:109], v85 offset:8192
v_mfma_f32_16x16x32_bf16 v[192:195], v[100:103], a[16:19], v[192:195]
s_and_b32 s44, s28, 1
ds_read_b64_tr_b16 v[110:111], v85 offset:9216
v_mfma_f32_16x16x32_bf16 v[196:199], v[96:99], a[4:7], 0
buffer_store_dwordx4 v[24:27], v1, s[60:63], s32 offen offset:1024 sc1
v_mfma_f32_16x16x32_bf16 v[196:199], v[100:103], a[20:23], v[196:199]
s_sub_i32 s6, s6, s44
v_mfma_f32_16x16x32_bf16 v[200:203], v[96:99], a[8:11], 0
s_cmp_lt_i32 s6, 0
s_cselect_b32 s6, 4, s6
ds_read_b64_tr_b16 v[112:113], v86 offset:0
v_mfma_f32_16x16x32_bf16 v[200:203], v[100:103], a[24:27], v[200:203]
s_mul_i32 s28, s28, 655360
ds_read_b64_tr_b16 v[114:115], v86 offset:1024
v_mfma_f32_16x16x32_bf16 v[204:207], v[96:99], a[12:15], 0
s_lshl_b32 s6, s6, 10
buffer_load_dwordx4 v90, s[52:55], s7 offen offset:2048  lds
v_mfma_f32_16x16x32_bf16 v[204:207], v[100:103], a[28:31], v[204:207]
s_waitcnt lgkmcnt(2)
v_mfma_f32_16x16x32_bf16 v[220:223], v[104:107], a[12:15], 0
s_add_u32 s28, s28, s6
ds_read_b64_tr_b16 v[116:117], v86 offset:8192
v_mfma_f32_16x16x32_bf16 v[220:223], v[108:111], a[28:31], v[220:223]
s_add_u32 s20, s28, s36
ds_read_b64_tr_b16 v[118:119], v86 offset:9216
v_mfma_f32_16x16x32_bf16 v[216:219], v[104:107], a[8:11], 0
s_lshl_b32 s44, s37, 2
buffer_load_dwordx4 v91, s[52:55], s7 offen offset:3072  lds
v_mfma_f32_16x16x32_bf16 v[216:219], v[108:111], a[24:27], v[216:219]
s_add_u32 s44, s44, 1
v_mfma_f32_16x16x32_bf16 v[212:215], v[104:107], a[4:7], 0
s_mul_hi_u32 s28, s44, 858993460
ds_read_b64_tr_b16 v[96:97], v87 offset:0
v_mfma_f32_16x16x32_bf16 v[212:215], v[108:111], a[20:23], v[212:215]
s_mul_i32 s6, s28, 5
ds_read_b64_tr_b16 v[98:99], v87 offset:1024
v_mfma_f32_16x16x32_bf16 v[208:211], v[104:107], a[0:3], 0
s_add_u32 s32, s14, 60416
v_mfma_f32_16x16x32_bf16 v[208:211], v[108:111], a[16:19], v[208:211]
s_waitcnt lgkmcnt(2)
v_mfma_f32_16x16x32_bf16 v[224:227], v[112:115], a[0:3], 0
s_sub_u32 s6, s44, s6
ds_read_b64_tr_b16 v[100:101], v87 offset:8192
v_mfma_f32_16x16x32_bf16 v[224:227], v[116:119], a[16:19], v[224:227]
s_add_u32 s8, s99, 16384
ds_read_b64_tr_b16 v[102:103], v87 offset:9216
v_mfma_f32_16x16x32_bf16 v[228:231], v[112:115], a[4:7], 0
buffer_store_dwordx4 v[28:31], v1, s[60:63], s32 offen offset:1024 sc1
v_mfma_f32_16x16x32_bf16 v[228:231], v[116:119], a[20:23], v[228:231]
s_add_u32 s9, s100, 16384
s_barrier
v_mfma_f32_16x16x32_bf16 v[232:235], v[112:115], a[8:11], 0
s_and_b32 s44, s28, 1
ds_read_b64_tr_b16 v[104:105], v80 offset:16384
v_mfma_f32_16x16x32_bf16 v[232:235], v[116:119], a[24:27], v[232:235]
s_sub_i32 s6, s6, s44
ds_read_b64_tr_b16 v[106:107], v80 offset:17408
v_mfma_f32_16x16x32_bf16 v[236:239], v[112:115], a[12:15], 0
buffer_load_dwordx4 a[128:131], v1, s[60:63], s8 offen offset:0 sc1
v_mfma_f32_16x16x32_bf16 v[236:239], v[116:119], a[28:31], v[236:239]
s_waitcnt lgkmcnt(2)
v_mfma_f32_16x16x32_bf16 v[252:255], v[96:99], a[12:15], 0
s_cmp_lt_i32 s6, 0
s_cselect_b32 s6, 4, s6
ds_read_b64_tr_b16 v[108:109], v80 offset:24576
v_mfma_f32_16x16x32_bf16 v[252:255], v[100:103], a[28:31], v[252:255]
s_mul_i32 s28, s28, 655360
ds_read_b64_tr_b16 v[110:111], v80 offset:25600
v_mfma_f32_16x16x32_bf16 v[248:251], v[96:99], a[8:11], 0
s_lshl_b32 s6, s6, 10
buffer_load_dwordx4 a[132:135], v1, s[60:63], s8 offen offset:1024 sc1
v_mfma_f32_16x16x32_bf16 v[248:251], v[100:103], a[24:27], v[248:251]
s_add_u32 s28, s28, s6
v_mfma_f32_16x16x32_bf16 v[244:247], v[96:99], a[4:7], 0
s_add_u32 s21, s28, s36
ds_read_b64_tr_b16 v[112:113], v81 offset:16384
v_mfma_f32_16x16x32_bf16 v[244:247], v[100:103], a[20:23], v[244:247]
s_lshl_b32 s44, s37, 2
ds_read_b64_tr_b16 v[114:115], v81 offset:17408
v_mfma_f32_16x16x32_bf16 v[240:243], v[96:99], a[0:3], 0
s_add_u32 s32, s14, 43008
v_mfma_f32_16x16x32_bf16 v[240:243], v[100:103], a[16:19], v[240:243]
s_waitcnt lgkmcnt(2)
v_mfma_f32_16x16x32_bf16 v[128:131], v[104:107], a[32:35], v[128:131]
s_add_u32 s44, s44, 2
ds_read_b64_tr_b16 v[116:117], v81 offset:24576
v_mfma_f32_16x16x32_bf16 v[128:131], v[108:111], a[48:51], v[128:131]
s_mul_hi_u32 s28, s44, 858993460
ds_read_b64_tr_b16 v[118:119], v81 offset:25600
v_mfma_f32_16x16x32_bf16 v[132:135], v[108:111], a[52:55], v[132:135]
buffer_store_dwordx4 v[32:35], v1, s[60:63], s32 offen offset:2048 sc1
v_mfma_f32_16x16x32_bf16 v[132:135], v[104:107], a[36:39], v[132:135]
s_mul_i32 s6, s28, 5
v_mfma_f32_16x16x32_bf16 v[136:139], v[104:107], a[40:43], v[136:139]
s_sub_u32 s6, s44, s6
ds_read_b64_tr_b16 v[96:97], v82 offset:16384
v_mfma_f32_16x16x32_bf16 v[136:139], v[108:111], a[56:59], v[136:139]
s_and_b32 s44, s28, 1
ds_read_b64_tr_b16 v[98:99], v82 offset:17408
v_mfma_f32_16x16x32_bf16 v[140:143], v[108:111], a[60:63], v[140:143]
s_sub_i32 s6, s6, s44
buffer_load_dwordx4 a[136:139], v1, s[60:63], s9 offen offset:0 sc1
v_mfma_f32_16x16x32_bf16 v[140:143], v[104:107], a[44:47], v[140:143]
s_waitcnt lgkmcnt(2)
v_mfma_f32_16x16x32_bf16 v[156:159], v[112:115], a[44:47], v[156:159]
s_cmp_lt_i32 s6, 0
s_cselect_b32 s6, 4, s6
ds_read_b64_tr_b16 v[100:101], v82 offset:24576
v_mfma_f32_16x16x32_bf16 v[156:159], v[116:119], a[60:63], v[156:159]
s_mul_i32 s28, s28, 655360
ds_read_b64_tr_b16 v[102:103], v82 offset:25600
v_mfma_f32_16x16x32_bf16 v[152:155], v[116:119], a[56:59], v[152:155]
s_add_u32 s32, s14, 60416
v_mfma_f32_16x16x32_bf16 v[152:155], v[112:115], a[40:43], v[152:155]
buffer_store_dwordx4 v[36:39], v1, s[60:63], s32 offen offset:2048 sc1
v_mfma_f32_16x16x32_bf16 v[148:151], v[112:115], a[36:39], v[148:151]
s_lshl_b32 s6, s6, 10
ds_read_b64_tr_b16 v[104:105], v83 offset:16384
v_mfma_f32_16x16x32_bf16 v[148:151], v[116:119], a[52:55], v[148:151]
s_add_u32 s28, s28, s6
ds_read_b64_tr_b16 v[106:107], v83 offset:17408
v_mfma_f32_16x16x32_bf16 v[144:147], v[116:119], a[48:51], v[144:147]
s_add_u32 s22, s28, s36
v_mfma_f32_16x16x32_bf16 v[144:147], v[112:115], a[32:35], v[144:147]
s_waitcnt lgkmcnt(2)
v_mfma_f32_16x16x32_bf16 v[160:163], v[96:99], a[32:35], v[160:163]
s_lshl_b32 s44, s37, 2
ds_read_b64_tr_b16 v[108:109], v83 offset:24576
v_mfma_f32_16x16x32_bf16 v[160:163], v[100:103], a[48:51], v[160:163]
s_add_u32 s44, s44, 3
ds_read_b64_tr_b16 v[110:111], v83 offset:25600
v_mfma_f32_16x16x32_bf16 v[164:167], v[100:103], a[52:55], v[164:167]
s_mul_hi_u32 s28, s44, 858993460
buffer_load_dwordx4 a[140:143], v1, s[60:63], s9 offen offset:1024 sc1
v_mfma_f32_16x16x32_bf16 v[164:167], v[96:99], a[36:39], v[164:167]
s_mul_i32 s6, s28, 5
v_mfma_f32_16x16x32_bf16 v[168:171], v[96:99], a[40:43], v[168:171]
s_sub_u32 s6, s44, s6
ds_read_b64_tr_b16 v[112:113], v84 offset:16384
v_mfma_f32_16x16x32_bf16 v[168:171], v[100:103], a[56:59], v[168:171]
s_and_b32 s44, s28, 1
ds_read_b64_tr_b16 v[114:115], v84 offset:17408
v_mfma_f32_16x16x32_bf16 v[172:175], v[100:103], a[60:63], v[172:175]
s_sub_i32 s6, s6, s44
buffer_load_dwordx4 a[144:147], v1, s[60:63], s8 offen offset:2048 sc1
v_mfma_f32_16x16x32_bf16 v[172:175], v[96:99], a[44:47], v[172:175]
s_waitcnt lgkmcnt(2)
v_mfma_f32_16x16x32_bf16 v[188:191], v[104:107], a[44:47], v[188:191]
s_add_u32 s32, s14, 43008
ds_read_b64_tr_b16 v[116:117], v84 offset:24576
v_mfma_f32_16x16x32_bf16 v[188:191], v[108:111], a[60:63], v[188:191]
s_cmp_lt_i32 s6, 0
s_cselect_b32 s6, 4, s6
ds_read_b64_tr_b16 v[118:119], v84 offset:25600
v_mfma_f32_16x16x32_bf16 v[184:187], v[108:111], a[56:59], v[184:187]
buffer_store_dwordx4 v[40:43], v1, s[60:63], s32 offen offset:3072 sc1
v_mfma_f32_16x16x32_bf16 v[184:187], v[104:107], a[40:43], v[184:187]
s_mul_i32 s28, s28, 655360
v_mfma_f32_16x16x32_bf16 v[180:183], v[104:107], a[36:39], v[180:183]
s_lshl_b32 s6, s6, 10
ds_read_b64_tr_b16 v[96:97], v85 offset:16384
v_mfma_f32_16x16x32_bf16 v[180:183], v[108:111], a[52:55], v[180:183]
s_add_u32 s28, s28, s6
ds_read_b64_tr_b16 v[98:99], v85 offset:17408
v_mfma_f32_16x16x32_bf16 v[176:179], v[108:111], a[48:51], v[176:179]
s_add_u32 s23, s28, s36
v_mfma_f32_16x16x32_bf16 v[176:179], v[104:107], a[32:35], v[176:179]
s_waitcnt lgkmcnt(2)
buffer_load_dwordx4 a[148:151], v1, s[60:63], s8 offen offset:3072 sc1
v_mfma_f32_16x16x32_bf16 v[192:195], v[112:115], a[32:35], v[192:195]
s_add_u32 s64, s56, 2621440
s_addc_u32 s65, s57, 0
ds_read_b64_tr_b16 v[100:101], v85 offset:24576
v_mfma_f32_16x16x32_bf16 v[192:195], v[116:119], a[48:51], v[192:195]
s_mov_b32 s66, s58
ds_read_b64_tr_b16 v[102:103], v85 offset:25600
v_mfma_f32_16x16x32_bf16 v[196:199], v[116:119], a[52:55], v[196:199]
s_add_u32 s40, s20, 327680
v_mfma_f32_16x16x32_bf16 v[196:199], v[112:115], a[36:39], v[196:199]
s_add_u32 s41, s21, 327680
v_mfma_f32_16x16x32_bf16 v[200:203], v[112:115], a[40:43], v[200:203]
s_add_u32 s42, s22, 327680
ds_read_b64_tr_b16 v[104:105], v86 offset:16384
v_mfma_f32_16x16x32_bf16 v[200:203], v[116:119], a[56:59], v[200:203]
s_add_u32 s43, s23, 327680
ds_read_b64_tr_b16 v[106:107], v86 offset:17408
v_mfma_f32_16x16x32_bf16 v[204:207], v[116:119], a[60:63], v[204:207]
s_sub_u32 s33, s10, 100
buffer_load_dwordx4 a[152:155], v1, s[60:63], s9 offen offset:2048 sc1
v_mfma_f32_16x16x32_bf16 v[204:207], v[112:115], a[44:47], v[204:207]
s_waitcnt lgkmcnt(2)
v_mfma_f32_16x16x32_bf16 v[220:223], v[96:99], a[44:47], v[220:223]
s_add_u32 s32, s14, 60416
ds_read_b64_tr_b16 v[108:109], v86 offset:24576
v_mfma_f32_16x16x32_bf16 v[220:223], v[100:103], a[60:63], v[220:223]
s_max_i32 s33, s33, 0
ds_read_b64_tr_b16 v[110:111], v86 offset:25600
v_mfma_f32_16x16x32_bf16 v[216:219], v[100:103], a[56:59], v[216:219]
buffer_store_dwordx4 v[44:47], v1, s[60:63], s32 offen offset:3072 sc1
v_mfma_f32_16x16x32_bf16 v[216:219], v[96:99], a[40:43], v[216:219]
s_mul_hi_u32 s36, s33, 159072863
v_mfma_f32_16x16x32_bf16 v[212:215], v[96:99], a[36:39], v[212:215]
s_mul_i32 s37, s36, 27
ds_read_b64_tr_b16 v[112:113], v87 offset:16384
v_mfma_f32_16x16x32_bf16 v[212:215], v[100:103], a[52:55], v[212:215]
s_sub_u32 s37, s33, s37
ds_read_b64_tr_b16 v[114:115], v87 offset:17408
v_mfma_f32_16x16x32_bf16 v[208:211], v[100:103], a[48:51], v[208:211]
s_mul_i32 s44, s36, 110592
v_mfma_f32_16x16x32_bf16 v[208:211], v[96:99], a[32:35], v[208:211]
s_waitcnt lgkmcnt(2)
buffer_load_dwordx4 a[156:159], v1, s[60:63], s9 offen offset:3072 sc1
v_mfma_f32_16x16x32_bf16 v[224:227], v[104:107], a[32:35], v[224:227]
s_lshl_b32 s28, s37, 7
ds_read_b64_tr_b16 v[116:117], v87 offset:24576
v_mfma_f32_16x16x32_bf16 v[224:227], v[108:111], a[48:51], v[224:227]
s_add_u32 s44, s44, s28
ds_read_b64_tr_b16 v[118:119], v87 offset:25600
v_mfma_f32_16x16x32_bf16 v[228:231], v[108:111], a[52:55], v[228:231]
s_waitcnt vmcnt(45)
v_mfma_f32_16x16x32_bf16 v[228:231], v[104:107], a[36:39], v[228:231]
s_add_u32 s72, s30, s44
s_addc_u32 s73, s31, 0
s_barrier
v_mfma_f32_16x16x32_bf16 v[232:235], v[104:107], a[40:43], v[232:235]
s_add_u32 s32, s14, 47104
ds_read_b64_tr_b16 v[96:97], v80 offset:32768
v_mfma_f32_16x16x32_bf16 v[232:235], v[108:111], a[56:59], v[232:235]
s_mov_b32 s74, 107264
ds_read_b64_tr_b16 v[98:99], v80 offset:33792
v_mfma_f32_16x16x32_bf16 v[236:239], v[108:111], a[60:63], v[236:239]
buffer_store_dwordx4 v[48:51], v1, s[60:63], s32 offen offset:0 sc1
v_mfma_f32_16x16x32_bf16 v[236:239], v[104:107], a[44:47], v[236:239]
s_waitcnt lgkmcnt(2)
v_mfma_f32_16x16x32_bf16 v[252:255], v[112:115], a[44:47], v[252:255]
s_add_u32 m0, s13, 81920
ds_read_b64_tr_b16 v[100:101], v80 offset:40960
v_mfma_f32_16x16x32_bf16 v[252:255], v[116:119], a[60:63], v[252:255]
s_add_u32 s7, s15, 2621440
ds_read_b64_tr_b16 v[102:103], v80 offset:41984
v_mfma_f32_16x16x32_bf16 v[248:251], v[116:119], a[56:59], v[248:251]
s_mul_i32 s36, s36, 7168
buffer_load_dwordx4 v88, s[52:55], s7 offen offset:0  lds
v_mfma_f32_16x16x32_bf16 v[248:251], v[112:115], a[40:43], v[248:251]
s_add_u32 s36, s36, 19922944
v_mfma_f32_16x16x32_bf16 v[244:247], v[112:115], a[36:39], v[244:247]
s_lshl_b32 s44, s37, 2
ds_read_b64_tr_b16 v[104:105], v81 offset:32768
v_mfma_f32_16x16x32_bf16 v[244:247], v[116:119], a[52:55], v[244:247]
s_add_u32 s44, s44, 0
ds_read_b64_tr_b16 v[106:107], v81 offset:33792
v_mfma_f32_16x16x32_bf16 v[240:243], v[116:119], a[48:51], v[240:243]
s_mul_hi_u32 s28, s44, 613566757
v_mfma_f32_16x16x32_bf16 v[240:243], v[112:115], a[32:35], v[240:243]
s_waitcnt vmcnt(46) lgkmcnt(2)
buffer_load_dwordx4 v89, s[52:55], s7 offen offset:1024  lds
v_mfma_f32_16x16x32_bf16 v[128:131], v[96:99], a[64:67], v[128:131]
s_waitcnt vmcnt(41)
s_mul_i32 s6, s28, 7
ds_read_b64_tr_b16 v[108:109], v81 offset:40960
v_mfma_f32_16x16x32_bf16 v[128:131], v[100:103], a[80:83], v[128:131]
s_waitcnt vmcnt(40)
s_sub_u32 s6, s44, s6
ds_read_b64_tr_b16 v[110:111], v81 offset:41984
v_mfma_f32_16x16x32_bf16 v[132:135], v[100:103], a[84:87], v[132:135]
s_and_b32 s44, s28, 1
v_mfma_f32_16x16x32_bf16 v[132:135], v[96:99], a[68:71], v[132:135]
s_add_u32 s32, s14, 64512
v_mfma_f32_16x16x32_bf16 v[136:139], v[96:99], a[72:75], v[136:139]
s_waitcnt vmcnt(38)
s_sub_i32 s6, s6, s44
ds_read_b64_tr_b16 v[112:113], v82 offset:32768
v_mfma_f32_16x16x32_bf16 v[136:139], v[100:103], a[88:91], v[136:139]
s_waitcnt vmcnt(37)
s_cmp_lt_i32 s6, 0
s_cselect_b32 s6, 6, s6
ds_read_b64_tr_b16 v[114:115], v82 offset:33792
v_mfma_f32_16x16x32_bf16 v[140:143], v[100:103], a[92:95], v[140:143]
buffer_store_dwordx4 v[52:55], v1, s[60:63], s32 offen offset:0 sc1
v_mfma_f32_16x16x32_bf16 v[140:143], v[96:99], a[76:79], v[140:143]
s_waitcnt lgkmcnt(2)
v_mfma_f32_16x16x32_bf16 v[156:159], v[104:107], a[76:79], v[156:159]
s_mul_i32 s28, s28, 143360
ds_read_b64_tr_b16 v[116:117], v82 offset:40960
v_mfma_f32_16x16x32_bf16 v[156:159], v[108:111], a[92:95], v[156:159]
s_lshl_b32 s6, s6, 10
ds_read_b64_tr_b16 v[118:119], v82 offset:41984
v_mfma_f32_16x16x32_bf16 v[152:155], v[108:111], a[88:91], v[152:155]
s_add_u32 s28, s28, s6
buffer_load_dwordx4 v90, s[52:55], s7 offen offset:2048  lds
v_mfma_f32_16x16x32_bf16 v[152:155], v[104:107], a[72:75], v[152:155]
s_add_u32 s24, s28, s36
v_mfma_f32_16x16x32_bf16 v[148:151], v[104:107], a[68:71], v[148:151]
s_lshl_b32 s44, s37, 2
ds_read_b64_tr_b16 v[96:97], v83 offset:32768
v_mfma_f32_16x16x32_bf16 v[148:151], v[108:111], a[84:87], v[148:151]
s_add_u32 s44, s44, 1
ds_read_b64_tr_b16 v[98:99], v83 offset:33792
v_mfma_f32_16x16x32_bf16 v[144:147], v[108:111], a[80:83], v[144:147]
s_mul_hi_u32 s28, s44, 613566757
v_mfma_f32_16x16x32_bf16 v[144:147], v[104:107], a[64:67], v[144:147]
s_waitcnt lgkmcnt(2)
buffer_load_dwordx4 v91, s[52:55], s7 offen offset:3072  lds
v_mfma_f32_16x16x32_bf16 v[160:163], v[112:115], a[64:67], v[160:163]
s_mul_i32 s6, s28, 7
ds_read_b64_tr_b16 v[100:101], v83 offset:40960
v_mfma_f32_16x16x32_bf16 v[160:163], v[116:119], a[80:83], v[160:163]
s_sub_u32 s6, s44, s6
ds_read_b64_tr_b16 v[102:103], v83 offset:41984
v_mfma_f32_16x16x32_bf16 v[164:167], v[116:119], a[84:87], v[164:167]
s_add_u32 s32, s14, 47104
v_mfma_f32_16x16x32_bf16 v[164:167], v[112:115], a[68:71], v[164:167]
s_and_b32 s44, s28, 1
v_mfma_f32_16x16x32_bf16 v[168:171], v[112:115], a[72:75], v[168:171]
s_sub_i32 s6, s6, s44
ds_read_b64_tr_b16 v[104:105], v84 offset:32768
v_mfma_f32_16x16x32_bf16 v[168:171], v[116:119], a[88:91], v[168:171]
s_cmp_lt_i32 s6, 0
s_cselect_b32 s6, 6, s6
ds_read_b64_tr_b16 v[106:107], v84 offset:33792
v_mfma_f32_16x16x32_bf16 v[172:175], v[116:119], a[92:95], v[172:175]
buffer_store_dwordx4 v[56:59], v1, s[60:63], s32 offen offset:1024 sc1
v_mfma_f32_16x16x32_bf16 v[172:175], v[112:115], a[76:79], v[172:175]
s_waitcnt lgkmcnt(2)
v_mfma_f32_16x16x32_bf16 v[188:191], v[96:99], a[76:79], v[188:191]
s_add_u32 s8, s99, 20480
ds_read_b64_tr_b16 v[108:109], v84 offset:40960
v_mfma_f32_16x16x32_bf16 v[188:191], v[100:103], a[92:95], v[188:191]
s_add_u32 s9, s100, 20480
ds_read_b64_tr_b16 v[110:111], v84 offset:41984
v_mfma_f32_16x16x32_bf16 v[184:187], v[100:103], a[88:91], v[184:187]
s_mul_i32 s28, s28, 143360
buffer_load_dwordx4 a[160:163], v1, s[60:63], s8 offen offset:0 sc1
v_mfma_f32_16x16x32_bf16 v[184:187], v[96:99], a[72:75], v[184:187]
s_lshl_b32 s6, s6, 10
v_mfma_f32_16x16x32_bf16 v[180:183], v[96:99], a[68:71], v[180:183]
s_add_u32 s28, s28, s6
ds_read_b64_tr_b16 v[112:113], v85 offset:32768
v_mfma_f32_16x16x32_bf16 v[180:183], v[100:103], a[84:87], v[180:183]
s_add_u32 s25, s28, s36
ds_read_b64_tr_b16 v[114:115], v85 offset:33792
v_mfma_f32_16x16x32_bf16 v[176:179], v[100:103], a[80:83], v[176:179]
s_lshl_b32 s44, s37, 2
v_mfma_f32_16x16x32_bf16 v[176:179], v[96:99], a[64:67], v[176:179]
s_waitcnt lgkmcnt(2)
v_mfma_f32_16x16x32_bf16 v[192:195], v[104:107], a[64:67], v[192:195]
s_add_u32 s32, s14, 64512
ds_read_b64_tr_b16 v[116:117], v85 offset:40960
v_mfma_f32_16x16x32_bf16 v[192:195], v[108:111], a[80:83], v[192:195]
s_add_u32 s44, s44, 2
ds_read_b64_tr_b16 v[118:119], v85 offset:41984
v_mfma_f32_16x16x32_bf16 v[196:199], v[108:111], a[84:87], v[196:199]
buffer_store_dwordx4 v[60:63], v1, s[60:63], s32 offen offset:1024 sc1
v_mfma_f32_16x16x32_bf16 v[196:199], v[104:107], a[68:71], v[196:199]
s_mul_hi_u32 s28, s44, 613566757
v_mfma_f32_16x16x32_bf16 v[200:203], v[104:107], a[72:75], v[200:203]
s_mul_i32 s6, s28, 7
ds_read_b64_tr_b16 v[96:97], v86 offset:32768
v_mfma_f32_16x16x32_bf16 v[200:203], v[108:111], a[88:91], v[200:203]
s_sub_u32 s6, s44, s6
ds_read_b64_tr_b16 v[98:99], v86 offset:33792
v_mfma_f32_16x16x32_bf16 v[204:207], v[108:111], a[92:95], v[204:207]
s_and_b32 s44, s28, 1
buffer_load_dwordx4 a[164:167], v1, s[60:63], s8 offen offset:1024 sc1
v_mfma_f32_16x16x32_bf16 v[204:207], v[104:107], a[76:79], v[204:207]
s_waitcnt lgkmcnt(2)
v_mfma_f32_16x16x32_bf16 v[220:223], v[112:115], a[76:79], v[220:223]
s_sub_i32 s6, s6, s44
ds_read_b64_tr_b16 v[100:101], v86 offset:40960
v_mfma_f32_16x16x32_bf16 v[220:223], v[116:119], a[92:95], v[220:223]
s_cmp_lt_i32 s6, 0
s_cselect_b32 s6, 6, s6
ds_read_b64_tr_b16 v[102:103], v86 offset:41984
v_mfma_f32_16x16x32_bf16 v[216:219], v[116:119], a[88:91], v[216:219]
s_mul_i32 s28, s28, 143360
buffer_load_dwordx4 a[168:171], v1, s[60:63], s9 offen offset:0 sc1
v_mfma_f32_16x16x32_bf16 v[216:219], v[112:115], a[72:75], v[216:219]
s_lshl_b32 s6, s6, 10
v_mfma_f32_16x16x32_bf16 v[212:215], v[112:115], a[68:71], v[212:215]
s_add_u32 s28, s28, s6
ds_read_b64_tr_b16 v[104:105], v87 offset:32768
v_mfma_f32_16x16x32_bf16 v[212:215], v[116:119], a[84:87], v[212:215]
s_add_u32 s32, s14, 47104
ds_read_b64_tr_b16 v[106:107], v87 offset:33792
v_mfma_f32_16x16x32_bf16 v[208:211], v[116:119], a[80:83], v[208:211]
s_add_u32 s26, s28, s36
v_mfma_f32_16x16x32_bf16 v[208:211], v[112:115], a[64:67], v[208:211]
s_waitcnt lgkmcnt(2)
buffer_store_dwordx4 v[64:67], v1, s[60:63], s32 offen offset:2048 sc1
v_mfma_f32_16x16x32_bf16 v[224:227], v[96:99], a[64:67], v[224:227]
s_lshl_b32 s44, s37, 2
ds_read_b64_tr_b16 v[108:109], v87 offset:40960
v_mfma_f32_16x16x32_bf16 v[224:227], v[100:103], a[80:83], v[224:227]
s_add_u32 s44, s44, 3
ds_read_b64_tr_b16 v[110:111], v87 offset:41984
v_mfma_f32_16x16x32_bf16 v[228:231], v[100:103], a[84:87], v[228:231]
s_waitcnt vmcnt(40)
v_mfma_f32_16x16x32_bf16 v[228:231], v[96:99], a[68:71], v[228:231]
s_mul_hi_u32 s28, s44, 613566757
s_barrier
v_mfma_f32_16x16x32_bf16 v[232:235], v[96:99], a[72:75], v[232:235]
s_mul_i32 s6, s28, 7
ds_read_b64_tr_b16 v[112:113], v80 offset:49152
v_mfma_f32_16x16x32_bf16 v[232:235], v[100:103], a[88:91], v[232:235]
s_sub_u32 s6, s44, s6
ds_read_b64_tr_b16 v[114:115], v80 offset:50176
v_mfma_f32_16x16x32_bf16 v[236:239], v[100:103], a[92:95], v[236:239]
s_and_b32 s44, s28, 1
buffer_load_dwordx4 a[172:175], v1, s[60:63], s9 offen offset:1024 sc1
v_mfma_f32_16x16x32_bf16 v[236:239], v[96:99], a[76:79], v[236:239]
s_waitcnt lgkmcnt(2)
v_mfma_f32_16x16x32_bf16 v[252:255], v[104:107], a[76:79], v[252:255]
s_sub_i32 s6, s6, s44
ds_read_b64_tr_b16 v[116:117], v80 offset:57344
v_mfma_f32_16x16x32_bf16 v[252:255], v[108:111], a[92:95], v[252:255]
ds_read_b64_tr_b16 v[118:119], v80 offset:58368
v_add_u32 v80, 65536, v80
v_mfma_f32_16x16x32_bf16 v[248:251], v[108:111], a[88:91], v[248:251]
buffer_load_dwordx4 a[176:179], v1, s[60:63], s8 offen offset:2048 sc1
v_mfma_f32_16x16x32_bf16 v[248:251], v[104:107], a[72:75], v[248:251]
s_cmp_lt_i32 s6, 0
s_cselect_b32 s6, 6, s6
v_mfma_f32_16x16x32_bf16 v[244:247], v[104:107], a[68:71], v[244:247]
s_mul_i32 s28, s28, 143360
ds_read_b64_tr_b16 v[96:97], v81 offset:49152
v_mfma_f32_16x16x32_bf16 v[244:247], v[108:111], a[84:87], v[244:247]
s_add_u32 s32, s14, 64512
ds_read_b64_tr_b16 v[98:99], v81 offset:50176
v_mfma_f32_16x16x32_bf16 v[240:243], v[108:111], a[80:83], v[240:243]
s_lshl_b32 s6, s6, 10
v_mfma_f32_16x16x32_bf16 v[240:243], v[104:107], a[64:67], v[240:243]
s_waitcnt vmcnt(41) lgkmcnt(2)
buffer_store_dwordx4 v[68:71], v1, s[60:63], s32 offen offset:2048 sc1
v_mfma_f32_16x16x32_bf16 v[128:131], v[112:115], a[96:99], v[128:131]
s_waitcnt vmcnt(38)
s_add_u32 s28, s28, s6
ds_read_b64_tr_b16 v[100:101], v81 offset:57344
v_mfma_f32_16x16x32_bf16 v[128:131], v[116:119], a[112:115], v[128:131]
s_waitcnt vmcnt(37)
s_add_u32 s27, s28, s36
ds_read_b64_tr_b16 v[102:103], v81 offset:58368
v_add_u32 v81, 65536, v81
v_mfma_f32_16x16x32_bf16 v[132:135], v[116:119], a[116:119], v[132:135]
s_cmp_lt_u32 s10, 100
s_cmov_b32 s24, 268435456
v_mfma_f32_16x16x32_bf16 v[132:135], v[112:115], a[100:103], v[132:135]
s_cmp_lt_u32 s10, 100
s_cmov_b32 s25, 268435456
v_mfma_f32_16x16x32_bf16 v[136:139], v[112:115], a[104:107], v[136:139]
s_waitcnt vmcnt(36)
s_cmp_lt_u32 s10, 100
s_cmov_b32 s26, 268435456
ds_read_b64_tr_b16 v[104:105], v82 offset:49152
v_mfma_f32_16x16x32_bf16 v[136:139], v[116:119], a[120:123], v[136:139]
s_waitcnt vmcnt(34)
s_cmp_lt_u32 s10, 100
s_cmov_b32 s27, 268435456
ds_read_b64_tr_b16 v[106:107], v82 offset:50176
v_mfma_f32_16x16x32_bf16 v[140:143], v[116:119], a[124:127], v[140:143]
buffer_load_dwordx4 a[180:183], v1, s[60:63], s8 offen offset:3072 sc1
v_mfma_f32_16x16x32_bf16 v[140:143], v[112:115], a[108:111], v[140:143]
s_waitcnt lgkmcnt(2)
v_mfma_f32_16x16x32_bf16 v[156:159], v[96:99], a[108:111], v[156:159]
s_cmp_lt_u32 s10, 100
s_cmov_b32 s74, 0
ds_read_b64_tr_b16 v[108:109], v82 offset:57344
v_mfma_f32_16x16x32_bf16 v[156:159], v[100:103], a[124:127], v[156:159]
s_mov_b32 s12, 4096
ds_read_b64_tr_b16 v[110:111], v82 offset:58368
v_add_u32 v82, 65536, v82
v_mfma_f32_16x16x32_bf16 v[152:155], v[100:103], a[120:123], v[152:155]
s_mov_b32 s67, 4096
buffer_load_dwordx4 a[184:187], v1, s[60:63], s9 offen offset:2048 sc1
v_mfma_f32_16x16x32_bf16 v[152:155], v[96:99], a[104:107], v[152:155]
s_mov_b32 s71, 9216
v_mfma_f32_16x16x32_bf16 v[148:151], v[96:99], a[100:103], v[148:151]
s_mov_b32 s75, 26624
ds_read_b64_tr_b16 v[112:113], v83 offset:49152
v_mfma_f32_16x16x32_bf16 v[148:151], v[100:103], a[116:119], v[148:151]
s_add_u32 s32, s14, 47104
ds_read_b64_tr_b16 v[114:115], v83 offset:50176
v_mfma_f32_16x16x32_bf16 v[144:147], v[100:103], a[112:115], v[144:147]
s_mov_b32 s16, 268435456
v_mfma_f32_16x16x32_bf16 v[144:147], v[96:99], a[96:99], v[144:147]
s_waitcnt lgkmcnt(2)
buffer_store_dwordx4 v[72:75], v1, s[60:63], s32 offen offset:3072 sc1
v_mfma_f32_16x16x32_bf16 v[160:163], v[104:107], a[96:99], v[160:163]
s_mov_b32 s17, 268435456
ds_read_b64_tr_b16 v[116:117], v83 offset:57344
v_mfma_f32_16x16x32_bf16 v[160:163], v[108:111], a[112:115], v[160:163]
s_mov_b32 s18, 268435456
ds_read_b64_tr_b16 v[118:119], v83 offset:58368
v_add_u32 v83, 65536, v83
v_mfma_f32_16x16x32_bf16 v[164:167], v[108:111], a[116:119], v[164:167]
s_mov_b32 s19, 268435456
v_mfma_f32_16x16x32_bf16 v[164:167], v[104:107], a[100:103], v[164:167]
v_mfma_f32_16x16x32_bf16 v[168:171], v[104:107], a[104:107], v[168:171]
ds_read_b64_tr_b16 v[96:97], v84 offset:49152
v_mfma_f32_16x16x32_bf16 v[168:171], v[108:111], a[120:123], v[168:171]
ds_read_b64_tr_b16 v[98:99], v84 offset:50176
v_mfma_f32_16x16x32_bf16 v[172:175], v[108:111], a[124:127], v[172:175]
buffer_load_dwordx4 a[188:191], v1, s[60:63], s9 offen offset:3072 sc1
v_mfma_f32_16x16x32_bf16 v[172:175], v[104:107], a[108:111], v[172:175]
s_waitcnt lgkmcnt(2)
v_mfma_f32_16x16x32_bf16 v[188:191], v[112:115], a[108:111], v[188:191]
s_add_u32 s32, s14, 64512
ds_read_b64_tr_b16 v[100:101], v84 offset:57344
v_mfma_f32_16x16x32_bf16 v[188:191], v[116:119], a[124:127], v[188:191]
ds_read_b64_tr_b16 v[102:103], v84 offset:58368
v_add_u32 v84, 65536, v84
v_mfma_f32_16x16x32_bf16 v[184:187], v[116:119], a[120:123], v[184:187]
buffer_store_dwordx4 v[76:79], v1, s[60:63], s32 offen offset:3072 sc1
v_mfma_f32_16x16x32_bf16 v[184:187], v[112:115], a[104:107], v[184:187]
s_add_u32 m0, s13, 98304
v_mfma_f32_16x16x32_bf16 v[180:183], v[112:115], a[100:103], v[180:183]
s_add_u32 s7, s15, 3145728
ds_read_b64_tr_b16 v[104:105], v85 offset:49152
v_mfma_f32_16x16x32_bf16 v[180:183], v[116:119], a[116:119], v[180:183]
ds_read_b64_tr_b16 v[106:107], v85 offset:50176
v_mfma_f32_16x16x32_bf16 v[176:179], v[116:119], a[112:115], v[176:179]
v_mfma_f32_16x16x32_bf16 v[176:179], v[112:115], a[96:99], v[176:179]
s_waitcnt lgkmcnt(2)
buffer_load_dwordx4 v88, s[52:55], s7 offen offset:0  lds
v_mfma_f32_16x16x32_bf16 v[192:195], v[96:99], a[96:99], v[192:195]
ds_read_b64_tr_b16 v[108:109], v85 offset:57344
v_mfma_f32_16x16x32_bf16 v[192:195], v[100:103], a[112:115], v[192:195]
ds_read_b64_tr_b16 v[110:111], v85 offset:58368
v_add_u32 v85, 65536, v85
v_mfma_f32_16x16x32_bf16 v[196:199], v[100:103], a[116:119], v[196:199]
v_mfma_f32_16x16x32_bf16 v[196:199], v[96:99], a[100:103], v[196:199]
v_mfma_f32_16x16x32_bf16 v[200:203], v[96:99], a[104:107], v[200:203]
ds_read_b64_tr_b16 v[112:113], v86 offset:49152
v_mfma_f32_16x16x32_bf16 v[200:203], v[100:103], a[120:123], v[200:203]
ds_read_b64_tr_b16 v[114:115], v86 offset:50176
v_mfma_f32_16x16x32_bf16 v[204:207], v[100:103], a[124:127], v[204:207]
buffer_load_dwordx4 v89, s[52:55], s7 offen offset:1024  lds
v_mfma_f32_16x16x32_bf16 v[204:207], v[96:99], a[108:111], v[204:207]
s_waitcnt lgkmcnt(2)
v_mfma_f32_16x16x32_bf16 v[220:223], v[104:107], a[108:111], v[220:223]
ds_read_b64_tr_b16 v[116:117], v86 offset:57344
v_mfma_f32_16x16x32_bf16 v[220:223], v[108:111], a[124:127], v[220:223]
ds_read_b64_tr_b16 v[118:119], v86 offset:58368
v_add_u32 v86, 65536, v86
v_mfma_f32_16x16x32_bf16 v[216:219], v[108:111], a[120:123], v[216:219]
buffer_load_dwordx4 v90, s[52:55], s7 offen offset:2048  lds
v_mfma_f32_16x16x32_bf16 v[216:219], v[104:107], a[104:107], v[216:219]
v_mfma_f32_16x16x32_bf16 v[212:215], v[104:107], a[100:103], v[212:215]
ds_read_b64_tr_b16 v[96:97], v87 offset:49152
v_mfma_f32_16x16x32_bf16 v[212:215], v[108:111], a[116:119], v[212:215]
ds_read_b64_tr_b16 v[98:99], v87 offset:50176
v_mfma_f32_16x16x32_bf16 v[208:211], v[108:111], a[112:115], v[208:211]
v_mfma_f32_16x16x32_bf16 v[208:211], v[104:107], a[96:99], v[208:211]
s_waitcnt lgkmcnt(2)
buffer_load_dwordx4 v91, s[52:55], s7 offen offset:3072  lds
v_mfma_f32_16x16x32_bf16 v[224:227], v[112:115], a[96:99], v[224:227]
s_add_u32 s8, s99, 24576
ds_read_b64_tr_b16 v[100:101], v87 offset:57344
v_mfma_f32_16x16x32_bf16 v[224:227], v[116:119], a[112:115], v[224:227]
s_add_u32 s9, s100, 24576
ds_read_b64_tr_b16 v[102:103], v87 offset:58368
v_add_u32 v87, 65536, v87
v_mfma_f32_16x16x32_bf16 v[228:231], v[116:119], a[116:119], v[228:231]
s_waitcnt vmcnt(37)
v_mfma_f32_16x16x32_bf16 v[228:231], v[112:115], a[100:103], v[228:231]
s_barrier
v_mfma_f32_16x16x32_bf16 v[232:235], v[112:115], a[104:107], v[232:235]
ds_read_b64_tr_b16 v[104:105], v80 offset:0
v_mfma_f32_16x16x32_bf16 v[232:235], v[116:119], a[120:123], v[232:235]
ds_read_b64_tr_b16 v[106:107], v80 offset:1024
v_mfma_f32_16x16x32_bf16 v[236:239], v[116:119], a[124:127], v[236:239]
buffer_load_dwordx4 a[192:195], v1, s[60:63], s8 offen offset:0 sc1
v_mfma_f32_16x16x32_bf16 v[236:239], v[112:115], a[108:111], v[236:239]
s_waitcnt lgkmcnt(2)
v_mfma_f32_16x16x32_bf16 v[252:255], v[96:99], a[108:111], v[252:255]
ds_read_b64_tr_b16 v[108:109], v80 offset:8192
v_mfma_f32_16x16x32_bf16 v[252:255], v[100:103], a[124:127], v[252:255]
ds_read_b64_tr_b16 v[110:111], v80 offset:9216
v_mfma_f32_16x16x32_bf16 v[248:251], v[100:103], a[120:123], v[248:251]
buffer_load_dwordx4 a[196:199], v1, s[60:63], s8 offen offset:1024 sc1
v_mfma_f32_16x16x32_bf16 v[248:251], v[96:99], a[104:107], v[248:251]
v_mfma_f32_16x16x32_bf16 v[244:247], v[96:99], a[100:103], v[244:247]
ds_read_b64_tr_b16 v[112:113], v81 offset:0
v_mfma_f32_16x16x32_bf16 v[244:247], v[100:103], a[116:119], v[244:247]
ds_read_b64_tr_b16 v[114:115], v81 offset:1024
v_mfma_f32_16x16x32_bf16 v[240:243], v[100:103], a[112:115], v[240:243]
buffer_load_dwordx4 a[200:203], v1, s[60:63], s9 offen offset:0 sc1
v_mfma_f32_16x16x32_bf16 v[240:243], v[96:99], a[96:99], v[240:243]
s_waitcnt vmcnt(38) lgkmcnt(2)
v_mfma_f32_16x16x32_bf16 v[128:131], v[104:107], a[128:131], v[128:131]
s_waitcnt vmcnt(32)
ds_read_b64_tr_b16 v[116:117], v81 offset:8192
v_mfma_f32_16x16x32_bf16 v[128:131], v[108:111], a[144:147], v[128:131]
s_waitcnt vmcnt(30)
ds_read_b64_tr_b16 v[118:119], v81 offset:9216
v_mfma_f32_16x16x32_bf16 v[132:135], v[108:111], a[148:151], v[132:135]
s_lshl_b32 s29, s4, 7
v_mfma_f32_16x16x32_bf16 v[132:135], v[104:107], a[132:135], v[132:135]
s_add_u32 s29, s29, 395264
v_mfma_f32_16x16x32_bf16 v[136:139], v[104:107], a[136:139], v[136:139]
s_waitcnt vmcnt(29)
ds_read_b64_tr_b16 v[96:97], v82 offset:0
buffer_load_dwordx4 a[204:207], v1, s[60:63], s9 offen offset:1024 sc1
v_mfma_f32_16x16x32_bf16 v[136:139], v[108:111], a[152:155], v[136:139]
s_waitcnt vmcnt(28)
ds_read_b64_tr_b16 v[98:99], v82 offset:1024
v_mfma_f32_16x16x32_bf16 v[140:143], v[108:111], a[156:159], v[140:143]
s_cmp_eq_u32 s3, 0
s_cselect_b32 s28, s29, 268435456
s_cselect_b32 s39, 8, 0
v_mfma_f32_16x16x32_bf16 v[140:143], v[104:107], a[140:143], v[140:143]
s_waitcnt lgkmcnt(2)
v_mov_b32 v123, 0
v_mfma_f32_16x16x32_bf16 v[156:159], v[112:115], a[140:143], v[156:159]
ds_read_b64_tr_b16 v[100:101], v82 offset:8192
v_mfma_f32_16x16x32_bf16 v[156:159], v[116:119], a[156:159], v[156:159]
ds_read_b64_tr_b16 v[102:103], v82 offset:9216
v_mfma_f32_16x16x32_bf16 v[152:155], v[116:119], a[152:155], v[152:155]
buffer_load_dwordx4 a[208:211], v1, s[60:63], s8 offen offset:2048 sc1
v_mfma_f32_16x16x32_bf16 v[152:155], v[112:115], a[136:139], v[152:155]
v_mfma_f32_16x16x32_bf16 v[148:151], v[112:115], a[132:135], v[148:151]
ds_read_b64_tr_b16 v[104:105], v83 offset:0
v_mfma_f32_16x16x32_bf16 v[148:151], v[116:119], a[148:151], v[148:151]
ds_read_b64_tr_b16 v[106:107], v83 offset:1024
v_mfma_f32_16x16x32_bf16 v[144:147], v[116:119], a[144:147], v[144:147]
buffer_load_dwordx4 a[212:215], v1, s[60:63], s8 offen offset:3072 sc1
v_mfma_f32_16x16x32_bf16 v[144:147], v[112:115], a[128:131], v[144:147]
s_waitcnt lgkmcnt(2)
v_mfma_f32_16x16x32_bf16 v[160:163], v[96:99], a[128:131], v[160:163]
ds_read_b64_tr_b16 v[108:109], v83 offset:8192
v_mfma_f32_16x16x32_bf16 v[160:163], v[100:103], a[144:147], v[160:163]
ds_read_b64_tr_b16 v[110:111], v83 offset:9216
v_mfma_f32_16x16x32_bf16 v[164:167], v[100:103], a[148:151], v[164:167]
v_mfma_f32_16x16x32_bf16 v[164:167], v[96:99], a[132:135], v[164:167]
v_mfma_f32_16x16x32_bf16 v[168:171], v[96:99], a[136:139], v[168:171]
ds_read_b64_tr_b16 v[112:113], v84 offset:0
v_mfma_f32_16x16x32_bf16 v[168:171], v[100:103], a[152:155], v[168:171]
ds_read_b64_tr_b16 v[114:115], v84 offset:1024
v_mfma_f32_16x16x32_bf16 v[172:175], v[100:103], a[156:159], v[172:175]
buffer_load_dwordx4 a[216:219], v1, s[60:63], s9 offen offset:2048 sc1
v_mfma_f32_16x16x32_bf16 v[172:175], v[96:99], a[140:143], v[172:175]
s_waitcnt lgkmcnt(2)
v_mfma_f32_16x16x32_bf16 v[188:191], v[104:107], a[140:143], v[188:191]
ds_read_b64_tr_b16 v[116:117], v84 offset:8192
v_mfma_f32_16x16x32_bf16 v[188:191], v[108:111], a[156:159], v[188:191]
ds_read_b64_tr_b16 v[118:119], v84 offset:9216
v_mfma_f32_16x16x32_bf16 v[184:187], v[108:111], a[152:155], v[184:187]
s_add_u32 m0, s13, 114688
buffer_load_dwordx4 a[220:223], v1, s[60:63], s9 offen offset:3072 sc1
v_mfma_f32_16x16x32_bf16 v[184:187], v[104:107], a[136:139], v[184:187]
s_add_u32 s7, s15, 3670016
v_mfma_f32_16x16x32_bf16 v[180:183], v[104:107], a[132:135], v[180:183]
ds_read_b64_tr_b16 v[96:97], v85 offset:0
v_mfma_f32_16x16x32_bf16 v[180:183], v[108:111], a[148:151], v[180:183]
ds_read_b64_tr_b16 v[98:99], v85 offset:1024
v_mfma_f32_16x16x32_bf16 v[176:179], v[108:111], a[144:147], v[176:179]
buffer_load_dwordx4 v88, s[52:55], s7 offen offset:0  lds
v_mfma_f32_16x16x32_bf16 v[176:179], v[104:107], a[128:131], v[176:179]
s_waitcnt lgkmcnt(2)
v_mfma_f32_16x16x32_bf16 v[192:195], v[112:115], a[128:131], v[192:195]
ds_read_b64_tr_b16 v[100:101], v85 offset:8192
v_mfma_f32_16x16x32_bf16 v[192:195], v[116:119], a[144:147], v[192:195]
ds_read_b64_tr_b16 v[102:103], v85 offset:9216
v_mfma_f32_16x16x32_bf16 v[196:199], v[116:119], a[148:151], v[196:199]
v_mfma_f32_16x16x32_bf16 v[196:199], v[112:115], a[132:135], v[196:199]
v_mfma_f32_16x16x32_bf16 v[200:203], v[112:115], a[136:139], v[200:203]
ds_read_b64_tr_b16 v[104:105], v86 offset:0
v_mfma_f32_16x16x32_bf16 v[200:203], v[116:119], a[152:155], v[200:203]
ds_read_b64_tr_b16 v[106:107], v86 offset:1024
v_mfma_f32_16x16x32_bf16 v[204:207], v[116:119], a[156:159], v[204:207]
buffer_load_dwordx4 v89, s[52:55], s7 offen offset:1024  lds
v_mfma_f32_16x16x32_bf16 v[204:207], v[112:115], a[140:143], v[204:207]
s_waitcnt lgkmcnt(2)
v_mfma_f32_16x16x32_bf16 v[220:223], v[96:99], a[140:143], v[220:223]
ds_read_b64_tr_b16 v[108:109], v86 offset:8192
v_mfma_f32_16x16x32_bf16 v[220:223], v[100:103], a[156:159], v[220:223]
ds_read_b64_tr_b16 v[110:111], v86 offset:9216
v_mfma_f32_16x16x32_bf16 v[216:219], v[100:103], a[152:155], v[216:219]
buffer_load_dwordx4 v90, s[52:55], s7 offen offset:2048  lds
v_mfma_f32_16x16x32_bf16 v[216:219], v[96:99], a[136:139], v[216:219]
v_mfma_f32_16x16x32_bf16 v[212:215], v[96:99], a[132:135], v[212:215]
ds_read_b64_tr_b16 v[112:113], v87 offset:0
v_mfma_f32_16x16x32_bf16 v[212:215], v[100:103], a[148:151], v[212:215]
ds_read_b64_tr_b16 v[114:115], v87 offset:1024
v_mfma_f32_16x16x32_bf16 v[208:211], v[100:103], a[144:147], v[208:211]
buffer_load_dwordx4 v91, s[52:55], s7 offen offset:3072  lds
v_mfma_f32_16x16x32_bf16 v[208:211], v[96:99], a[128:131], v[208:211]
s_waitcnt lgkmcnt(2)
v_mfma_f32_16x16x32_bf16 v[224:227], v[104:107], a[128:131], v[224:227]
s_add_u32 s8, s99, 28672
ds_read_b64_tr_b16 v[116:117], v87 offset:8192
v_mfma_f32_16x16x32_bf16 v[224:227], v[108:111], a[144:147], v[224:227]
s_add_u32 s9, s100, 28672
ds_read_b64_tr_b16 v[118:119], v87 offset:9216
v_mfma_f32_16x16x32_bf16 v[228:231], v[108:111], a[148:151], v[228:231]
s_waitcnt vmcnt(16)
v_mfma_f32_16x16x32_bf16 v[228:231], v[104:107], a[132:135], v[228:231]
s_barrier
buffer_load_dwordx4 a[224:227], v1, s[60:63], s8 offen offset:0 sc1
v_mfma_f32_16x16x32_bf16 v[232:235], v[104:107], a[136:139], v[232:235]
ds_read_b64_tr_b16 v[96:97], v80 offset:16384
v_mfma_f32_16x16x32_bf16 v[232:235], v[108:111], a[152:155], v[232:235]
ds_read_b64_tr_b16 v[98:99], v80 offset:17408
v_mfma_f32_16x16x32_bf16 v[236:239], v[108:111], a[156:159], v[236:239]
buffer_atomic_add v127, v126, s[60:63], s28 offen sc1
v_mfma_f32_16x16x32_bf16 v[236:239], v[104:107], a[140:143], v[236:239]
s_waitcnt lgkmcnt(2)
v_mfma_f32_16x16x32_bf16 v[252:255], v[112:115], a[140:143], v[252:255]
ds_read_b64_tr_b16 v[100:101], v80 offset:24576
v_mfma_f32_16x16x32_bf16 v[252:255], v[116:119], a[156:159], v[252:255]
ds_read_b64_tr_b16 v[102:103], v80 offset:25600
v_mfma_f32_16x16x32_bf16 v[248:251], v[116:119], a[152:155], v[248:251]
buffer_load_dwordx4 a[228:231], v1, s[60:63], s8 offen offset:1024 sc1
v_mfma_f32_16x16x32_bf16 v[248:251], v[112:115], a[136:139], v[248:251]
v_mfma_f32_16x16x32_bf16 v[244:247], v[112:115], a[132:135], v[244:247]
ds_read_b64_tr_b16 v[104:105], v81 offset:16384
v_mfma_f32_16x16x32_bf16 v[244:247], v[116:119], a[148:151], v[244:247]
ds_read_b64_tr_b16 v[106:107], v81 offset:17408
v_mfma_f32_16x16x32_bf16 v[240:243], v[116:119], a[144:147], v[240:243]
buffer_load_dwordx4 a[232:235], v1, s[60:63], s9 offen offset:0 sc1
v_mfma_f32_16x16x32_bf16 v[240:243], v[112:115], a[128:131], v[240:243]
s_waitcnt lgkmcnt(2)
v_mfma_f32_16x16x32_bf16 v[128:131], v[96:99], a[160:163], v[128:131]
ds_read_b64_tr_b16 v[108:109], v81 offset:24576
v_mfma_f32_16x16x32_bf16 v[128:131], v[100:103], a[176:179], v[128:131]
ds_read_b64_tr_b16 v[110:111], v81 offset:25600
v_mfma_f32_16x16x32_bf16 v[132:135], v[100:103], a[180:183], v[132:135]
v_and_b32 v8, 7, v2
v_lshrrev_b32 v7, 2, v2
v_mfma_f32_16x16x32_bf16 v[132:135], v[96:99], a[164:167], v[132:135]
buffer_load_dwordx4 a[236:239], v1, s[60:63], s9 offen offset:1024 sc1
v_mfma_f32_16x16x32_bf16 v[136:139], v[96:99], a[168:171], v[136:139]
ds_read_b64_tr_b16 v[112:113], v82 offset:16384
v_and_b32 v7, 4, v7
v_mfma_f32_16x16x32_bf16 v[136:139], v[100:103], a[184:187], v[136:139]
ds_read_b64_tr_b16 v[114:115], v82 offset:17408
v_xor_b32 v8, v8, v7
v_mfma_f32_16x16x32_bf16 v[140:143], v[100:103], a[188:191], v[140:143]
v_lshlrev_b32 v9, 4, v8
v_lshrrev_b32 v7, 3, v2
v_mfma_f32_16x16x32_bf16 v[140:143], v[96:99], a[172:175], v[140:143]
s_waitcnt lgkmcnt(2)
v_mul_u32_u24 v93, 1280, v7
v_add_u32 v93, v93, v9
v_mfma_f32_16x16x32_bf16 v[156:159], v[104:107], a[172:175], v[156:159]
ds_read_b64_tr_b16 v[116:117], v82 offset:24576
v_mul_u32_u24 v94, 3456, v7
v_mfma_f32_16x16x32_bf16 v[156:159], v[108:111], a[188:191], v[156:159]
ds_read_b64_tr_b16 v[118:119], v82 offset:25600
v_add_u32 v94, v94, v9
v_mfma_f32_16x16x32_bf16 v[152:155], v[108:111], a[184:187], v[152:155]
buffer_load_dwordx4 a[240:243], v1, s[60:63], s8 offen offset:2048 sc1
v_mfma_f32_16x16x32_bf16 v[152:155], v[104:107], a[168:171], v[152:155]
v_lshrrev_b32 v7, 5, v2
v_mul_u32_u24 v92, 15360, v7
v_mfma_f32_16x16x32_bf16 v[148:151], v[104:107], a[164:167], v[148:151]
ds_read_b64_tr_b16 v[96:97], v83 offset:16384
v_add_u32 v92, v92, v93
v_mfma_f32_16x16x32_bf16 v[148:151], v[108:111], a[180:183], v[148:151]
ds_read_b64_tr_b16 v[98:99], v83 offset:17408
v_and_b32 v8, 15, v2
v_mfma_f32_16x16x32_bf16 v[144:147], v[108:111], a[176:179], v[144:147]
buffer_load_dwordx4 a[244:247], v1, s[60:63], s8 offen offset:3072 sc1
v_mfma_f32_16x16x32_bf16 v[144:147], v[104:107], a[160:163], v[144:147]
s_waitcnt lgkmcnt(2)
v_lshrrev_b32 v6, 4, v2
v_lshrrev_b32 v7, 2, v8
v_mfma_f32_16x16x32_bf16 v[160:163], v[112:115], a[160:163], v[160:163]
ds_read_b64_tr_b16 v[100:101], v83 offset:24576
v_lshl_add_u32 v7, v6, 3, v7
v_mfma_f32_16x16x32_bf16 v[160:163], v[116:119], a[176:179], v[160:163]
ds_read_b64_tr_b16 v[102:103], v83 offset:25600
v_lshlrev_b32 v7, 7, v7
v_mfma_f32_16x16x32_bf16 v[164:167], v[116:119], a[180:183], v[164:167]
v_and_b32 v9, 3, v2
v_lshl_add_u32 v95, v9, 4, v7
v_mfma_f32_16x16x32_bf16 v[164:167], v[112:115], a[164:167], v[164:167]
buffer_load_dwordx4 a[248:251], v1, s[60:63], s9 offen offset:2048 sc1
v_mfma_f32_16x16x32_bf16 v[168:171], v[112:115], a[168:171], v[168:171]
ds_read_b64_tr_b16 v[104:105], v84 offset:16384
v_and_b32 v9, 8, v2
v_mfma_f32_16x16x32_bf16 v[168:171], v[116:119], a[184:187], v[168:171]
ds_read_b64_tr_b16 v[106:107], v84 offset:17408
v_lshl_add_u32 v95, v9, 3, v95
v_mfma_f32_16x16x32_bf16 v[172:175], v[116:119], a[188:191], v[172:175]
v_lshlrev_b32 v7, 2, v6
v_sub_u32 v7, v8, v7
v_mfma_f32_16x16x32_bf16 v[172:175], v[112:115], a[172:175], v[172:175]
s_waitcnt lgkmcnt(2)
v_cmp_gt_i32 s[76:77], 0, v7
v_cmp_gt_i32 s[78:79], 1, v7
v_mfma_f32_16x16x32_bf16 v[188:191], v[96:99], a[172:175], v[188:191]
ds_read_b64_tr_b16 v[108:109], v84 offset:24576
v_cmp_gt_i32 s[80:81], 2, v7
v_mfma_f32_16x16x32_bf16 v[188:191], v[100:103], a[188:191], v[188:191]
ds_read_b64_tr_b16 v[110:111], v84 offset:25600
v_cmp_gt_i32 s[82:83], 3, v7
v_mfma_f32_16x16x32_bf16 v[184:187], v[100:103], a[184:187], v[184:187]
s_add_u32 m0, s13, 131072
buffer_load_dwordx4 a[252:255], v1, s[60:63], s9 offen offset:3072 sc1
v_mfma_f32_16x16x32_bf16 v[184:187], v[96:99], a[168:171], v[184:187]
s_add_u32 s7, s15, 4194304
v_mov_b32 v12, 0
v_mov_b32 v13, 0
v_mfma_f32_16x16x32_bf16 v[180:183], v[96:99], a[164:167], v[180:183]
ds_read_b64_tr_b16 v[112:113], v85 offset:16384
v_mov_b32 v14, 0
v_mfma_f32_16x16x32_bf16 v[180:183], v[100:103], a[180:183], v[180:183]
ds_read_b64_tr_b16 v[114:115], v85 offset:17408
v_mov_b32 v15, 0
v_mfma_f32_16x16x32_bf16 v[176:179], v[100:103], a[176:179], v[176:179]
buffer_load_dwordx4 v88, s[52:55], s7 offen offset:0  lds
v_mfma_f32_16x16x32_bf16 v[176:179], v[96:99], a[160:163], v[176:179]
s_waitcnt lgkmcnt(2)
v_mov_b32 v11, 0xf149f2ca
v_mov_b32 v10, 0x3f803f80
v_mfma_f32_16x16x32_bf16 v[192:195], v[104:107], a[160:163], v[192:195]
ds_read_b64_tr_b16 v[116:117], v85 offset:24576
v_mfma_f32_16x16x32_bf16 v[192:195], v[108:111], a[176:179], v[192:195]
ds_read_b64_tr_b16 v[118:119], v85 offset:25600
v_mfma_f32_16x16x32_bf16 v[196:199], v[108:111], a[180:183], v[196:199]
v_mfma_f32_16x16x32_bf16 v[196:199], v[104:107], a[164:167], v[196:199]
buffer_load_dwordx4 v89, s[52:55], s7 offen offset:1024  lds
v_mfma_f32_16x16x32_bf16 v[200:203], v[104:107], a[168:171], v[200:203]
ds_read_b64_tr_b16 v[96:97], v86 offset:16384
v_mfma_f32_16x16x32_bf16 v[200:203], v[108:111], a[184:187], v[200:203]
ds_read_b64_tr_b16 v[98:99], v86 offset:17408
v_mfma_f32_16x16x32_bf16 v[204:207], v[108:111], a[188:191], v[204:207]
v_mfma_f32_16x16x32_bf16 v[204:207], v[104:107], a[172:175], v[204:207]
s_waitcnt lgkmcnt(2)
v_mfma_f32_16x16x32_bf16 v[220:223], v[112:115], a[172:175], v[220:223]
ds_read_b64_tr_b16 v[100:101], v86 offset:24576
v_mfma_f32_16x16x32_bf16 v[220:223], v[116:119], a[188:191], v[220:223]
ds_read_b64_tr_b16 v[102:103], v86 offset:25600
v_mfma_f32_16x16x32_bf16 v[216:219], v[116:119], a[184:187], v[216:219]
buffer_load_dwordx4 v90, s[52:55], s7 offen offset:2048  lds
v_mfma_f32_16x16x32_bf16 v[216:219], v[112:115], a[168:171], v[216:219]
v_mfma_f32_16x16x32_bf16 v[212:215], v[112:115], a[164:167], v[212:215]
ds_read_b64_tr_b16 v[104:105], v87 offset:16384
v_mfma_f32_16x16x32_bf16 v[212:215], v[116:119], a[180:183], v[212:215]
ds_read_b64_tr_b16 v[106:107], v87 offset:17408
v_mfma_f32_16x16x32_bf16 v[208:211], v[116:119], a[176:179], v[208:211]
buffer_load_dwordx4 v91, s[52:55], s7 offen offset:3072  lds
v_mfma_f32_16x16x32_bf16 v[208:211], v[112:115], a[160:163], v[208:211]
s_waitcnt lgkmcnt(2)
v_mfma_f32_16x16x32_bf16 v[224:227], v[96:99], a[160:163], v[224:227]
s_add_u32 s8, s99, 32768
ds_read_b64_tr_b16 v[108:109], v87 offset:24576
v_mfma_f32_16x16x32_bf16 v[224:227], v[100:103], a[176:179], v[224:227]
s_add_u32 s9, s100, 32768
ds_read_b64_tr_b16 v[110:111], v87 offset:25600
v_mfma_f32_16x16x32_bf16 v[228:231], v[100:103], a[180:183], v[228:231]
s_waitcnt vmcnt(25)
v_mfma_f32_16x16x32_bf16 v[228:231], v[96:99], a[164:167], v[228:231]
s_barrier
buffer_load_dwordx4 a[0:3], v1, s[60:63], s8 offen offset:0 sc1
v_mfma_f32_16x16x32_bf16 v[232:235], v[96:99], a[168:171], v[232:235]
ds_read_b64_tr_b16 v[112:113], v80 offset:32768
v_mfma_f32_16x16x32_bf16 v[232:235], v[100:103], a[184:187], v[232:235]
ds_read_b64_tr_b16 v[114:115], v80 offset:33792
v_mfma_f32_16x16x32_bf16 v[236:239], v[100:103], a[188:191], v[236:239]
v_mfma_f32_16x16x32_bf16 v[236:239], v[96:99], a[172:175], v[236:239]
s_waitcnt lgkmcnt(2)
v_mfma_f32_16x16x32_bf16 v[252:255], v[104:107], a[172:175], v[252:255]
ds_read_b64_tr_b16 v[116:117], v80 offset:40960
v_mfma_f32_16x16x32_bf16 v[252:255], v[108:111], a[188:191], v[252:255]
ds_read_b64_tr_b16 v[118:119], v80 offset:41984
v_mfma_f32_16x16x32_bf16 v[248:251], v[108:111], a[184:187], v[248:251]
buffer_load_dwordx4 a[4:7], v1, s[60:63], s8 offen offset:1024 sc1
v_mfma_f32_16x16x32_bf16 v[248:251], v[104:107], a[168:171], v[248:251]
v_mfma_f32_16x16x32_bf16 v[244:247], v[104:107], a[164:167], v[244:247]
ds_read_b64_tr_b16 v[96:97], v81 offset:32768
v_mfma_f32_16x16x32_bf16 v[244:247], v[108:111], a[180:183], v[244:247]
ds_read_b64_tr_b16 v[98:99], v81 offset:33792
v_mfma_f32_16x16x32_bf16 v[240:243], v[108:111], a[176:179], v[240:243]
buffer_load_dwordx4 a[8:11], v1, s[60:63], s9 offen offset:0 sc1
v_mfma_f32_16x16x32_bf16 v[240:243], v[104:107], a[160:163], v[240:243]
s_waitcnt vmcnt(27) lgkmcnt(2)
v_mfma_f32_16x16x32_bf16 v[128:131], v[112:115], a[192:195], v[128:131]
s_waitcnt vmcnt(23)
ds_read_b64_tr_b16 v[100:101], v81 offset:40960
v_mfma_f32_16x16x32_bf16 v[128:131], v[116:119], a[208:211], v[128:131]
s_waitcnt vmcnt(22)
ds_read_b64_tr_b16 v[102:103], v81 offset:41984
v_mfma_f32_16x16x32_bf16 v[132:135], v[116:119], a[212:215], v[132:135]
v_mfma_f32_16x16x32_bf16 v[132:135], v[112:115], a[196:199], v[132:135]
buffer_load_dwordx4 a[12:15], v1, s[60:63], s9 offen offset:1024 sc1
v_mfma_f32_16x16x32_bf16 v[136:139], v[112:115], a[200:203], v[136:139]
s_waitcnt vmcnt(22)
ds_read_b64_tr_b16 v[104:105], v82 offset:32768
v_mfma_f32_16x16x32_bf16 v[136:139], v[116:119], a[216:219], v[136:139]
s_waitcnt vmcnt(21)
ds_read_b64_tr_b16 v[106:107], v82 offset:33792
v_mfma_f32_16x16x32_bf16 v[140:143], v[116:119], a[220:223], v[140:143]
v_mfma_f32_16x16x32_bf16 v[140:143], v[112:115], a[204:207], v[140:143]
s_waitcnt lgkmcnt(2)
v_mfma_f32_16x16x32_bf16 v[156:159], v[96:99], a[204:207], v[156:159]
ds_read_b64_tr_b16 v[108:109], v82 offset:40960
v_mfma_f32_16x16x32_bf16 v[156:159], v[100:103], a[220:223], v[156:159]
ds_read_b64_tr_b16 v[110:111], v82 offset:41984
v_mfma_f32_16x16x32_bf16 v[152:155], v[100:103], a[216:219], v[152:155]
buffer_load_dwordx4 a[16:19], v1, s[60:63], s8 offen offset:2048 sc1
v_mfma_f32_16x16x32_bf16 v[152:155], v[96:99], a[200:203], v[152:155]
v_mfma_f32_16x16x32_bf16 v[148:151], v[96:99], a[196:199], v[148:151]
ds_read_b64_tr_b16 v[112:113], v83 offset:32768
v_mfma_f32_16x16x32_bf16 v[148:151], v[100:103], a[212:215], v[148:151]
ds_read_b64_tr_b16 v[114:115], v83 offset:33792
v_mfma_f32_16x16x32_bf16 v[144:147], v[100:103], a[208:211], v[144:147]
buffer_load_dwordx4 a[20:23], v1, s[60:63], s8 offen offset:3072 sc1
v_mfma_f32_16x16x32_bf16 v[144:147], v[96:99], a[192:195], v[144:147]
s_waitcnt lgkmcnt(2)
v_mfma_f32_16x16x32_bf16 v[160:163], v[104:107], a[192:195], v[160:163]
ds_read_b64_tr_b16 v[116:117], v83 offset:40960
v_mfma_f32_16x16x32_bf16 v[160:163], v[108:111], a[208:211], v[160:163]
ds_read_b64_tr_b16 v[118:119], v83 offset:41984
v_mfma_f32_16x16x32_bf16 v[164:167], v[108:111], a[212:215], v[164:167]
v_mfma_f32_16x16x32_bf16 v[164:167], v[104:107], a[196:199], v[164:167]
buffer_load_dwordx4 a[24:27], v1, s[60:63], s9 offen offset:2048 sc1
v_mfma_f32_16x16x32_bf16 v[168:171], v[104:107], a[200:203], v[168:171]
s_getpc_b64 s[84:85]
L_fr_pcx1:
ds_read_b64_tr_b16 v[96:97], v84 offset:32768
v_mfma_f32_16x16x32_bf16 v[168:171], v[108:111], a[216:219], v[168:171]
s_add_u32 s84, s84, L_at_nd0-L_fr_pcx1
s_addc_u32 s85, s85, 0
ds_read_b64_tr_b16 v[98:99], v84 offset:33792
v_mfma_f32_16x16x32_bf16 v[172:175], v[108:111], a[220:223], v[172:175]
s_lshr_b32 s86, s2, 3
v_mfma_f32_16x16x32_bf16 v[172:175], v[104:107], a[204:207], v[172:175]
s_waitcnt lgkmcnt(2)
v_mfma_f32_16x16x32_bf16 v[188:191], v[112:115], a[204:207], v[188:191]
s_and_b32 s86, s86, 3
ds_read_b64_tr_b16 v[100:101], v84 offset:40960
v_mfma_f32_16x16x32_bf16 v[188:191], v[116:119], a[220:223], v[188:191]
s_add_u32 m0, s13, 147456
ds_read_b64_tr_b16 v[102:103], v84 offset:41984
v_mfma_f32_16x16x32_bf16 v[184:187], v[116:119], a[216:219], v[184:187]
s_add_u32 s7, s15, 4718592
buffer_load_dwordx4 a[28:31], v1, s[60:63], s9 offen offset:3072 sc1
v_mfma_f32_16x16x32_bf16 v[184:187], v[112:115], a[200:203], v[184:187]
s_lshl_b32 s86, s86, 13
v_mfma_f32_16x16x32_bf16 v[180:183], v[112:115], a[196:199], v[180:183]
s_lshr_b32 s87, s13, 1
ds_read_b64_tr_b16 v[104:105], v85 offset:32768
v_mfma_f32_16x16x32_bf16 v[180:183], v[116:119], a[212:215], v[180:183]
s_add_u32 s86, s86, s87
ds_read_b64_tr_b16 v[106:107], v85 offset:33792
v_and_b32 v125, 15, v2
v_mfma_f32_16x16x32_bf16 v[176:179], v[116:119], a[208:211], v[176:179]
buffer_load_dwordx4 v88, s[52:55], s7 offen offset:0  lds
v_mfma_f32_16x16x32_bf16 v[176:179], v[112:115], a[192:195], v[176:179]
s_waitcnt lgkmcnt(2)
v_lshl_add_u32 v125, v125, 7, s86
v_mfma_f32_16x16x32_bf16 v[192:195], v[96:99], a[192:195], v[192:195]
ds_read_b64_tr_b16 v[108:109], v85 offset:40960
v_mfma_f32_16x16x32_bf16 v[192:195], v[100:103], a[208:211], v[192:195]
ds_read_b64_tr_b16 v[110:111], v85 offset:41984
v_mfma_f32_16x16x32_bf16 v[196:199], v[100:103], a[212:215], v[196:199]
global_load_dword v125, v125, s[84:85]
v_mfma_f32_16x16x32_bf16 v[196:199], v[96:99], a[196:199], v[196:199]
buffer_load_dwordx4 v89, s[52:55], s7 offen offset:1024  lds
v_mfma_f32_16x16x32_bf16 v[200:203], v[96:99], a[200:203], v[200:203]
ds_read_b64_tr_b16 v[112:113], v86 offset:32768
v_mfma_f32_16x16x32_bf16 v[200:203], v[100:103], a[216:219], v[200:203]
ds_read_b64_tr_b16 v[114:115], v86 offset:33792
v_mfma_f32_16x16x32_bf16 v[204:207], v[100:103], a[220:223], v[204:207]
v_mfma_f32_16x16x32_bf16 v[204:207], v[96:99], a[204:207], v[204:207]
s_waitcnt lgkmcnt(2)
v_mfma_f32_16x16x32_bf16 v[220:223], v[104:107], a[204:207], v[220:223]
ds_read_b64_tr_b16 v[116:117], v86 offset:40960
v_mfma_f32_16x16x32_bf16 v[220:223], v[108:111], a[220:223], v[220:223]
ds_read_b64_tr_b16 v[118:119], v86 offset:41984
v_mfma_f32_16x16x32_bf16 v[216:219], v[108:111], a[216:219], v[216:219]
buffer_load_dwordx4 v90, s[52:55], s7 offen offset:2048  lds
v_mfma_f32_16x16x32_bf16 v[216:219], v[104:107], a[200:203], v[216:219]
v_mfma_f32_16x16x32_bf16 v[212:215], v[104:107], a[196:199], v[212:215]
ds_read_b64_tr_b16 v[96:97], v87 offset:32768
v_mfma_f32_16x16x32_bf16 v[212:215], v[108:111], a[212:215], v[212:215]
ds_read_b64_tr_b16 v[98:99], v87 offset:33792
v_mfma_f32_16x16x32_bf16 v[208:211], v[108:111], a[208:211], v[208:211]
buffer_load_dwordx4 v91, s[52:55], s7 offen offset:3072  lds
v_mfma_f32_16x16x32_bf16 v[208:211], v[104:107], a[192:195], v[208:211]
s_waitcnt lgkmcnt(2)
v_mfma_f32_16x16x32_bf16 v[224:227], v[112:115], a[192:195], v[224:227]
s_add_u32 s8, s99, 36864
ds_read_b64_tr_b16 v[100:101], v87 offset:40960
v_mfma_f32_16x16x32_bf16 v[224:227], v[116:119], a[208:211], v[224:227]
s_add_u32 s9, s100, 36864
ds_read_b64_tr_b16 v[102:103], v87 offset:41984
v_mfma_f32_16x16x32_bf16 v[228:231], v[116:119], a[212:215], v[228:231]
s_waitcnt vmcnt(26)
v_mfma_f32_16x16x32_bf16 v[228:231], v[112:115], a[196:199], v[228:231]
s_barrier
buffer_load_dwordx4 a[32:35], v1, s[60:63], s8 offen offset:0 sc1
v_mfma_f32_16x16x32_bf16 v[232:235], v[112:115], a[200:203], v[232:235]
ds_read_b64_tr_b16 v[104:105], v80 offset:49152
v_mfma_f32_16x16x32_bf16 v[232:235], v[116:119], a[216:219], v[232:235]
ds_read_b64_tr_b16 v[106:107], v80 offset:50176
v_mfma_f32_16x16x32_bf16 v[236:239], v[116:119], a[220:223], v[236:239]
v_mfma_f32_16x16x32_bf16 v[236:239], v[112:115], a[204:207], v[236:239]
s_waitcnt lgkmcnt(2)
v_mfma_f32_16x16x32_bf16 v[252:255], v[96:99], a[204:207], v[252:255]
ds_read_b64_tr_b16 v[108:109], v80 offset:57344
v_mfma_f32_16x16x32_bf16 v[252:255], v[100:103], a[220:223], v[252:255]
ds_read_b64_tr_b16 v[110:111], v80 offset:58368
v_add_u32 v80, 65536, v80
v_mfma_f32_16x16x32_bf16 v[248:251], v[100:103], a[216:219], v[248:251]
buffer_load_dwordx4 a[36:39], v1, s[60:63], s8 offen offset:1024 sc1
v_mfma_f32_16x16x32_bf16 v[248:251], v[96:99], a[200:203], v[248:251]
v_mfma_f32_16x16x32_bf16 v[244:247], v[96:99], a[196:199], v[244:247]
ds_read_b64_tr_b16 v[112:113], v81 offset:49152
v_mfma_f32_16x16x32_bf16 v[244:247], v[100:103], a[212:215], v[244:247]
ds_read_b64_tr_b16 v[114:115], v81 offset:50176
v_mfma_f32_16x16x32_bf16 v[240:243], v[100:103], a[208:211], v[240:243]
buffer_load_dwordx4 a[40:43], v1, s[60:63], s9 offen offset:0 sc1
v_mfma_f32_16x16x32_bf16 v[240:243], v[96:99], a[192:195], v[240:243]
s_waitcnt vmcnt(28) lgkmcnt(2)
v_mfma_f32_16x16x32_bf16 v[128:131], v[104:107], a[224:227], v[128:131]
s_waitcnt vmcnt(23)
s_min_u32 s33, s10, 539
ds_read_b64_tr_b16 v[116:117], v81 offset:57344
v_mfma_f32_16x16x32_bf16 v[128:131], v[108:111], a[240:243], v[128:131]
s_waitcnt vmcnt(22)
s_mul_hi_u32 s36, s33, 429496730
ds_read_b64_tr_b16 v[118:119], v81 offset:58368
v_add_u32 v81, 65536, v81
v_mfma_f32_16x16x32_bf16 v[132:135], v[108:111], a[244:247], v[132:135]
s_mul_i32 s37, s36, 10
v_mfma_f32_16x16x32_bf16 v[132:135], v[104:107], a[228:231], v[132:135]
s_sub_u32 s37, s33, s37
buffer_load_dwordx4 a[44:47], v1, s[60:63], s9 offen offset:1024 sc1
v_mfma_f32_16x16x32_bf16 v[136:139], v[104:107], a[232:235], v[136:139]
s_waitcnt vmcnt(22)
s_mul_i32 s44, s36, 40960
ds_read_b64_tr_b16 v[96:97], v82 offset:49152
v_mfma_f32_16x16x32_bf16 v[136:139], v[108:111], a[248:251], v[136:139]
s_waitcnt vmcnt(21)
s_lshl_b32 s45, s37, 7
ds_read_b64_tr_b16 v[98:99], v82 offset:50176
v_mfma_f32_16x16x32_bf16 v[140:143], v[108:111], a[252:255], v[140:143]
s_add_u32 s44, s44, s45
v_mfma_f32_16x16x32_bf16 v[140:143], v[104:107], a[236:239], v[140:143]
s_waitcnt lgkmcnt(2)
v_mfma_f32_16x16x32_bf16 v[156:159], v[112:115], a[236:239], v[156:159]
s_add_u32 s68, s34, s44
s_addc_u32 s69, s35, 0
ds_read_b64_tr_b16 v[100:101], v82 offset:57344
v_mfma_f32_16x16x32_bf16 v[156:159], v[116:119], a[252:255], v[156:159]
s_mov_b32 s70, 39808
ds_read_b64_tr_b16 v[102:103], v82 offset:58368
v_add_u32 v82, 65536, v82
v_mfma_f32_16x16x32_bf16 v[152:155], v[116:119], a[248:251], v[152:155]
s_mul_i32 s36, s36, 5120
buffer_load_dwordx4 a[48:51], v1, s[60:63], s8 offen offset:2048 sc1
v_mfma_f32_16x16x32_bf16 v[152:155], v[112:115], a[232:235], v[152:155]
s_add_u32 s36, s36, 23068672
v_mfma_f32_16x16x32_bf16 v[148:151], v[112:115], a[228:231], v[148:151]
s_lshl_b32 s44, s37, 2
ds_read_b64_tr_b16 v[104:105], v83 offset:49152
v_mfma_f32_16x16x32_bf16 v[148:151], v[116:119], a[244:247], v[148:151]
s_add_u32 s44, s44, 0
ds_read_b64_tr_b16 v[106:107], v83 offset:50176
v_mfma_f32_16x16x32_bf16 v[144:147], v[116:119], a[240:243], v[144:147]
s_mul_hi_u32 s45, s44, 858993460
buffer_load_dwordx4 a[52:55], v1, s[60:63], s8 offen offset:3072 sc1
v_mfma_f32_16x16x32_bf16 v[144:147], v[112:115], a[224:227], v[144:147]
s_waitcnt lgkmcnt(2)
v_mfma_f32_16x16x32_bf16 v[160:163], v[96:99], a[224:227], v[160:163]
s_mul_i32 s6, s45, 5
ds_read_b64_tr_b16 v[108:109], v83 offset:57344
v_mfma_f32_16x16x32_bf16 v[160:163], v[100:103], a[240:243], v[160:163]
s_sub_u32 s6, s44, s6
ds_read_b64_tr_b16 v[110:111], v83 offset:58368
v_add_u32 v83, 65536, v83
v_mfma_f32_16x16x32_bf16 v[164:167], v[100:103], a[244:247], v[164:167]
s_and_b32 s44, s45, 1
buffer_load_dwordx4 a[56:59], v1, s[60:63], s9 offen offset:2048 sc1
v_mfma_f32_16x16x32_bf16 v[164:167], v[96:99], a[228:231], v[164:167]
s_sub_i32 s6, s6, s44
v_mfma_f32_16x16x32_bf16 v[168:171], v[96:99], a[232:235], v[168:171]
s_cmp_lt_i32 s6, 0
s_cselect_b32 s6, 4, s6
ds_read_b64_tr_b16 v[112:113], v84 offset:49152
v_mfma_f32_16x16x32_bf16 v[168:171], v[100:103], a[248:251], v[168:171]
s_mul_i32 s45, s45, 276480
ds_read_b64_tr_b16 v[114:115], v84 offset:50176
v_mfma_f32_16x16x32_bf16 v[172:175], v[100:103], a[252:255], v[172:175]
s_lshl_b32 s6, s6, 10
buffer_load_dword v122, v123, s[60:63], s28 offen sc1
v_mfma_f32_16x16x32_bf16 v[172:175], v[96:99], a[236:239], v[172:175]
s_waitcnt lgkmcnt(2)
v_mfma_f32_16x16x32_bf16 v[188:191], v[104:107], a[236:239], v[188:191]
s_add_u32 s45, s45, s6
ds_read_b64_tr_b16 v[116:117], v84 offset:57344
v_mfma_f32_16x16x32_bf16 v[188:191], v[108:111], a[252:255], v[188:191]
s_add_u32 s52, s45, s36
ds_read_b64_tr_b16 v[118:119], v84 offset:58368
v_add_u32 v84, 65536, v84
v_mfma_f32_16x16x32_bf16 v[184:187], v[108:111], a[248:251], v[184:187]
s_lshl_b32 s44, s37, 2
buffer_load_dwordx4 a[60:63], v1, s[60:63], s9 offen offset:3072 sc1
v_mfma_f32_16x16x32_bf16 v[184:187], v[104:107], a[232:235], v[184:187]
s_add_u32 s44, s44, 1
v_mfma_f32_16x16x32_bf16 v[180:183], v[104:107], a[228:231], v[180:183]
s_mul_hi_u32 s45, s44, 858993460
ds_read_b64_tr_b16 v[96:97], v85 offset:49152
v_mfma_f32_16x16x32_bf16 v[180:183], v[108:111], a[244:247], v[180:183]
s_mul_i32 s6, s45, 5
ds_read_b64_tr_b16 v[98:99], v85 offset:50176
v_mfma_f32_16x16x32_bf16 v[176:179], v[108:111], a[240:243], v[176:179]
s_sub_u32 s6, s44, s6
v_mfma_f32_16x16x32_bf16 v[176:179], v[104:107], a[224:227], v[176:179]
s_waitcnt lgkmcnt(2)
v_mfma_f32_16x16x32_bf16 v[192:195], v[112:115], a[224:227], v[192:195]
s_and_b32 s44, s45, 1
ds_read_b64_tr_b16 v[100:101], v85 offset:57344
v_mfma_f32_16x16x32_bf16 v[192:195], v[116:119], a[240:243], v[192:195]
s_sub_i32 s6, s6, s44
ds_read_b64_tr_b16 v[102:103], v85 offset:58368
v_add_u32 v85, 65536, v85
v_mfma_f32_16x16x32_bf16 v[196:199], v[116:119], a[244:247], v[196:199]
s_cmp_lt_i32 s6, 0
s_cselect_b32 s6, 4, s6
v_mfma_f32_16x16x32_bf16 v[196:199], v[112:115], a[228:231], v[196:199]
s_mul_i32 s45, s45, 276480
v_mfma_f32_16x16x32_bf16 v[200:203], v[112:115], a[232:235], v[200:203]
s_lshl_b32 s6, s6, 10
ds_read_b64_tr_b16 v[104:105], v86 offset:49152
v_mfma_f32_16x16x32_bf16 v[200:203], v[116:119], a[248:251], v[200:203]
s_add_u32 s45, s45, s6
ds_read_b64_tr_b16 v[106:107], v86 offset:50176
v_mfma_f32_16x16x32_bf16 v[204:207], v[116:119], a[252:255], v[204:207]
s_add_u32 s53, s45, s36
v_mfma_f32_16x16x32_bf16 v[204:207], v[112:115], a[236:239], v[204:207]
s_waitcnt lgkmcnt(2)
v_mfma_f32_16x16x32_bf16 v[220:223], v[96:99], a[236:239], v[220:223]
s_lshl_b32 s44, s37, 2
ds_read_b64_tr_b16 v[108:109], v86 offset:57344
v_mfma_f32_16x16x32_bf16 v[220:223], v[100:103], a[252:255], v[220:223]
s_add_u32 s44, s44, 2
ds_read_b64_tr_b16 v[110:111], v86 offset:58368
v_add_u32 v86, 65536, v86
v_mfma_f32_16x16x32_bf16 v[216:219], v[100:103], a[248:251], v[216:219]
s_mul_hi_u32 s45, s44, 858993460
v_mfma_f32_16x16x32_bf16 v[216:219], v[96:99], a[232:235], v[216:219]
s_mul_i32 s6, s45, 5
v_mfma_f32_16x16x32_bf16 v[212:215], v[96:99], a[228:231], v[212:215]
s_sub_u32 s6, s44, s6
ds_read_b64_tr_b16 v[112:113], v87 offset:49152
v_mfma_f32_16x16x32_bf16 v[212:215], v[100:103], a[244:247], v[212:215]
s_and_b32 s44, s45, 1
ds_read_b64_tr_b16 v[114:115], v87 offset:50176
v_mfma_f32_16x16x32_bf16 v[208:211], v[100:103], a[240:243], v[208:211]
s_sub_i32 s6, s6, s44
v_mfma_f32_16x16x32_bf16 v[208:211], v[96:99], a[224:227], v[208:211]
s_waitcnt lgkmcnt(2)
v_mfma_f32_16x16x32_bf16 v[224:227], v[104:107], a[224:227], v[224:227]
s_cmp_lt_i32 s6, 0
s_cselect_b32 s6, 4, s6
ds_read_b64_tr_b16 v[116:117], v87 offset:57344
v_mfma_f32_16x16x32_bf16 v[224:227], v[108:111], a[240:243], v[224:227]
s_waitcnt vmcnt(1)
s_mul_i32 s45, s45, 276480
ds_read_b64_tr_b16 v[118:119], v87 offset:58368
v_add_u32 v87, 65536, v87
v_cmp_gt_u32 vcc, s39, v122
s_nop 1
s_cbranch_vccnz L_fr_spink
L_fr_gok:
v_mfma_f32_16x16x32_bf16 v[228:231], v[108:111], a[244:247], v[228:231]
v_mfma_f32_16x16x32_bf16 v[228:231], v[104:107], a[228:231], v[228:231]
s_lshl_b32 s6, s6, 10
s_barrier
v_mfma_f32_16x16x32_bf16 v[232:235], v[104:107], a[232:235], v[232:235]
s_add_u32 m0, s13, 0
ds_read_b64_tr_b16 v[96:97], v80 offset:0
v_mfma_f32_16x16x32_bf16 v[232:235], v[108:111], a[248:251], v[232:235]
s_add_u32 s7, s13, 0
ds_read_b64_tr_b16 v[98:99], v80 offset:1024
v_mfma_f32_16x16x32_bf16 v[236:239], v[108:111], a[252:255], v[236:239]
s_cmp_ge_u32 s3, 2
s_cmov_b32 s7, 268435456
v_mfma_f32_16x16x32_bf16 v[236:239], v[104:107], a[236:239], v[236:239]
s_waitcnt lgkmcnt(2)
buffer_load_dwordx4 v1, s[48:51], s7 offen offset:0 sc1 lds
v_mfma_f32_16x16x32_bf16 v[252:255], v[112:115], a[236:239], v[252:255]
s_add_u32 s45, s45, s6
ds_read_b64_tr_b16 v[100:101], v80 offset:8192
v_mfma_f32_16x16x32_bf16 v[252:255], v[116:119], a[252:255], v[252:255]
s_add_u32 s54, s45, s36
ds_read_b64_tr_b16 v[102:103], v80 offset:9216
v_mfma_f32_16x16x32_bf16 v[248:251], v[116:119], a[248:251], v[248:251]
s_lshl_b32 s44, s37, 2
buffer_load_dwordx4 v1, s[48:51], s7 offen offset:1024 sc1 lds
v_mfma_f32_16x16x32_bf16 v[248:251], v[112:115], a[232:235], v[248:251]
s_add_u32 s44, s44, 3
v_mfma_f32_16x16x32_bf16 v[244:247], v[112:115], a[228:231], v[244:247]
s_mul_hi_u32 s45, s44, 858993460
ds_read_b64_tr_b16 v[104:105], v81 offset:0
v_mfma_f32_16x16x32_bf16 v[244:247], v[116:119], a[244:247], v[244:247]
s_mul_i32 s6, s45, 5
ds_read_b64_tr_b16 v[106:107], v81 offset:1024
v_mfma_f32_16x16x32_bf16 v[240:243], v[116:119], a[240:243], v[240:243]
s_sub_u32 s6, s44, s6
v_mfma_f32_16x16x32_bf16 v[240:243], v[112:115], a[224:227], v[240:243]
s_waitcnt lgkmcnt(2)
buffer_load_dwordx4 v1, s[48:51], s7 offen offset:2048 sc1 lds
v_mfma_f32_16x16x32_bf16 v[128:131], v[96:99], a[0:3], v[128:131]
s_and_b32 s44, s45, 1
ds_read_b64_tr_b16 v[108:109], v81 offset:8192
v_mfma_f32_16x16x32_bf16 v[128:131], v[100:103], a[16:19], v[128:131]
s_sub_i32 s6, s6, s44
ds_read_b64_tr_b16 v[110:111], v81 offset:9216
v_mfma_f32_16x16x32_bf16 v[132:135], v[100:103], a[20:23], v[132:135]
s_cmp_lt_i32 s6, 0
s_cselect_b32 s6, 4, s6
v_mfma_f32_16x16x32_bf16 v[132:135], v[96:99], a[4:7], v[132:135]
s_mul_i32 s45, s45, 276480
v_mfma_f32_16x16x32_bf16 v[136:139], v[96:99], a[8:11], v[136:139]
s_lshl_b32 s6, s6, 10
ds_read_b64_tr_b16 v[112:113], v82 offset:0
v_accvgpr_write_b32 a176, v10
v_mfma_f32_16x16x32_bf16 v[136:139], v[100:103], a[24:27], v[136:139]
s_add_u32 s45, s45, s6
ds_read_b64_tr_b16 v[114:115], v82 offset:1024
v_accvgpr_write_b32 a177, v10
v_mfma_f32_16x16x32_bf16 v[140:143], v[100:103], a[28:31], v[140:143]
s_add_u32 s55, s45, s36
buffer_load_dwordx4 v1, s[48:51], s7 offen offset:3072 sc1 lds
v_mfma_f32_16x16x32_bf16 v[140:143], v[96:99], a[12:15], v[140:143]
s_waitcnt lgkmcnt(2)
s_cmp_ge_u32 s10, 540
s_cmov_b32 s52, 268435456
v_accvgpr_write_b32 a178, v10
v_mfma_f32_16x16x32_bf16 v[156:159], v[104:107], a[12:15], v[156:159]
s_add_u32 m0, s13, 16384
ds_read_b64_tr_b16 v[116:117], v82 offset:8192
v_accvgpr_write_b32 a179, v10
v_mfma_f32_16x16x32_bf16 v[156:159], v[108:111], a[28:31], v[156:159]
s_add_u32 s7, s13, 17408
ds_read_b64_tr_b16 v[118:119], v82 offset:9216
v_and_b32 v121, 31, v2
v_mfma_f32_16x16x32_bf16 v[152:155], v[108:111], a[24:27], v[152:155]
s_cmp_ge_u32 s3, 2
s_cmov_b32 s7, 268435456
v_mul_u32_u24 v120, 1280, v121
v_mfma_f32_16x16x32_bf16 v[152:155], v[104:107], a[8:11], v[152:155]
buffer_load_dwordx4 v1, s[48:51], s7 offen offset:0 sc1 lds
v_mfma_f32_16x16x32_bf16 v[148:151], v[104:107], a[4:7], v[148:151]
s_cmp_ge_u32 s10, 540
s_cmov_b32 s53, 268435456
ds_read_b64_tr_b16 v[96:97], v83 offset:0
v_mfma_f32_16x16x32_bf16 v[148:151], v[108:111], a[20:23], v[148:151]
s_cmp_ge_u32 s10, 540
s_cmov_b32 s54, 268435456
ds_read_b64_tr_b16 v[98:99], v83 offset:1024
v_mfma_f32_16x16x32_bf16 v[144:147], v[108:111], a[16:19], v[144:147]
s_cmp_ge_u32 s10, 540
s_cmov_b32 s55, 268435456
v_mul_u32_u24 v121, 3456, v121
v_mfma_f32_16x16x32_bf16 v[144:147], v[104:107], a[0:3], v[144:147]
s_waitcnt lgkmcnt(2)
buffer_load_dwordx4 v1, s[48:51], s7 offen offset:1024 sc1 lds
v_mfma_f32_16x16x32_bf16 v[160:163], v[112:115], a[0:3], v[160:163]
s_cmp_ge_u32 s10, 540
s_cmov_b32 s70, 0
ds_read_b64_tr_b16 v[100:101], v83 offset:8192
v_mfma_f32_16x16x32_bf16 v[160:163], v[116:119], a[16:19], v[160:163]
s_lshl_b32 s11, s3, 13
ds_read_b64_tr_b16 v[102:103], v83 offset:9216
v_mfma_f32_16x16x32_bf16 v[164:167], v[116:119], a[20:23], v[164:167]
s_add_u32 s11, s11, 131072
v_mfma_f32_16x16x32_bf16 v[164:167], v[112:115], a[4:7], v[164:167]
v_mfma_f32_16x16x32_bf16 v[168:171], v[112:115], a[8:11], v[168:171]
ds_read_b64_tr_b16 v[104:105], v84 offset:0
v_mfma_f32_16x16x32_bf16 v[168:171], v[116:119], a[24:27], v[168:171]
ds_read_b64_tr_b16 v[106:107], v84 offset:1024
v_mfma_f32_16x16x32_bf16 v[172:175], v[116:119], a[28:31], v[172:175]
buffer_load_dwordx4 v1, s[48:51], s7 offen offset:2048 sc1 lds
v_mfma_f32_16x16x32_bf16 v[172:175], v[112:115], a[12:15], v[172:175]
s_waitcnt lgkmcnt(2)
v_mfma_f32_16x16x32_bf16 v[188:191], v[96:99], a[12:15], v[188:191]
ds_read_b64_tr_b16 v[108:109], v84 offset:8192
v_mfma_f32_16x16x32_bf16 v[188:191], v[100:103], a[28:31], v[188:191]
ds_read_b64_tr_b16 v[110:111], v84 offset:9216
v_mfma_f32_16x16x32_bf16 v[184:187], v[100:103], a[24:27], v[184:187]
buffer_load_dwordx4 v1, s[48:51], s7 offen offset:3072 sc1 lds
v_mfma_f32_16x16x32_bf16 v[184:187], v[96:99], a[8:11], v[184:187]
s_add_u32 m0, s13, 32768
v_mfma_f32_16x16x32_bf16 v[180:183], v[96:99], a[4:7], v[180:183]
s_add_u32 s7, s13, 34816
ds_read_b64_tr_b16 v[112:113], v85 offset:0
v_mfma_f32_16x16x32_bf16 v[180:183], v[100:103], a[20:23], v[180:183]
ds_read_b64_tr_b16 v[114:115], v85 offset:1024
v_mfma_f32_16x16x32_bf16 v[176:179], v[100:103], a[16:19], v[176:179]
buffer_load_dwordx4 v1, s[48:51], s7 offen offset:0 sc1 lds
v_mfma_f32_16x16x32_bf16 v[176:179], v[96:99], a[0:3], v[176:179]
s_waitcnt lgkmcnt(2)
v_mfma_f32_16x16x32_bf16 v[192:195], v[104:107], a[0:3], v[192:195]
ds_read_b64_tr_b16 v[116:117], v85 offset:8192
v_mfma_f32_16x16x32_bf16 v[192:195], v[108:111], a[16:19], v[192:195]
ds_read_b64_tr_b16 v[118:119], v85 offset:9216
v_mfma_f32_16x16x32_bf16 v[196:199], v[108:111], a[20:23], v[196:199]
v_mfma_f32_16x16x32_bf16 v[196:199], v[104:107], a[4:7], v[196:199]
v_mfma_f32_16x16x32_bf16 v[200:203], v[104:107], a[8:11], v[200:203]
ds_read_b64_tr_b16 v[96:97], v86 offset:0
v_mfma_f32_16x16x32_bf16 v[200:203], v[108:111], a[24:27], v[200:203]
ds_read_b64_tr_b16 v[98:99], v86 offset:1024
v_mfma_f32_16x16x32_bf16 v[204:207], v[108:111], a[28:31], v[204:207]
buffer_load_dwordx4 v1, s[48:51], s7 offen offset:1024 sc1 lds
v_mfma_f32_16x16x32_bf16 v[204:207], v[104:107], a[12:15], v[204:207]
s_waitcnt lgkmcnt(2)
v_mfma_f32_16x16x32_bf16 v[220:223], v[112:115], a[12:15], v[220:223]
ds_read_b64_tr_b16 v[100:101], v86 offset:8192
v_mfma_f32_16x16x32_bf16 v[220:223], v[116:119], a[28:31], v[220:223]
ds_read_b64_tr_b16 v[102:103], v86 offset:9216
v_mfma_f32_16x16x32_bf16 v[216:219], v[116:119], a[24:27], v[216:219]
buffer_load_dwordx4 v1, s[48:51], s7 offen offset:2048 sc1 lds
v_mfma_f32_16x16x32_bf16 v[216:219], v[112:115], a[8:11], v[216:219]
v_mfma_f32_16x16x32_bf16 v[212:215], v[112:115], a[4:7], v[212:215]
ds_read_b64_tr_b16 v[104:105], v87 offset:0
v_mfma_f32_16x16x32_bf16 v[212:215], v[116:119], a[20:23], v[212:215]
ds_read_b64_tr_b16 v[106:107], v87 offset:1024
v_mfma_f32_16x16x32_bf16 v[208:211], v[116:119], a[16:19], v[208:211]
buffer_load_dwordx4 v1, s[48:51], s7 offen offset:3072 sc1 lds
v_mfma_f32_16x16x32_bf16 v[208:211], v[112:115], a[0:3], v[208:211]
s_waitcnt lgkmcnt(2)
v_mfma_f32_16x16x32_bf16 v[224:227], v[96:99], a[0:3], v[224:227]
s_add_u32 m0, s13, 49152
ds_read_b64_tr_b16 v[108:109], v87 offset:8192
v_mfma_f32_16x16x32_bf16 v[224:227], v[100:103], a[16:19], v[224:227]
s_add_u32 s7, s13, 52224
ds_read_b64_tr_b16 v[110:111], v87 offset:9216
v_mfma_f32_16x16x32_bf16 v[228:231], v[100:103], a[20:23], v[228:231]
v_mfma_f32_16x16x32_bf16 v[228:231], v[96:99], a[4:7], v[228:231]
s_barrier
v_mfma_f32_16x16x32_bf16 v[232:235], v[96:99], a[8:11], v[232:235]
ds_read_b64_tr_b16 v[112:113], v80 offset:16384
v_mfma_f32_16x16x32_bf16 v[232:235], v[100:103], a[24:27], v[232:235]
ds_read_b64_tr_b16 v[114:115], v80 offset:17408
v_mfma_f32_16x16x32_bf16 v[236:239], v[100:103], a[28:31], v[236:239]
buffer_load_dwordx4 v1, s[48:51], s7 offen offset:0 sc1 lds
v_mfma_f32_16x16x32_bf16 v[236:239], v[96:99], a[12:15], v[236:239]
s_waitcnt lgkmcnt(2)
v_mfma_f32_16x16x32_bf16 v[252:255], v[104:107], a[12:15], v[252:255]
ds_read_b64_tr_b16 v[116:117], v80 offset:24576
v_mfma_f32_16x16x32_bf16 v[252:255], v[108:111], a[28:31], v[252:255]
ds_read_b64_tr_b16 v[118:119], v80 offset:25600
v_mfma_f32_16x16x32_bf16 v[248:251], v[108:111], a[24:27], v[248:251]
buffer_load_dwordx4 v1, s[48:51], s7 offen offset:1024 sc1 lds
v_mfma_f32_16x16x32_bf16 v[248:251], v[104:107], a[8:11], v[248:251]
v_mfma_f32_16x16x32_bf16 v[244:247], v[104:107], a[4:7], v[244:247]
ds_read_b64_tr_b16 v[96:97], v81 offset:16384
v_mfma_f32_16x16x32_bf16 v[244:247], v[108:111], a[20:23], v[244:247]
ds_read_b64_tr_b16 v[98:99], v81 offset:17408
v_mfma_f32_16x16x32_bf16 v[240:243], v[108:111], a[16:19], v[240:243]
buffer_load_dwordx4 v1, s[48:51], s7 offen offset:2048 sc1 lds
v_mfma_f32_16x16x32_bf16 v[240:243], v[104:107], a[0:3], v[240:243]
s_waitcnt lgkmcnt(2)
v_mfma_f32_16x16x32_bf16 v[140:143], v[112:115], a[44:47], v[140:143]
s_waitcnt vmcnt(15)
ds_read_b64_tr_b16 v[100:101], v81 offset:24576
v_mfma_f32_16x16x32_bf16 v[140:143], v[116:119], a[60:63], v[140:143]
ds_read_b64_tr_b16 v[102:103], v81 offset:25600
v_mfma_f32_16x16x32_bf16 v[136:139], v[116:119], a[56:59], v[136:139]
v_mfma_f32_16x16x32_bf16 v[136:139], v[112:115], a[40:43], v[136:139]
v_mfma_f32_16x16x32_bf16 v[132:135], v[112:115], a[36:39], v[132:135]
ds_read_b64_tr_b16 v[104:105], v82 offset:16384
v_mfma_f32_16x16x32_bf16 v[132:135], v[116:119], a[52:55], v[132:135]
ds_read_b64_tr_b16 v[106:107], v82 offset:17408
v_mfma_f32_16x16x32_bf16 v[128:131], v[116:119], a[48:51], v[128:131]
buffer_load_dwordx4 v1, s[48:51], s7 offen offset:3072 sc1 lds
v_mfma_f32_16x16x32_bf16 v[128:131], v[112:115], a[32:35], v[128:131]
s_waitcnt lgkmcnt(2)
v_mfma_f32_16x16x32_bf16 v[156:159], v[96:99], a[44:47], v[156:159]
s_add_u32 m0, s13, 65536
ds_read_b64_tr_b16 v[108:109], v82 offset:24576
v_mfma_f32_16x16x32_bf16 v[156:159], v[100:103], a[60:63], v[156:159]
s_add_u32 s7, s13, 69632
ds_read_b64_tr_b16 v[110:111], v82 offset:25600
v_mfma_f32_16x16x32_bf16 v[152:155], v[100:103], a[56:59], v[152:155]
buffer_load_dwordx4 v1, s[48:51], s7 offen offset:0 sc1 lds
v_mfma_f32_16x16x32_bf16 v[152:155], v[96:99], a[40:43], v[152:155]
v_mfma_f32_16x16x32_bf16 v[148:151], v[96:99], a[36:39], v[148:151]
ds_read_b64_tr_b16 v[112:113], v83 offset:16384
v_mfma_f32_16x16x32_bf16 v[148:151], v[100:103], a[52:55], v[148:151]
ds_read_b64_tr_b16 v[114:115], v83 offset:17408
v_mfma_f32_16x16x32_bf16 v[144:147], v[100:103], a[48:51], v[144:147]
buffer_load_dwordx4 v1, s[48:51], s7 offen offset:1024 sc1 lds
v_mfma_f32_16x16x32_bf16 v[144:147], v[96:99], a[32:35], v[144:147]
s_waitcnt lgkmcnt(2)
v_mfma_f32_16x16x32_bf16 v[172:175], v[104:107], a[44:47], v[172:175]
ds_read_b64_tr_b16 v[116:117], v83 offset:24576
v_mfma_f32_16x16x32_bf16 v[172:175], v[108:111], a[60:63], v[172:175]
ds_read_b64_tr_b16 v[118:119], v83 offset:25600
v_mfma_f32_16x16x32_bf16 v[168:171], v[108:111], a[56:59], v[168:171]
v_mfma_f32_16x16x32_bf16 v[168:171], v[104:107], a[40:43], v[168:171]
buffer_load_dwordx4 v1, s[48:51], s7 offen offset:2048 sc1 lds
v_mfma_f32_16x16x32_bf16 v[164:167], v[104:107], a[36:39], v[164:167]
ds_read_b64_tr_b16 v[96:97], v84 offset:16384
v_mfma_f32_16x16x32_bf16 v[164:167], v[108:111], a[52:55], v[164:167]
ds_read_b64_tr_b16 v[98:99], v84 offset:17408
v_cvt_pk_bf16_f32 v32, v132, v133
v_mfma_f32_16x16x32_bf16 v[160:163], v[108:111], a[48:51], v[160:163]
v_cvt_pk_bf16_f32 v33, v134, v135
v_cvt_pk_bf16_f32 v34, v148, v149
v_mfma_f32_16x16x32_bf16 v[160:163], v[104:107], a[32:35], v[160:163]
s_waitcnt lgkmcnt(2)
v_cvt_pk_bf16_f32 v35, v150, v151
v_cvt_pk_bf16_f32 v16, v128, v129
v_mfma_f32_16x16x32_bf16 v[188:191], v[112:115], a[44:47], v[188:191]
ds_read_b64_tr_b16 v[100:101], v84 offset:24576
v_cvt_pk_bf16_f32 v17, v130, v131
v_mfma_f32_16x16x32_bf16 v[188:191], v[116:119], a[60:63], v[188:191]
ds_read_b64_tr_b16 v[102:103], v84 offset:25600
v_cvt_pk_bf16_f32 v18, v144, v145
v_mfma_f32_16x16x32_bf16 v[184:187], v[116:119], a[56:59], v[184:187]
buffer_load_dwordx4 v1, s[48:51], s7 offen offset:3072 sc1 lds
v_mfma_f32_16x16x32_bf16 v[184:187], v[112:115], a[40:43], v[184:187]
s_add_u32 m0, s13, 81920
v_cvt_pk_bf16_f32 v19, v146, v147
v_cvt_pk_bf16_f32 v76, v140, v141
v_mfma_f32_16x16x32_bf16 v[180:183], v[112:115], a[36:39], v[180:183]
s_add_u32 s7, s13, 87040
ds_read_b64_tr_b16 v[104:105], v85 offset:16384
v_cvt_pk_bf16_f32 v77, v142, v143
v_mfma_f32_16x16x32_bf16 v[180:183], v[116:119], a[52:55], v[180:183]
ds_read_b64_tr_b16 v[106:107], v85 offset:17408
v_cvt_pk_bf16_f32 v78, v156, v157
v_mfma_f32_16x16x32_bf16 v[176:179], v[116:119], a[48:51], v[176:179]
buffer_load_dwordx4 v1, s[48:51], s7 offen offset:0 sc1 lds
v_mfma_f32_16x16x32_bf16 v[176:179], v[112:115], a[32:35], v[176:179]
s_waitcnt lgkmcnt(2)
v_cvt_pk_bf16_f32 v79, v158, v159
v_accvgpr_write_b32 a80, v76
v_mfma_f32_16x16x32_bf16 v[204:207], v[96:99], a[44:47], v[204:207]
ds_read_b64_tr_b16 v[108:109], v85 offset:24576
v_accvgpr_write_b32 a81, v77
v_mfma_f32_16x16x32_bf16 v[204:207], v[100:103], a[60:63], v[204:207]
ds_read_b64_tr_b16 v[110:111], v85 offset:25600
v_accvgpr_write_b32 a82, v78
v_mfma_f32_16x16x32_bf16 v[200:203], v[100:103], a[56:59], v[200:203]
v_accvgpr_write_b32 a83, v79
v_cvt_pk_bf16_f32 v72, v136, v137
v_mfma_f32_16x16x32_bf16 v[200:203], v[96:99], a[40:43], v[200:203]
buffer_load_dwordx4 v1, s[48:51], s7 offen offset:1024 sc1 lds
v_mfma_f32_16x16x32_bf16 v[196:199], v[96:99], a[36:39], v[196:199]
ds_read_b64_tr_b16 v[112:113], v86 offset:16384
v_cvt_pk_bf16_f32 v73, v138, v139
v_mfma_f32_16x16x32_bf16 v[196:199], v[100:103], a[52:55], v[196:199]
ds_read_b64_tr_b16 v[114:115], v86 offset:17408
v_cvt_pk_bf16_f32 v74, v152, v153
v_mfma_f32_16x16x32_bf16 v[192:195], v[100:103], a[48:51], v[192:195]
v_cvt_pk_bf16_f32 v75, v154, v155
v_accvgpr_write_b32 a64, v72
v_mfma_f32_16x16x32_bf16 v[192:195], v[96:99], a[32:35], v[192:195]
s_waitcnt lgkmcnt(2)
v_accvgpr_write_b32 a65, v73
v_accvgpr_write_b32 a66, v74
v_mfma_f32_16x16x32_bf16 v[220:223], v[104:107], a[44:47], v[220:223]
ds_read_b64_tr_b16 v[116:117], v86 offset:24576
v_accvgpr_write_b32 a67, v75
v_mfma_f32_16x16x32_bf16 v[220:223], v[108:111], a[60:63], v[220:223]
ds_read_b64_tr_b16 v[118:119], v86 offset:25600
v_cvt_pk_bf16_f32 v36, v164, v165
v_mfma_f32_16x16x32_bf16 v[216:219], v[108:111], a[56:59], v[216:219]
buffer_load_dwordx4 v1, s[48:51], s7 offen offset:2048 sc1 lds
v_add_u32 v4, 0, v1
v_mfma_f32_16x16x32_bf16 v[216:219], v[104:107], a[40:43], v[216:219]
v_cvt_pk_bf16_f32 v37, v166, v167
v_cvt_pk_bf16_f32 v38, v180, v181
v_mfma_f32_16x16x32_bf16 v[212:215], v[104:107], a[36:39], v[212:215]
ds_read_b64_tr_b16 v[96:97], v87 offset:16384
v_cvt_pk_bf16_f32 v39, v182, v183
v_mfma_f32_16x16x32_bf16 v[212:215], v[108:111], a[52:55], v[212:215]
ds_read_b64_tr_b16 v[98:99], v87 offset:17408
v_cvt_pk_bf16_f32 v20, v160, v161
v_mfma_f32_16x16x32_bf16 v[208:211], v[108:111], a[48:51], v[208:211]
buffer_load_dwordx4 v1, s[48:51], s7 offen offset:3072 sc1 lds
v_mfma_f32_16x16x32_bf16 v[208:211], v[104:107], a[32:35], v[208:211]
s_waitcnt lgkmcnt(2)
v_cvt_pk_bf16_f32 v21, v162, v163
v_cvt_pk_bf16_f32 v22, v176, v177
v_mfma_f32_16x16x32_bf16 v[236:239], v[112:115], a[44:47], v[236:239]
ds_read_b64_tr_b16 v[100:101], v87 offset:24576
v_cvt_pk_bf16_f32 v23, v178, v179
v_mfma_f32_16x16x32_bf16 v[236:239], v[116:119], a[60:63], v[236:239]
ds_read_b64_tr_b16 v[102:103], v87 offset:25600
v_cvt_pk_bf16_f32 v68, v172, v173
v_mfma_f32_16x16x32_bf16 v[232:235], v[116:119], a[56:59], v[232:235]
v_cvt_pk_bf16_f32 v69, v174, v175
v_cvt_pk_bf16_f32 v70, v188, v189
v_mfma_f32_16x16x32_bf16 v[232:235], v[112:115], a[40:43], v[232:235]
v_cvt_pk_bf16_f32 v71, v190, v191
v_accvgpr_write_b32 a84, v68
v_mfma_f32_16x16x32_bf16 v[228:231], v[112:115], a[36:39], v[228:231]
v_accvgpr_write_b32 a85, v69
v_accvgpr_write_b32 a86, v70
v_mfma_f32_16x16x32_bf16 v[228:231], v[116:119], a[52:55], v[228:231]
s_waitcnt vmcnt(12) lgkmcnt(0)
v_accvgpr_write_b32 a87, v71
v_cvt_pk_bf16_f32 v40, v196, v197
v_mfma_f32_16x16x32_bf16 v[224:227], v[116:119], a[48:51], v[224:227]
s_barrier
v_cvt_pk_bf16_f32 v41, v198, v199
v_cvt_pk_bf16_f32 v42, v212, v213
v_mfma_f32_16x16x32_bf16 v[224:227], v[112:115], a[32:35], v[224:227]
ds_read_b128 a[96:99], v4 offset:0
v_cvt_pk_bf16_f32 v43, v214, v215
v_mfma_f32_16x16x32_bf16 v[252:255], v[96:99], a[44:47], v[252:255]
ds_read_b128 a[100:103], v4 offset:1024
v_cvt_pk_bf16_f32 v24, v192, v193
v_mfma_f32_16x16x32_bf16 v[252:255], v[100:103], a[60:63], v[252:255]
ds_read_b128 a[104:107], v4 offset:2048
v_cvt_pk_bf16_f32 v25, v194, v195
v_mfma_f32_16x16x32_bf16 v[248:251], v[100:103], a[56:59], v[248:251]
ds_read_b128 a[108:111], v4 offset:3072
v_cvt_pk_bf16_f32 v26, v208, v209
v_mfma_f32_16x16x32_bf16 v[248:251], v[96:99], a[40:43], v[248:251]
ds_read_b128 a[112:115], v4 offset:4096
v_cvt_pk_bf16_f32 v27, v210, v211
v_mfma_f32_16x16x32_bf16 v[244:247], v[96:99], a[36:39], v[244:247]
ds_read_b128 a[116:119], v4 offset:5120
v_mfma_f32_16x16x32_bf16 v[244:247], v[100:103], a[52:55], v[244:247]
ds_read_b128 a[120:123], v4 offset:6144
v_mfma_f32_16x16x32_bf16 v[240:243], v[100:103], a[48:51], v[240:243]
ds_read_b128 a[124:127], v4 offset:7168
v_mfma_f32_16x16x32_bf16 v[240:243], v[96:99], a[32:35], v[240:243]
global_load_dword a0, v120, s[64:65]
global_load_dword a0, v120, s[68:69]
global_load_dword a0, v121, s[72:73]
v_cvt_pk_bf16_f32 v44, v228, v229
v_cvt_pk_bf16_f32 v45, v230, v231
v_cvt_pk_bf16_f32 v28, v224, v225
v_cvt_pk_bf16_f32 v29, v226, v227
s_waitcnt lgkmcnt(7)
v_mfma_f32_16x16x32_bf16 v[48:51], a[96:99], v[16:19], 0
v_cvt_pk_bf16_f32 v46, v244, v245
v_cvt_pk_bf16_f32 v47, v246, v247
v_mfma_f32_16x16x32_bf16 v[56:59], a[96:99], v[32:35], 0
s_waitcnt lgkmcnt(6)
v_cvt_pk_bf16_f32 v30, v240, v241
v_cvt_pk_bf16_f32 v31, v242, v243
v_mfma_f32_16x16x32_bf16 v[56:59], a[100:103], v[36:39], v[56:59]
v_cvt_pk_bf16_f32 v64, v168, v169
v_cvt_pk_bf16_f32 v65, v170, v171
v_mfma_f32_16x16x32_bf16 v[48:51], a[100:103], v[20:23], v[48:51]
s_waitcnt lgkmcnt(5)
v_cvt_pk_bf16_f32 v66, v184, v185
v_cvt_pk_bf16_f32 v67, v186, v187
v_mfma_f32_16x16x32_bf16 v[48:51], a[104:107], v[24:27], v[48:51]
v_accvgpr_write_b32 a68, v64
v_accvgpr_write_b32 a69, v65
v_mfma_f32_16x16x32_bf16 v[56:59], a[104:107], v[40:43], v[56:59]
s_waitcnt lgkmcnt(4)
v_accvgpr_write_b32 a70, v66
v_accvgpr_write_b32 a71, v67
v_mfma_f32_16x16x32_bf16 v[56:59], a[108:111], v[44:47], v[56:59]
v_cvt_pk_bf16_f32 v76, v204, v205
v_cvt_pk_bf16_f32 v77, v206, v207
v_mfma_f32_16x16x32_bf16 v[48:51], a[108:111], v[28:31], v[48:51]
s_waitcnt lgkmcnt(3)
v_cvt_pk_bf16_f32 v78, v220, v221
v_cvt_pk_bf16_f32 v79, v222, v223
v_mfma_f32_16x16x32_bf16 v[52:55], a[112:115], v[16:19], 0
v_accvgpr_write_b32 a88, v76
v_accvgpr_write_b32 a89, v77
v_mfma_f32_16x16x32_bf16 v[60:63], a[112:115], v[32:35], 0
s_waitcnt lgkmcnt(2)
v_accvgpr_write_b32 a90, v78
v_accvgpr_write_b32 a91, v79
v_mfma_f32_16x16x32_bf16 v[60:63], a[116:119], v[36:39], v[60:63]
v_cvt_pk_bf16_f32 v72, v200, v201
v_cvt_pk_bf16_f32 v73, v202, v203
v_mfma_f32_16x16x32_bf16 v[52:55], a[116:119], v[20:23], v[52:55]
s_waitcnt lgkmcnt(1)
v_cvt_pk_bf16_f32 v74, v216, v217
v_cvt_pk_bf16_f32 v75, v218, v219
v_mfma_f32_16x16x32_bf16 v[52:55], a[120:123], v[24:27], v[52:55]
v_accvgpr_write_b32 a72, v72
v_accvgpr_write_b32 a73, v73
v_mfma_f32_16x16x32_bf16 v[60:63], a[120:123], v[40:43], v[60:63]
s_waitcnt lgkmcnt(0)
v_accvgpr_write_b32 a74, v74
v_accvgpr_write_b32 a75, v75
v_mfma_f32_16x16x32_bf16 v[60:63], a[124:127], v[44:47], v[60:63]
v_cvt_pk_bf16_f32 v68, v236, v237
v_cvt_pk_bf16_f32 v69, v238, v239
v_mfma_f32_16x16x32_bf16 v[52:55], a[124:127], v[28:31], v[52:55]
v_cvt_pk_bf16_f32 v70, v252, v253
v_cvt_pk_bf16_f32 v71, v254, v255
v_accvgpr_write_b32 a92, v68
v_accvgpr_write_b32 a93, v69
v_accvgpr_write_b32 a94, v70
v_accvgpr_write_b32 a95, v71
v_cvt_pk_bf16_f32 v64, v232, v233
v_cvt_pk_bf16_f32 v65, v234, v235
v_cvt_pk_bf16_f32 v66, v248, v249
v_cvt_pk_bf16_f32 v67, v250, v251
v_accvgpr_write_b32 a76, v64
v_accvgpr_write_b32 a77, v65
v_accvgpr_write_b32 a78, v66
v_accvgpr_write_b32 a79, v67
v_mfma_f32_16x16x32_bf16 v[64:67], a[96:99], a[64:67], 0
v_mfma_f32_16x16x32_bf16 v[72:75], a[96:99], a[80:83], 0
v_max3_f32 v6, v48, v49, v50
v_max3_f32 v6, v6, v51, v52
v_mfma_f32_16x16x32_bf16 v[72:75], a[100:103], a[84:87], v[72:75]
v_max3_f32 v6, v6, v53, v54
v_max_f32 v6, v6, v55
v_mfma_f32_16x16x32_bf16 v[64:67], a[100:103], a[68:71], v[64:67]
v_max3_f32 v7, v56, v57, v58
v_max3_f32 v7, v7, v59, v60
v_mfma_f32_16x16x32_bf16 v[64:67], a[104:107], a[72:75], v[64:67]
v_max3_f32 v7, v7, v61, v62
v_max_f32 v7, v7, v63
v_mfma_f32_16x16x32_bf16 v[72:75], a[104:107], a[88:91], v[72:75]
v_mov_b32 v8, v6
v_mov_b32 v9, v7
v_mfma_f32_16x16x32_bf16 v[72:75], a[108:111], a[92:95], v[72:75]
v_permlane16_swap_b32 v6, v8
v_permlane16_swap_b32 v7, v9
v_mfma_f32_16x16x32_bf16 v[64:67], a[108:111], a[76:79], v[64:67]
v_max_f32 v6, v6, v8
v_max_f32 v7, v7, v9
v_mfma_f32_16x16x32_bf16 v[68:71], a[112:115], a[64:67], 0
v_mov_b32 v8, v6
v_mov_b32 v9, v7
v_mfma_f32_16x16x32_bf16 v[76:79], a[112:115], a[80:83], 0
v_permlane32_swap_b32 v6, v8
v_permlane32_swap_b32 v7, v9
v_mfma_f32_16x16x32_bf16 v[76:79], a[116:119], a[84:87], v[76:79]
v_max_f32 v6, v6, v8
v_max_f32 v7, v7, v9
v_mfma_f32_16x16x32_bf16 v[68:71], a[116:119], a[68:71], v[68:71]
v_sub_f32 v48, v48, v6
v_sub_f32 v49, v49, v6
v_mfma_f32_16x16x32_bf16 v[68:71], a[120:123], a[72:75], v[68:71]
v_sub_f32 v50, v50, v6
v_sub_f32 v51, v51, v6
v_mfma_f32_16x16x32_bf16 v[76:79], a[120:123], a[88:91], v[76:79]
v_sub_f32 v52, v52, v6
v_sub_f32 v53, v53, v6
v_mfma_f32_16x16x32_bf16 v[76:79], a[124:127], a[92:95], v[76:79]
v_sub_f32 v54, v54, v6
v_sub_f32 v55, v55, v6
v_mfma_f32_16x16x32_bf16 v[68:71], a[124:127], a[76:79], v[68:71]
v_sub_f32 v56, v56, v7
v_sub_f32 v57, v57, v7
v_mfma_f32_32x32x16_bf16 v[128:143], v[12:15], v[12:15], 0
v_sub_f32 v58, v58, v7
v_sub_f32 v59, v59, v7
v_sub_f32 v60, v60, v7
v_sub_f32 v61, v61, v7
v_sub_f32 v62, v62, v7
v_sub_f32 v63, v63, v7
v_mfma_f32_32x32x16_bf16 v[144:159], v[12:15], v[12:15], 0
v_sub_f32 v96, 0, v6
v_sub_f32 v97, 0, v6
v_sub_f32 v98, 0, v6
v_sub_f32 v99, 0, v6
v_sub_f32 v100, 0, v6
v_sub_f32 v101, 0, v6
v_mfma_f32_32x32x16_bf16 v[160:175], v[12:15], v[12:15], 0
s_mov_b32 s84, 32768
v_sub_f32 v102, 0, v6
v_sub_f32 v103, 0, v6
v_sub_f32 v104, 0, v7
v_sub_f32 v105, 0, v7
v_sub_f32 v106, 0, v7
v_sub_f32 v107, 0, v7
v_mfma_f32_32x32x16_bf16 v[176:191], v[12:15], v[12:15], 0
s_mov_b32 s85, 32768
ds_read_b128 a[96:99], v4 offset:16384
ds_read_b128 a[100:103], v4 offset:17408
v_sub_f32 v108, 0, v7
v_sub_f32 v109, 0, v7
v_sub_f32 v110, 0, v7
v_sub_f32 v111, 0, v7
v_mfma_f32_32x32x16_bf16 v[192:207], v[12:15], v[12:15], 0
s_add_u32 s87, s13, 87040
ds_read_b128 a[104:107], v4 offset:18432
ds_read_b128 a[108:111], v4 offset:19456
v_exp_f32 v48, v48
v_exp_f32 v49, v49
v_mfma_f32_32x32x16_bf16 v[208:223], v[12:15], v[12:15], 0
s_mov_b32 s86, 81920
ds_read_b128 a[112:115], v4 offset:20480
ds_read_b128 a[116:119], v4 offset:21504
v_exp_f32 v50, v50
v_exp_f32 v51, v51
v_mfma_f32_32x32x16_bf16 v[224:239], v[12:15], v[12:15], 0
s_sub_u32 s14, 3, s3
ds_read_b128 a[120:123], v4 offset:22528
ds_read_b128 a[124:127], v4 offset:23552
v_exp_f32 v52, v52
v_exp_f32 v53, v53
v_mfma_f32_32x32x16_bf16 v[240:255], v[12:15], v[12:15], 0
s_sub_u32 s89, s88, 1
v_exp_f32 v54, v54
v_exp_f32 v55, v55
v_exp_f32 v56, v56
v_mfma_f32_32x32x16_bf16 a[160:175], v[12:15], v[12:15], 0
s_mov_b32 s101, 0
v_exp_f32 v57, v57
v_exp_f32 v58, v58
v_exp_f32 v59, v59
v_exp_f32 v60, v60
v_exp_f32 v61, v61
v_exp_f32 v62, v62
v_exp_f32 v63, v63
v_cvt_pk_bf16_f32 v80, v48, v49
v_cvt_pk_bf16_f32 v81, v50, v51
v_cvt_pk_bf16_f32 v82, v52, v53
v_cvt_pk_bf16_f32 v83, v54, v55
v_cvt_pk_bf16_f32 v84, v56, v57
v_cvt_pk_bf16_f32 v85, v58, v59
v_cvt_pk_bf16_f32 v86, v60, v61
v_cvt_pk_bf16_f32 v87, v62, v63
s_cmp_eq_u32 s88, 1
s_cbranch_scc1 L_at_dg0
L_at_nd0:
v_max3_f32 v6, v64, v65, v66
v_max3_f32 v6, v6, v67, v68
v_max3_f32 v6, v6, v69, v70
v_max_f32 v6, v6, v71
v_max3_f32 v7, v72, v73, v74
v_max3_f32 v7, v7, v75, v76
v_max3_f32 v7, v7, v77, v78
v_max_f32 v7, v7, v79
v_mov_b32 v8, v6
v_mov_b32 v9, v7
s_nop 0
v_permlane16_swap_b32 v6, v8
v_permlane16_swap_b32 v7, v9
v_max_f32 v6, v6, v8
v_max_f32 v7, v7, v9
v_mov_b32 v8, v6
v_mov_b32 v9, v7
s_nop 0
v_permlane32_swap_b32 v6, v8
v_permlane32_swap_b32 v7, v9
v_max_f32 v6, v6, v8
v_max_f32 v7, v7, v9
v_pk_add_f32 v[64:65], v[64:65], v[6:7] op_sel_hi:[1,0] neg_lo:[0,1] neg_hi:[0,1]
v_pk_add_f32 v[66:67], v[66:67], v[6:7] op_sel_hi:[1,0] neg_lo:[0,1] neg_hi:[0,1]
v_pk_add_f32 v[68:69], v[68:69], v[6:7] op_sel_hi:[1,0] neg_lo:[0,1] neg_hi:[0,1]
v_pk_add_f32 v[70:71], v[70:71], v[6:7] op_sel_hi:[1,0] neg_lo:[0,1] neg_hi:[0,1]
v_pk_add_f32 v[72:73], v[72:73], v[6:7] op_sel:[0,1] neg_lo:[0,1] neg_hi:[0,1]
v_pk_add_f32 v[74:75], v[74:75], v[6:7] op_sel:[0,1] neg_lo:[0,1] neg_hi:[0,1]
v_pk_add_f32 v[76:77], v[76:77], v[6:7] op_sel:[0,1] neg_lo:[0,1] neg_hi:[0,1]
v_pk_add_f32 v[78:79], v[78:79], v[6:7] op_sel:[0,1] neg_lo:[0,1] neg_hi:[0,1]
v_pk_add_f32 v[112:113], v[12:13], v[6:7] op_sel_hi:[1,0] neg_lo:[0,1] neg_hi:[0,1]
v_pk_add_f32 v[114:115], v[12:13], v[6:7] op_sel_hi:[1,0] neg_lo:[0,1] neg_hi:[0,1]
v_pk_add_f32 v[116:117], v[12:13], v[6:7] op_sel_hi:[1,0] neg_lo:[0,1] neg_hi:[0,1]
v_pk_add_f32 v[118:119], v[12:13], v[6:7] op_sel_hi:[1,0] neg_lo:[0,1] neg_hi:[0,1]
v_pk_add_f32 v[120:121], v[12:13], v[6:7] op_sel:[0,1] neg_lo:[0,1] neg_hi:[0,1]
v_pk_add_f32 v[122:123], v[12:13], v[6:7] op_sel:[0,1] neg_lo:[0,1] neg_hi:[0,1]
v_pk_add_f32 v[124:125], v[12:13], v[6:7] op_sel:[0,1] neg_lo:[0,1] neg_hi:[0,1]
v_pk_add_f32 v[126:127], v[12:13], v[6:7] op_sel:[0,1] neg_lo:[0,1] neg_hi:[0,1]
v_mov_b32 v12, v92
v_mov_b32 v13, v92
v_mov_b32 v14, v93
v_mov_b32 v15, v94
v_add_u32 v10, s11, v95
v_xor_b32 v9, 64, v10
v_add_u32 v4, 32768, v1
v_add_u32 v5, 32768, v1
s_cmp_lt_u32 s5, 6
s_cselect_b32 s15, 7, 0
s_cmp_eq_u32 s5, 6
s_cmov_b32 s15, 3
s_cmp_ge_u32 s5, 3
s_waitcnt lgkmcnt(0)
s_cbranch_scc1 L_at_pf
s_cmp_eq_u32 s5, 0
s_cbranch_scc1 L_at_trans
s_branch L_at_shared
L_at_dg0:
v_cndmask_b32 v64, v64, v11, s[76:77]
v_cndmask_b32 v65, v65, v11, s[78:79]
v_cndmask_b32 v66, v66, v11, s[80:81]
v_cndmask_b32 v67, v67, v11, s[82:83]
v_mov_b32 v68, v11
v_mov_b32 v69, v11
v_mov_b32 v70, v11
v_mov_b32 v71, v11
v_cndmask_b32 v76, v76, v11, s[76:77]
v_cndmask_b32 v77, v77, v11, s[78:79]
v_cndmask_b32 v78, v78, v11, s[80:81]
v_cndmask_b32 v79, v79, v11, s[82:83]
s_branch L_at_nd0
L_at_pf:
s_sub_u32 s101, s89, 10
.p2align 5
L_at_pfl:
v_mfma_f32_16x16x32_bf16 v[48:51], a[96:99], v[16:19], v[96:99]
s_xor_b32 s11, s11, 4096
v_exp_f32 v64, v64
v_mfma_f32_16x16x32_bf16 v[48:51], a[100:103], v[20:23], v[48:51]
ds_read_b128 a[128:131], v5 offset:8192
ds_read_b128 a[132:135], v5 offset:9216
v_mfma_f32_16x16x32_bf16 v[48:51], a[104:107], v[24:27], v[48:51]
s_mov_b32 m0, s11
v_exp_f32 v65, v65
v_mfma_f32_16x16x32_bf16 v[48:51], a[108:111], v[28:31], v[48:51]
ds_read_b128 a[136:139], v5 offset:10240
v_cvt_pk_bf16_f32 v88, v64, v65
v_mfma_f32_16x16x32_bf16 v[56:59], a[108:111], v[44:47], v[104:107]
s_lshl_b32 s8, s12, 1
v_exp_f32 v66, v66
v_mfma_f32_16x16x32_bf16 v[56:59], a[104:107], v[40:43], v[56:59]
buffer_load_dwordx4 v12, s[56:59], 0 offen offset:0 lds
v_mfma_f32_16x16x32_bf16 v[56:59], a[100:103], v[36:39], v[56:59]
s_add_u32 s9, s8, s12
v_exp_f32 v67, v67
v_mfma_f32_16x16x32_bf16 v[56:59], a[96:99], v[32:35], v[56:59]
s_waitcnt lgkmcnt(3)
ds_read_b128 a[140:143], v5 offset:11264
v_cvt_pk_bf16_f32 v89, v66, v67
v_mfma_f32_16x16x32_bf16 v[52:55], a[112:115], v[16:19], v[100:103]
v_exp_f32 v68, v68
v_mfma_f32_16x16x32_bf16 v[52:55], a[116:119], v[20:23], v[52:55]
ds_read_b128 a[144:147], v5 offset:12288
ds_read_b128 a[148:151], v5 offset:13312
v_mfma_f32_16x16x32_bf16 v[52:55], a[120:123], v[24:27], v[52:55]
v_exp_f32 v69, v69
v_mfma_f32_16x16x32_bf16 v[52:55], a[124:127], v[28:31], v[52:55]
ds_read_b128 a[152:155], v5 offset:14336
v_cvt_pk_bf16_f32 v90, v68, v69
v_mfma_f32_16x16x32_bf16 v[60:63], a[124:127], v[44:47], v[108:111]
v_exp_f32 v70, v70
v_mfma_f32_16x16x32_bf16 v[60:63], a[120:123], v[40:43], v[60:63]
buffer_load_dwordx4 v12, s[56:59], s12 offen offset:1024 lds
v_mfma_f32_16x16x32_bf16 v[60:63], a[116:119], v[36:39], v[60:63]
s_waitcnt vmcnt(10)
v_exp_f32 v71, v71
v_mfma_f32_16x16x32_bf16 v[60:63], a[112:115], v[32:35], v[60:63]
s_waitcnt lgkmcnt(1)
ds_read_b128 a[156:159], v5 offset:15360
v_cvt_pk_bf16_f32 v91, v70, v71
v_mfma_f32_16x16x32_bf16 v[128:131], a[128:131], v[80:83], v[128:131]
v_exp_f32 v72, v72
v_mfma_f32_16x16x32_bf16 v[132:135], a[128:131], v[84:87], v[132:135]
s_barrier
ds_read_b64_tr_b16 a[192:193], v10 offset:0
ds_read_b64_tr_b16 a[194:195], v10 offset:512
v_mfma_f32_16x16x32_bf16 v[140:143], a[132:135], v[84:87], v[140:143]
s_add_u32 s85, s85, 16384
v_exp_f32 v73, v73
v_mfma_f32_16x16x32_bf16 v[136:139], a[132:135], v[80:83], v[136:139]
ds_read_b64_tr_b16 a[196:197], v10 offset:8
v_cvt_pk_bf16_f32 v92, v72, v73
v_mfma_f32_16x16x32_bf16 v[144:147], a[136:139], v[80:83], v[144:147]
s_cmp_eq_u32 s85, 131072
v_exp_f32 v74, v74
v_mfma_f32_16x16x32_bf16 v[148:151], a[136:139], v[84:87], v[148:151]
ds_read_b64_tr_b16 a[198:199], v10 offset:520
ds_read_b64_tr_b16 a[200:201], v9 offset:0
v_mfma_f32_16x16x32_bf16 v[156:159], a[140:143], v[84:87], v[156:159]
s_cselect_b32 s85, 0, s85
v_exp_f32 v75, v75
v_mfma_f32_16x16x32_bf16 v[152:155], a[140:143], v[80:83], v[152:155]
s_waitcnt lgkmcnt(5)
ds_read_b64_tr_b16 a[202:203], v9 offset:512
v_cvt_pk_bf16_f32 v93, v74, v75
v_mfma_f32_16x16x32_bf16 v[160:163], a[144:147], v[80:83], v[160:163]
v_exp_f32 v76, v76
v_mfma_f32_16x16x32_bf16 v[164:167], a[144:147], v[84:87], v[164:167]
buffer_load_dwordx4 v12, s[56:59], s8 offen offset:2048 lds
v_mfma_f32_16x16x32_bf16 v[172:175], a[148:151], v[84:87], v[172:175]
v_exp_f32 v77, v77
v_mfma_f32_16x16x32_bf16 v[168:171], a[148:151], v[80:83], v[168:171]
ds_read_b64_tr_b16 a[204:205], v9 offset:8
v_cvt_pk_bf16_f32 v94, v76, v77
v_mfma_f32_16x16x32_bf16 v[176:179], a[152:155], v[80:83], v[176:179]
v_exp_f32 v78, v78
v_mfma_f32_16x16x32_bf16 v[180:183], a[152:155], v[84:87], v[180:183]
buffer_load_dwordx4 v12, s[56:59], s9 offen offset:3072 lds
v_mfma_f32_16x16x32_bf16 v[188:191], a[156:159], v[84:87], v[188:191]
v_exp_f32 v79, v79
v_mfma_f32_16x16x32_bf16 v[184:187], a[156:159], v[80:83], v[184:187]
ds_read_b64_tr_b16 a[206:207], v9 offset:520
v_cvt_pk_bf16_f32 v95, v78, v79
v_mfma_f32_16x16x32_bf16 a[160:163], a[176:179], v[80:83], a[160:163]
v_add_u32 v5, s85, v1
v_mov_b32 v12, v13
v_mfma_f32_16x16x32_bf16 a[164:167], a[176:179], v[84:87], a[164:167]
v_xor_b32 v10, 4096, v10
v_xor_b32 v9, 4096, v9
v_mfma_f32_16x16x32_bf16 v[64:67], a[96:99], a[64:67], v[112:115]
s_add_u32 s86, s86, 16384
v_exp_f32 v48, v48
v_mfma_f32_16x16x32_bf16 v[64:67], a[100:103], a[68:71], v[64:67]
s_cmp_eq_u32 s86, 131072
v_mov_b32 v13, v14
v_mov_b32 v14, v15
v_mfma_f32_16x16x32_bf16 v[64:67], a[104:107], a[72:75], v[64:67]
s_cselect_b32 s86, 0, s86
v_exp_f32 v49, v49
v_mfma_f32_16x16x32_bf16 v[64:67], a[108:111], a[76:79], v[64:67]
s_add_u32 m0, s86, s13
v_cvt_pk_bf16_f32 v80, v48, v49
v_mfma_f32_16x16x32_bf16 v[72:75], a[108:111], a[92:95], v[120:123]
s_add_u32 s87, s87, 17408
v_exp_f32 v50, v50
v_mfma_f32_16x16x32_bf16 v[72:75], a[104:107], a[88:91], v[72:75]
buffer_load_dwordx4 v1, s[48:51], s87 offen offset:0 sc1 lds
v_mfma_f32_16x16x32_bf16 v[72:75], a[100:103], a[84:87], v[72:75]
v_exp_f32 v51, v51
v_mfma_f32_16x16x32_bf16 v[72:75], a[96:99], a[80:83], v[72:75]
v_cvt_pk_bf16_f32 v81, v50, v51
v_mfma_f32_16x16x32_bf16 v[68:71], a[112:115], a[64:67], v[116:119]
s_waitcnt lgkmcnt(0)
v_exp_f32 v52, v52
v_mfma_f32_16x16x32_bf16 v[68:71], a[116:119], a[68:71], v[68:71]
buffer_store_dwordx4 a[192:195], v1, s[60:63], s16 offen sc1
v_mfma_f32_16x16x32_bf16 v[68:71], a[120:123], a[72:75], v[68:71]
v_exp_f32 v53, v53
v_mfma_f32_16x16x32_bf16 v[68:71], a[124:127], a[76:79], v[68:71]
v_cvt_pk_bf16_f32 v82, v52, v53
v_mfma_f32_16x16x32_bf16 v[76:79], a[124:127], a[92:95], v[124:127]
v_exp_f32 v54, v54
v_mfma_f32_16x16x32_bf16 v[76:79], a[120:123], a[88:91], v[76:79]
buffer_load_dwordx4 v1, s[48:51], s87 offen offset:1024 sc1 lds
v_mfma_f32_16x16x32_bf16 v[76:79], a[116:119], a[84:87], v[76:79]
v_exp_f32 v55, v55
v_mfma_f32_16x16x32_bf16 v[76:79], a[112:115], a[80:83], v[76:79]
v_cvt_pk_bf16_f32 v83, v54, v55
v_mfma_f32_16x16x32_bf16 v[192:195], a[128:131], v[88:91], v[192:195]
v_exp_f32 v56, v56
v_mfma_f32_16x16x32_bf16 v[196:199], a[128:131], v[92:95], v[196:199]
ds_read_b128 a[96:99], v4 offset:0
ds_read_b128 a[100:103], v4 offset:1024
v_mfma_f32_16x16x32_bf16 v[204:207], a[132:135], v[92:95], v[204:207]
v_exp_f32 v57, v57
v_mfma_f32_16x16x32_bf16 v[200:203], a[132:135], v[88:91], v[200:203]
ds_read_b128 a[104:107], v4 offset:2048
v_cvt_pk_bf16_f32 v84, v56, v57
v_mfma_f32_16x16x32_bf16 v[208:211], a[136:139], v[88:91], v[208:211]
v_exp_f32 v58, v58
v_mfma_f32_16x16x32_bf16 v[212:215], a[136:139], v[92:95], v[212:215]
buffer_load_dwordx4 v1, s[48:51], s87 offen offset:2048 sc1 lds
v_mfma_f32_16x16x32_bf16 v[220:223], a[140:143], v[92:95], v[220:223]
v_exp_f32 v59, v59
v_mfma_f32_16x16x32_bf16 v[216:219], a[140:143], v[88:91], v[216:219]
ds_read_b128 a[108:111], v4 offset:3072
v_cvt_pk_bf16_f32 v85, v58, v59
v_mfma_f32_16x16x32_bf16 v[224:227], a[144:147], v[88:91], v[224:227]
s_add_u32 s84, s84, 16384
v_exp_f32 v60, v60
v_mfma_f32_16x16x32_bf16 v[228:231], a[144:147], v[92:95], v[228:231]
s_cmp_eq_u32 s84, 131072
ds_read_b128 a[112:115], v4 offset:4096
ds_read_b128 a[116:119], v4 offset:5120
v_mfma_f32_16x16x32_bf16 v[236:239], a[148:151], v[92:95], v[236:239]
s_cselect_b32 s84, 0, s84
v_exp_f32 v61, v61
v_mfma_f32_16x16x32_bf16 v[232:235], a[148:151], v[88:91], v[232:235]
ds_read_b128 a[120:123], v4 offset:6144
v_cvt_pk_bf16_f32 v86, v60, v61
v_mfma_f32_16x16x32_bf16 v[240:243], a[152:155], v[88:91], v[240:243]
v_exp_f32 v62, v62
v_mfma_f32_16x16x32_bf16 v[244:247], a[152:155], v[92:95], v[244:247]
buffer_load_dwordx4 v1, s[48:51], s87 offen offset:3072 sc1 lds
v_mfma_f32_16x16x32_bf16 v[252:255], a[156:159], v[92:95], v[252:255]
v_exp_f32 v63, v63
v_mfma_f32_16x16x32_bf16 v[248:251], a[156:159], v[88:91], v[248:251]
ds_read_b128 a[124:127], v4 offset:7168
v_cvt_pk_bf16_f32 v87, v62, v63
v_mfma_f32_16x16x32_bf16 a[168:171], a[176:179], v[88:91], a[168:171]
v_add_u32 v4, s84, v1
v_mfma_f32_16x16x32_bf16 a[172:175], a[176:179], v[92:95], a[172:175]
s_waitcnt lgkmcnt(2)
buffer_store_dwordx4 a[196:199], v1, s[60:63], s17 offen sc1
v_mfma_f32_16x16x32_bf16 v[48:51], a[96:99], v[16:19], v[96:99]
s_mov_b64 s[56:57], s[64:65]
v_exp_f32 v64, v64
v_mfma_f32_16x16x32_bf16 v[48:51], a[100:103], v[20:23], v[48:51]
ds_read_b128 a[128:131], v5 offset:8192
ds_read_b128 a[132:135], v5 offset:9216
v_mfma_f32_16x16x32_bf16 v[48:51], a[104:107], v[24:27], v[48:51]
s_mov_b32 s58, s66
v_exp_f32 v65, v65
v_mfma_f32_16x16x32_bf16 v[48:51], a[108:111], v[28:31], v[48:51]
ds_read_b128 a[136:139], v5 offset:10240
v_cvt_pk_bf16_f32 v88, v64, v65
v_mfma_f32_16x16x32_bf16 v[56:59], a[108:111], v[44:47], v[104:107]
s_mov_b32 s12, s67
v_exp_f32 v66, v66
v_mfma_f32_16x16x32_bf16 v[56:59], a[104:107], v[40:43], v[56:59]
buffer_store_dwordx4 a[200:203], v1, s[60:63], s18 offen sc1
v_mfma_f32_16x16x32_bf16 v[56:59], a[100:103], v[36:39], v[56:59]
s_mov_b64 s[64:65], s[68:69]
v_exp_f32 v67, v67
v_mfma_f32_16x16x32_bf16 v[56:59], a[96:99], v[32:35], v[56:59]
s_waitcnt lgkmcnt(3)
ds_read_b128 a[140:143], v5 offset:11264
v_cvt_pk_bf16_f32 v89, v66, v67
v_mfma_f32_16x16x32_bf16 v[52:55], a[112:115], v[16:19], v[100:103]
s_mov_b64 s[66:67], s[70:71]
v_exp_f32 v68, v68
v_mfma_f32_16x16x32_bf16 v[52:55], a[116:119], v[20:23], v[52:55]
ds_read_b128 a[144:147], v5 offset:12288
ds_read_b128 a[148:151], v5 offset:13312
v_mfma_f32_16x16x32_bf16 v[52:55], a[120:123], v[24:27], v[52:55]
s_mov_b64 s[68:69], s[72:73]
v_exp_f32 v69, v69
v_mfma_f32_16x16x32_bf16 v[52:55], a[124:127], v[28:31], v[52:55]
ds_read_b128 a[152:155], v5 offset:14336
v_cvt_pk_bf16_f32 v90, v68, v69
v_mfma_f32_16x16x32_bf16 v[60:63], a[124:127], v[44:47], v[108:111]
s_mov_b64 s[70:71], s[74:75]
v_exp_f32 v70, v70
v_mfma_f32_16x16x32_bf16 v[60:63], a[120:123], v[40:43], v[60:63]
buffer_store_dwordx4 a[204:207], v1, s[60:63], s19 offen sc1
v_mfma_f32_16x16x32_bf16 v[60:63], a[116:119], v[36:39], v[60:63]
s_waitcnt vmcnt(16)
s_mov_b32 s74, 0
v_exp_f32 v71, v71
v_mfma_f32_16x16x32_bf16 v[60:63], a[112:115], v[32:35], v[60:63]
s_waitcnt lgkmcnt(1)
ds_read_b128 a[156:159], v5 offset:15360
v_cvt_pk_bf16_f32 v91, v70, v71
v_mfma_f32_16x16x32_bf16 v[128:131], a[128:131], v[80:83], v[128:131]
v_exp_f32 v72, v72
v_mfma_f32_16x16x32_bf16 v[132:135], a[128:131], v[84:87], v[132:135]
s_barrier
v_mfma_f32_16x16x32_bf16 v[140:143], a[132:135], v[84:87], v[140:143]
s_add_u32 s85, s85, 16384
v_exp_f32 v73, v73
v_mfma_f32_16x16x32_bf16 v[136:139], a[132:135], v[80:83], v[136:139]
v_cvt_pk_bf16_f32 v92, v72, v73
v_mfma_f32_16x16x32_bf16 v[144:147], a[136:139], v[80:83], v[144:147]
s_cmp_eq_u32 s85, 131072
v_exp_f32 v74, v74
v_mfma_f32_16x16x32_bf16 v[148:151], a[136:139], v[84:87], v[148:151]
v_mfma_f32_16x16x32_bf16 v[156:159], a[140:143], v[84:87], v[156:159]
s_cselect_b32 s85, 0, s85
v_exp_f32 v75, v75
v_mfma_f32_16x16x32_bf16 v[152:155], a[140:143], v[80:83], v[152:155]
s_waitcnt lgkmcnt(0)
v_cvt_pk_bf16_f32 v93, v74, v75
v_mfma_f32_16x16x32_bf16 v[160:163], a[144:147], v[80:83], v[160:163]
s_mov_b64 s[16:17], s[20:21]
v_exp_f32 v76, v76
v_mfma_f32_16x16x32_bf16 v[164:167], a[144:147], v[84:87], v[164:167]
s_mov_b64 s[18:19], s[22:23]
v_mfma_f32_16x16x32_bf16 v[172:175], a[148:151], v[84:87], v[172:175]
s_mov_b64 s[20:21], s[40:41]
v_exp_f32 v77, v77
v_mfma_f32_16x16x32_bf16 v[168:171], a[148:151], v[80:83], v[168:171]
s_mov_b64 s[22:23], s[42:43]
v_cvt_pk_bf16_f32 v94, v76, v77
v_mfma_f32_16x16x32_bf16 v[176:179], a[152:155], v[80:83], v[176:179]
s_mov_b64 s[40:41], s[52:53]
v_exp_f32 v78, v78
v_mfma_f32_16x16x32_bf16 v[180:183], a[152:155], v[84:87], v[180:183]
s_mov_b64 s[42:43], s[54:55]
v_mfma_f32_16x16x32_bf16 v[188:191], a[156:159], v[84:87], v[188:191]
s_mov_b64 s[52:53], s[24:25]
v_exp_f32 v79, v79
v_mfma_f32_16x16x32_bf16 v[184:187], a[156:159], v[80:83], v[184:187]
s_mov_b64 s[54:55], s[26:27]
v_cvt_pk_bf16_f32 v95, v78, v79
v_mfma_f32_16x16x32_bf16 a[160:163], a[176:179], v[80:83], a[160:163]
v_add_u32 v5, s85, v1
v_mfma_f32_16x16x32_bf16 a[164:167], a[176:179], v[84:87], a[164:167]
v_mfma_f32_16x16x32_bf16 v[64:67], a[96:99], a[64:67], v[112:115]
s_add_u32 s86, s86, 16384
v_exp_f32 v48, v48
v_mfma_f32_16x16x32_bf16 v[64:67], a[100:103], a[68:71], v[64:67]
s_cmp_eq_u32 s86, 131072
v_mfma_f32_16x16x32_bf16 v[64:67], a[104:107], a[72:75], v[64:67]
s_cselect_b32 s86, 0, s86
v_exp_f32 v49, v49
v_mfma_f32_16x16x32_bf16 v[64:67], a[108:111], a[76:79], v[64:67]
s_add_u32 m0, s86, s13
v_cvt_pk_bf16_f32 v80, v48, v49
v_mfma_f32_16x16x32_bf16 v[72:75], a[108:111], a[92:95], v[120:123]
s_add_u32 s87, s87, 17408
v_exp_f32 v50, v50
v_mfma_f32_16x16x32_bf16 v[72:75], a[104:107], a[88:91], v[72:75]
buffer_load_dwordx4 v1, s[48:51], s87 offen offset:0 sc1 lds
v_mfma_f32_16x16x32_bf16 v[72:75], a[100:103], a[84:87], v[72:75]
v_exp_f32 v51, v51
v_mfma_f32_16x16x32_bf16 v[72:75], a[96:99], a[80:83], v[72:75]
v_cvt_pk_bf16_f32 v81, v50, v51
v_mfma_f32_16x16x32_bf16 v[68:71], a[112:115], a[64:67], v[116:119]
v_exp_f32 v52, v52
v_mfma_f32_16x16x32_bf16 v[68:71], a[116:119], a[68:71], v[68:71]
v_mfma_f32_16x16x32_bf16 v[68:71], a[120:123], a[72:75], v[68:71]
v_exp_f32 v53, v53
v_mfma_f32_16x16x32_bf16 v[68:71], a[124:127], a[76:79], v[68:71]
v_cvt_pk_bf16_f32 v82, v52, v53
v_mfma_f32_16x16x32_bf16 v[76:79], a[124:127], a[92:95], v[124:127]
v_exp_f32 v54, v54
v_mfma_f32_16x16x32_bf16 v[76:79], a[120:123], a[88:91], v[76:79]
buffer_load_dwordx4 v1, s[48:51], s87 offen offset:1024 sc1 lds
v_mfma_f32_16x16x32_bf16 v[76:79], a[116:119], a[84:87], v[76:79]
v_exp_f32 v55, v55
v_mfma_f32_16x16x32_bf16 v[76:79], a[112:115], a[80:83], v[76:79]
v_cvt_pk_bf16_f32 v83, v54, v55
v_mfma_f32_16x16x32_bf16 v[192:195], a[128:131], v[88:91], v[192:195]
v_exp_f32 v56, v56
v_mfma_f32_16x16x32_bf16 v[196:199], a[128:131], v[92:95], v[196:199]
ds_read_b128 a[96:99], v4 offset:0
ds_read_b128 a[100:103], v4 offset:1024
v_mfma_f32_16x16x32_bf16 v[204:207], a[132:135], v[92:95], v[204:207]
v_exp_f32 v57, v57
v_mfma_f32_16x16x32_bf16 v[200:203], a[132:135], v[88:91], v[200:203]
ds_read_b128 a[104:107], v4 offset:2048
v_cvt_pk_bf16_f32 v84, v56, v57
v_mfma_f32_16x16x32_bf16 v[208:211], a[136:139], v[88:91], v[208:211]
v_exp_f32 v58, v58
v_mfma_f32_16x16x32_bf16 v[212:215], a[136:139], v[92:95], v[212:215]
buffer_load_dwordx4 v1, s[48:51], s87 offen offset:2048 sc1 lds
v_mfma_f32_16x16x32_bf16 v[220:223], a[140:143], v[92:95], v[220:223]
v_exp_f32 v59, v59
v_mfma_f32_16x16x32_bf16 v[216:219], a[140:143], v[88:91], v[216:219]
ds_read_b128 a[108:111], v4 offset:3072
v_cvt_pk_bf16_f32 v85, v58, v59
v_mfma_f32_16x16x32_bf16 v[224:227], a[144:147], v[88:91], v[224:227]
s_add_u32 s84, s84, 16384
v_exp_f32 v60, v60
v_mfma_f32_16x16x32_bf16 v[228:231], a[144:147], v[92:95], v[228:231]
s_cmp_eq_u32 s84, 131072
ds_read_b128 a[112:115], v4 offset:4096
ds_read_b128 a[116:119], v4 offset:5120
v_mfma_f32_16x16x32_bf16 v[236:239], a[148:151], v[92:95], v[236:239]
s_cselect_b32 s84, 0, s84
v_exp_f32 v61, v61
v_mfma_f32_16x16x32_bf16 v[232:235], a[148:151], v[88:91], v[232:235]
ds_read_b128 a[120:123], v4 offset:6144
v_cvt_pk_bf16_f32 v86, v60, v61
v_mfma_f32_16x16x32_bf16 v[240:243], a[152:155], v[88:91], v[240:243]
v_exp_f32 v62, v62
v_mfma_f32_16x16x32_bf16 v[244:247], a[152:155], v[92:95], v[244:247]
s_sub_u32 s89, s89, 2
buffer_load_dwordx4 v1, s[48:51], s87 offen offset:3072 sc1 lds
v_mfma_f32_16x16x32_bf16 v[252:255], a[156:159], v[92:95], v[252:255]
s_cmp_lg_u32 s89, s101
v_exp_f32 v63, v63
v_mfma_f32_16x16x32_bf16 v[248:251], a[156:159], v[88:91], v[248:251]
ds_read_b128 a[124:127], v4 offset:7168
v_cvt_pk_bf16_f32 v87, v62, v63
v_mfma_f32_16x16x32_bf16 a[168:171], a[176:179], v[88:91], a[168:171]
s_waitcnt lgkmcnt(2)
v_add_u32 v4, s84, v1
v_mfma_f32_16x16x32_bf16 a[172:175], a[176:179], v[92:95], a[172:175]
s_cbranch_scc1 L_at_pfl
s_branch L_at_shared
L_at_pfsig:
s_cmp_lg_u32 s11, 0
s_cbranch_scc0 L_at_vis
s_and_b32 s6, s2, 7
s_lshl_b32 s6, s6, 7
s_add_u32 s6, s6, 399360
v_min_u32 v6, 1, v2
v_lshlrev_b32 v6, 28, v6
v_mov_b32 v7, 1
s_waitcnt vmcnt(4)
buffer_atomic_add v7, v6, s[60:63], s6 offen sc1
s_mov_b32 s11, 0
s_sub_u32 s101, 9, s3
s_cmp_lt_u32 s5, 6
s_cmov_b32 s101, 0
s_branch L_at_E
L_at_side:
s_cmp_lg_u32 s89, 1
s_cbranch_scc1 L_at_pfsig
v_cndmask_b32 v112, v112, v11, s[76:77]
v_cndmask_b32 v113, v113, v11, s[78:79]
v_cndmask_b32 v114, v114, v11, s[80:81]
v_cndmask_b32 v115, v115, v11, s[82:83]
v_mov_b32 v116, v11
v_mov_b32 v117, v11
v_mov_b32 v118, v11
v_mov_b32 v119, v11
v_cndmask_b32 v124, v124, v11, s[76:77]
v_cndmask_b32 v125, v125, v11, s[78:79]
v_cndmask_b32 v126, v126, v11, s[80:81]
v_cndmask_b32 v127, v127, v11, s[82:83]
s_branch L_at_E
L_at_diagx:
v_cndmask_b32 v112, v112, v11, s[76:77]
v_cndmask_b32 v113, v113, v11, s[78:79]
v_cndmask_b32 v114, v114, v11, s[80:81]
v_cndmask_b32 v115, v115, v11, s[82:83]
v_mov_b32 v116, v11
v_mov_b32 v117, v11
v_mov_b32 v118, v11
v_mov_b32 v119, v11
v_cndmask_b32 v124, v124, v11, s[76:77]
v_cndmask_b32 v125, v125, v11, s[78:79]
v_cndmask_b32 v126, v126, v11, s[80:81]
v_cndmask_b32 v127, v127, v11, s[82:83]
s_branch L_at_Ex
.p2align 5
L_at_shared:
v_mfma_f32_16x16x32_bf16 v[48:51], a[96:99], v[16:19], v[96:99]
v_exp_f32 v64, v64
v_mfma_f32_16x16x32_bf16 v[48:51], a[100:103], v[20:23], v[48:51]
ds_read_b128 a[128:131], v5 offset:8192
ds_read_b128 a[132:135], v5 offset:9216
v_mfma_f32_16x16x32_bf16 v[48:51], a[104:107], v[24:27], v[48:51]
v_exp_f32 v65, v65
v_mfma_f32_16x16x32_bf16 v[48:51], a[108:111], v[28:31], v[48:51]
ds_read_b128 a[136:139], v5 offset:10240
v_cvt_pk_bf16_f32 v88, v64, v65
v_mfma_f32_16x16x32_bf16 v[56:59], a[108:111], v[44:47], v[104:107]
v_exp_f32 v66, v66
v_mfma_f32_16x16x32_bf16 v[56:59], a[104:107], v[40:43], v[56:59]
v_mfma_f32_16x16x32_bf16 v[56:59], a[100:103], v[36:39], v[56:59]
v_exp_f32 v67, v67
v_mfma_f32_16x16x32_bf16 v[56:59], a[96:99], v[32:35], v[56:59]
s_waitcnt lgkmcnt(3)
ds_read_b128 a[140:143], v5 offset:11264
v_cvt_pk_bf16_f32 v89, v66, v67
v_mfma_f32_16x16x32_bf16 v[52:55], a[112:115], v[16:19], v[100:103]
v_exp_f32 v68, v68
v_mfma_f32_16x16x32_bf16 v[52:55], a[116:119], v[20:23], v[52:55]
ds_read_b128 a[144:147], v5 offset:12288
ds_read_b128 a[148:151], v5 offset:13312
v_mfma_f32_16x16x32_bf16 v[52:55], a[120:123], v[24:27], v[52:55]
v_exp_f32 v69, v69
v_mfma_f32_16x16x32_bf16 v[52:55], a[124:127], v[28:31], v[52:55]
ds_read_b128 a[152:155], v5 offset:14336
v_cvt_pk_bf16_f32 v90, v68, v69
v_mfma_f32_16x16x32_bf16 v[60:63], a[124:127], v[44:47], v[108:111]
v_exp_f32 v70, v70
v_mfma_f32_16x16x32_bf16 v[60:63], a[120:123], v[40:43], v[60:63]
v_mfma_f32_16x16x32_bf16 v[60:63], a[116:119], v[36:39], v[60:63]
s_waitcnt vmcnt(8)
v_exp_f32 v71, v71
v_mfma_f32_16x16x32_bf16 v[60:63], a[112:115], v[32:35], v[60:63]
s_waitcnt lgkmcnt(1)
ds_read_b128 a[156:159], v5 offset:15360
v_cvt_pk_bf16_f32 v91, v70, v71
v_mfma_f32_16x16x32_bf16 v[128:131], a[128:131], v[80:83], v[128:131]
v_exp_f32 v72, v72
v_mfma_f32_16x16x32_bf16 v[132:135], a[128:131], v[84:87], v[132:135]
s_barrier
v_mfma_f32_16x16x32_bf16 v[140:143], a[132:135], v[84:87], v[140:143]
s_add_u32 s85, s85, 16384
v_exp_f32 v73, v73
v_mfma_f32_16x16x32_bf16 v[136:139], a[132:135], v[80:83], v[136:139]
v_cvt_pk_bf16_f32 v92, v72, v73
v_mfma_f32_16x16x32_bf16 v[144:147], a[136:139], v[80:83], v[144:147]
s_cmp_eq_u32 s85, 163840
v_exp_f32 v74, v74
v_mfma_f32_16x16x32_bf16 v[148:151], a[136:139], v[84:87], v[148:151]
v_mfma_f32_16x16x32_bf16 v[156:159], a[140:143], v[84:87], v[156:159]
s_cselect_b32 s85, 0, s85
v_exp_f32 v75, v75
v_mfma_f32_16x16x32_bf16 v[152:155], a[140:143], v[80:83], v[152:155]
s_waitcnt lgkmcnt(0)
v_cvt_pk_bf16_f32 v93, v74, v75
v_mfma_f32_16x16x32_bf16 v[160:163], a[144:147], v[80:83], v[160:163]
v_exp_f32 v76, v76
v_mfma_f32_16x16x32_bf16 v[164:167], a[144:147], v[84:87], v[164:167]
v_mfma_f32_16x16x32_bf16 v[172:175], a[148:151], v[84:87], v[172:175]
v_exp_f32 v77, v77
v_mfma_f32_16x16x32_bf16 v[168:171], a[148:151], v[80:83], v[168:171]
v_cvt_pk_bf16_f32 v94, v76, v77
v_mfma_f32_16x16x32_bf16 v[176:179], a[152:155], v[80:83], v[176:179]
s_cmp_eq_u32 s89, s101
v_exp_f32 v78, v78
v_mfma_f32_16x16x32_bf16 v[180:183], a[152:155], v[84:87], v[180:183]
s_cselect_b32 s6, 1, s89
v_mfma_f32_16x16x32_bf16 v[188:191], a[156:159], v[84:87], v[188:191]
s_cmp_eq_u32 s6, 1
v_exp_f32 v79, v79
v_mfma_f32_16x16x32_bf16 v[184:187], a[156:159], v[80:83], v[184:187]
v_cvt_pk_bf16_f32 v95, v78, v79
v_mfma_f32_16x16x32_bf16 a[160:163], a[176:179], v[80:83], a[160:163]
v_add_u32 v5, s85, v1
v_mfma_f32_16x16x32_bf16 a[164:167], a[176:179], v[84:87], a[164:167]
s_cbranch_scc1 L_at_side
L_at_E:
v_mfma_f32_16x16x32_bf16 v[64:67], a[96:99], a[64:67], v[112:115]
s_add_u32 s86, s86, 16384
v_exp_f32 v48, v48
v_mfma_f32_16x16x32_bf16 v[64:67], a[100:103], a[68:71], v[64:67]
s_cmp_eq_u32 s86, 163840
v_mfma_f32_16x16x32_bf16 v[64:67], a[104:107], a[72:75], v[64:67]
s_cselect_b32 s86, 0, s86
v_exp_f32 v49, v49
v_mfma_f32_16x16x32_bf16 v[64:67], a[108:111], a[76:79], v[64:67]
s_add_u32 m0, s86, s13
v_cvt_pk_bf16_f32 v80, v48, v49
v_mfma_f32_16x16x32_bf16 v[72:75], a[108:111], a[92:95], v[120:123]
s_add_u32 s87, s87, 17408
v_exp_f32 v50, v50
v_mfma_f32_16x16x32_bf16 v[72:75], a[104:107], a[88:91], v[72:75]
buffer_load_dwordx4 v1, s[48:51], s87 offen offset:0 sc1 lds
v_mfma_f32_16x16x32_bf16 v[72:75], a[100:103], a[84:87], v[72:75]
v_exp_f32 v51, v51
v_mfma_f32_16x16x32_bf16 v[72:75], a[96:99], a[80:83], v[72:75]
v_cvt_pk_bf16_f32 v81, v50, v51
v_mfma_f32_16x16x32_bf16 v[68:71], a[112:115], a[64:67], v[116:119]
v_exp_f32 v52, v52
v_mfma_f32_16x16x32_bf16 v[68:71], a[116:119], a[68:71], v[68:71]
v_mfma_f32_16x16x32_bf16 v[68:71], a[120:123], a[72:75], v[68:71]
v_exp_f32 v53, v53
v_mfma_f32_16x16x32_bf16 v[68:71], a[124:127], a[76:79], v[68:71]
v_cvt_pk_bf16_f32 v82, v52, v53
v_mfma_f32_16x16x32_bf16 v[76:79], a[124:127], a[92:95], v[124:127]
v_exp_f32 v54, v54
v_mfma_f32_16x16x32_bf16 v[76:79], a[120:123], a[88:91], v[76:79]
buffer_load_dwordx4 v1, s[48:51], s87 offen offset:1024 sc1 lds
v_mfma_f32_16x16x32_bf16 v[76:79], a[116:119], a[84:87], v[76:79]
v_exp_f32 v55, v55
v_mfma_f32_16x16x32_bf16 v[76:79], a[112:115], a[80:83], v[76:79]
v_cvt_pk_bf16_f32 v83, v54, v55
v_mfma_f32_16x16x32_bf16 v[192:195], a[128:131], v[88:91], v[192:195]
v_exp_f32 v56, v56
v_mfma_f32_16x16x32_bf16 v[196:199], a[128:131], v[92:95], v[196:199]
ds_read_b128 a[96:99], v4 offset:0
ds_read_b128 a[100:103], v4 offset:1024
v_mfma_f32_16x16x32_bf16 v[204:207], a[132:135], v[92:95], v[204:207]
v_exp_f32 v57, v57
v_mfma_f32_16x16x32_bf16 v[200:203], a[132:135], v[88:91], v[200:203]
ds_read_b128 a[104:107], v4 offset:2048
v_cvt_pk_bf16_f32 v84, v56, v57
v_mfma_f32_16x16x32_bf16 v[208:211], a[136:139], v[88:91], v[208:211]
v_exp_f32 v58, v58
v_mfma_f32_16x16x32_bf16 v[212:215], a[136:139], v[92:95], v[212:215]
buffer_load_dwordx4 v1, s[48:51], s87 offen offset:2048 sc1 lds
v_mfma_f32_16x16x32_bf16 v[220:223], a[140:143], v[92:95], v[220:223]
v_exp_f32 v59, v59
v_mfma_f32_16x16x32_bf16 v[216:219], a[140:143], v[88:91], v[216:219]
ds_read_b128 a[108:111], v4 offset:3072
v_cvt_pk_bf16_f32 v85, v58, v59
v_mfma_f32_16x16x32_bf16 v[224:227], a[144:147], v[88:91], v[224:227]
s_add_u32 s84, s84, 16384
v_exp_f32 v60, v60
v_mfma_f32_16x16x32_bf16 v[228:231], a[144:147], v[92:95], v[228:231]
s_cmp_eq_u32 s84, 163840
ds_read_b128 a[112:115], v4 offset:4096
ds_read_b128 a[116:119], v4 offset:5120
v_mfma_f32_16x16x32_bf16 v[236:239], a[148:151], v[92:95], v[236:239]
s_cselect_b32 s84, 0, s84
v_exp_f32 v61, v61
v_mfma_f32_16x16x32_bf16 v[232:235], a[148:151], v[88:91], v[232:235]
ds_read_b128 a[120:123], v4 offset:6144
v_cvt_pk_bf16_f32 v86, v60, v61
v_mfma_f32_16x16x32_bf16 v[240:243], a[152:155], v[88:91], v[240:243]
v_exp_f32 v62, v62
v_mfma_f32_16x16x32_bf16 v[244:247], a[152:155], v[92:95], v[244:247]
s_sub_u32 s89, s89, 1
buffer_load_dwordx4 v1, s[48:51], s87 offen offset:3072 sc1 lds
v_mfma_f32_16x16x32_bf16 v[252:255], a[156:159], v[92:95], v[252:255]
s_cmp_lg_u32 s89, s14
v_exp_f32 v63, v63
v_mfma_f32_16x16x32_bf16 v[248:251], a[156:159], v[88:91], v[248:251]
ds_read_b128 a[124:127], v4 offset:7168
v_cvt_pk_bf16_f32 v87, v62, v63
v_mfma_f32_16x16x32_bf16 a[168:171], a[176:179], v[88:91], a[168:171]
s_waitcnt lgkmcnt(2)
v_add_u32 v4, s84, v1
v_mfma_f32_16x16x32_bf16 a[172:175], a[176:179], v[92:95], a[172:175]
s_cbranch_scc1 L_at_shared
L_at_trans:
s_cmp_eq_u32 s89, 0
s_cbranch_scc1 L_at_oprime
.p2align 5
L_at_trl:
v_mfma_f32_16x16x32_bf16 v[48:51], a[96:99], v[16:19], v[96:99]
s_add_u32 s86, s86, 16384
v_exp_f32 v64, v64
v_mfma_f32_16x16x32_bf16 v[48:51], a[100:103], v[20:23], v[48:51]
s_cmp_eq_u32 s86, 163840
ds_read_b128 a[128:131], v5 offset:8192
ds_read_b128 a[132:135], v5 offset:9216
v_mfma_f32_16x16x32_bf16 v[48:51], a[104:107], v[24:27], v[48:51]
s_cselect_b32 s86, 0, s86
v_exp_f32 v65, v65
v_mfma_f32_16x16x32_bf16 v[48:51], a[108:111], v[28:31], v[48:51]
s_add_u32 m0, s86, s13
ds_read_b128 a[136:139], v5 offset:10240
v_cvt_pk_bf16_f32 v88, v64, v65
v_mfma_f32_16x16x32_bf16 v[56:59], a[108:111], v[44:47], v[104:107]
s_add_u32 s87, s87, 17408
v_exp_f32 v66, v66
v_mfma_f32_16x16x32_bf16 v[56:59], a[104:107], v[40:43], v[56:59]
buffer_load_dwordx4 v1, s[48:51], s87 offen offset:0 sc1 lds
v_mfma_f32_16x16x32_bf16 v[56:59], a[100:103], v[36:39], v[56:59]
v_exp_f32 v67, v67
v_mfma_f32_16x16x32_bf16 v[56:59], a[96:99], v[32:35], v[56:59]
s_waitcnt lgkmcnt(3)
ds_read_b128 a[140:143], v5 offset:11264
v_cvt_pk_bf16_f32 v89, v66, v67
v_mfma_f32_16x16x32_bf16 v[52:55], a[112:115], v[16:19], v[100:103]
v_exp_f32 v68, v68
v_mfma_f32_16x16x32_bf16 v[52:55], a[116:119], v[20:23], v[52:55]
ds_read_b128 a[144:147], v5 offset:12288
ds_read_b128 a[148:151], v5 offset:13312
v_mfma_f32_16x16x32_bf16 v[52:55], a[120:123], v[24:27], v[52:55]
v_exp_f32 v69, v69
v_mfma_f32_16x16x32_bf16 v[52:55], a[124:127], v[28:31], v[52:55]
ds_read_b128 a[152:155], v5 offset:14336
v_cvt_pk_bf16_f32 v90, v68, v69
v_mfma_f32_16x16x32_bf16 v[60:63], a[124:127], v[44:47], v[108:111]
v_exp_f32 v70, v70
v_mfma_f32_16x16x32_bf16 v[60:63], a[120:123], v[40:43], v[60:63]
buffer_load_dwordx4 v1, s[48:51], s87 offen offset:1024 sc1 lds
v_mfma_f32_16x16x32_bf16 v[60:63], a[116:119], v[36:39], v[60:63]
s_waitcnt vmcnt(10)
v_exp_f32 v71, v71
v_mfma_f32_16x16x32_bf16 v[60:63], a[112:115], v[32:35], v[60:63]
s_waitcnt lgkmcnt(1)
ds_read_b128 a[156:159], v5 offset:15360
v_cvt_pk_bf16_f32 v91, v70, v71
v_mfma_f32_16x16x32_bf16 v[128:131], a[128:131], v[80:83], v[128:131]
v_exp_f32 v72, v72
v_mfma_f32_16x16x32_bf16 v[132:135], a[128:131], v[84:87], v[132:135]
s_barrier
v_mfma_f32_16x16x32_bf16 v[140:143], a[132:135], v[84:87], v[140:143]
s_add_u32 s85, s85, 16384
v_exp_f32 v73, v73
v_mfma_f32_16x16x32_bf16 v[136:139], a[132:135], v[80:83], v[136:139]
v_cvt_pk_bf16_f32 v92, v72, v73
v_mfma_f32_16x16x32_bf16 v[144:147], a[136:139], v[80:83], v[144:147]
s_cmp_eq_u32 s85, 163840
v_exp_f32 v74, v74
v_mfma_f32_16x16x32_bf16 v[148:151], a[136:139], v[84:87], v[148:151]
buffer_load_dwordx4 v1, s[48:51], s87 offen offset:2048 sc1 lds
v_mfma_f32_16x16x32_bf16 v[156:159], a[140:143], v[84:87], v[156:159]
s_cselect_b32 s85, 0, s85
v_exp_f32 v75, v75
v_mfma_f32_16x16x32_bf16 v[152:155], a[140:143], v[80:83], v[152:155]
s_waitcnt lgkmcnt(0)
v_cvt_pk_bf16_f32 v93, v74, v75
v_mfma_f32_16x16x32_bf16 v[160:163], a[144:147], v[80:83], v[160:163]
v_exp_f32 v76, v76
v_mfma_f32_16x16x32_bf16 v[164:167], a[144:147], v[84:87], v[164:167]
v_mfma_f32_16x16x32_bf16 v[172:175], a[148:151], v[84:87], v[172:175]
v_exp_f32 v77, v77
v_mfma_f32_16x16x32_bf16 v[168:171], a[148:151], v[80:83], v[168:171]
v_cvt_pk_bf16_f32 v94, v76, v77
v_mfma_f32_16x16x32_bf16 v[176:179], a[152:155], v[80:83], v[176:179]
v_exp_f32 v78, v78
v_mfma_f32_16x16x32_bf16 v[180:183], a[152:155], v[84:87], v[180:183]
buffer_load_dwordx4 v1, s[48:51], s87 offen offset:3072 sc1 lds
v_mfma_f32_16x16x32_bf16 v[188:191], a[156:159], v[84:87], v[188:191]
s_cmp_eq_u32 s89, 1
v_exp_f32 v79, v79
v_mfma_f32_16x16x32_bf16 v[184:187], a[156:159], v[80:83], v[184:187]
v_cvt_pk_bf16_f32 v95, v78, v79
v_mfma_f32_16x16x32_bf16 a[160:163], a[176:179], v[80:83], a[160:163]
v_add_u32 v5, s85, v1
v_mfma_f32_16x16x32_bf16 a[164:167], a[176:179], v[84:87], a[164:167]
s_cbranch_scc1 L_at_diagx
L_at_Ex:
v_mfma_f32_16x16x32_bf16 v[64:67], a[96:99], a[64:67], v[112:115]
s_add_u32 s86, s86, 16384
v_exp_f32 v48, v48
v_mfma_f32_16x16x32_bf16 v[64:67], a[100:103], a[68:71], v[64:67]
s_cmp_eq_u32 s86, 163840
v_mfma_f32_16x16x32_bf16 v[64:67], a[104:107], a[72:75], v[64:67]
s_cselect_b32 s86, 0, s86
v_exp_f32 v49, v49
v_mfma_f32_16x16x32_bf16 v[64:67], a[108:111], a[76:79], v[64:67]
s_add_u32 m0, s86, s13
v_cvt_pk_bf16_f32 v80, v48, v49
v_mfma_f32_16x16x32_bf16 v[72:75], a[108:111], a[92:95], v[120:123]
s_add_u32 s87, s87, 17408
v_exp_f32 v50, v50
v_mfma_f32_16x16x32_bf16 v[72:75], a[104:107], a[88:91], v[72:75]
buffer_load_dwordx4 v1, s[48:51], s87 offen offset:0 sc1 lds
v_mfma_f32_16x16x32_bf16 v[72:75], a[100:103], a[84:87], v[72:75]
v_exp_f32 v51, v51
v_mfma_f32_16x16x32_bf16 v[72:75], a[96:99], a[80:83], v[72:75]
v_cvt_pk_bf16_f32 v81, v50, v51
v_mfma_f32_16x16x32_bf16 v[68:71], a[112:115], a[64:67], v[116:119]
v_exp_f32 v52, v52
v_mfma_f32_16x16x32_bf16 v[68:71], a[116:119], a[68:71], v[68:71]
v_mfma_f32_16x16x32_bf16 v[68:71], a[120:123], a[72:75], v[68:71]
v_exp_f32 v53, v53
v_mfma_f32_16x16x32_bf16 v[68:71], a[124:127], a[76:79], v[68:71]
v_cvt_pk_bf16_f32 v82, v52, v53
v_mfma_f32_16x16x32_bf16 v[76:79], a[124:127], a[92:95], v[124:127]
v_exp_f32 v54, v54
v_mfma_f32_16x16x32_bf16 v[76:79], a[120:123], a[88:91], v[76:79]
buffer_load_dwordx4 v1, s[48:51], s87 offen offset:1024 sc1 lds
v_mfma_f32_16x16x32_bf16 v[76:79], a[116:119], a[84:87], v[76:79]
v_exp_f32 v55, v55
v_mfma_f32_16x16x32_bf16 v[76:79], a[112:115], a[80:83], v[76:79]
v_cvt_pk_bf16_f32 v83, v54, v55
v_mfma_f32_16x16x32_bf16 v[192:195], a[128:131], v[88:91], v[192:195]
v_exp_f32 v56, v56
v_mfma_f32_16x16x32_bf16 v[196:199], a[128:131], v[92:95], v[196:199]
ds_read_b128 a[96:99], v4 offset:0
ds_read_b128 a[100:103], v4 offset:1024
v_mfma_f32_16x16x32_bf16 v[204:207], a[132:135], v[92:95], v[204:207]
v_exp_f32 v57, v57
v_mfma_f32_16x16x32_bf16 v[200:203], a[132:135], v[88:91], v[200:203]
ds_read_b128 a[104:107], v4 offset:2048
v_cvt_pk_bf16_f32 v84, v56, v57
v_mfma_f32_16x16x32_bf16 v[208:211], a[136:139], v[88:91], v[208:211]
v_exp_f32 v58, v58
v_mfma_f32_16x16x32_bf16 v[212:215], a[136:139], v[92:95], v[212:215]
buffer_load_dwordx4 v1, s[48:51], s87 offen offset:2048 sc1 lds
v_mfma_f32_16x16x32_bf16 v[220:223], a[140:143], v[92:95], v[220:223]
v_exp_f32 v59, v59
v_mfma_f32_16x16x32_bf16 v[216:219], a[140:143], v[88:91], v[216:219]
ds_read_b128 a[108:111], v4 offset:3072
v_cvt_pk_bf16_f32 v85, v58, v59
v_mfma_f32_16x16x32_bf16 v[224:227], a[144:147], v[88:91], v[224:227]
s_add_u32 s84, s84, 16384
v_exp_f32 v60, v60
v_mfma_f32_16x16x32_bf16 v[228:231], a[144:147], v[92:95], v[228:231]
s_cmp_eq_u32 s84, 163840
ds_read_b128 a[112:115], v4 offset:4096
ds_read_b128 a[116:119], v4 offset:5120
v_mfma_f32_16x16x32_bf16 v[236:239], a[148:151], v[92:95], v[236:239]
s_cselect_b32 s84, 0, s84
v_exp_f32 v61, v61
v_mfma_f32_16x16x32_bf16 v[232:235], a[148:151], v[88:91], v[232:235]
ds_read_b128 a[120:123], v4 offset:6144
v_cvt_pk_bf16_f32 v86, v60, v61
v_mfma_f32_16x16x32_bf16 v[240:243], a[152:155], v[88:91], v[240:243]
v_exp_f32 v62, v62
v_mfma_f32_16x16x32_bf16 v[244:247], a[152:155], v[92:95], v[244:247]
s_sub_u32 s89, s89, 1
buffer_load_dwordx4 v1, s[48:51], s87 offen offset:3072 sc1 lds
v_mfma_f32_16x16x32_bf16 v[252:255], a[156:159], v[92:95], v[252:255]
s_cmp_lg_u32 s89, 0
v_exp_f32 v63, v63
v_mfma_f32_16x16x32_bf16 v[248:251], a[156:159], v[88:91], v[248:251]
ds_read_b128 a[124:127], v4 offset:7168
v_cvt_pk_bf16_f32 v87, v62, v63
v_mfma_f32_16x16x32_bf16 a[168:171], a[176:179], v[88:91], a[168:171]
s_waitcnt lgkmcnt(2)
v_add_u32 v4, s84, v1
v_mfma_f32_16x16x32_bf16 a[172:175], a[176:179], v[92:95], a[172:175]
s_cbranch_scc1 L_at_trl
L_at_oprime:
s_cmp_eq_u32 s90, 1
s_cbranch_scc1 L_at_short
v_mfma_f32_16x16x32_bf16 v[48:51], a[96:99], v[16:19], v[96:99]
v_exp_f32 v64, v64
v_mfma_f32_16x16x32_bf16 v[48:51], a[100:103], v[20:23], v[48:51]
ds_read_b128 a[128:131], v5 offset:8192
ds_read_b128 a[132:135], v5 offset:9216
v_mfma_f32_16x16x32_bf16 v[48:51], a[104:107], v[24:27], v[48:51]
v_exp_f32 v65, v65
v_mfma_f32_16x16x32_bf16 v[48:51], a[108:111], v[28:31], v[48:51]
ds_read_b128 a[136:139], v5 offset:10240
v_cvt_pk_bf16_f32 v88, v64, v65
v_mfma_f32_16x16x32_bf16 v[56:59], a[108:111], v[44:47], v[104:107]
v_exp_f32 v66, v66
v_mfma_f32_16x16x32_bf16 v[56:59], a[104:107], v[40:43], v[56:59]
v_mfma_f32_16x16x32_bf16 v[56:59], a[100:103], v[36:39], v[56:59]
v_exp_f32 v67, v67
v_mfma_f32_16x16x32_bf16 v[56:59], a[96:99], v[32:35], v[56:59]
s_waitcnt lgkmcnt(3)
ds_read_b128 a[140:143], v5 offset:11264
v_cvt_pk_bf16_f32 v89, v66, v67
v_mfma_f32_16x16x32_bf16 v[52:55], a[112:115], v[16:19], v[100:103]
v_exp_f32 v68, v68
v_mfma_f32_16x16x32_bf16 v[52:55], a[116:119], v[20:23], v[52:55]
ds_read_b128 a[144:147], v5 offset:12288
ds_read_b128 a[148:151], v5 offset:13312
v_mfma_f32_16x16x32_bf16 v[52:55], a[120:123], v[24:27], v[52:55]
v_exp_f32 v69, v69
v_mfma_f32_16x16x32_bf16 v[52:55], a[124:127], v[28:31], v[52:55]
ds_read_b128 a[152:155], v5 offset:14336
v_cvt_pk_bf16_f32 v90, v68, v69
v_mfma_f32_16x16x32_bf16 v[60:63], a[124:127], v[44:47], v[108:111]
v_exp_f32 v70, v70
v_mfma_f32_16x16x32_bf16 v[60:63], a[120:123], v[40:43], v[60:63]
v_mfma_f32_16x16x32_bf16 v[60:63], a[116:119], v[36:39], v[60:63]
s_waitcnt vmcnt(8)
v_exp_f32 v71, v71
v_mfma_f32_16x16x32_bf16 v[60:63], a[112:115], v[32:35], v[60:63]
s_waitcnt lgkmcnt(1)
ds_read_b128 a[156:159], v5 offset:15360
v_cvt_pk_bf16_f32 v91, v70, v71
v_mfma_f32_16x16x32_bf16 v[128:131], a[128:131], v[80:83], v[128:131]
s_barrier
v_exp_f32 v72, v72
v_mfma_f32_16x16x32_bf16 v[132:135], a[128:131], v[84:87], v[132:135]
ds_read_b128 a[96:99], v4 offset:0
ds_read_b128 a[100:103], v4 offset:1024
v_mfma_f32_16x16x32_bf16 v[140:143], a[132:135], v[84:87], v[140:143]
s_add_u32 s85, s85, 16384
v_exp_f32 v73, v73
v_mfma_f32_16x16x32_bf16 v[136:139], a[132:135], v[80:83], v[136:139]
ds_read_b128 a[104:107], v4 offset:2048
v_cvt_pk_bf16_f32 v92, v72, v73
v_mfma_f32_16x16x32_bf16 v[144:147], a[136:139], v[80:83], v[144:147]
s_cmp_eq_u32 s85, 163840
v_exp_f32 v74, v74
v_mfma_f32_16x16x32_bf16 v[148:151], a[136:139], v[84:87], v[148:151]
v_mfma_f32_16x16x32_bf16 v[156:159], a[140:143], v[84:87], v[156:159]
s_cselect_b32 s85, 0, s85
v_exp_f32 v75, v75
v_mfma_f32_16x16x32_bf16 v[152:155], a[140:143], v[80:83], v[152:155]
s_waitcnt lgkmcnt(3)
ds_read_b128 a[108:111], v4 offset:3072
v_cvt_pk_bf16_f32 v93, v74, v75
v_mfma_f32_16x16x32_bf16 v[160:163], a[144:147], v[80:83], v[160:163]
s_add_u32 s84, s84, 16384
v_exp_f32 v76, v76
v_mfma_f32_16x16x32_bf16 v[164:167], a[144:147], v[84:87], v[164:167]
s_cmp_eq_u32 s84, 163840
ds_read_b128 a[112:115], v4 offset:4096
ds_read_b128 a[116:119], v4 offset:5120
v_mfma_f32_16x16x32_bf16 v[172:175], a[148:151], v[84:87], v[172:175]
s_cselect_b32 s84, 0, s84
v_exp_f32 v77, v77
v_mfma_f32_16x16x32_bf16 v[168:171], a[148:151], v[80:83], v[168:171]
ds_read_b128 a[120:123], v4 offset:6144
v_cvt_pk_bf16_f32 v94, v76, v77
v_mfma_f32_16x16x32_bf16 v[176:179], a[152:155], v[80:83], v[176:179]
v_exp_f32 v78, v78
v_mfma_f32_16x16x32_bf16 v[180:183], a[152:155], v[84:87], v[180:183]
v_mfma_f32_16x16x32_bf16 v[188:191], a[156:159], v[84:87], v[188:191]
v_exp_f32 v79, v79
v_mfma_f32_16x16x32_bf16 v[184:187], a[156:159], v[80:83], v[184:187]
ds_read_b128 a[124:127], v4 offset:7168
v_cvt_pk_bf16_f32 v95, v78, v79
v_mfma_f32_16x16x32_bf16 a[160:163], a[176:179], v[80:83], a[160:163]
v_add_u32 v5, s85, v1
v_add_u32 v4, s84, v1
v_mfma_f32_16x16x32_bf16 a[164:167], a[176:179], v[84:87], a[164:167]
s_waitcnt lgkmcnt(2)
v_mfma_f32_16x16x32_bf16 v[64:67], a[96:99], v[16:19], v[96:99]
s_add_u32 s86, s86, 16384
v_exp_f32 v48, v48
v_mfma_f32_16x16x32_bf16 v[64:67], a[100:103], v[20:23], v[64:67]
s_cmp_eq_u32 s86, 163840
v_mfma_f32_16x16x32_bf16 v[64:67], a[104:107], v[24:27], v[64:67]
s_cselect_b32 s86, 0, s86
v_exp_f32 v49, v49
v_mfma_f32_16x16x32_bf16 v[64:67], a[108:111], v[28:31], v[64:67]
s_add_u32 m0, s86, s13
v_cvt_pk_bf16_f32 v80, v48, v49
v_mfma_f32_16x16x32_bf16 v[72:75], a[108:111], v[44:47], v[104:107]
s_add_u32 s87, s87, 17408
v_exp_f32 v50, v50
v_mfma_f32_16x16x32_bf16 v[72:75], a[104:107], v[40:43], v[72:75]
buffer_load_dwordx4 v1, s[48:51], s87 offen offset:0 sc1 lds
v_mfma_f32_16x16x32_bf16 v[72:75], a[100:103], v[36:39], v[72:75]
v_exp_f32 v51, v51
v_mfma_f32_16x16x32_bf16 v[72:75], a[96:99], v[32:35], v[72:75]
s_waitcnt lgkmcnt(0)
v_cvt_pk_bf16_f32 v81, v50, v51
v_mfma_f32_16x16x32_bf16 v[68:71], a[112:115], v[16:19], v[100:103]
v_exp_f32 v52, v52
v_mfma_f32_16x16x32_bf16 v[68:71], a[116:119], v[20:23], v[68:71]
v_mfma_f32_16x16x32_bf16 v[68:71], a[120:123], v[24:27], v[68:71]
v_exp_f32 v53, v53
v_mfma_f32_16x16x32_bf16 v[68:71], a[124:127], v[28:31], v[68:71]
v_cvt_pk_bf16_f32 v82, v52, v53
v_mfma_f32_16x16x32_bf16 v[76:79], a[124:127], v[44:47], v[108:111]
v_exp_f32 v54, v54
v_mfma_f32_16x16x32_bf16 v[76:79], a[120:123], v[40:43], v[76:79]
buffer_load_dwordx4 v1, s[48:51], s87 offen offset:1024 sc1 lds
v_mfma_f32_16x16x32_bf16 v[76:79], a[116:119], v[36:39], v[76:79]
v_exp_f32 v55, v55
v_mfma_f32_16x16x32_bf16 v[76:79], a[112:115], v[32:35], v[76:79]
v_cvt_pk_bf16_f32 v83, v54, v55
v_mfma_f32_16x16x32_bf16 v[192:195], a[128:131], v[88:91], v[192:195]
v_exp_f32 v56, v56
v_mfma_f32_16x16x32_bf16 v[196:199], a[128:131], v[92:95], v[196:199]
ds_read_b128 a[96:99], v4 offset:0
ds_read_b128 a[100:103], v4 offset:1024
v_mfma_f32_16x16x32_bf16 v[204:207], a[132:135], v[92:95], v[204:207]
v_exp_f32 v57, v57
v_mfma_f32_16x16x32_bf16 v[200:203], a[132:135], v[88:91], v[200:203]
ds_read_b128 a[104:107], v4 offset:2048
v_cvt_pk_bf16_f32 v84, v56, v57
v_mfma_f32_16x16x32_bf16 v[208:211], a[136:139], v[88:91], v[208:211]
v_exp_f32 v58, v58
v_mfma_f32_16x16x32_bf16 v[212:215], a[136:139], v[92:95], v[212:215]
buffer_load_dwordx4 v1, s[48:51], s87 offen offset:2048 sc1 lds
v_mfma_f32_16x16x32_bf16 v[220:223], a[140:143], v[92:95], v[220:223]
v_exp_f32 v59, v59
v_mfma_f32_16x16x32_bf16 v[216:219], a[140:143], v[88:91], v[216:219]
ds_read_b128 a[108:111], v4 offset:3072
v_cvt_pk_bf16_f32 v85, v58, v59
v_mfma_f32_16x16x32_bf16 v[224:227], a[144:147], v[88:91], v[224:227]
s_add_u32 s84, s84, 16384
v_exp_f32 v60, v60
v_mfma_f32_16x16x32_bf16 v[228:231], a[144:147], v[92:95], v[228:231]
s_cmp_eq_u32 s84, 163840
ds_read_b128 a[112:115], v4 offset:4096
ds_read_b128 a[116:119], v4 offset:5120
v_mfma_f32_16x16x32_bf16 v[236:239], a[148:151], v[92:95], v[236:239]
s_cselect_b32 s84, 0, s84
v_exp_f32 v61, v61
v_mfma_f32_16x16x32_bf16 v[232:235], a[148:151], v[88:91], v[232:235]
ds_read_b128 a[120:123], v4 offset:6144
v_cvt_pk_bf16_f32 v86, v60, v61
v_mfma_f32_16x16x32_bf16 v[240:243], a[152:155], v[88:91], v[240:243]
v_exp_f32 v62, v62
v_mfma_f32_16x16x32_bf16 v[244:247], a[152:155], v[92:95], v[244:247]
buffer_load_dwordx4 v1, s[48:51], s87 offen offset:3072 sc1 lds
v_mfma_f32_16x16x32_bf16 v[252:255], a[156:159], v[92:95], v[252:255]
v_exp_f32 v63, v63
v_mfma_f32_16x16x32_bf16 v[248:251], a[156:159], v[88:91], v[248:251]
ds_read_b128 a[124:127], v4 offset:7168
v_cvt_pk_bf16_f32 v87, v62, v63
v_mfma_f32_16x16x32_bf16 a[168:171], a[176:179], v[88:91], a[168:171]
v_add_u32 v4, s84, v1
v_mfma_f32_16x16x32_bf16 a[172:175], a[176:179], v[92:95], a[172:175]
s_waitcnt lgkmcnt(2)
s_nop 4
v_accvgpr_read_b32 v6, a168
s_nop 0
v_accvgpr_read_b32 v7, a172
v_rcp_f32 v8, v6
v_rcp_f32 v9, v7
v_add_f32 v6, v6, v7
v_cmp_nge_f32 vcc, 0x5d800000, v6
s_add_u32 s6, s96, 0
s_nop 0
s_cmp_lg_u64 vcc, 0
s_cselect_b32 s7, 2, 0
s_or_b32 s97, s97, s7
v_pk_mul_f32 v[192:193], v[192:193], v[8:9] op_sel_hi:[1,0]
v_pk_mul_f32 v[194:195], v[194:195], v[8:9] op_sel_hi:[1,0]
v_pk_mul_f32 v[200:201], v[200:201], v[8:9] op_sel_hi:[1,0]
v_pk_mul_f32 v[202:203], v[202:203], v[8:9] op_sel_hi:[1,0]
v_cvt_pk_bf16_f32 v192, v192, v193
v_cvt_pk_bf16_f32 v193, v194, v195
v_cvt_pk_bf16_f32 v194, v200, v201
v_cvt_pk_bf16_f32 v195, v202, v203
v_pk_mul_f32 v[196:197], v[196:197], v[8:9] op_sel:[0,1]
v_pk_mul_f32 v[198:199], v[198:199], v[8:9] op_sel:[0,1]
v_pk_mul_f32 v[204:205], v[204:205], v[8:9] op_sel:[0,1]
v_pk_mul_f32 v[206:207], v[206:207], v[8:9] op_sel:[0,1]
v_cvt_pk_bf16_f32 v196, v196, v197
v_cvt_pk_bf16_f32 v197, v198, v199
v_cvt_pk_bf16_f32 v198, v204, v205
v_cvt_pk_bf16_f32 v199, v206, v207
buffer_store_dwordx4 v[192:195], v1, s[60:63], s6 offen offset:0 sc1
buffer_store_dwordx4 v[196:199], v1, s[60:63], s6 offen offset:1024 sc1
s_add_u32 s6, s6, 4096
v_pk_mul_f32 v[208:209], v[208:209], v[8:9] op_sel_hi:[1,0]
v_pk_mul_f32 v[210:211], v[210:211], v[8:9] op_sel_hi:[1,0]
v_pk_mul_f32 v[216:217], v[216:217], v[8:9] op_sel_hi:[1,0]
v_pk_mul_f32 v[218:219], v[218:219], v[8:9] op_sel_hi:[1,0]
v_cvt_pk_bf16_f32 v208, v208, v209
v_cvt_pk_bf16_f32 v209, v210, v211
v_cvt_pk_bf16_f32 v210, v216, v217
v_cvt_pk_bf16_f32 v211, v218, v219
v_pk_mul_f32 v[212:213], v[212:213], v[8:9] op_sel:[0,1]
v_pk_mul_f32 v[214:215], v[214:215], v[8:9] op_sel:[0,1]
v_pk_mul_f32 v[220:221], v[220:221], v[8:9] op_sel:[0,1]
v_pk_mul_f32 v[222:223], v[222:223], v[8:9] op_sel:[0,1]
v_cvt_pk_bf16_f32 v212, v212, v213
v_cvt_pk_bf16_f32 v213, v214, v215
v_cvt_pk_bf16_f32 v214, v220, v221
v_cvt_pk_bf16_f32 v215, v222, v223
buffer_store_dwordx4 v[208:211], v1, s[60:63], s6 offen offset:0 sc1
buffer_store_dwordx4 v[212:215], v1, s[60:63], s6 offen offset:1024 sc1
s_add_u32 s6, s6, 4096
s_waitcnt vmcnt(12) lgkmcnt(0)
s_barrier
v_pk_mul_f32 v[224:225], v[224:225], v[8:9] op_sel_hi:[1,0]
v_pk_mul_f32 v[226:227], v[226:227], v[8:9] op_sel_hi:[1,0]
v_pk_mul_f32 v[232:233], v[232:233], v[8:9] op_sel_hi:[1,0]
v_pk_mul_f32 v[234:235], v[234:235], v[8:9] op_sel_hi:[1,0]
v_cvt_pk_bf16_f32 v224, v224, v225
v_cvt_pk_bf16_f32 v225, v226, v227
v_cvt_pk_bf16_f32 v226, v232, v233
v_cvt_pk_bf16_f32 v227, v234, v235
v_pk_mul_f32 v[228:229], v[228:229], v[8:9] op_sel:[0,1]
v_pk_mul_f32 v[230:231], v[230:231], v[8:9] op_sel:[0,1]
v_pk_mul_f32 v[236:237], v[236:237], v[8:9] op_sel:[0,1]
v_pk_mul_f32 v[238:239], v[238:239], v[8:9] op_sel:[0,1]
v_cvt_pk_bf16_f32 v228, v228, v229
v_cvt_pk_bf16_f32 v229, v230, v231
v_cvt_pk_bf16_f32 v230, v236, v237
v_cvt_pk_bf16_f32 v231, v238, v239
buffer_store_dwordx4 v[224:227], v1, s[60:63], s6 offen offset:0 sc1
buffer_store_dwordx4 v[228:231], v1, s[60:63], s6 offen offset:1024 sc1
s_add_u32 s6, s6, 4096
v_pk_mul_f32 v[240:241], v[240:241], v[8:9] op_sel_hi:[1,0]
v_pk_mul_f32 v[242:243], v[242:243], v[8:9] op_sel_hi:[1,0]
v_pk_mul_f32 v[248:249], v[248:249], v[8:9] op_sel_hi:[1,0]
v_pk_mul_f32 v[250:251], v[250:251], v[8:9] op_sel_hi:[1,0]
v_cvt_pk_bf16_f32 v240, v240, v241
v_cvt_pk_bf16_f32 v241, v242, v243
v_cvt_pk_bf16_f32 v242, v248, v249
v_cvt_pk_bf16_f32 v243, v250, v251
v_pk_mul_f32 v[244:245], v[244:245], v[8:9] op_sel:[0,1]
v_pk_mul_f32 v[246:247], v[246:247], v[8:9] op_sel:[0,1]
v_pk_mul_f32 v[252:253], v[252:253], v[8:9] op_sel:[0,1]
v_pk_mul_f32 v[254:255], v[254:255], v[8:9] op_sel:[0,1]
v_cvt_pk_bf16_f32 v244, v244, v245
v_cvt_pk_bf16_f32 v245, v246, v247
v_cvt_pk_bf16_f32 v246, v252, v253
v_cvt_pk_bf16_f32 v247, v254, v255
buffer_store_dwordx4 v[240:243], v1, s[60:63], s6 offen offset:0 sc1
buffer_store_dwordx4 v[244:247], v1, s[60:63], s6 offen offset:1024 sc1
s_sub_u32 s89, s90, 3
s_lshr_b32 s89, s89, 1
s_cmp_eq_u32 s89, s15
s_cbranch_scc1 L_at_sg0
.p2align 5
L_at_single:
v_mfma_f32_16x16x32_bf16 v[48:51], a[96:99], v[16:19], v[96:99]
s_add_u32 s86, s86, 16384
v_exp_f32 v64, v64
v_mfma_f32_16x16x32_bf16 v[48:51], a[100:103], v[20:23], v[48:51]
s_cmp_eq_u32 s86, 163840
ds_read_b128 a[128:131], v5 offset:8192
ds_read_b128 a[132:135], v5 offset:9216
v_mfma_f32_16x16x32_bf16 v[48:51], a[104:107], v[24:27], v[48:51]
s_cselect_b32 s86, 0, s86
v_exp_f32 v65, v65
v_mfma_f32_16x16x32_bf16 v[48:51], a[108:111], v[28:31], v[48:51]
s_add_u32 m0, s86, s13
ds_read_b128 a[136:139], v5 offset:10240
v_cvt_pk_bf16_f32 v88, v64, v65
v_mfma_f32_16x16x32_bf16 v[56:59], a[108:111], v[44:47], v[104:107]
s_add_u32 s87, s87, 17408
v_exp_f32 v66, v66
v_mfma_f32_16x16x32_bf16 v[56:59], a[104:107], v[40:43], v[56:59]
buffer_load_dwordx4 v1, s[48:51], s87 offen offset:0 sc1 lds
v_mfma_f32_16x16x32_bf16 v[56:59], a[100:103], v[36:39], v[56:59]
v_exp_f32 v67, v67
v_mfma_f32_16x16x32_bf16 v[56:59], a[96:99], v[32:35], v[56:59]
s_waitcnt lgkmcnt(3)
ds_read_b128 a[140:143], v5 offset:11264
v_cvt_pk_bf16_f32 v89, v66, v67
v_mfma_f32_16x16x32_bf16 v[52:55], a[112:115], v[16:19], v[100:103]
v_exp_f32 v68, v68
v_mfma_f32_16x16x32_bf16 v[52:55], a[116:119], v[20:23], v[52:55]
ds_read_b128 a[144:147], v5 offset:12288
ds_read_b128 a[148:151], v5 offset:13312
v_mfma_f32_16x16x32_bf16 v[52:55], a[120:123], v[24:27], v[52:55]
v_exp_f32 v69, v69
v_mfma_f32_16x16x32_bf16 v[52:55], a[124:127], v[28:31], v[52:55]
ds_read_b128 a[152:155], v5 offset:14336
v_cvt_pk_bf16_f32 v90, v68, v69
v_mfma_f32_16x16x32_bf16 v[60:63], a[124:127], v[44:47], v[108:111]
v_exp_f32 v70, v70
v_mfma_f32_16x16x32_bf16 v[60:63], a[120:123], v[40:43], v[60:63]
buffer_load_dwordx4 v1, s[48:51], s87 offen offset:1024 sc1 lds
v_mfma_f32_16x16x32_bf16 v[60:63], a[116:119], v[36:39], v[60:63]
v_exp_f32 v71, v71
v_mfma_f32_16x16x32_bf16 v[60:63], a[112:115], v[32:35], v[60:63]
s_waitcnt lgkmcnt(1)
ds_read_b128 a[156:159], v5 offset:15360
v_cvt_pk_bf16_f32 v91, v70, v71
v_mfma_f32_16x16x32_bf16 v[128:131], a[128:131], v[80:83], v[128:131]
v_exp_f32 v72, v72
v_mfma_f32_16x16x32_bf16 v[132:135], a[128:131], v[84:87], v[132:135]
ds_read_b128 a[96:99], v4 offset:0
ds_read_b128 a[100:103], v4 offset:1024
v_mfma_f32_16x16x32_bf16 v[140:143], a[132:135], v[84:87], v[140:143]
s_add_u32 s85, s85, 16384
v_exp_f32 v73, v73
v_mfma_f32_16x16x32_bf16 v[136:139], a[132:135], v[80:83], v[136:139]
ds_read_b128 a[104:107], v4 offset:2048
v_cvt_pk_bf16_f32 v92, v72, v73
v_mfma_f32_16x16x32_bf16 v[144:147], a[136:139], v[80:83], v[144:147]
s_cmp_eq_u32 s85, 163840
v_exp_f32 v74, v74
v_mfma_f32_16x16x32_bf16 v[148:151], a[136:139], v[84:87], v[148:151]
buffer_load_dwordx4 v1, s[48:51], s87 offen offset:2048 sc1 lds
v_mfma_f32_16x16x32_bf16 v[156:159], a[140:143], v[84:87], v[156:159]
s_cselect_b32 s85, 0, s85
v_exp_f32 v75, v75
v_mfma_f32_16x16x32_bf16 v[152:155], a[140:143], v[80:83], v[152:155]
s_waitcnt lgkmcnt(3)
ds_read_b128 a[108:111], v4 offset:3072
v_cvt_pk_bf16_f32 v93, v74, v75
v_mfma_f32_16x16x32_bf16 v[160:163], a[144:147], v[80:83], v[160:163]
s_add_u32 s84, s84, 16384
v_exp_f32 v76, v76
v_mfma_f32_16x16x32_bf16 v[164:167], a[144:147], v[84:87], v[164:167]
s_cmp_eq_u32 s84, 163840
ds_read_b128 a[112:115], v4 offset:4096
ds_read_b128 a[116:119], v4 offset:5120
v_mfma_f32_16x16x32_bf16 v[172:175], a[148:151], v[84:87], v[172:175]
s_cselect_b32 s84, 0, s84
v_exp_f32 v77, v77
v_mfma_f32_16x16x32_bf16 v[168:171], a[148:151], v[80:83], v[168:171]
ds_read_b128 a[120:123], v4 offset:6144
v_cvt_pk_bf16_f32 v94, v76, v77
v_mfma_f32_16x16x32_bf16 v[176:179], a[152:155], v[80:83], v[176:179]
v_exp_f32 v78, v78
v_mfma_f32_16x16x32_bf16 v[180:183], a[152:155], v[84:87], v[180:183]
buffer_load_dwordx4 v1, s[48:51], s87 offen offset:3072 sc1 lds
v_mfma_f32_16x16x32_bf16 v[188:191], a[156:159], v[84:87], v[188:191]
v_exp_f32 v79, v79
v_mfma_f32_16x16x32_bf16 v[184:187], a[156:159], v[80:83], v[184:187]
ds_read_b128 a[124:127], v4 offset:7168
v_cvt_pk_bf16_f32 v95, v78, v79
v_mfma_f32_16x16x32_bf16 a[160:163], a[176:179], v[80:83], a[160:163]
v_add_u32 v5, s85, v1
v_add_u32 v4, s84, v1
v_mfma_f32_16x16x32_bf16 a[164:167], a[176:179], v[84:87], a[164:167]
s_waitcnt lgkmcnt(2)
v_mfma_f32_16x16x32_bf16 v[64:67], a[96:99], v[16:19], v[96:99]
s_add_u32 s86, s86, 16384
v_exp_f32 v48, v48
v_mfma_f32_16x16x32_bf16 v[64:67], a[100:103], v[20:23], v[64:67]
s_cmp_eq_u32 s86, 163840
ds_read_b128 a[128:131], v5 offset:8192
ds_read_b128 a[132:135], v5 offset:9216
v_mfma_f32_16x16x32_bf16 v[64:67], a[104:107], v[24:27], v[64:67]
s_cselect_b32 s86, 0, s86
v_exp_f32 v49, v49
v_mfma_f32_16x16x32_bf16 v[64:67], a[108:111], v[28:31], v[64:67]
s_add_u32 m0, s86, s13
ds_read_b128 a[136:139], v5 offset:10240
v_cvt_pk_bf16_f32 v80, v48, v49
v_mfma_f32_16x16x32_bf16 v[72:75], a[108:111], v[44:47], v[104:107]
s_add_u32 s87, s87, 17408
v_exp_f32 v50, v50
v_mfma_f32_16x16x32_bf16 v[72:75], a[104:107], v[40:43], v[72:75]
buffer_load_dwordx4 v1, s[48:51], s87 offen offset:0 sc1 lds
v_mfma_f32_16x16x32_bf16 v[72:75], a[100:103], v[36:39], v[72:75]
v_exp_f32 v51, v51
v_mfma_f32_16x16x32_bf16 v[72:75], a[96:99], v[32:35], v[72:75]
s_waitcnt lgkmcnt(3)
ds_read_b128 a[140:143], v5 offset:11264
v_cvt_pk_bf16_f32 v81, v50, v51
v_mfma_f32_16x16x32_bf16 v[68:71], a[112:115], v[16:19], v[100:103]
v_exp_f32 v52, v52
v_mfma_f32_16x16x32_bf16 v[68:71], a[116:119], v[20:23], v[68:71]
ds_read_b128 a[144:147], v5 offset:12288
ds_read_b128 a[148:151], v5 offset:13312
v_mfma_f32_16x16x32_bf16 v[68:71], a[120:123], v[24:27], v[68:71]
v_exp_f32 v53, v53
v_mfma_f32_16x16x32_bf16 v[68:71], a[124:127], v[28:31], v[68:71]
ds_read_b128 a[152:155], v5 offset:14336
v_cvt_pk_bf16_f32 v82, v52, v53
v_mfma_f32_16x16x32_bf16 v[76:79], a[124:127], v[44:47], v[108:111]
v_exp_f32 v54, v54
v_mfma_f32_16x16x32_bf16 v[76:79], a[120:123], v[40:43], v[76:79]
buffer_load_dwordx4 v1, s[48:51], s87 offen offset:1024 sc1 lds
v_mfma_f32_16x16x32_bf16 v[76:79], a[116:119], v[36:39], v[76:79]
s_waitcnt vmcnt(6)
v_exp_f32 v55, v55
v_mfma_f32_16x16x32_bf16 v[76:79], a[112:115], v[32:35], v[76:79]
s_waitcnt lgkmcnt(1)
ds_read_b128 a[156:159], v5 offset:15360
v_cvt_pk_bf16_f32 v83, v54, v55
v_mfma_f32_16x16x32_bf16 v[128:131], a[128:131], v[88:91], v[128:131]
s_barrier
v_exp_f32 v56, v56
v_mfma_f32_16x16x32_bf16 v[132:135], a[128:131], v[92:95], v[132:135]
ds_read_b128 a[96:99], v4 offset:0
ds_read_b128 a[100:103], v4 offset:1024
v_mfma_f32_16x16x32_bf16 v[140:143], a[132:135], v[92:95], v[140:143]
s_add_u32 s85, s85, 16384
v_exp_f32 v57, v57
v_mfma_f32_16x16x32_bf16 v[136:139], a[132:135], v[88:91], v[136:139]
ds_read_b128 a[104:107], v4 offset:2048
v_cvt_pk_bf16_f32 v84, v56, v57
v_mfma_f32_16x16x32_bf16 v[144:147], a[136:139], v[88:91], v[144:147]
s_cmp_eq_u32 s85, 163840
v_exp_f32 v58, v58
v_mfma_f32_16x16x32_bf16 v[148:151], a[136:139], v[92:95], v[148:151]
buffer_load_dwordx4 v1, s[48:51], s87 offen offset:2048 sc1 lds
v_mfma_f32_16x16x32_bf16 v[156:159], a[140:143], v[92:95], v[156:159]
s_cselect_b32 s85, 0, s85
v_exp_f32 v59, v59
v_mfma_f32_16x16x32_bf16 v[152:155], a[140:143], v[88:91], v[152:155]
s_waitcnt lgkmcnt(3)
ds_read_b128 a[108:111], v4 offset:3072
v_cvt_pk_bf16_f32 v85, v58, v59
v_mfma_f32_16x16x32_bf16 v[160:163], a[144:147], v[88:91], v[160:163]
s_add_u32 s84, s84, 16384
v_exp_f32 v60, v60
v_mfma_f32_16x16x32_bf16 v[164:167], a[144:147], v[92:95], v[164:167]
s_cmp_eq_u32 s84, 163840
ds_read_b128 a[112:115], v4 offset:4096
ds_read_b128 a[116:119], v4 offset:5120
v_mfma_f32_16x16x32_bf16 v[172:175], a[148:151], v[92:95], v[172:175]
s_cselect_b32 s84, 0, s84
v_exp_f32 v61, v61
v_mfma_f32_16x16x32_bf16 v[168:171], a[148:151], v[88:91], v[168:171]
ds_read_b128 a[120:123], v4 offset:6144
v_cvt_pk_bf16_f32 v86, v60, v61
v_mfma_f32_16x16x32_bf16 v[176:179], a[152:155], v[88:91], v[176:179]
v_exp_f32 v62, v62
v_mfma_f32_16x16x32_bf16 v[180:183], a[152:155], v[92:95], v[180:183]
s_sub_u32 s89, s89, 1
buffer_load_dwordx4 v1, s[48:51], s87 offen offset:3072 sc1 lds
v_mfma_f32_16x16x32_bf16 v[188:191], a[156:159], v[92:95], v[188:191]
s_cmp_lg_u32 s89, s15
v_exp_f32 v63, v63
v_mfma_f32_16x16x32_bf16 v[184:187], a[156:159], v[88:91], v[184:187]
ds_read_b128 a[124:127], v4 offset:7168
v_cvt_pk_bf16_f32 v87, v62, v63
v_mfma_f32_16x16x32_bf16 a[160:163], a[176:179], v[88:91], a[160:163]
s_waitcnt lgkmcnt(2)
v_add_u32 v5, s85, v1
v_add_u32 v4, s84, v1
v_mfma_f32_16x16x32_bf16 a[164:167], a[176:179], v[92:95], a[164:167]
s_cbranch_scc1 L_at_single
L_at_sg0:
s_cmp_ge_u32 s5, 6
s_cbranch_scc1 L_at_sgx
v_and_b32 v13, 7, v2
v_lshlrev_b32 v13, 7, v13
s_mov_b32 s8, 399360
buffer_load_dword v12, v13, s[60:63], s8 offen sc1
s_getpc_b64 s[64:65]
L_at_pc3:
s_add_u32 s64, s64, L_at_sgp-L_at_pc3
s_addc_u32 s65, s65, 0
s_lshr_b32 s6, s2, 3
s_and_b32 s6, s6, 7
s_lshl_b32 s6, s6, 13
s_lshr_b32 s9, s13, 1
s_add_u32 s6, s6, s9
v_and_b32 v14, 15, v2
v_lshl_add_u32 v14, v14, 7, s6
v_min_u32 v14, L_fr_codeend-L_at_sgp-4, v14
global_load_dword v14, v14, s[64:65]
L_at_sgp:
v_mfma_f32_16x16x32_bf16 v[48:51], a[96:99], v[16:19], v[96:99]
s_add_u32 s86, s86, 16384
v_exp_f32 v64, v64
v_mfma_f32_16x16x32_bf16 v[48:51], a[100:103], v[20:23], v[48:51]
s_cmp_eq_u32 s86, 163840
ds_read_b128 a[128:131], v5 offset:8192
ds_read_b128 a[132:135], v5 offset:9216
v_mfma_f32_16x16x32_bf16 v[48:51], a[104:107], v[24:27], v[48:51]
s_cselect_b32 s86, 0, s86
v_exp_f32 v65, v65
v_mfma_f32_16x16x32_bf16 v[48:51], a[108:111], v[28:31], v[48:51]
s_add_u32 m0, s86, s13
ds_read_b128 a[136:139], v5 offset:10240
v_cvt_pk_bf16_f32 v88, v64, v65
v_mfma_f32_16x16x32_bf16 v[56:59], a[108:111], v[44:47], v[104:107]
s_add_u32 s87, s87, 17408
v_exp_f32 v66, v66
v_mfma_f32_16x16x32_bf16 v[56:59], a[104:107], v[40:43], v[56:59]
s_and_b32 s40, s2, 6
buffer_load_dwordx4 v1, s[48:51], s87 offen offset:0 sc1 lds
v_mfma_f32_16x16x32_bf16 v[56:59], a[100:103], v[36:39], v[56:59]
s_lshr_b32 s41, s2, 6
v_exp_f32 v67, v67
v_mfma_f32_16x16x32_bf16 v[56:59], a[96:99], v[32:35], v[56:59]
s_waitcnt lgkmcnt(3)
ds_read_b128 a[140:143], v5 offset:11264
v_cvt_pk_bf16_f32 v89, v66, v67
v_mfma_f32_16x16x32_bf16 v[52:55], a[112:115], v[16:19], v[100:103]
s_lshl1_add_u32 s40, s40, s41
v_exp_f32 v68, v68
v_mfma_f32_16x16x32_bf16 v[52:55], a[116:119], v[20:23], v[52:55]
s_and_b32 s42, s2, 1
ds_read_b128 a[144:147], v5 offset:12288
ds_read_b128 a[148:151], v5 offset:13312
v_mfma_f32_16x16x32_bf16 v[52:55], a[120:123], v[24:27], v[52:55]
s_lshl1_add_u32 s40, s40, s42
v_exp_f32 v69, v69
v_mfma_f32_16x16x32_bf16 v[52:55], a[124:127], v[28:31], v[52:55]
s_lshr_b32 s41, s2, 3
ds_read_b128 a[152:155], v5 offset:14336
v_cvt_pk_bf16_f32 v90, v68, v69
v_mfma_f32_16x16x32_bf16 v[60:63], a[124:127], v[44:47], v[108:111]
s_and_b32 s41, s41, 7
v_exp_f32 v70, v70
v_mfma_f32_16x16x32_bf16 v[60:63], a[120:123], v[40:43], v[60:63]
s_lshl1_add_u32 s43, s41, s42
buffer_load_dwordx4 v1, s[48:51], s87 offen offset:1024 sc1 lds
v_mfma_f32_16x16x32_bf16 v[60:63], a[116:119], v[36:39], v[60:63]
v_exp_f32 v71, v71
v_mfma_f32_16x16x32_bf16 v[60:63], a[112:115], v[32:35], v[60:63]
s_waitcnt lgkmcnt(1)
ds_read_b128 a[156:159], v5 offset:15360
v_cvt_pk_bf16_f32 v91, v70, v71
v_mfma_f32_16x16x32_bf16 v[128:131], a[128:131], v[80:83], v[128:131]
v_exp_f32 v72, v72
v_mfma_f32_16x16x32_bf16 v[132:135], a[128:131], v[84:87], v[132:135]
ds_read_b128 a[96:99], v4 offset:0
ds_read_b128 a[100:103], v4 offset:1024
v_mfma_f32_16x16x32_bf16 v[140:143], a[132:135], v[84:87], v[140:143]
s_add_u32 s85, s85, 16384
v_exp_f32 v73, v73
v_mfma_f32_16x16x32_bf16 v[136:139], a[132:135], v[80:83], v[136:139]
ds_read_b128 a[104:107], v4 offset:2048
v_cvt_pk_bf16_f32 v92, v72, v73
v_mfma_f32_16x16x32_bf16 v[144:147], a[136:139], v[80:83], v[144:147]
s_cmp_eq_u32 s85, 163840
v_exp_f32 v74, v74
v_mfma_f32_16x16x32_bf16 v[148:151], a[136:139], v[84:87], v[148:151]
buffer_load_dwordx4 v1, s[48:51], s87 offen offset:2048 sc1 lds
v_mfma_f32_16x16x32_bf16 v[156:159], a[140:143], v[84:87], v[156:159]
s_cselect_b32 s85, 0, s85
v_exp_f32 v75, v75
v_mfma_f32_16x16x32_bf16 v[152:155], a[140:143], v[80:83], v[152:155]
s_waitcnt lgkmcnt(3)
ds_read_b128 a[108:111], v4 offset:3072
v_cvt_pk_bf16_f32 v93, v74, v75
v_mfma_f32_16x16x32_bf16 v[160:163], a[144:147], v[80:83], v[160:163]
s_add_u32 s84, s84, 16384
v_exp_f32 v76, v76
v_mfma_f32_16x16x32_bf16 v[164:167], a[144:147], v[84:87], v[164:167]
s_cmp_eq_u32 s84, 163840
ds_read_b128 a[112:115], v4 offset:4096
ds_read_b128 a[116:119], v4 offset:5120
v_mfma_f32_16x16x32_bf16 v[172:175], a[148:151], v[84:87], v[172:175]
s_cselect_b32 s84, 0, s84
v_exp_f32 v77, v77
v_mfma_f32_16x16x32_bf16 v[168:171], a[148:151], v[80:83], v[168:171]
s_lshl4_add_u32 s43, s43, s3
ds_read_b128 a[120:123], v4 offset:6144
v_cvt_pk_bf16_f32 v94, v76, v77
v_mfma_f32_16x16x32_bf16 v[176:179], a[152:155], v[80:83], v[176:179]
s_mul_i32 s43, s43, 20480
v_exp_f32 v78, v78
v_mfma_f32_16x16x32_bf16 v[180:183], a[152:155], v[84:87], v[180:183]
s_add_u32 s43, s43, 13631488
buffer_load_dwordx4 v1, s[48:51], s87 offen offset:3072 sc1 lds
v_mfma_f32_16x16x32_bf16 v[188:191], a[156:159], v[84:87], v[188:191]
v_exp_f32 v79, v79
v_mfma_f32_16x16x32_bf16 v[184:187], a[156:159], v[80:83], v[184:187]
ds_read_b128 a[124:127], v4 offset:7168
v_cvt_pk_bf16_f32 v95, v78, v79
v_mfma_f32_16x16x32_bf16 a[160:163], a[176:179], v[80:83], a[160:163]
v_add_u32 v5, s85, v1
v_add_u32 v4, s84, v1
v_mfma_f32_16x16x32_bf16 a[164:167], a[176:179], v[84:87], a[164:167]
s_waitcnt vmcnt(5) lgkmcnt(2)
v_cmp_gt_u32 vcc, 80, v12
s_nop 1
s_cbranch_vccnz L_at_spinr
L_at_gor:
v_mfma_f32_16x16x32_bf16 v[64:67], a[96:99], v[16:19], v[96:99]
s_add_u32 s86, s86, 16384
v_exp_f32 v48, v48
v_mfma_f32_16x16x32_bf16 v[64:67], a[100:103], v[20:23], v[64:67]
s_cmp_eq_u32 s86, 163840
ds_read_b128 a[128:131], v5 offset:8192
ds_read_b128 a[132:135], v5 offset:9216
v_mfma_f32_16x16x32_bf16 v[64:67], a[104:107], v[24:27], v[64:67]
s_cselect_b32 s86, 0, s86
v_exp_f32 v49, v49
v_mfma_f32_16x16x32_bf16 v[64:67], a[108:111], v[28:31], v[64:67]
s_add_u32 m0, s86, s13
ds_read_b128 a[136:139], v5 offset:10240
v_cvt_pk_bf16_f32 v80, v48, v49
v_mfma_f32_16x16x32_bf16 v[72:75], a[108:111], v[44:47], v[104:107]
s_add_u32 s87, s87, 17408
v_exp_f32 v50, v50
v_mfma_f32_16x16x32_bf16 v[72:75], a[104:107], v[40:43], v[72:75]
buffer_load_dwordx4 v1, s[48:51], s87 offen offset:0 sc1 lds
v_mfma_f32_16x16x32_bf16 v[72:75], a[100:103], v[36:39], v[72:75]
v_exp_f32 v51, v51
v_mfma_f32_16x16x32_bf16 v[72:75], a[96:99], v[32:35], v[72:75]
s_waitcnt lgkmcnt(3)
ds_read_b128 a[140:143], v5 offset:11264
v_cvt_pk_bf16_f32 v81, v50, v51
v_mfma_f32_16x16x32_bf16 v[68:71], a[112:115], v[16:19], v[100:103]
v_exp_f32 v52, v52
v_mfma_f32_16x16x32_bf16 v[68:71], a[116:119], v[20:23], v[68:71]
ds_read_b128 a[144:147], v5 offset:12288
ds_read_b128 a[148:151], v5 offset:13312
buffer_load_dwordx4 a[0:3], v1, s[60:63], s43 offen offset:0 sc1
v_mfma_f32_16x16x32_bf16 v[68:71], a[120:123], v[24:27], v[68:71]
v_exp_f32 v53, v53
v_mfma_f32_16x16x32_bf16 v[68:71], a[124:127], v[28:31], v[68:71]
ds_read_b128 a[152:155], v5 offset:14336
v_cvt_pk_bf16_f32 v82, v52, v53
v_mfma_f32_16x16x32_bf16 v[76:79], a[124:127], v[44:47], v[108:111]
v_exp_f32 v54, v54
v_mfma_f32_16x16x32_bf16 v[76:79], a[120:123], v[40:43], v[76:79]
buffer_load_dwordx4 v1, s[48:51], s87 offen offset:1024 sc1 lds
v_mfma_f32_16x16x32_bf16 v[76:79], a[116:119], v[36:39], v[76:79]
v_exp_f32 v55, v55
v_mfma_f32_16x16x32_bf16 v[76:79], a[112:115], v[32:35], v[76:79]
s_waitcnt lgkmcnt(1)
ds_read_b128 a[156:159], v5 offset:15360
v_cvt_pk_bf16_f32 v83, v54, v55
v_mfma_f32_16x16x32_bf16 v[128:131], a[128:131], v[88:91], v[128:131]
s_barrier
v_exp_f32 v56, v56
v_mfma_f32_16x16x32_bf16 v[132:135], a[128:131], v[92:95], v[132:135]
ds_read_b128 a[96:99], v4 offset:0
ds_read_b128 a[100:103], v4 offset:1024
buffer_load_dwordx4 a[4:7], v1, s[60:63], s43 offen offset:1024 sc1
v_mfma_f32_16x16x32_bf16 v[140:143], a[132:135], v[92:95], v[140:143]
s_add_u32 s85, s85, 16384
v_exp_f32 v57, v57
v_mfma_f32_16x16x32_bf16 v[136:139], a[132:135], v[88:91], v[136:139]
ds_read_b128 a[104:107], v4 offset:2048
v_cvt_pk_bf16_f32 v84, v56, v57
v_mfma_f32_16x16x32_bf16 v[144:147], a[136:139], v[88:91], v[144:147]
s_cmp_eq_u32 s85, 163840
v_exp_f32 v58, v58
v_mfma_f32_16x16x32_bf16 v[148:151], a[136:139], v[92:95], v[148:151]
buffer_load_dwordx4 v1, s[48:51], s87 offen offset:2048 sc1 lds
v_mfma_f32_16x16x32_bf16 v[156:159], a[140:143], v[92:95], v[156:159]
s_cselect_b32 s85, 0, s85
v_exp_f32 v59, v59
v_mfma_f32_16x16x32_bf16 v[152:155], a[140:143], v[88:91], v[152:155]
s_waitcnt lgkmcnt(3)
ds_read_b128 a[108:111], v4 offset:3072
v_cvt_pk_bf16_f32 v85, v58, v59
v_mfma_f32_16x16x32_bf16 v[160:163], a[144:147], v[88:91], v[160:163]
s_add_u32 s84, s84, 16384
v_exp_f32 v60, v60
v_mfma_f32_16x16x32_bf16 v[164:167], a[144:147], v[92:95], v[164:167]
s_cmp_eq_u32 s84, 163840
ds_read_b128 a[112:115], v4 offset:4096
ds_read_b128 a[116:119], v4 offset:5120
buffer_load_dwordx4 a[8:11], v1, s[60:63], s43 offen offset:2048 sc1
v_mfma_f32_16x16x32_bf16 v[172:175], a[148:151], v[92:95], v[172:175]
s_cselect_b32 s84, 0, s84
v_exp_f32 v61, v61
v_mfma_f32_16x16x32_bf16 v[168:171], a[148:151], v[88:91], v[168:171]
ds_read_b128 a[120:123], v4 offset:6144
v_cvt_pk_bf16_f32 v86, v60, v61
v_mfma_f32_16x16x32_bf16 v[176:179], a[152:155], v[88:91], v[176:179]
v_exp_f32 v62, v62
v_mfma_f32_16x16x32_bf16 v[180:183], a[152:155], v[92:95], v[180:183]
buffer_load_dwordx4 v1, s[48:51], s87 offen offset:3072 sc1 lds
v_mfma_f32_16x16x32_bf16 v[188:191], a[156:159], v[92:95], v[188:191]
v_exp_f32 v63, v63
v_mfma_f32_16x16x32_bf16 v[184:187], a[156:159], v[88:91], v[184:187]
ds_read_b128 a[124:127], v4 offset:7168
v_cvt_pk_bf16_f32 v87, v62, v63
v_mfma_f32_16x16x32_bf16 a[160:163], a[176:179], v[88:91], a[160:163]
v_add_u32 v5, s85, v1
v_add_u32 v4, s84, v1
v_mfma_f32_16x16x32_bf16 a[164:167], a[176:179], v[92:95], a[164:167]
s_waitcnt lgkmcnt(2)
buffer_load_dwordx4 a[12:15], v1, s[60:63], s43 offen offset:3072 sc1
s_add_u32 s43, s43, 4096
v_mfma_f32_16x16x32_bf16 v[48:51], a[96:99], v[16:19], v[96:99]
s_add_u32 s86, s86, 16384
v_exp_f32 v64, v64
v_mfma_f32_16x16x32_bf16 v[48:51], a[100:103], v[20:23], v[48:51]
s_cmp_eq_u32 s86, 163840
ds_read_b128 a[128:131], v5 offset:8192
ds_read_b128 a[132:135], v5 offset:9216
v_mfma_f32_16x16x32_bf16 v[48:51], a[104:107], v[24:27], v[48:51]
s_cselect_b32 s86, 0, s86
v_exp_f32 v65, v65
v_mfma_f32_16x16x32_bf16 v[48:51], a[108:111], v[28:31], v[48:51]
s_add_u32 m0, s86, s13
ds_read_b128 a[136:139], v5 offset:10240
v_cvt_pk_bf16_f32 v88, v64, v65
v_mfma_f32_16x16x32_bf16 v[56:59], a[108:111], v[44:47], v[104:107]
s_add_u32 s87, s87, 17408
v_exp_f32 v66, v66
v_mfma_f32_16x16x32_bf16 v[56:59], a[104:107], v[40:43], v[56:59]
buffer_load_dwordx4 v1, s[48:51], s87 offen offset:0 sc1 lds
v_mfma_f32_16x16x32_bf16 v[56:59], a[100:103], v[36:39], v[56:59]
v_exp_f32 v67, v67
v_mfma_f32_16x16x32_bf16 v[56:59], a[96:99], v[32:35], v[56:59]
s_waitcnt lgkmcnt(3)
ds_read_b128 a[140:143], v5 offset:11264
v_cvt_pk_bf16_f32 v89, v66, v67
v_mfma_f32_16x16x32_bf16 v[52:55], a[112:115], v[16:19], v[100:103]
v_exp_f32 v68, v68
v_mfma_f32_16x16x32_bf16 v[52:55], a[116:119], v[20:23], v[52:55]
ds_read_b128 a[144:147], v5 offset:12288
ds_read_b128 a[148:151], v5 offset:13312
buffer_load_dwordx4 a[16:19], v1, s[60:63], s43 offen offset:0 sc1
v_mfma_f32_16x16x32_bf16 v[52:55], a[120:123], v[24:27], v[52:55]
v_exp_f32 v69, v69
v_mfma_f32_16x16x32_bf16 v[52:55], a[124:127], v[28:31], v[52:55]
ds_read_b128 a[152:155], v5 offset:14336
v_cvt_pk_bf16_f32 v90, v68, v69
v_mfma_f32_16x16x32_bf16 v[60:63], a[124:127], v[44:47], v[108:111]
v_exp_f32 v70, v70
v_mfma_f32_16x16x32_bf16 v[60:63], a[120:123], v[40:43], v[60:63]
buffer_load_dwordx4 v1, s[48:51], s87 offen offset:1024 sc1 lds
v_mfma_f32_16x16x32_bf16 v[60:63], a[116:119], v[36:39], v[60:63]
v_exp_f32 v71, v71
v_mfma_f32_16x16x32_bf16 v[60:63], a[112:115], v[32:35], v[60:63]
s_waitcnt lgkmcnt(1)
ds_read_b128 a[156:159], v5 offset:15360
v_cvt_pk_bf16_f32 v91, v70, v71
v_mfma_f32_16x16x32_bf16 v[128:131], a[128:131], v[80:83], v[128:131]
v_exp_f32 v72, v72
v_mfma_f32_16x16x32_bf16 v[132:135], a[128:131], v[84:87], v[132:135]
ds_read_b128 a[96:99], v4 offset:0
ds_read_b128 a[100:103], v4 offset:1024
buffer_load_dwordx4 a[20:23], v1, s[60:63], s43 offen offset:1024 sc1
v_mfma_f32_16x16x32_bf16 v[140:143], a[132:135], v[84:87], v[140:143]
s_add_u32 s85, s85, 16384
v_exp_f32 v73, v73
v_mfma_f32_16x16x32_bf16 v[136:139], a[132:135], v[80:83], v[136:139]
ds_read_b128 a[104:107], v4 offset:2048
v_cvt_pk_bf16_f32 v92, v72, v73
v_mfma_f32_16x16x32_bf16 v[144:147], a[136:139], v[80:83], v[144:147]
s_cmp_eq_u32 s85, 163840
v_exp_f32 v74, v74
v_mfma_f32_16x16x32_bf16 v[148:151], a[136:139], v[84:87], v[148:151]
buffer_load_dwordx4 v1, s[48:51], s87 offen offset:2048 sc1 lds
v_mfma_f32_16x16x32_bf16 v[156:159], a[140:143], v[84:87], v[156:159]
s_cselect_b32 s85, 0, s85
v_exp_f32 v75, v75
v_mfma_f32_16x16x32_bf16 v[152:155], a[140:143], v[80:83], v[152:155]
s_waitcnt lgkmcnt(3)
ds_read_b128 a[108:111], v4 offset:3072
v_cvt_pk_bf16_f32 v93, v74, v75
v_mfma_f32_16x16x32_bf16 v[160:163], a[144:147], v[80:83], v[160:163]
s_add_u32 s84, s84, 16384
v_exp_f32 v76, v76
v_mfma_f32_16x16x32_bf16 v[164:167], a[144:147], v[84:87], v[164:167]
s_cmp_eq_u32 s84, 163840
ds_read_b128 a[112:115], v4 offset:4096
ds_read_b128 a[116:119], v4 offset:5120
buffer_load_dwordx4 a[24:27], v1, s[60:63], s43 offen offset:2048 sc1
v_mfma_f32_16x16x32_bf16 v[172:175], a[148:151], v[84:87], v[172:175]
s_cselect_b32 s84, 0, s84
v_exp_f32 v77, v77
v_mfma_f32_16x16x32_bf16 v[168:171], a[148:151], v[80:83], v[168:171]
ds_read_b128 a[120:123], v4 offset:6144
v_cvt_pk_bf16_f32 v94, v76, v77
v_mfma_f32_16x16x32_bf16 v[176:179], a[152:155], v[80:83], v[176:179]
v_exp_f32 v78, v78
v_mfma_f32_16x16x32_bf16 v[180:183], a[152:155], v[84:87], v[180:183]
buffer_load_dwordx4 v1, s[48:51], s87 offen offset:3072 sc1 lds
v_mfma_f32_16x16x32_bf16 v[188:191], a[156:159], v[84:87], v[188:191]
v_exp_f32 v79, v79
v_mfma_f32_16x16x32_bf16 v[184:187], a[156:159], v[80:83], v[184:187]
ds_read_b128 a[124:127], v4 offset:7168
v_cvt_pk_bf16_f32 v95, v78, v79
v_mfma_f32_16x16x32_bf16 a[160:163], a[176:179], v[80:83], a[160:163]
v_add_u32 v5, s85, v1
v_add_u32 v4, s84, v1
v_mfma_f32_16x16x32_bf16 a[164:167], a[176:179], v[84:87], a[164:167]
s_waitcnt lgkmcnt(2)
buffer_load_dwordx4 a[28:31], v1, s[60:63], s43 offen offset:3072 sc1
s_add_u32 s43, s43, 4096
v_mfma_f32_16x16x32_bf16 v[64:67], a[96:99], v[16:19], v[96:99]
s_add_u32 s86, s86, 16384
v_exp_f32 v48, v48
v_mfma_f32_16x16x32_bf16 v[64:67], a[100:103], v[20:23], v[64:67]
s_cmp_eq_u32 s86, 163840
ds_read_b128 a[128:131], v5 offset:8192
ds_read_b128 a[132:135], v5 offset:9216
v_mfma_f32_16x16x32_bf16 v[64:67], a[104:107], v[24:27], v[64:67]
s_cselect_b32 s86, 0, s86
v_exp_f32 v49, v49
v_mfma_f32_16x16x32_bf16 v[64:67], a[108:111], v[28:31], v[64:67]
s_add_u32 m0, s86, s13
ds_read_b128 a[136:139], v5 offset:10240
v_cvt_pk_bf16_f32 v80, v48, v49
v_mfma_f32_16x16x32_bf16 v[72:75], a[108:111], v[44:47], v[104:107]
s_add_u32 s87, s87, 17408
v_exp_f32 v50, v50
v_mfma_f32_16x16x32_bf16 v[72:75], a[104:107], v[40:43], v[72:75]
buffer_load_dwordx4 v1, s[48:51], s87 offen offset:0 sc1 lds
v_mfma_f32_16x16x32_bf16 v[72:75], a[100:103], v[36:39], v[72:75]
v_exp_f32 v51, v51
v_mfma_f32_16x16x32_bf16 v[72:75], a[96:99], v[32:35], v[72:75]
s_waitcnt lgkmcnt(3)
ds_read_b128 a[140:143], v5 offset:11264
v_cvt_pk_bf16_f32 v81, v50, v51
v_mfma_f32_16x16x32_bf16 v[68:71], a[112:115], v[16:19], v[100:103]
v_exp_f32 v52, v52
v_mfma_f32_16x16x32_bf16 v[68:71], a[116:119], v[20:23], v[68:71]
ds_read_b128 a[144:147], v5 offset:12288
ds_read_b128 a[148:151], v5 offset:13312
buffer_load_dwordx4 a[32:35], v1, s[60:63], s43 offen offset:0 sc1
v_mfma_f32_16x16x32_bf16 v[68:71], a[120:123], v[24:27], v[68:71]
v_exp_f32 v53, v53
v_mfma_f32_16x16x32_bf16 v[68:71], a[124:127], v[28:31], v[68:71]
ds_read_b128 a[152:155], v5 offset:14336
v_cvt_pk_bf16_f32 v82, v52, v53
v_mfma_f32_16x16x32_bf16 v[76:79], a[124:127], v[44:47], v[108:111]
v_exp_f32 v54, v54
v_mfma_f32_16x16x32_bf16 v[76:79], a[120:123], v[40:43], v[76:79]
buffer_load_dwordx4 v1, s[48:51], s87 offen offset:1024 sc1 lds
v_mfma_f32_16x16x32_bf16 v[76:79], a[116:119], v[36:39], v[76:79]
s_waitcnt vmcnt(12)
v_exp_f32 v55, v55
v_mfma_f32_16x16x32_bf16 v[76:79], a[112:115], v[32:35], v[76:79]
s_waitcnt lgkmcnt(1)
ds_read_b128 a[156:159], v5 offset:15360
v_cvt_pk_bf16_f32 v83, v54, v55
v_mfma_f32_16x16x32_bf16 v[128:131], a[128:131], v[88:91], v[128:131]
s_barrier
v_exp_f32 v56, v56
v_mfma_f32_16x16x32_bf16 v[132:135], a[128:131], v[92:95], v[132:135]
ds_read_b128 a[96:99], v4 offset:0
ds_read_b128 a[100:103], v4 offset:1024
buffer_load_dwordx4 a[36:39], v1, s[60:63], s43 offen offset:1024 sc1
v_mfma_f32_16x16x32_bf16 v[140:143], a[132:135], v[92:95], v[140:143]
s_add_u32 s85, s85, 16384
v_exp_f32 v57, v57
v_mfma_f32_16x16x32_bf16 v[136:139], a[132:135], v[88:91], v[136:139]
s_add_u32 s43, s43, 4096
ds_read_b128 a[104:107], v4 offset:2048
v_cvt_pk_bf16_f32 v84, v56, v57
v_mfma_f32_16x16x32_bf16 v[144:147], a[136:139], v[88:91], v[144:147]
s_cmp_eq_u32 s85, 163840
v_exp_f32 v58, v58
v_mfma_f32_16x16x32_bf16 v[148:151], a[136:139], v[92:95], v[148:151]
buffer_load_dwordx4 v1, s[48:51], s87 offen offset:2048 sc1 lds
v_mfma_f32_16x16x32_bf16 v[156:159], a[140:143], v[92:95], v[156:159]
s_cselect_b32 s85, 0, s85
v_exp_f32 v59, v59
v_mfma_f32_16x16x32_bf16 v[152:155], a[140:143], v[88:91], v[152:155]
s_waitcnt lgkmcnt(3)
ds_read_b128 a[108:111], v4 offset:3072
v_cvt_pk_bf16_f32 v85, v58, v59
v_mfma_f32_16x16x32_bf16 v[160:163], a[144:147], v[88:91], v[160:163]
s_add_u32 s84, s84, 16384
v_exp_f32 v60, v60
v_mfma_f32_16x16x32_bf16 v[164:167], a[144:147], v[92:95], v[164:167]
s_cmp_eq_u32 s84, 163840
ds_read_b128 a[112:115], v4 offset:4096
ds_read_b128 a[116:119], v4 offset:5120
buffer_load_dwordx4 a[40:43], v1, s[60:63], s43 offen offset:3072 sc1
v_mfma_f32_16x16x32_bf16 v[172:175], a[148:151], v[92:95], v[172:175]
s_cselect_b32 s84, 0, s84
v_exp_f32 v61, v61
v_mfma_f32_16x16x32_bf16 v[168:171], a[148:151], v[88:91], v[168:171]
s_add_u32 s43, s43, 4096
ds_read_b128 a[120:123], v4 offset:6144
v_cvt_pk_bf16_f32 v86, v60, v61
v_mfma_f32_16x16x32_bf16 v[176:179], a[152:155], v[88:91], v[176:179]
v_exp_f32 v62, v62
v_mfma_f32_16x16x32_bf16 v[180:183], a[152:155], v[92:95], v[180:183]
buffer_load_dwordx4 v1, s[48:51], s87 offen offset:3072 sc1 lds
v_mfma_f32_16x16x32_bf16 v[188:191], a[156:159], v[92:95], v[188:191]
v_exp_f32 v63, v63
v_mfma_f32_16x16x32_bf16 v[184:187], a[156:159], v[88:91], v[184:187]
ds_read_b128 a[124:127], v4 offset:7168
v_cvt_pk_bf16_f32 v87, v62, v63
v_mfma_f32_16x16x32_bf16 a[160:163], a[176:179], v[88:91], a[160:163]
v_add_u32 v5, s85, v1
v_add_u32 v4, s84, v1
v_mfma_f32_16x16x32_bf16 a[164:167], a[176:179], v[92:95], a[164:167]
s_waitcnt lgkmcnt(2)
buffer_load_dwordx4 a[44:47], v1, s[60:63], s43 offen offset:0 sc1
v_mfma_f32_16x16x32_bf16 v[48:51], a[96:99], v[16:19], v[96:99]
s_add_u32 s86, s86, 16384
v_exp_f32 v64, v64
v_mfma_f32_16x16x32_bf16 v[48:51], a[100:103], v[20:23], v[48:51]
s_cmp_eq_u32 s86, 163840
ds_read_b128 a[128:131], v5 offset:8192
ds_read_b128 a[132:135], v5 offset:9216
v_mfma_f32_16x16x32_bf16 v[48:51], a[104:107], v[24:27], v[48:51]
s_cselect_b32 s86, 0, s86
v_exp_f32 v65, v65
v_mfma_f32_16x16x32_bf16 v[48:51], a[108:111], v[28:31], v[48:51]
s_add_u32 m0, s86, s13
ds_read_b128 a[136:139], v5 offset:10240
v_cvt_pk_bf16_f32 v88, v64, v65
v_mfma_f32_16x16x32_bf16 v[56:59], a[108:111], v[44:47], v[104:107]
s_add_u32 s87, s87, 17408
v_exp_f32 v66, v66
v_mfma_f32_16x16x32_bf16 v[56:59], a[104:107], v[40:43], v[56:59]
buffer_load_dwordx4 v1, s[48:51], s87 offen offset:0 sc1 lds
v_mfma_f32_16x16x32_bf16 v[56:59], a[100:103], v[36:39], v[56:59]
v_exp_f32 v67, v67
v_mfma_f32_16x16x32_bf16 v[56:59], a[96:99], v[32:35], v[56:59]
s_waitcnt lgkmcnt(3)
ds_read_b128 a[140:143], v5 offset:11264
v_cvt_pk_bf16_f32 v89, v66, v67
v_mfma_f32_16x16x32_bf16 v[52:55], a[112:115], v[16:19], v[100:103]
v_exp_f32 v68, v68
v_mfma_f32_16x16x32_bf16 v[52:55], a[116:119], v[20:23], v[52:55]
ds_read_b128 a[144:147], v5 offset:12288
ds_read_b128 a[148:151], v5 offset:13312
buffer_load_dwordx4 a[48:51], v1, s[60:63], s43 offen offset:1024 sc1
v_mfma_f32_16x16x32_bf16 v[52:55], a[120:123], v[24:27], v[52:55]
v_exp_f32 v69, v69
v_mfma_f32_16x16x32_bf16 v[52:55], a[124:127], v[28:31], v[52:55]
ds_read_b128 a[152:155], v5 offset:14336
v_cvt_pk_bf16_f32 v90, v68, v69
v_mfma_f32_16x16x32_bf16 v[60:63], a[124:127], v[44:47], v[108:111]
v_exp_f32 v70, v70
v_mfma_f32_16x16x32_bf16 v[60:63], a[120:123], v[40:43], v[60:63]
buffer_load_dwordx4 v1, s[48:51], s87 offen offset:1024 sc1 lds
v_mfma_f32_16x16x32_bf16 v[60:63], a[116:119], v[36:39], v[60:63]
v_exp_f32 v71, v71
v_mfma_f32_16x16x32_bf16 v[60:63], a[112:115], v[32:35], v[60:63]
s_waitcnt lgkmcnt(1)
ds_read_b128 a[156:159], v5 offset:15360
v_cvt_pk_bf16_f32 v91, v70, v71
v_mfma_f32_16x16x32_bf16 v[128:131], a[128:131], v[80:83], v[128:131]
v_exp_f32 v72, v72
v_mfma_f32_16x16x32_bf16 v[132:135], a[128:131], v[84:87], v[132:135]
ds_read_b128 a[96:99], v4 offset:0
ds_read_b128 a[100:103], v4 offset:1024
buffer_load_dwordx4 a[52:55], v1, s[60:63], s43 offen offset:2048 sc1
v_mfma_f32_16x16x32_bf16 v[140:143], a[132:135], v[84:87], v[140:143]
s_add_u32 s85, s85, 16384
v_exp_f32 v73, v73
v_mfma_f32_16x16x32_bf16 v[136:139], a[132:135], v[80:83], v[136:139]
ds_read_b128 a[104:107], v4 offset:2048
v_cvt_pk_bf16_f32 v92, v72, v73
v_mfma_f32_16x16x32_bf16 v[144:147], a[136:139], v[80:83], v[144:147]
s_cmp_eq_u32 s85, 163840
v_exp_f32 v74, v74
v_mfma_f32_16x16x32_bf16 v[148:151], a[136:139], v[84:87], v[148:151]
buffer_load_dwordx4 v1, s[48:51], s87 offen offset:2048 sc1 lds
v_mfma_f32_16x16x32_bf16 v[156:159], a[140:143], v[84:87], v[156:159]
s_cselect_b32 s85, 0, s85
v_exp_f32 v75, v75
v_mfma_f32_16x16x32_bf16 v[152:155], a[140:143], v[80:83], v[152:155]
s_waitcnt lgkmcnt(3)
ds_read_b128 a[108:111], v4 offset:3072
v_cvt_pk_bf16_f32 v93, v74, v75
v_mfma_f32_16x16x32_bf16 v[160:163], a[144:147], v[80:83], v[160:163]
s_add_u32 s84, s84, 16384
v_exp_f32 v76, v76
v_mfma_f32_16x16x32_bf16 v[164:167], a[144:147], v[84:87], v[164:167]
s_cmp_eq_u32 s84, 163840
ds_read_b128 a[112:115], v4 offset:4096
ds_read_b128 a[116:119], v4 offset:5120
buffer_load_dwordx4 a[56:59], v1, s[60:63], s43 offen offset:3072 sc1
v_mfma_f32_16x16x32_bf16 v[172:175], a[148:151], v[84:87], v[172:175]
s_cselect_b32 s84, 0, s84
v_exp_f32 v77, v77
v_mfma_f32_16x16x32_bf16 v[168:171], a[148:151], v[80:83], v[168:171]
s_add_u32 s43, s43, 147456
ds_read_b128 a[120:123], v4 offset:6144
v_cvt_pk_bf16_f32 v94, v76, v77
v_mfma_f32_16x16x32_bf16 v[176:179], a[152:155], v[80:83], v[176:179]
v_exp_f32 v78, v78
v_mfma_f32_16x16x32_bf16 v[180:183], a[152:155], v[84:87], v[180:183]
buffer_load_dwordx4 v1, s[48:51], s87 offen offset:3072 sc1 lds
v_mfma_f32_16x16x32_bf16 v[188:191], a[156:159], v[84:87], v[188:191]
v_exp_f32 v79, v79
v_mfma_f32_16x16x32_bf16 v[184:187], a[156:159], v[80:83], v[184:187]
ds_read_b128 a[124:127], v4 offset:7168
v_cvt_pk_bf16_f32 v95, v78, v79
v_mfma_f32_16x16x32_bf16 a[160:163], a[176:179], v[80:83], a[160:163]
v_add_u32 v5, s85, v1
v_add_u32 v4, s84, v1
v_mfma_f32_16x16x32_bf16 a[164:167], a[176:179], v[84:87], a[164:167]
s_waitcnt lgkmcnt(2)
buffer_load_dwordx4 a[180:183], v1, s[60:63], s43 offen offset:0 sc1
v_mfma_f32_16x16x32_bf16 v[64:67], a[96:99], v[16:19], v[96:99]
s_add_u32 s86, s86, 16384
v_exp_f32 v48, v48
v_mfma_f32_16x16x32_bf16 v[64:67], a[100:103], v[20:23], v[64:67]
s_cmp_eq_u32 s86, 163840
ds_read_b128 a[128:131], v5 offset:8192
ds_read_b128 a[132:135], v5 offset:9216
v_mfma_f32_16x16x32_bf16 v[64:67], a[104:107], v[24:27], v[64:67]
s_cselect_b32 s86, 0, s86
v_exp_f32 v49, v49
v_mfma_f32_16x16x32_bf16 v[64:67], a[108:111], v[28:31], v[64:67]
s_add_u32 m0, s86, s13
ds_read_b128 a[136:139], v5 offset:10240
v_cvt_pk_bf16_f32 v80, v48, v49
v_mfma_f32_16x16x32_bf16 v[72:75], a[108:111], v[44:47], v[104:107]
s_add_u32 s87, s87, 17408
v_exp_f32 v50, v50
v_mfma_f32_16x16x32_bf16 v[72:75], a[104:107], v[40:43], v[72:75]
buffer_load_dwordx4 v1, s[48:51], s87 offen offset:0 sc1 lds
v_mfma_f32_16x16x32_bf16 v[72:75], a[100:103], v[36:39], v[72:75]
v_exp_f32 v51, v51
v_mfma_f32_16x16x32_bf16 v[72:75], a[96:99], v[32:35], v[72:75]
s_waitcnt lgkmcnt(3)
ds_read_b128 a[140:143], v5 offset:11264
v_cvt_pk_bf16_f32 v81, v50, v51
v_mfma_f32_16x16x32_bf16 v[68:71], a[112:115], v[16:19], v[100:103]
v_exp_f32 v52, v52
v_mfma_f32_16x16x32_bf16 v[68:71], a[116:119], v[20:23], v[68:71]
ds_read_b128 a[144:147], v5 offset:12288
ds_read_b128 a[148:151], v5 offset:13312
buffer_load_dwordx4 a[184:187], v1, s[60:63], s43 offen offset:1024 sc1
v_mfma_f32_16x16x32_bf16 v[68:71], a[120:123], v[24:27], v[68:71]
v_exp_f32 v53, v53
v_mfma_f32_16x16x32_bf16 v[68:71], a[124:127], v[28:31], v[68:71]
ds_read_b128 a[152:155], v5 offset:14336
v_cvt_pk_bf16_f32 v82, v52, v53
v_mfma_f32_16x16x32_bf16 v[76:79], a[124:127], v[44:47], v[108:111]
v_exp_f32 v54, v54
v_mfma_f32_16x16x32_bf16 v[76:79], a[120:123], v[40:43], v[76:79]
buffer_load_dwordx4 v1, s[48:51], s87 offen offset:1024 sc1 lds
v_mfma_f32_16x16x32_bf16 v[76:79], a[116:119], v[36:39], v[76:79]
s_waitcnt vmcnt(12)
v_exp_f32 v55, v55
v_mfma_f32_16x16x32_bf16 v[76:79], a[112:115], v[32:35], v[76:79]
s_waitcnt lgkmcnt(1)
ds_read_b128 a[156:159], v5 offset:15360
v_cvt_pk_bf16_f32 v83, v54, v55
v_mfma_f32_16x16x32_bf16 v[128:131], a[128:131], v[88:91], v[128:131]
s_barrier
v_exp_f32 v56, v56
v_mfma_f32_16x16x32_bf16 v[132:135], a[128:131], v[92:95], v[132:135]
ds_read_b128 a[96:99], v4 offset:0
ds_read_b128 a[100:103], v4 offset:1024
buffer_load_dwordx4 a[188:191], v1, s[60:63], s43 offen offset:2048 sc1
v_mfma_f32_16x16x32_bf16 v[140:143], a[132:135], v[92:95], v[140:143]
s_add_u32 s85, s85, 16384
v_exp_f32 v57, v57
v_mfma_f32_16x16x32_bf16 v[136:139], a[132:135], v[88:91], v[136:139]
ds_read_b128 a[104:107], v4 offset:2048
v_cvt_pk_bf16_f32 v84, v56, v57
v_mfma_f32_16x16x32_bf16 v[144:147], a[136:139], v[88:91], v[144:147]
s_cmp_eq_u32 s85, 163840
v_exp_f32 v58, v58
v_mfma_f32_16x16x32_bf16 v[148:151], a[136:139], v[92:95], v[148:151]
buffer_load_dwordx4 v1, s[48:51], s87 offen offset:2048 sc1 lds
v_mfma_f32_16x16x32_bf16 v[156:159], a[140:143], v[92:95], v[156:159]
s_cselect_b32 s85, 0, s85
v_exp_f32 v59, v59
v_mfma_f32_16x16x32_bf16 v[152:155], a[140:143], v[88:91], v[152:155]
s_waitcnt lgkmcnt(3)
ds_read_b128 a[108:111], v4 offset:3072
v_cvt_pk_bf16_f32 v85, v58, v59
v_mfma_f32_16x16x32_bf16 v[160:163], a[144:147], v[88:91], v[160:163]
s_add_u32 s84, s84, 16384
v_exp_f32 v60, v60
v_mfma_f32_16x16x32_bf16 v[164:167], a[144:147], v[92:95], v[164:167]
s_cmp_eq_u32 s84, 163840
ds_read_b128 a[112:115], v4 offset:4096
ds_read_b128 a[116:119], v4 offset:5120
buffer_load_dwordx4 a[192:195], v1, s[60:63], s43 offen offset:3072 sc1
v_mfma_f32_16x16x32_bf16 v[172:175], a[148:151], v[92:95], v[172:175]
s_cselect_b32 s84, 0, s84
v_exp_f32 v61, v61
v_mfma_f32_16x16x32_bf16 v[168:171], a[148:151], v[88:91], v[168:171]
s_add_u32 s43, s43, 4096
ds_read_b128 a[120:123], v4 offset:6144
v_cvt_pk_bf16_f32 v86, v60, v61
v_mfma_f32_16x16x32_bf16 v[176:179], a[152:155], v[88:91], v[176:179]
v_exp_f32 v62, v62
v_mfma_f32_16x16x32_bf16 v[180:183], a[152:155], v[92:95], v[180:183]
buffer_load_dwordx4 v1, s[48:51], s87 offen offset:3072 sc1 lds
v_mfma_f32_16x16x32_bf16 v[188:191], a[156:159], v[92:95], v[188:191]
v_exp_f32 v63, v63
v_mfma_f32_16x16x32_bf16 v[184:187], a[156:159], v[88:91], v[184:187]
ds_read_b128 a[124:127], v4 offset:7168
v_cvt_pk_bf16_f32 v87, v62, v63
v_mfma_f32_16x16x32_bf16 a[160:163], a[176:179], v[88:91], a[160:163]
v_add_u32 v5, s85, v1
v_add_u32 v4, s84, v1
v_mfma_f32_16x16x32_bf16 a[164:167], a[176:179], v[92:95], a[164:167]
s_waitcnt lgkmcnt(2)
buffer_load_dwordx4 a[196:199], v1, s[60:63], s43 offen offset:0 sc1
v_mfma_f32_16x16x32_bf16 v[48:51], a[96:99], v[16:19], v[96:99]
s_add_u32 s86, s86, 16384
v_exp_f32 v64, v64
v_mfma_f32_16x16x32_bf16 v[48:51], a[100:103], v[20:23], v[48:51]
s_cmp_eq_u32 s86, 163840
ds_read_b128 a[128:131], v5 offset:8192
ds_read_b128 a[132:135], v5 offset:9216
v_mfma_f32_16x16x32_bf16 v[48:51], a[104:107], v[24:27], v[48:51]
s_cselect_b32 s86, 0, s86
v_exp_f32 v65, v65
v_mfma_f32_16x16x32_bf16 v[48:51], a[108:111], v[28:31], v[48:51]
s_add_u32 m0, s86, s13
ds_read_b128 a[136:139], v5 offset:10240
v_cvt_pk_bf16_f32 v88, v64, v65
v_mfma_f32_16x16x32_bf16 v[56:59], a[108:111], v[44:47], v[104:107]
s_add_u32 s87, s87, 17408
v_exp_f32 v66, v66
v_mfma_f32_16x16x32_bf16 v[56:59], a[104:107], v[40:43], v[56:59]
buffer_load_dwordx4 v1, s[48:51], s87 offen offset:0 sc1 lds
v_mfma_f32_16x16x32_bf16 v[56:59], a[100:103], v[36:39], v[56:59]
v_exp_f32 v67, v67
v_mfma_f32_16x16x32_bf16 v[56:59], a[96:99], v[32:35], v[56:59]
s_waitcnt lgkmcnt(3)
ds_read_b128 a[140:143], v5 offset:11264
v_cvt_pk_bf16_f32 v89, v66, v67
v_mfma_f32_16x16x32_bf16 v[52:55], a[112:115], v[16:19], v[100:103]
v_exp_f32 v68, v68
v_mfma_f32_16x16x32_bf16 v[52:55], a[116:119], v[20:23], v[52:55]
ds_read_b128 a[144:147], v5 offset:12288
ds_read_b128 a[148:151], v5 offset:13312
buffer_load_dwordx4 a[200:203], v1, s[60:63], s43 offen offset:1024 sc1
v_mfma_f32_16x16x32_bf16 v[52:55], a[120:123], v[24:27], v[52:55]
v_exp_f32 v69, v69
v_mfma_f32_16x16x32_bf16 v[52:55], a[124:127], v[28:31], v[52:55]
ds_read_b128 a[152:155], v5 offset:14336
v_cvt_pk_bf16_f32 v90, v68, v69
v_mfma_f32_16x16x32_bf16 v[60:63], a[124:127], v[44:47], v[108:111]
v_exp_f32 v70, v70
v_mfma_f32_16x16x32_bf16 v[60:63], a[120:123], v[40:43], v[60:63]
buffer_load_dwordx4 v1, s[48:51], s87 offen offset:1024 sc1 lds
v_mfma_f32_16x16x32_bf16 v[60:63], a[116:119], v[36:39], v[60:63]
v_exp_f32 v71, v71
v_mfma_f32_16x16x32_bf16 v[60:63], a[112:115], v[32:35], v[60:63]
s_waitcnt lgkmcnt(1)
ds_read_b128 a[156:159], v5 offset:15360
v_cvt_pk_bf16_f32 v91, v70, v71
v_mfma_f32_16x16x32_bf16 v[128:131], a[128:131], v[80:83], v[128:131]
v_exp_f32 v72, v72
v_mfma_f32_16x16x32_bf16 v[132:135], a[128:131], v[84:87], v[132:135]
ds_read_b128 a[96:99], v4 offset:0
ds_read_b128 a[100:103], v4 offset:1024
buffer_load_dwordx4 a[204:207], v1, s[60:63], s43 offen offset:2048 sc1
v_mfma_f32_16x16x32_bf16 v[140:143], a[132:135], v[84:87], v[140:143]
s_add_u32 s85, s85, 16384
v_exp_f32 v73, v73
v_mfma_f32_16x16x32_bf16 v[136:139], a[132:135], v[80:83], v[136:139]
ds_read_b128 a[104:107], v4 offset:2048
v_cvt_pk_bf16_f32 v92, v72, v73
v_mfma_f32_16x16x32_bf16 v[144:147], a[136:139], v[80:83], v[144:147]
s_cmp_eq_u32 s85, 163840
v_exp_f32 v74, v74
v_mfma_f32_16x16x32_bf16 v[148:151], a[136:139], v[84:87], v[148:151]
buffer_load_dwordx4 v1, s[48:51], s87 offen offset:2048 sc1 lds
v_mfma_f32_16x16x32_bf16 v[156:159], a[140:143], v[84:87], v[156:159]
s_cselect_b32 s85, 0, s85
v_exp_f32 v75, v75
v_mfma_f32_16x16x32_bf16 v[152:155], a[140:143], v[80:83], v[152:155]
s_waitcnt lgkmcnt(3)
ds_read_b128 a[108:111], v4 offset:3072
v_cvt_pk_bf16_f32 v93, v74, v75
v_mfma_f32_16x16x32_bf16 v[160:163], a[144:147], v[80:83], v[160:163]
s_add_u32 s84, s84, 16384
v_exp_f32 v76, v76
v_mfma_f32_16x16x32_bf16 v[164:167], a[144:147], v[84:87], v[164:167]
s_cmp_eq_u32 s84, 163840
ds_read_b128 a[112:115], v4 offset:4096
ds_read_b128 a[116:119], v4 offset:5120
buffer_load_dwordx4 a[208:211], v1, s[60:63], s43 offen offset:3072 sc1
v_mfma_f32_16x16x32_bf16 v[172:175], a[148:151], v[84:87], v[172:175]
s_cselect_b32 s84, 0, s84
v_exp_f32 v77, v77
v_mfma_f32_16x16x32_bf16 v[168:171], a[148:151], v[80:83], v[168:171]
s_add_u32 s43, s43, 4096
ds_read_b128 a[120:123], v4 offset:6144
v_cvt_pk_bf16_f32 v94, v76, v77
v_mfma_f32_16x16x32_bf16 v[176:179], a[152:155], v[80:83], v[176:179]
v_exp_f32 v78, v78
v_mfma_f32_16x16x32_bf16 v[180:183], a[152:155], v[84:87], v[180:183]
buffer_load_dwordx4 v1, s[48:51], s87 offen offset:3072 sc1 lds
v_mfma_f32_16x16x32_bf16 v[188:191], a[156:159], v[84:87], v[188:191]
v_exp_f32 v79, v79
v_mfma_f32_16x16x32_bf16 v[184:187], a[156:159], v[80:83], v[184:187]
ds_read_b128 a[124:127], v4 offset:7168
v_cvt_pk_bf16_f32 v95, v78, v79
v_mfma_f32_16x16x32_bf16 a[160:163], a[176:179], v[80:83], a[160:163]
v_add_u32 v5, s85, v1
v_add_u32 v4, s84, v1
v_mfma_f32_16x16x32_bf16 a[164:167], a[176:179], v[84:87], a[164:167]
s_waitcnt lgkmcnt(2)
buffer_load_dwordx4 a[212:215], v1, s[60:63], s43 offen offset:0 sc1
v_mfma_f32_16x16x32_bf16 v[64:67], a[96:99], v[16:19], v[96:99]
s_add_u32 s86, s86, 16384
v_exp_f32 v48, v48
v_mfma_f32_16x16x32_bf16 v[64:67], a[100:103], v[20:23], v[64:67]
s_cmp_eq_u32 s86, 163840
ds_read_b128 a[128:131], v5 offset:8192
ds_read_b128 a[132:135], v5 offset:9216
v_mfma_f32_16x16x32_bf16 v[64:67], a[104:107], v[24:27], v[64:67]
s_cselect_b32 s86, 0, s86
v_exp_f32 v49, v49
v_mfma_f32_16x16x32_bf16 v[64:67], a[108:111], v[28:31], v[64:67]
s_add_u32 m0, s86, s13
ds_read_b128 a[136:139], v5 offset:10240
v_cvt_pk_bf16_f32 v80, v48, v49
v_mfma_f32_16x16x32_bf16 v[72:75], a[108:111], v[44:47], v[104:107]
s_add_u32 s87, s87, 17408
v_exp_f32 v50, v50
v_mfma_f32_16x16x32_bf16 v[72:75], a[104:107], v[40:43], v[72:75]
buffer_load_dwordx4 v1, s[48:51], s87 offen offset:0 sc1 lds
v_mfma_f32_16x16x32_bf16 v[72:75], a[100:103], v[36:39], v[72:75]
v_exp_f32 v51, v51
v_mfma_f32_16x16x32_bf16 v[72:75], a[96:99], v[32:35], v[72:75]
s_waitcnt lgkmcnt(3)
ds_read_b128 a[140:143], v5 offset:11264
v_cvt_pk_bf16_f32 v81, v50, v51
v_mfma_f32_16x16x32_bf16 v[68:71], a[112:115], v[16:19], v[100:103]
v_exp_f32 v52, v52
v_mfma_f32_16x16x32_bf16 v[68:71], a[116:119], v[20:23], v[68:71]
ds_read_b128 a[144:147], v5 offset:12288
ds_read_b128 a[148:151], v5 offset:13312
buffer_load_dwordx4 a[216:219], v1, s[60:63], s43 offen offset:1024 sc1
v_mfma_f32_16x16x32_bf16 v[68:71], a[120:123], v[24:27], v[68:71]
v_exp_f32 v53, v53
v_mfma_f32_16x16x32_bf16 v[68:71], a[124:127], v[28:31], v[68:71]
ds_read_b128 a[152:155], v5 offset:14336
v_cvt_pk_bf16_f32 v82, v52, v53
v_mfma_f32_16x16x32_bf16 v[76:79], a[124:127], v[44:47], v[108:111]
v_exp_f32 v54, v54
v_mfma_f32_16x16x32_bf16 v[76:79], a[120:123], v[40:43], v[76:79]
buffer_load_dwordx4 v1, s[48:51], s87 offen offset:1024 sc1 lds
v_mfma_f32_16x16x32_bf16 v[76:79], a[116:119], v[36:39], v[76:79]
s_waitcnt vmcnt(12)
v_exp_f32 v55, v55
v_mfma_f32_16x16x32_bf16 v[76:79], a[112:115], v[32:35], v[76:79]
s_waitcnt lgkmcnt(1)
ds_read_b128 a[156:159], v5 offset:15360
v_cvt_pk_bf16_f32 v83, v54, v55
v_mfma_f32_16x16x32_bf16 v[128:131], a[128:131], v[88:91], v[128:131]
s_barrier
v_exp_f32 v56, v56
v_mfma_f32_16x16x32_bf16 v[132:135], a[128:131], v[92:95], v[132:135]
ds_read_b128 a[96:99], v4 offset:0
ds_read_b128 a[100:103], v4 offset:1024
buffer_load_dwordx4 a[220:223], v1, s[60:63], s43 offen offset:2048 sc1
v_mfma_f32_16x16x32_bf16 v[140:143], a[132:135], v[92:95], v[140:143]
s_add_u32 s85, s85, 16384
v_exp_f32 v57, v57
v_mfma_f32_16x16x32_bf16 v[136:139], a[132:135], v[88:91], v[136:139]
ds_read_b128 a[104:107], v4 offset:2048
v_cvt_pk_bf16_f32 v84, v56, v57
v_mfma_f32_16x16x32_bf16 v[144:147], a[136:139], v[88:91], v[144:147]
s_cmp_eq_u32 s85, 163840
v_exp_f32 v58, v58
v_mfma_f32_16x16x32_bf16 v[148:151], a[136:139], v[92:95], v[148:151]
buffer_load_dwordx4 v1, s[48:51], s87 offen offset:2048 sc1 lds
v_mfma_f32_16x16x32_bf16 v[156:159], a[140:143], v[92:95], v[156:159]
s_cselect_b32 s85, 0, s85
v_exp_f32 v59, v59
v_mfma_f32_16x16x32_bf16 v[152:155], a[140:143], v[88:91], v[152:155]
s_waitcnt lgkmcnt(3)
ds_read_b128 a[108:111], v4 offset:3072
v_cvt_pk_bf16_f32 v85, v58, v59
v_mfma_f32_16x16x32_bf16 v[160:163], a[144:147], v[88:91], v[160:163]
s_add_u32 s84, s84, 16384
v_exp_f32 v60, v60
v_mfma_f32_16x16x32_bf16 v[164:167], a[144:147], v[92:95], v[164:167]
s_cmp_eq_u32 s84, 163840
ds_read_b128 a[112:115], v4 offset:4096
ds_read_b128 a[116:119], v4 offset:5120
buffer_load_dwordx4 a[224:227], v1, s[60:63], s43 offen offset:3072 sc1
v_mfma_f32_16x16x32_bf16 v[172:175], a[148:151], v[92:95], v[172:175]
s_cselect_b32 s84, 0, s84
v_exp_f32 v61, v61
v_mfma_f32_16x16x32_bf16 v[168:171], a[148:151], v[88:91], v[168:171]
s_add_u32 s43, s43, 4096
ds_read_b128 a[120:123], v4 offset:6144
v_cvt_pk_bf16_f32 v86, v60, v61
v_mfma_f32_16x16x32_bf16 v[176:179], a[152:155], v[88:91], v[176:179]
v_exp_f32 v62, v62
v_mfma_f32_16x16x32_bf16 v[180:183], a[152:155], v[92:95], v[180:183]
buffer_load_dwordx4 v1, s[48:51], s87 offen offset:3072 sc1 lds
v_mfma_f32_16x16x32_bf16 v[188:191], a[156:159], v[92:95], v[188:191]
v_exp_f32 v63, v63
v_mfma_f32_16x16x32_bf16 v[184:187], a[156:159], v[88:91], v[184:187]
ds_read_b128 a[124:127], v4 offset:7168
v_cvt_pk_bf16_f32 v87, v62, v63
v_mfma_f32_16x16x32_bf16 a[160:163], a[176:179], v[88:91], a[160:163]
v_add_u32 v5, s85, v1
v_add_u32 v4, s84, v1
v_mfma_f32_16x16x32_bf16 a[164:167], a[176:179], v[92:95], a[164:167]
s_waitcnt lgkmcnt(2)
buffer_load_dwordx4 a[228:231], v1, s[60:63], s43 offen offset:0 sc1
L_at_sg4:
v_mfma_f32_16x16x32_bf16 v[48:51], a[96:99], v[16:19], v[96:99]
s_add_u32 s86, s86, 16384
v_exp_f32 v64, v64
v_mfma_f32_16x16x32_bf16 v[48:51], a[100:103], v[20:23], v[48:51]
s_cmp_eq_u32 s86, 163840
ds_read_b128 a[128:131], v5 offset:8192
ds_read_b128 a[132:135], v5 offset:9216
v_mfma_f32_16x16x32_bf16 v[48:51], a[104:107], v[24:27], v[48:51]
s_cselect_b32 s86, 0, s86
v_exp_f32 v65, v65
v_mfma_f32_16x16x32_bf16 v[48:51], a[108:111], v[28:31], v[48:51]
s_add_u32 m0, s86, s13
ds_read_b128 a[136:139], v5 offset:10240
v_cvt_pk_bf16_f32 v88, v64, v65
v_mfma_f32_16x16x32_bf16 v[56:59], a[108:111], v[44:47], v[104:107]
s_add_u32 s87, s87, 17408
v_exp_f32 v66, v66
v_mfma_f32_16x16x32_bf16 v[56:59], a[104:107], v[40:43], v[56:59]
buffer_load_dwordx4 v1, s[48:51], s87 offen offset:0 sc1 lds
v_mfma_f32_16x16x32_bf16 v[56:59], a[100:103], v[36:39], v[56:59]
v_exp_f32 v67, v67
v_mfma_f32_16x16x32_bf16 v[56:59], a[96:99], v[32:35], v[56:59]
s_waitcnt lgkmcnt(3)
ds_read_b128 a[140:143], v5 offset:11264
v_cvt_pk_bf16_f32 v89, v66, v67
v_mfma_f32_16x16x32_bf16 v[52:55], a[112:115], v[16:19], v[100:103]
v_exp_f32 v68, v68
v_mfma_f32_16x16x32_bf16 v[52:55], a[116:119], v[20:23], v[52:55]
ds_read_b128 a[144:147], v5 offset:12288
ds_read_b128 a[148:151], v5 offset:13312
buffer_load_dwordx4 a[232:235], v1, s[60:63], s43 offen offset:1024 sc1
v_mfma_f32_16x16x32_bf16 v[52:55], a[120:123], v[24:27], v[52:55]
v_exp_f32 v69, v69
v_mfma_f32_16x16x32_bf16 v[52:55], a[124:127], v[28:31], v[52:55]
ds_read_b128 a[152:155], v5 offset:14336
v_cvt_pk_bf16_f32 v90, v68, v69
v_mfma_f32_16x16x32_bf16 v[60:63], a[124:127], v[44:47], v[108:111]
v_exp_f32 v70, v70
v_mfma_f32_16x16x32_bf16 v[60:63], a[120:123], v[40:43], v[60:63]
buffer_load_dwordx4 v1, s[48:51], s87 offen offset:1024 sc1 lds
v_mfma_f32_16x16x32_bf16 v[60:63], a[116:119], v[36:39], v[60:63]
v_exp_f32 v71, v71
v_mfma_f32_16x16x32_bf16 v[60:63], a[112:115], v[32:35], v[60:63]
s_waitcnt lgkmcnt(1)
ds_read_b128 a[156:159], v5 offset:15360
v_cvt_pk_bf16_f32 v91, v70, v71
v_mfma_f32_16x16x32_bf16 v[128:131], a[128:131], v[80:83], v[128:131]
v_exp_f32 v72, v72
v_mfma_f32_16x16x32_bf16 v[132:135], a[128:131], v[84:87], v[132:135]
ds_read_b128 a[96:99], v4 offset:0
ds_read_b128 a[100:103], v4 offset:1024
buffer_load_dwordx4 a[236:239], v1, s[60:63], s43 offen offset:2048 sc1
v_mfma_f32_16x16x32_bf16 v[140:143], a[132:135], v[84:87], v[140:143]
s_add_u32 s85, s85, 16384
v_exp_f32 v73, v73
v_mfma_f32_16x16x32_bf16 v[136:139], a[132:135], v[80:83], v[136:139]
s_add_u32 s43, s43, 4294873088
ds_read_b128 a[104:107], v4 offset:2048
v_cvt_pk_bf16_f32 v92, v72, v73
v_mfma_f32_16x16x32_bf16 v[144:147], a[136:139], v[80:83], v[144:147]
s_cmp_eq_u32 s85, 163840
v_exp_f32 v74, v74
v_mfma_f32_16x16x32_bf16 v[148:151], a[136:139], v[84:87], v[148:151]
buffer_load_dwordx4 v1, s[48:51], s87 offen offset:2048 sc1 lds
v_mfma_f32_16x16x32_bf16 v[156:159], a[140:143], v[84:87], v[156:159]
s_cselect_b32 s85, 0, s85
v_exp_f32 v75, v75
v_mfma_f32_16x16x32_bf16 v[152:155], a[140:143], v[80:83], v[152:155]
s_waitcnt lgkmcnt(3)
ds_read_b128 a[108:111], v4 offset:3072
v_cvt_pk_bf16_f32 v93, v74, v75
v_mfma_f32_16x16x32_bf16 v[160:163], a[144:147], v[80:83], v[160:163]
s_add_u32 s84, s84, 16384
v_exp_f32 v76, v76
v_mfma_f32_16x16x32_bf16 v[164:167], a[144:147], v[84:87], v[164:167]
s_cmp_eq_u32 s84, 163840
ds_read_b128 a[112:115], v4 offset:4096
ds_read_b128 a[116:119], v4 offset:5120
buffer_load_dwordx4 a[240:243], v1, s[60:63], s43 offen offset:0 sc1
v_mfma_f32_16x16x32_bf16 v[172:175], a[148:151], v[84:87], v[172:175]
s_cselect_b32 s84, 0, s84
v_exp_f32 v77, v77
v_mfma_f32_16x16x32_bf16 v[168:171], a[148:151], v[80:83], v[168:171]
ds_read_b128 a[120:123], v4 offset:6144
v_cvt_pk_bf16_f32 v94, v76, v77
v_mfma_f32_16x16x32_bf16 v[176:179], a[152:155], v[80:83], v[176:179]
v_exp_f32 v78, v78
v_mfma_f32_16x16x32_bf16 v[180:183], a[152:155], v[84:87], v[180:183]
buffer_load_dwordx4 v1, s[48:51], s87 offen offset:3072 sc1 lds
v_mfma_f32_16x16x32_bf16 v[188:191], a[156:159], v[84:87], v[188:191]
v_exp_f32 v79, v79
v_mfma_f32_16x16x32_bf16 v[184:187], a[156:159], v[80:83], v[184:187]
ds_read_b128 a[124:127], v4 offset:7168
v_cvt_pk_bf16_f32 v95, v78, v79
v_mfma_f32_16x16x32_bf16 a[160:163], a[176:179], v[80:83], a[160:163]
v_add_u32 v5, s85, v1
v_add_u32 v4, s84, v1
v_mfma_f32_16x16x32_bf16 a[164:167], a[176:179], v[84:87], a[164:167]
s_waitcnt lgkmcnt(2)
buffer_load_dwordx4 a[244:247], v1, s[60:63], s43 offen offset:1024 sc1
v_mfma_f32_16x16x32_bf16 v[64:67], a[96:99], v[16:19], v[96:99]
s_add_u32 s86, s86, 16384
v_exp_f32 v48, v48
v_mfma_f32_16x16x32_bf16 v[64:67], a[100:103], v[20:23], v[64:67]
s_cmp_eq_u32 s86, 163840
ds_read_b128 a[128:131], v5 offset:8192
ds_read_b128 a[132:135], v5 offset:9216
v_mfma_f32_16x16x32_bf16 v[64:67], a[104:107], v[24:27], v[64:67]
s_cselect_b32 s86, 0, s86
v_exp_f32 v49, v49
v_mfma_f32_16x16x32_bf16 v[64:67], a[108:111], v[28:31], v[64:67]
s_add_u32 m0, s86, s13
ds_read_b128 a[136:139], v5 offset:10240
v_cvt_pk_bf16_f32 v80, v48, v49
v_mfma_f32_16x16x32_bf16 v[72:75], a[108:111], v[44:47], v[104:107]
s_add_u32 s87, s87, 17408
v_exp_f32 v50, v50
v_mfma_f32_16x16x32_bf16 v[72:75], a[104:107], v[40:43], v[72:75]
buffer_load_dwordx4 v1, s[48:51], s87 offen offset:0 sc1 lds
v_mfma_f32_16x16x32_bf16 v[72:75], a[100:103], v[36:39], v[72:75]
v_exp_f32 v51, v51
v_mfma_f32_16x16x32_bf16 v[72:75], a[96:99], v[32:35], v[72:75]
s_waitcnt lgkmcnt(3)
ds_read_b128 a[140:143], v5 offset:11264
v_cvt_pk_bf16_f32 v81, v50, v51
v_mfma_f32_16x16x32_bf16 v[68:71], a[112:115], v[16:19], v[100:103]
v_exp_f32 v52, v52
v_mfma_f32_16x16x32_bf16 v[68:71], a[116:119], v[20:23], v[68:71]
ds_read_b128 a[144:147], v5 offset:12288
ds_read_b128 a[148:151], v5 offset:13312
buffer_load_dwordx4 a[248:251], v1, s[60:63], s43 offen offset:2048 sc1
v_mfma_f32_16x16x32_bf16 v[68:71], a[120:123], v[24:27], v[68:71]
v_exp_f32 v53, v53
v_mfma_f32_16x16x32_bf16 v[68:71], a[124:127], v[28:31], v[68:71]
ds_read_b128 a[152:155], v5 offset:14336
v_cvt_pk_bf16_f32 v82, v52, v53
v_mfma_f32_16x16x32_bf16 v[76:79], a[124:127], v[44:47], v[108:111]
v_exp_f32 v54, v54
v_mfma_f32_16x16x32_bf16 v[76:79], a[120:123], v[40:43], v[76:79]
buffer_load_dwordx4 v1, s[48:51], s87 offen offset:1024 sc1 lds
v_mfma_f32_16x16x32_bf16 v[76:79], a[116:119], v[36:39], v[76:79]
s_waitcnt vmcnt(11)
v_exp_f32 v55, v55
v_mfma_f32_16x16x32_bf16 v[76:79], a[112:115], v[32:35], v[76:79]
s_waitcnt lgkmcnt(1)
ds_read_b128 a[156:159], v5 offset:15360
v_cvt_pk_bf16_f32 v83, v54, v55
v_mfma_f32_16x16x32_bf16 v[128:131], a[128:131], v[88:91], v[128:131]
s_barrier
v_exp_f32 v56, v56
v_mfma_f32_16x16x32_bf16 v[132:135], a[128:131], v[92:95], v[132:135]
ds_read_b128 a[96:99], v4 offset:0
ds_read_b128 a[100:103], v4 offset:1024
buffer_load_dwordx4 a[252:255], v1, s[60:63], s43 offen offset:3072 sc1
v_mfma_f32_16x16x32_bf16 v[140:143], a[132:135], v[92:95], v[140:143]
s_add_u32 s85, s85, 16384
v_exp_f32 v57, v57
v_mfma_f32_16x16x32_bf16 v[136:139], a[132:135], v[88:91], v[136:139]
s_add_u32 s43, s43, 4096
ds_read_b128 a[104:107], v4 offset:2048
v_cvt_pk_bf16_f32 v84, v56, v57
v_mfma_f32_16x16x32_bf16 v[144:147], a[136:139], v[88:91], v[144:147]
s_cmp_eq_u32 s85, 163840
v_exp_f32 v58, v58
v_mfma_f32_16x16x32_bf16 v[148:151], a[136:139], v[92:95], v[148:151]
buffer_load_dwordx4 v1, s[48:51], s87 offen offset:2048 sc1 lds
v_mfma_f32_16x16x32_bf16 v[156:159], a[140:143], v[92:95], v[156:159]
s_cselect_b32 s85, 0, s85
v_exp_f32 v59, v59
v_mfma_f32_16x16x32_bf16 v[152:155], a[140:143], v[88:91], v[152:155]
s_waitcnt lgkmcnt(3)
ds_read_b128 a[108:111], v4 offset:3072
v_cvt_pk_bf16_f32 v85, v58, v59
v_mfma_f32_16x16x32_bf16 v[160:163], a[144:147], v[88:91], v[160:163]
s_add_u32 s84, s84, 16384
v_exp_f32 v60, v60
v_mfma_f32_16x16x32_bf16 v[164:167], a[144:147], v[92:95], v[164:167]
s_cmp_eq_u32 s84, 163840
ds_read_b128 a[112:115], v4 offset:4096
ds_read_b128 a[116:119], v4 offset:5120
buffer_load_dwordx4 a[60:63], v1, s[60:63], s43 offen offset:0 sc1
v_mfma_f32_16x16x32_bf16 v[172:175], a[148:151], v[92:95], v[172:175]
s_cselect_b32 s84, 0, s84
v_exp_f32 v61, v61
v_mfma_f32_16x16x32_bf16 v[168:171], a[148:151], v[88:91], v[168:171]
ds_read_b128 a[120:123], v4 offset:6144
v_cvt_pk_bf16_f32 v86, v60, v61
v_mfma_f32_16x16x32_bf16 v[176:179], a[152:155], v[88:91], v[176:179]
v_exp_f32 v62, v62
v_mfma_f32_16x16x32_bf16 v[180:183], a[152:155], v[92:95], v[180:183]
buffer_load_dwordx4 v1, s[48:51], s87 offen offset:3072 sc1 lds
v_mfma_f32_16x16x32_bf16 v[188:191], a[156:159], v[92:95], v[188:191]
v_exp_f32 v63, v63
v_mfma_f32_16x16x32_bf16 v[184:187], a[156:159], v[88:91], v[184:187]
ds_read_b128 a[124:127], v4 offset:7168
v_cvt_pk_bf16_f32 v87, v62, v63
v_mfma_f32_16x16x32_bf16 a[160:163], a[176:179], v[88:91], a[160:163]
v_add_u32 v5, s85, v1
v_add_u32 v4, s84, v1
v_mfma_f32_16x16x32_bf16 a[164:167], a[176:179], v[92:95], a[164:167]
s_waitcnt lgkmcnt(2)
buffer_load_dwordx4 v[192:195], v1, s[60:63], s43 offen offset:1024 sc1
v_mfma_f32_16x16x32_bf16 v[48:51], a[96:99], v[16:19], v[96:99]
s_add_u32 s86, s86, 16384
v_exp_f32 v64, v64
v_mfma_f32_16x16x32_bf16 v[48:51], a[100:103], v[20:23], v[48:51]
s_cmp_eq_u32 s86, 163840
ds_read_b128 a[128:131], v5 offset:8192
ds_read_b128 a[132:135], v5 offset:9216
v_mfma_f32_16x16x32_bf16 v[48:51], a[104:107], v[24:27], v[48:51]
s_cselect_b32 s86, 0, s86
v_exp_f32 v65, v65
v_mfma_f32_16x16x32_bf16 v[48:51], a[108:111], v[28:31], v[48:51]
s_add_u32 m0, s86, s13
ds_read_b128 a[136:139], v5 offset:10240
v_cvt_pk_bf16_f32 v88, v64, v65
v_mfma_f32_16x16x32_bf16 v[56:59], a[108:111], v[44:47], v[104:107]
s_add_u32 s87, s87, 17408
v_exp_f32 v66, v66
v_mfma_f32_16x16x32_bf16 v[56:59], a[104:107], v[40:43], v[56:59]
buffer_load_dwordx4 v1, s[48:51], s87 offen offset:0 sc1 lds
v_mfma_f32_16x16x32_bf16 v[56:59], a[100:103], v[36:39], v[56:59]
v_exp_f32 v67, v67
v_mfma_f32_16x16x32_bf16 v[56:59], a[96:99], v[32:35], v[56:59]
s_waitcnt lgkmcnt(3)
ds_read_b128 a[140:143], v5 offset:11264
v_cvt_pk_bf16_f32 v89, v66, v67
v_mfma_f32_16x16x32_bf16 v[52:55], a[112:115], v[16:19], v[100:103]
v_exp_f32 v68, v68
v_mfma_f32_16x16x32_bf16 v[52:55], a[116:119], v[20:23], v[52:55]
ds_read_b128 a[144:147], v5 offset:12288
ds_read_b128 a[148:151], v5 offset:13312
buffer_load_dwordx4 v[196:199], v1, s[60:63], s43 offen offset:2048 sc1
v_mfma_f32_16x16x32_bf16 v[52:55], a[120:123], v[24:27], v[52:55]
v_exp_f32 v69, v69
v_mfma_f32_16x16x32_bf16 v[52:55], a[124:127], v[28:31], v[52:55]
ds_read_b128 a[152:155], v5 offset:14336
v_cvt_pk_bf16_f32 v90, v68, v69
v_mfma_f32_16x16x32_bf16 v[60:63], a[124:127], v[44:47], v[108:111]
v_exp_f32 v70, v70
v_mfma_f32_16x16x32_bf16 v[60:63], a[120:123], v[40:43], v[60:63]
buffer_load_dwordx4 v1, s[48:51], s87 offen offset:1024 sc1 lds
v_mfma_f32_16x16x32_bf16 v[60:63], a[116:119], v[36:39], v[60:63]
v_exp_f32 v71, v71
v_mfma_f32_16x16x32_bf16 v[60:63], a[112:115], v[32:35], v[60:63]
s_waitcnt lgkmcnt(1)
ds_read_b128 a[156:159], v5 offset:15360
v_cvt_pk_bf16_f32 v91, v70, v71
v_mfma_f32_16x16x32_bf16 v[128:131], a[128:131], v[80:83], v[128:131]
v_exp_f32 v72, v72
v_mfma_f32_16x16x32_bf16 v[132:135], a[128:131], v[84:87], v[132:135]
ds_read_b128 a[96:99], v4 offset:0
ds_read_b128 a[100:103], v4 offset:1024
buffer_load_dwordx4 v[200:203], v1, s[60:63], s43 offen offset:3072 sc1
v_mfma_f32_16x16x32_bf16 v[140:143], a[132:135], v[84:87], v[140:143]
s_add_u32 s85, s85, 16384
v_exp_f32 v73, v73
v_mfma_f32_16x16x32_bf16 v[136:139], a[132:135], v[80:83], v[136:139]
s_add_u32 s43, s43, 4096
ds_read_b128 a[104:107], v4 offset:2048
v_cvt_pk_bf16_f32 v92, v72, v73
v_mfma_f32_16x16x32_bf16 v[144:147], a[136:139], v[80:83], v[144:147]
s_cmp_eq_u32 s85, 163840
v_exp_f32 v74, v74
v_mfma_f32_16x16x32_bf16 v[148:151], a[136:139], v[84:87], v[148:151]
buffer_load_dwordx4 v1, s[48:51], s87 offen offset:2048 sc1 lds
v_mfma_f32_16x16x32_bf16 v[156:159], a[140:143], v[84:87], v[156:159]
s_cselect_b32 s85, 0, s85
v_exp_f32 v75, v75
v_mfma_f32_16x16x32_bf16 v[152:155], a[140:143], v[80:83], v[152:155]
s_waitcnt lgkmcnt(3)
ds_read_b128 a[108:111], v4 offset:3072
v_cvt_pk_bf16_f32 v93, v74, v75
v_mfma_f32_16x16x32_bf16 v[160:163], a[144:147], v[80:83], v[160:163]
s_add_u32 s84, s84, 16384
v_exp_f32 v76, v76
v_mfma_f32_16x16x32_bf16 v[164:167], a[144:147], v[84:87], v[164:167]
s_cmp_eq_u32 s84, 163840
ds_read_b128 a[112:115], v4 offset:4096
ds_read_b128 a[116:119], v4 offset:5120
buffer_load_dwordx4 v[204:207], v1, s[60:63], s43 offen offset:0 sc1
v_mfma_f32_16x16x32_bf16 v[172:175], a[148:151], v[84:87], v[172:175]
s_cselect_b32 s84, 0, s84
v_exp_f32 v77, v77
v_mfma_f32_16x16x32_bf16 v[168:171], a[148:151], v[80:83], v[168:171]
ds_read_b128 a[120:123], v4 offset:6144
v_cvt_pk_bf16_f32 v94, v76, v77
v_mfma_f32_16x16x32_bf16 v[176:179], a[152:155], v[80:83], v[176:179]
v_exp_f32 v78, v78
v_mfma_f32_16x16x32_bf16 v[180:183], a[152:155], v[84:87], v[180:183]
buffer_load_dwordx4 v1, s[48:51], s87 offen offset:3072 sc1 lds
v_mfma_f32_16x16x32_bf16 v[188:191], a[156:159], v[84:87], v[188:191]
v_exp_f32 v79, v79
v_mfma_f32_16x16x32_bf16 v[184:187], a[156:159], v[80:83], v[184:187]
ds_read_b128 a[124:127], v4 offset:7168
v_cvt_pk_bf16_f32 v95, v78, v79
v_mfma_f32_16x16x32_bf16 a[160:163], a[176:179], v[80:83], a[160:163]
v_add_u32 v5, s85, v1
v_add_u32 v4, s84, v1
v_mfma_f32_16x16x32_bf16 a[164:167], a[176:179], v[84:87], a[164:167]
s_waitcnt lgkmcnt(2)
buffer_load_dwordx4 v[208:211], v1, s[60:63], s43 offen offset:1024 sc1
v_mfma_f32_16x16x32_bf16 v[64:67], a[96:99], v[16:19], v[96:99]
s_add_u32 s86, s86, 16384
v_exp_f32 v48, v48
v_mfma_f32_16x16x32_bf16 v[64:67], a[100:103], v[20:23], v[64:67]
s_cmp_eq_u32 s86, 163840
ds_read_b128 a[128:131], v5 offset:8192
ds_read_b128 a[132:135], v5 offset:9216
v_mfma_f32_16x16x32_bf16 v[64:67], a[104:107], v[24:27], v[64:67]
s_cselect_b32 s86, 0, s86
v_exp_f32 v49, v49
v_mfma_f32_16x16x32_bf16 v[64:67], a[108:111], v[28:31], v[64:67]
s_add_u32 m0, s86, s13
ds_read_b128 a[136:139], v5 offset:10240
v_cvt_pk_bf16_f32 v80, v48, v49
v_mfma_f32_16x16x32_bf16 v[72:75], a[108:111], v[44:47], v[104:107]
s_add_u32 s87, s87, 17408
v_exp_f32 v50, v50
v_mfma_f32_16x16x32_bf16 v[72:75], a[104:107], v[40:43], v[72:75]
buffer_load_dwordx4 v1, s[48:51], s87 offen offset:0 sc1 lds
v_mfma_f32_16x16x32_bf16 v[72:75], a[100:103], v[36:39], v[72:75]
v_exp_f32 v51, v51
v_mfma_f32_16x16x32_bf16 v[72:75], a[96:99], v[32:35], v[72:75]
s_waitcnt lgkmcnt(3)
ds_read_b128 a[140:143], v5 offset:11264
v_cvt_pk_bf16_f32 v81, v50, v51
v_mfma_f32_16x16x32_bf16 v[68:71], a[112:115], v[16:19], v[100:103]
v_exp_f32 v52, v52
v_mfma_f32_16x16x32_bf16 v[68:71], a[116:119], v[20:23], v[68:71]
ds_read_b128 a[144:147], v5 offset:12288
ds_read_b128 a[148:151], v5 offset:13312
buffer_load_dwordx4 v[212:215], v1, s[60:63], s43 offen offset:2048 sc1
v_mfma_f32_16x16x32_bf16 v[68:71], a[120:123], v[24:27], v[68:71]
v_exp_f32 v53, v53
v_mfma_f32_16x16x32_bf16 v[68:71], a[124:127], v[28:31], v[68:71]
ds_read_b128 a[152:155], v5 offset:14336
v_cvt_pk_bf16_f32 v82, v52, v53
v_mfma_f32_16x16x32_bf16 v[76:79], a[124:127], v[44:47], v[108:111]
v_exp_f32 v54, v54
v_mfma_f32_16x16x32_bf16 v[76:79], a[120:123], v[40:43], v[76:79]
buffer_load_dwordx4 v1, s[48:51], s87 offen offset:1024 sc1 lds
v_mfma_f32_16x16x32_bf16 v[76:79], a[116:119], v[36:39], v[76:79]
s_waitcnt vmcnt(12)
v_exp_f32 v55, v55
v_mfma_f32_16x16x32_bf16 v[76:79], a[112:115], v[32:35], v[76:79]
s_waitcnt lgkmcnt(1)
ds_read_b128 a[156:159], v5 offset:15360
v_cvt_pk_bf16_f32 v83, v54, v55
v_mfma_f32_16x16x32_bf16 v[128:131], a[128:131], v[88:91], v[128:131]
s_barrier
v_exp_f32 v56, v56
v_mfma_f32_16x16x32_bf16 v[132:135], a[128:131], v[92:95], v[132:135]
ds_read_b128 a[96:99], v4 offset:0
ds_read_b128 a[100:103], v4 offset:1024
buffer_load_dwordx4 v[216:219], v1, s[60:63], s43 offen offset:3072 sc1
v_mfma_f32_16x16x32_bf16 v[140:143], a[132:135], v[92:95], v[140:143]
s_add_u32 s85, s85, 16384
v_exp_f32 v57, v57
v_mfma_f32_16x16x32_bf16 v[136:139], a[132:135], v[88:91], v[136:139]
s_add_u32 s43, s43, 4096
ds_read_b128 a[104:107], v4 offset:2048
v_cvt_pk_bf16_f32 v84, v56, v57
v_mfma_f32_16x16x32_bf16 v[144:147], a[136:139], v[88:91], v[144:147]
s_cmp_eq_u32 s85, 163840
v_exp_f32 v58, v58
v_mfma_f32_16x16x32_bf16 v[148:151], a[136:139], v[92:95], v[148:151]
buffer_load_dwordx4 v1, s[48:51], s87 offen offset:2048 sc1 lds
v_mfma_f32_16x16x32_bf16 v[156:159], a[140:143], v[92:95], v[156:159]
s_cselect_b32 s85, 0, s85
v_exp_f32 v59, v59
v_mfma_f32_16x16x32_bf16 v[152:155], a[140:143], v[88:91], v[152:155]
s_waitcnt lgkmcnt(3)
ds_read_b128 a[108:111], v4 offset:3072
v_cvt_pk_bf16_f32 v85, v58, v59
v_mfma_f32_16x16x32_bf16 v[160:163], a[144:147], v[88:91], v[160:163]
s_add_u32 s84, s84, 16384
v_exp_f32 v60, v60
v_mfma_f32_16x16x32_bf16 v[164:167], a[144:147], v[92:95], v[164:167]
s_cmp_eq_u32 s84, 163840
ds_read_b128 a[112:115], v4 offset:4096
ds_read_b128 a[116:119], v4 offset:5120
buffer_load_dwordx4 v[220:223], v1, s[60:63], s43 offen offset:0 sc1
v_mfma_f32_16x16x32_bf16 v[172:175], a[148:151], v[92:95], v[172:175]
s_cselect_b32 s84, 0, s84
v_exp_f32 v61, v61
v_mfma_f32_16x16x32_bf16 v[168:171], a[148:151], v[88:91], v[168:171]
ds_read_b128 a[120:123], v4 offset:6144
v_cvt_pk_bf16_f32 v86, v60, v61
v_mfma_f32_16x16x32_bf16 v[176:179], a[152:155], v[88:91], v[176:179]
v_exp_f32 v62, v62
v_mfma_f32_16x16x32_bf16 v[180:183], a[152:155], v[92:95], v[180:183]
buffer_load_dwordx4 v1, s[48:51], s87 offen offset:3072 sc1 lds
v_mfma_f32_16x16x32_bf16 v[188:191], a[156:159], v[92:95], v[188:191]
v_exp_f32 v63, v63
v_mfma_f32_16x16x32_bf16 v[184:187], a[156:159], v[88:91], v[184:187]
ds_read_b128 a[124:127], v4 offset:7168
v_cvt_pk_bf16_f32 v87, v62, v63
v_mfma_f32_16x16x32_bf16 a[160:163], a[176:179], v[88:91], a[160:163]
v_add_u32 v5, s85, v1
v_add_u32 v4, s84, v1
v_mfma_f32_16x16x32_bf16 a[164:167], a[176:179], v[92:95], a[164:167]
s_waitcnt lgkmcnt(2)
buffer_load_dwordx4 v[224:227], v1, s[60:63], s43 offen offset:1024 sc1
v_mfma_f32_16x16x32_bf16 v[48:51], a[96:99], v[16:19], v[96:99]
s_add_u32 s86, s86, 16384
v_exp_f32 v64, v64
v_mfma_f32_16x16x32_bf16 v[48:51], a[100:103], v[20:23], v[48:51]
s_cmp_eq_u32 s86, 163840
ds_read_b128 a[128:131], v5 offset:8192
ds_read_b128 a[132:135], v5 offset:9216
v_mfma_f32_16x16x32_bf16 v[48:51], a[104:107], v[24:27], v[48:51]
s_cselect_b32 s86, 0, s86
v_exp_f32 v65, v65
v_mfma_f32_16x16x32_bf16 v[48:51], a[108:111], v[28:31], v[48:51]
s_add_u32 m0, s86, s13
ds_read_b128 a[136:139], v5 offset:10240
v_cvt_pk_bf16_f32 v88, v64, v65
v_mfma_f32_16x16x32_bf16 v[56:59], a[108:111], v[44:47], v[104:107]
s_add_u32 s87, s87, 17408
v_exp_f32 v66, v66
v_mfma_f32_16x16x32_bf16 v[56:59], a[104:107], v[40:43], v[56:59]
buffer_load_dwordx4 v1, s[48:51], s87 offen offset:0 sc1 lds
v_mfma_f32_16x16x32_bf16 v[56:59], a[100:103], v[36:39], v[56:59]
v_exp_f32 v67, v67
v_mfma_f32_16x16x32_bf16 v[56:59], a[96:99], v[32:35], v[56:59]
s_waitcnt lgkmcnt(3)
ds_read_b128 a[140:143], v5 offset:11264
v_cvt_pk_bf16_f32 v89, v66, v67
v_mfma_f32_16x16x32_bf16 v[52:55], a[112:115], v[16:19], v[100:103]
v_exp_f32 v68, v68
v_mfma_f32_16x16x32_bf16 v[52:55], a[116:119], v[20:23], v[52:55]
ds_read_b128 a[144:147], v5 offset:12288
ds_read_b128 a[148:151], v5 offset:13312
buffer_load_dwordx4 v[228:231], v1, s[60:63], s43 offen offset:2048 sc1
v_mfma_f32_16x16x32_bf16 v[52:55], a[120:123], v[24:27], v[52:55]
v_exp_f32 v69, v69
v_mfma_f32_16x16x32_bf16 v[52:55], a[124:127], v[28:31], v[52:55]
ds_read_b128 a[152:155], v5 offset:14336
v_cvt_pk_bf16_f32 v90, v68, v69
v_mfma_f32_16x16x32_bf16 v[60:63], a[124:127], v[44:47], v[108:111]
v_exp_f32 v70, v70
v_mfma_f32_16x16x32_bf16 v[60:63], a[120:123], v[40:43], v[60:63]
buffer_load_dwordx4 v1, s[48:51], s87 offen offset:1024 sc1 lds
v_mfma_f32_16x16x32_bf16 v[60:63], a[116:119], v[36:39], v[60:63]
v_exp_f32 v71, v71
v_mfma_f32_16x16x32_bf16 v[60:63], a[112:115], v[32:35], v[60:63]
s_waitcnt lgkmcnt(1)
ds_read_b128 a[156:159], v5 offset:15360
v_cvt_pk_bf16_f32 v91, v70, v71
v_mfma_f32_16x16x32_bf16 v[128:131], a[128:131], v[80:83], v[128:131]
v_exp_f32 v72, v72
v_mfma_f32_16x16x32_bf16 v[132:135], a[128:131], v[84:87], v[132:135]
ds_read_b128 a[96:99], v4 offset:0
ds_read_b128 a[100:103], v4 offset:1024
buffer_load_dwordx4 v[232:235], v1, s[60:63], s43 offen offset:3072 sc1
v_mfma_f32_16x16x32_bf16 v[140:143], a[132:135], v[84:87], v[140:143]
s_add_u32 s85, s85, 16384
v_exp_f32 v73, v73
v_mfma_f32_16x16x32_bf16 v[136:139], a[132:135], v[80:83], v[136:139]
s_add_u32 s43, s43, 4096
ds_read_b128 a[104:107], v4 offset:2048
v_cvt_pk_bf16_f32 v92, v72, v73
v_mfma_f32_16x16x32_bf16 v[144:147], a[136:139], v[80:83], v[144:147]
s_cmp_eq_u32 s85, 163840
v_exp_f32 v74, v74
v_mfma_f32_16x16x32_bf16 v[148:151], a[136:139], v[84:87], v[148:151]
buffer_load_dwordx4 v1, s[48:51], s87 offen offset:2048 sc1 lds
v_mfma_f32_16x16x32_bf16 v[156:159], a[140:143], v[84:87], v[156:159]
s_cselect_b32 s85, 0, s85
v_exp_f32 v75, v75
v_mfma_f32_16x16x32_bf16 v[152:155], a[140:143], v[80:83], v[152:155]
s_waitcnt lgkmcnt(3)
ds_read_b128 a[108:111], v4 offset:3072
v_cvt_pk_bf16_f32 v93, v74, v75
v_mfma_f32_16x16x32_bf16 v[160:163], a[144:147], v[80:83], v[160:163]
s_add_u32 s84, s84, 16384
v_exp_f32 v76, v76
v_mfma_f32_16x16x32_bf16 v[164:167], a[144:147], v[84:87], v[164:167]
s_cmp_eq_u32 s84, 163840
ds_read_b128 a[112:115], v4 offset:4096
ds_read_b128 a[116:119], v4 offset:5120
buffer_load_dwordx4 v[236:239], v1, s[60:63], s43 offen offset:0 sc1
v_mfma_f32_16x16x32_bf16 v[172:175], a[148:151], v[84:87], v[172:175]
s_cselect_b32 s84, 0, s84
v_exp_f32 v77, v77
v_mfma_f32_16x16x32_bf16 v[168:171], a[148:151], v[80:83], v[168:171]
ds_read_b128 a[120:123], v4 offset:6144
v_cvt_pk_bf16_f32 v94, v76, v77
v_mfma_f32_16x16x32_bf16 v[176:179], a[152:155], v[80:83], v[176:179]
v_exp_f32 v78, v78
v_mfma_f32_16x16x32_bf16 v[180:183], a[152:155], v[84:87], v[180:183]
buffer_load_dwordx4 v1, s[48:51], s87 offen offset:3072 sc1 lds
v_mfma_f32_16x16x32_bf16 v[188:191], a[156:159], v[84:87], v[188:191]
v_exp_f32 v79, v79
v_mfma_f32_16x16x32_bf16 v[184:187], a[156:159], v[80:83], v[184:187]
ds_read_b128 a[124:127], v4 offset:7168
v_cvt_pk_bf16_f32 v95, v78, v79
v_mfma_f32_16x16x32_bf16 a[160:163], a[176:179], v[80:83], a[160:163]
v_add_u32 v5, s85, v1
v_add_u32 v4, s84, v1
v_mfma_f32_16x16x32_bf16 a[164:167], a[176:179], v[84:87], a[164:167]
s_waitcnt lgkmcnt(2)
buffer_load_dwordx4 v[240:243], v1, s[60:63], s43 offen offset:1024 sc1
v_mfma_f32_16x16x32_bf16 v[64:67], a[96:99], v[16:19], v[96:99]
s_add_u32 s86, s86, 16384
v_exp_f32 v48, v48
v_mfma_f32_16x16x32_bf16 v[64:67], a[100:103], v[20:23], v[64:67]
s_cmp_eq_u32 s86, 163840
ds_read_b128 a[128:131], v5 offset:8192
ds_read_b128 a[132:135], v5 offset:9216
v_mfma_f32_16x16x32_bf16 v[64:67], a[104:107], v[24:27], v[64:67]
s_cselect_b32 s86, 0, s86
v_exp_f32 v49, v49
v_mfma_f32_16x16x32_bf16 v[64:67], a[108:111], v[28:31], v[64:67]
s_add_u32 m0, s86, s13
ds_read_b128 a[136:139], v5 offset:10240
v_cvt_pk_bf16_f32 v80, v48, v49
v_mfma_f32_16x16x32_bf16 v[72:75], a[108:111], v[44:47], v[104:107]
s_add_u32 s87, s87, 17408
v_exp_f32 v50, v50
v_mfma_f32_16x16x32_bf16 v[72:75], a[104:107], v[40:43], v[72:75]
buffer_load_dwordx4 v1, s[48:51], s87 offen offset:0 sc1 lds
v_mfma_f32_16x16x32_bf16 v[72:75], a[100:103], v[36:39], v[72:75]
v_exp_f32 v51, v51
v_mfma_f32_16x16x32_bf16 v[72:75], a[96:99], v[32:35], v[72:75]
s_waitcnt lgkmcnt(3)
ds_read_b128 a[140:143], v5 offset:11264
v_cvt_pk_bf16_f32 v81, v50, v51
v_mfma_f32_16x16x32_bf16 v[68:71], a[112:115], v[16:19], v[100:103]
v_exp_f32 v52, v52
v_mfma_f32_16x16x32_bf16 v[68:71], a[116:119], v[20:23], v[68:71]
ds_read_b128 a[144:147], v5 offset:12288
ds_read_b128 a[148:151], v5 offset:13312
buffer_load_dwordx4 v[244:247], v1, s[60:63], s43 offen offset:2048 sc1
v_mfma_f32_16x16x32_bf16 v[68:71], a[120:123], v[24:27], v[68:71]
v_exp_f32 v53, v53
v_mfma_f32_16x16x32_bf16 v[68:71], a[124:127], v[28:31], v[68:71]
ds_read_b128 a[152:155], v5 offset:14336
v_cvt_pk_bf16_f32 v82, v52, v53
v_mfma_f32_16x16x32_bf16 v[76:79], a[124:127], v[44:47], v[108:111]
v_exp_f32 v54, v54
v_mfma_f32_16x16x32_bf16 v[76:79], a[120:123], v[40:43], v[76:79]
buffer_load_dwordx4 v1, s[48:51], s87 offen offset:1024 sc1 lds
v_mfma_f32_16x16x32_bf16 v[76:79], a[116:119], v[36:39], v[76:79]
s_waitcnt vmcnt(12)
v_exp_f32 v55, v55
v_mfma_f32_16x16x32_bf16 v[76:79], a[112:115], v[32:35], v[76:79]
s_waitcnt lgkmcnt(1)
ds_read_b128 a[156:159], v5 offset:15360
v_cvt_pk_bf16_f32 v83, v54, v55
v_mfma_f32_16x16x32_bf16 v[128:131], a[128:131], v[88:91], v[128:131]
s_barrier
v_exp_f32 v56, v56
v_mfma_f32_16x16x32_bf16 v[132:135], a[128:131], v[92:95], v[132:135]
ds_read_b128 a[96:99], v4 offset:0
ds_read_b128 a[100:103], v4 offset:1024
buffer_load_dwordx4 v[248:251], v1, s[60:63], s43 offen offset:3072 sc1
v_mfma_f32_16x16x32_bf16 v[140:143], a[132:135], v[92:95], v[140:143]
s_add_u32 s85, s85, 16384
v_exp_f32 v57, v57
v_mfma_f32_16x16x32_bf16 v[136:139], a[132:135], v[88:91], v[136:139]
s_add_u32 s43, s43, 151552
ds_read_b128 a[104:107], v4 offset:2048
v_cvt_pk_bf16_f32 v84, v56, v57
v_mfma_f32_16x16x32_bf16 v[144:147], a[136:139], v[88:91], v[144:147]
s_cmp_eq_u32 s85, 163840
v_exp_f32 v58, v58
v_mfma_f32_16x16x32_bf16 v[148:151], a[136:139], v[92:95], v[148:151]
buffer_load_dwordx4 v1, s[48:51], s87 offen offset:2048 sc1 lds
v_mfma_f32_16x16x32_bf16 v[156:159], a[140:143], v[92:95], v[156:159]
s_cselect_b32 s85, 0, s85
v_exp_f32 v59, v59
v_mfma_f32_16x16x32_bf16 v[152:155], a[140:143], v[88:91], v[152:155]
s_waitcnt lgkmcnt(3)
ds_read_b128 a[108:111], v4 offset:3072
v_cvt_pk_bf16_f32 v85, v58, v59
v_mfma_f32_16x16x32_bf16 v[160:163], a[144:147], v[88:91], v[160:163]
s_add_u32 s84, s84, 16384
v_exp_f32 v60, v60
v_mfma_f32_16x16x32_bf16 v[164:167], a[144:147], v[92:95], v[164:167]
s_cmp_eq_u32 s84, 163840
ds_read_b128 a[112:115], v4 offset:4096
ds_read_b128 a[116:119], v4 offset:5120
buffer_load_dwordx4 v[252:255], v1, s[60:63], s43 offen offset:1024 sc1
v_mfma_f32_16x16x32_bf16 v[172:175], a[148:151], v[92:95], v[172:175]
s_cselect_b32 s84, 0, s84
v_exp_f32 v61, v61
v_mfma_f32_16x16x32_bf16 v[168:171], a[148:151], v[88:91], v[168:171]
ds_read_b128 a[120:123], v4 offset:6144
v_cvt_pk_bf16_f32 v86, v60, v61
v_mfma_f32_16x16x32_bf16 v[176:179], a[152:155], v[88:91], v[176:179]
v_exp_f32 v62, v62
v_mfma_f32_16x16x32_bf16 v[180:183], a[152:155], v[92:95], v[180:183]
buffer_load_dwordx4 v1, s[48:51], s87 offen offset:3072 sc1 lds
v_mfma_f32_16x16x32_bf16 v[188:191], a[156:159], v[92:95], v[188:191]
v_exp_f32 v63, v63
v_mfma_f32_16x16x32_bf16 v[184:187], a[156:159], v[88:91], v[184:187]
ds_read_b128 a[124:127], v4 offset:7168
v_cvt_pk_bf16_f32 v87, v62, v63
v_mfma_f32_16x16x32_bf16 a[160:163], a[176:179], v[88:91], a[160:163]
v_add_u32 v5, s85, v1
v_add_u32 v4, s84, v1
v_mfma_f32_16x16x32_bf16 a[164:167], a[176:179], v[92:95], a[164:167]
s_waitcnt lgkmcnt(2)
buffer_load_dwordx4 v[112:115], v1, s[60:63], s43 offen offset:2048 sc1
L_at_last:
v_cndmask_b32 v96, v96, v11, s[76:77]
v_cndmask_b32 v97, v97, v11, s[78:79]
v_cndmask_b32 v98, v98, v11, s[80:81]
v_cndmask_b32 v99, v99, v11, s[82:83]
v_mov_b32 v100, v11
v_mov_b32 v101, v11
v_mov_b32 v102, v11
v_mov_b32 v103, v11
v_cndmask_b32 v108, v108, v11, s[76:77]
v_cndmask_b32 v109, v109, v11, s[78:79]
v_cndmask_b32 v110, v110, v11, s[80:81]
v_cndmask_b32 v111, v111, v11, s[82:83]
v_mfma_f32_16x16x32_bf16 v[48:51], a[96:99], v[16:19], v[96:99]
s_add_u32 s85, s85, 16384
v_exp_f32 v64, v64
v_mfma_f32_16x16x32_bf16 v[48:51], a[100:103], v[20:23], v[48:51]
ds_read_b128 a[128:131], v5 offset:8192
ds_read_b128 a[132:135], v5 offset:9216
v_mfma_f32_16x16x32_bf16 v[48:51], a[104:107], v[24:27], v[48:51]
s_cmp_eq_u32 s85, 163840
v_exp_f32 v65, v65
v_mfma_f32_16x16x32_bf16 v[48:51], a[108:111], v[28:31], v[48:51]
ds_read_b128 a[136:139], v5 offset:10240
v_cvt_pk_bf16_f32 v88, v64, v65
v_mfma_f32_16x16x32_bf16 v[56:59], a[108:111], v[44:47], v[104:107]
s_cselect_b32 s85, 0, s85
v_exp_f32 v66, v66
v_mfma_f32_16x16x32_bf16 v[56:59], a[104:107], v[40:43], v[56:59]
v_add_u32 v4, s85, v1
v_mfma_f32_16x16x32_bf16 v[56:59], a[100:103], v[36:39], v[56:59]
v_exp_f32 v67, v67
v_mfma_f32_16x16x32_bf16 v[56:59], a[96:99], v[32:35], v[56:59]
s_waitcnt lgkmcnt(3)
ds_read_b128 a[140:143], v5 offset:11264
v_cvt_pk_bf16_f32 v89, v66, v67
v_mfma_f32_16x16x32_bf16 v[52:55], a[112:115], v[16:19], v[100:103]
v_exp_f32 v68, v68
v_mfma_f32_16x16x32_bf16 v[52:55], a[116:119], v[20:23], v[52:55]
ds_read_b128 a[144:147], v5 offset:12288
ds_read_b128 a[148:151], v5 offset:13312
v_mfma_f32_16x16x32_bf16 v[52:55], a[120:123], v[24:27], v[52:55]
v_exp_f32 v69, v69
v_mfma_f32_16x16x32_bf16 v[52:55], a[124:127], v[28:31], v[52:55]
ds_read_b128 a[152:155], v5 offset:14336
v_cvt_pk_bf16_f32 v90, v68, v69
v_mfma_f32_16x16x32_bf16 v[60:63], a[124:127], v[44:47], v[108:111]
v_exp_f32 v70, v70
v_mfma_f32_16x16x32_bf16 v[60:63], a[120:123], v[40:43], v[60:63]
buffer_load_dwordx4 v[116:119], v1, s[60:63], s43 offen offset:3072 sc1
v_mfma_f32_16x16x32_bf16 v[60:63], a[116:119], v[36:39], v[60:63]
v_exp_f32 v71, v71
v_mfma_f32_16x16x32_bf16 v[60:63], a[112:115], v[32:35], v[60:63]
s_waitcnt lgkmcnt(1)
ds_read_b128 a[156:159], v5 offset:15360
v_cvt_pk_bf16_f32 v91, v70, v71
v_mfma_f32_16x16x32_bf16 v[128:131], a[128:131], v[80:83], v[128:131]
s_add_u32 s43, s43, 4096
v_exp_f32 v72, v72
v_mfma_f32_16x16x32_bf16 v[132:135], a[128:131], v[84:87], v[132:135]
ds_read_b128 a[96:99], v4 offset:8192
ds_read_b128 a[100:103], v4 offset:9216
v_mfma_f32_16x16x32_bf16 v[140:143], a[132:135], v[84:87], v[140:143]
s_add_u32 s85, s85, 16384
v_exp_f32 v73, v73
v_mfma_f32_16x16x32_bf16 v[136:139], a[132:135], v[80:83], v[136:139]
ds_read_b128 a[104:107], v4 offset:10240
v_cvt_pk_bf16_f32 v92, v72, v73
v_mfma_f32_16x16x32_bf16 v[144:147], a[136:139], v[80:83], v[144:147]
s_cmp_eq_u32 s85, 163840
v_exp_f32 v74, v74
v_mfma_f32_16x16x32_bf16 v[148:151], a[136:139], v[84:87], v[148:151]
ds_read_b128 a[108:111], v4 offset:11264
ds_read_b128 a[112:115], v4 offset:12288
v_mfma_f32_16x16x32_bf16 v[156:159], a[140:143], v[84:87], v[156:159]
s_cselect_b32 s85, 0, s85
v_exp_f32 v75, v75
v_mfma_f32_16x16x32_bf16 v[152:155], a[140:143], v[80:83], v[152:155]
s_waitcnt lgkmcnt(5)
ds_read_b128 a[116:119], v4 offset:13312
v_cvt_pk_bf16_f32 v93, v74, v75
v_mfma_f32_16x16x32_bf16 v[160:163], a[144:147], v[80:83], v[160:163]
v_exp_f32 v76, v76
v_mfma_f32_16x16x32_bf16 v[164:167], a[144:147], v[84:87], v[164:167]
ds_read_b128 a[120:123], v4 offset:14336
ds_read_b128 a[124:127], v4 offset:15360
v_mfma_f32_16x16x32_bf16 v[172:175], a[148:151], v[84:87], v[172:175]
v_exp_f32 v77, v77
v_mfma_f32_16x16x32_bf16 v[168:171], a[148:151], v[80:83], v[168:171]
buffer_load_dwordx4 v[120:123], v1, s[60:63], s43 offen offset:0 sc1
v_cvt_pk_bf16_f32 v94, v76, v77
v_mfma_f32_16x16x32_bf16 v[176:179], a[152:155], v[80:83], v[176:179]
s_waitcnt vmcnt(6)
v_exp_f32 v78, v78
v_mfma_f32_16x16x32_bf16 v[180:183], a[152:155], v[84:87], v[180:183]
s_barrier
v_mfma_f32_16x16x32_bf16 v[188:191], a[156:159], v[84:87], v[188:191]
v_exp_f32 v79, v79
v_mfma_f32_16x16x32_bf16 v[184:187], a[156:159], v[80:83], v[184:187]
v_cvt_pk_bf16_f32 v95, v78, v79
v_mfma_f32_16x16x32_bf16 a[160:163], a[176:179], v[80:83], a[160:163]
v_add_u32 v5, s85, v1
v_mfma_f32_16x16x32_bf16 a[164:167], a[176:179], v[84:87], a[164:167]
s_waitcnt lgkmcnt(0)
buffer_load_dwordx4 v[124:127], v1, s[60:63], s43 offen offset:1024 sc1
v_mfma_f32_16x16x32_bf16 v[128:131], a[96:99], v[88:91], v[128:131]
ds_read_b128 a[128:131], v5 offset:8192
v_exp_f32 v48, v48
v_mfma_f32_16x16x32_bf16 v[132:135], a[96:99], v[92:95], v[132:135]
ds_read_b128 a[132:135], v5 offset:9216
v_exp_f32 v49, v49
v_mfma_f32_16x16x32_bf16 v[140:143], a[100:103], v[92:95], v[140:143]
ds_read_b128 a[136:139], v5 offset:10240
v_exp_f32 v50, v50
v_mfma_f32_16x16x32_bf16 v[136:139], a[100:103], v[88:91], v[136:139]
ds_read_b128 a[140:143], v5 offset:11264
v_exp_f32 v51, v51
v_mfma_f32_16x16x32_bf16 v[144:147], a[104:107], v[88:91], v[144:147]
ds_read_b128 a[144:147], v5 offset:12288
v_exp_f32 v52, v52
v_mfma_f32_16x16x32_bf16 v[148:151], a[104:107], v[92:95], v[148:151]
ds_read_b128 a[148:151], v5 offset:13312
v_exp_f32 v53, v53
v_mfma_f32_16x16x32_bf16 v[156:159], a[108:111], v[92:95], v[156:159]
ds_read_b128 a[152:155], v5 offset:14336
v_exp_f32 v54, v54
v_mfma_f32_16x16x32_bf16 v[152:155], a[108:111], v[88:91], v[152:155]
ds_read_b128 a[156:159], v5 offset:15360
v_exp_f32 v55, v55
v_mfma_f32_16x16x32_bf16 v[160:163], a[112:115], v[88:91], v[160:163]
v_exp_f32 v56, v56
v_cvt_pk_bf16_f32 v80, v48, v49
v_mfma_f32_16x16x32_bf16 v[164:167], a[112:115], v[92:95], v[164:167]
v_exp_f32 v57, v57
v_mfma_f32_16x16x32_bf16 v[172:175], a[116:119], v[92:95], v[172:175]
v_exp_f32 v58, v58
v_cvt_pk_bf16_f32 v81, v50, v51
v_mfma_f32_16x16x32_bf16 v[168:171], a[116:119], v[88:91], v[168:171]
v_exp_f32 v59, v59
v_mfma_f32_16x16x32_bf16 v[176:179], a[120:123], v[88:91], v[176:179]
v_exp_f32 v60, v60
v_cvt_pk_bf16_f32 v82, v52, v53
v_mfma_f32_16x16x32_bf16 v[180:183], a[120:123], v[92:95], v[180:183]
v_exp_f32 v61, v61
v_mfma_f32_16x16x32_bf16 v[188:191], a[124:127], v[92:95], v[188:191]
v_exp_f32 v62, v62
v_cvt_pk_bf16_f32 v83, v54, v55
v_mfma_f32_16x16x32_bf16 v[184:187], a[124:127], v[88:91], v[184:187]
v_exp_f32 v63, v63
v_mfma_f32_16x16x32_bf16 a[160:163], a[176:179], v[88:91], a[160:163]
v_cvt_pk_bf16_f32 v84, v56, v57
v_cvt_pk_bf16_f32 v85, v58, v59
v_mfma_f32_16x16x32_bf16 a[164:167], a[176:179], v[92:95], a[164:167]
s_waitcnt lgkmcnt(0)
v_cvt_pk_bf16_f32 v86, v60, v61
v_cvt_pk_bf16_f32 v87, v62, v63
L_at_u65:
v_mfma_f32_16x16x32_bf16 a[160:163], a[176:179], v[80:83], a[160:163]
s_waitcnt vmcnt(3)
v_mfma_f32_16x16x32_bf16 a[164:167], a[176:179], v[84:87], a[164:167]
s_barrier
v_mfma_f32_16x16x32_bf16 v[128:131], a[128:131], v[80:83], v[128:131]
buffer_load_dwordx4 a[96:99], v1, s[60:63], s43 offen offset:2048 sc1
v_mfma_f32_16x16x32_bf16 v[132:135], a[128:131], v[84:87], v[132:135]
v_mfma_f32_16x16x32_bf16 v[140:143], a[132:135], v[84:87], v[140:143]
v_mfma_f32_16x16x32_bf16 v[136:139], a[132:135], v[80:83], v[136:139]
buffer_load_dwordx4 a[100:103], v1, s[60:63], s43 offen offset:3072 sc1
v_mfma_f32_16x16x32_bf16 v[144:147], a[136:139], v[80:83], v[144:147]
v_mfma_f32_16x16x32_bf16 v[148:151], a[136:139], v[84:87], v[148:151]
v_mfma_f32_16x16x32_bf16 v[156:159], a[140:143], v[84:87], v[156:159]
v_accvgpr_read_b32 v6, a160
v_accvgpr_read_b32 v7, a164
v_mfma_f32_16x16x32_bf16 v[152:155], a[140:143], v[80:83], v[152:155]
s_add_u32 s43, s43, 4096
buffer_load_dwordx4 a[104:107], v1, s[60:63], s43 offen offset:0 sc1
v_mfma_f32_16x16x32_bf16 v[160:163], a[144:147], v[80:83], v[160:163]
v_rcp_f32 v8, v6
v_mfma_f32_16x16x32_bf16 v[164:167], a[144:147], v[84:87], v[164:167]
v_mfma_f32_16x16x32_bf16 v[172:175], a[148:151], v[84:87], v[172:175]
v_rcp_f32 v9, v7
v_mfma_f32_16x16x32_bf16 v[168:171], a[148:151], v[80:83], v[168:171]
s_add_u32 s6, s91, 0
buffer_load_dwordx4 a[108:111], v1, s[60:63], s43 offen offset:1024 sc1
v_mfma_f32_16x16x32_bf16 v[176:179], a[152:155], v[80:83], v[176:179]
v_add_f32 v6, v6, v7
v_cmp_nge_f32 vcc, 0x5d800000, v6
v_mfma_f32_16x16x32_bf16 v[180:183], a[152:155], v[84:87], v[180:183]
v_mfma_f32_16x16x32_bf16 v[188:191], a[156:159], v[84:87], v[188:191]
s_cmp_lg_u64 vcc, 0
s_cselect_b32 s7, 1, 0
v_mfma_f32_16x16x32_bf16 v[184:187], a[156:159], v[80:83], v[184:187]
s_or_b32 s97, s97, s7
v_pk_mul_f32 v[128:129], v[128:129], v[8:9] op_sel_hi:[1,0]
v_pk_mul_f32 v[130:131], v[130:131], v[8:9] op_sel_hi:[1,0]
v_pk_mul_f32 v[136:137], v[136:137], v[8:9] op_sel_hi:[1,0]
v_pk_mul_f32 v[138:139], v[138:139], v[8:9] op_sel_hi:[1,0]
v_cvt_pk_bf16_f32 v128, v128, v129
v_cvt_pk_bf16_f32 v129, v130, v131
v_cvt_pk_bf16_f32 v130, v136, v137
v_cvt_pk_bf16_f32 v131, v138, v139
v_pk_mul_f32 v[132:133], v[132:133], v[8:9] op_sel:[0,1]
v_pk_mul_f32 v[134:135], v[134:135], v[8:9] op_sel:[0,1]
v_pk_mul_f32 v[140:141], v[140:141], v[8:9] op_sel:[0,1]
v_pk_mul_f32 v[142:143], v[142:143], v[8:9] op_sel:[0,1]
v_cvt_pk_bf16_f32 v132, v132, v133
v_cvt_pk_bf16_f32 v133, v134, v135
v_cvt_pk_bf16_f32 v134, v140, v141
v_cvt_pk_bf16_f32 v135, v142, v143
buffer_store_dwordx4 v[128:131], v1, s[60:63], s6 offen offset:0 sc1
buffer_store_dwordx4 v[132:135], v1, s[60:63], s6 offen offset:1024 sc1
s_add_u32 s6, s6, 4096
v_pk_mul_f32 v[144:145], v[144:145], v[8:9] op_sel_hi:[1,0]
v_pk_mul_f32 v[146:147], v[146:147], v[8:9] op_sel_hi:[1,0]
v_pk_mul_f32 v[152:153], v[152:153], v[8:9] op_sel_hi:[1,0]
v_pk_mul_f32 v[154:155], v[154:155], v[8:9] op_sel_hi:[1,0]
v_cvt_pk_bf16_f32 v144, v144, v145
v_cvt_pk_bf16_f32 v145, v146, v147
v_cvt_pk_bf16_f32 v146, v152, v153
v_cvt_pk_bf16_f32 v147, v154, v155
v_pk_mul_f32 v[148:149], v[148:149], v[8:9] op_sel:[0,1]
v_pk_mul_f32 v[150:151], v[150:151], v[8:9] op_sel:[0,1]
v_pk_mul_f32 v[156:157], v[156:157], v[8:9] op_sel:[0,1]
v_pk_mul_f32 v[158:159], v[158:159], v[8:9] op_sel:[0,1]
v_cvt_pk_bf16_f32 v148, v148, v149
v_cvt_pk_bf16_f32 v149, v150, v151
v_cvt_pk_bf16_f32 v150, v156, v157
v_cvt_pk_bf16_f32 v151, v158, v159
buffer_store_dwordx4 v[144:147], v1, s[60:63], s6 offen offset:0 sc1
buffer_store_dwordx4 v[148:151], v1, s[60:63], s6 offen offset:1024 sc1
s_add_u32 s6, s6, 4096
v_pk_mul_f32 v[160:161], v[160:161], v[8:9] op_sel_hi:[1,0]
v_pk_mul_f32 v[162:163], v[162:163], v[8:9] op_sel_hi:[1,0]
v_pk_mul_f32 v[168:169], v[168:169], v[8:9] op_sel_hi:[1,0]
v_pk_mul_f32 v[170:171], v[170:171], v[8:9] op_sel_hi:[1,0]
v_cvt_pk_bf16_f32 v160, v160, v161
v_cvt_pk_bf16_f32 v161, v162, v163
v_cvt_pk_bf16_f32 v162, v168, v169
v_cvt_pk_bf16_f32 v163, v170, v171
v_pk_mul_f32 v[164:165], v[164:165], v[8:9] op_sel:[0,1]
v_pk_mul_f32 v[166:167], v[166:167], v[8:9] op_sel:[0,1]
v_pk_mul_f32 v[172:173], v[172:173], v[8:9] op_sel:[0,1]
v_pk_mul_f32 v[174:175], v[174:175], v[8:9] op_sel:[0,1]
v_cvt_pk_bf16_f32 v164, v164, v165
v_cvt_pk_bf16_f32 v165, v166, v167
v_cvt_pk_bf16_f32 v166, v172, v173
v_cvt_pk_bf16_f32 v167, v174, v175
buffer_store_dwordx4 v[160:163], v1, s[60:63], s6 offen offset:0 sc1
buffer_store_dwordx4 v[164:167], v1, s[60:63], s6 offen offset:1024 sc1
s_add_u32 s6, s6, 4096
v_pk_mul_f32 v[176:177], v[176:177], v[8:9] op_sel_hi:[1,0]
v_pk_mul_f32 v[178:179], v[178:179], v[8:9] op_sel_hi:[1,0]
v_pk_mul_f32 v[184:185], v[184:185], v[8:9] op_sel_hi:[1,0]
v_pk_mul_f32 v[186:187], v[186:187], v[8:9] op_sel_hi:[1,0]
v_cvt_pk_bf16_f32 v176, v176, v177
v_cvt_pk_bf16_f32 v177, v178, v179
v_cvt_pk_bf16_f32 v178, v184, v185
v_cvt_pk_bf16_f32 v179, v186, v187
v_pk_mul_f32 v[180:181], v[180:181], v[8:9] op_sel:[0,1]
v_pk_mul_f32 v[182:183], v[182:183], v[8:9] op_sel:[0,1]
v_pk_mul_f32 v[188:189], v[188:189], v[8:9] op_sel:[0,1]
v_pk_mul_f32 v[190:191], v[190:191], v[8:9] op_sel:[0,1]
v_cvt_pk_bf16_f32 v180, v180, v181
v_cvt_pk_bf16_f32 v181, v182, v183
v_cvt_pk_bf16_f32 v182, v188, v189
v_cvt_pk_bf16_f32 v183, v190, v191
buffer_store_dwordx4 v[176:179], v1, s[60:63], s6 offen offset:0 sc1
buffer_store_dwordx4 v[180:183], v1, s[60:63], s6 offen offset:1024 sc1
s_cmp_lg_u32 s97, 0
s_cbranch_scc1 L_at_slow
L_at_fin:
buffer_load_dwordx4 a[112:115], v1, s[60:63], s43 offen offset:2048 sc1
buffer_load_dwordx4 a[116:119], v1, s[60:63], s43 offen offset:3072 sc1
s_add_u32 s43, s43, 4096
buffer_load_dwordx4 a[120:123], v1, s[60:63], s43 offen offset:0 sc1
buffer_load_dwordx4 a[124:127], v1, s[60:63], s43 offen offset:1024 sc1
buffer_load_dwordx4 a[160:163], v1, s[60:63], s43 offen offset:2048 sc1
buffer_load_dwordx4 a[164:167], v1, s[60:63], s43 offen offset:3072 sc1
s_add_u32 s43, s43, 4294713344
s_load_dwordx2 s[24:25], s[0:1], 0
s_load_dwordx2 s[28:29], s[0:1], 64
s_load_dwordx2 s[64:65], s[0:1], 80
s_load_dwordx2 s[66:67], s[0:1], 104
v_min_u32 v6, 1, v2
v_lshlrev_b32 v6, 28, v6
v_mov_b32 v7, 1
v_mov_b32 v4, 0
s_lshr_b32 s6, s2, 5
s_bfe_u32 s7, s2, 0x10002
s_lshl1_add_u32 s6, s6, s7
s_and_b32 s7, s2, 1
s_lshl1_add_u32 s6, s6, s7
s_lshl_b32 s6, s6, 7
s_add_u32 s6, s6, 393220
s_cmp_eq_u32 s3, 0
s_cselect_b32 s53, s6, 268435456
s_mul_i32 s56, s3, 15360
s_add_u32 s56, s56, 28672
s_add_u32 m0, s56, -2048
s_nop 0
buffer_load_dwordx4 v1, s[60:63], s43 offen offset:2048 sc1 lds
buffer_load_dwordx4 v1, s[60:63], s43 offen offset:3072 sc1 lds
s_add_u32 s43, s43, 4096
s_add_u32 m0, s56, 2048
s_nop 0
buffer_load_dwordx4 v1, s[60:63], s43 offen offset:0 sc1 lds
buffer_load_dwordx4 v1, s[60:63], s43 offen offset:1024 sc1 lds
s_waitcnt vmcnt(10)
s_barrier
buffer_atomic_add v7, v6, s[60:63], s53 offen offset:0 sc1
s_cmp_ge_u32 s2, 224
s_cbranch_scc1 L_tl_late
L_tl_lated:
s_lshr_b32 s7, s40, 1
s_sub_u32 s6, 15, s7
s_min_u32 s6, s6, s7
s_and_b32 s8, s40, 1
s_lshl1_add_u32 s6, s6, s8
s_lshl_b32 s6, s6, 8
s_add_u32 s6, s6, 393220
s_cmp_eq_u32 s3, 0
s_cselect_b32 s52, s6, 268435456
s_cselect_b32 s39, 8, 0
s_add_u32 s82, s52, 128
s_lshl_b32 s7, s7, 9
s_add_u32 s7, s7, 417792
s_cmp_eq_u32 s3, 0
s_cselect_b32 s54, s7, 268435456
s_and_b32 s7, s41, 0
s_lshl_b32 s7, s7, 7
s_add_u32 s55, s54, s7
s_lshr_b32 s6, s40, 1
s_lshl_b32 s6, s6, 20
s_add_u32 s6, s6, 34603008
s_add_u32 s16, s46, s6
s_addc_u32 s17, s47, 0
s_mov_b32 s18, 1048576
s_mov_b32 s19, 0x20000
s_and_b32 s6, s40, 1
s_mul_i32 s100, s6, 786432
s_lshl_b32 s6, s3, 14
s_add_u32 s100, s100, s6
s_xor_b32 s42, s100, 524288
s_lshl_b32 s6, s3, 10
v_add_u32 v12, s6, v1
v_xor_b32 v13, 1024, v12
v_xor_b32 v14, 2048, v12
v_xor_b32 v15, 3072, v12
s_and_b32 s36, s41, 1
s_mul_i32 s6, s41, 5
s_add_u32 s44, s6, s36
s_lshr_b32 s44, s44, 1
s_mul_i32 s7, s36, 3
s_add_u32 s45, s44, 2
s_sub_u32 s45, s45, s7
s_lshl_b32 s37, s40, 6
s_lshl_b32 s6, s3, 4
s_add_u32 s37, s37, s6
v_lshrrev_b32 v26, 4, v2
v_and_b32 v11, 15, v2
v_lshrrev_b32 v8, 2, v2
v_mul_u32_u24 v8, 1280, v8
v_and_b32 v9, 3, v2
v_lshl_add_u32 v8, v9, 4, v8
v_lshlrev_b32 v9, 5, v26
v_lshlrev_b32 v10, 4, v26
s_and_b32 s83, s2, 1
s_lshl_b32 s83, s83, 8
s_or_b32 s83, s83, s2
s_lshr_b32 s83, s83, 1
s_mul_hi_u32 s68, s83, 613566757
s_mul_i32 s69, s68, 7
s_sub_u32 s69, s83, s69
s_mul_i32 s70, s68, 143360
s_lshl_b32 s6, s69, 10
s_add_u32 s70, s70, s6
s_mul_i32 s6, s3, 35840
s_add_u32 s70, s70, s6
s_add_u32 s70, s70, 19922944
s_and_b32 s6, s68, 1
s_add_u32 s69, s69, s6
s_cmp_eq_u32 s69, 7
s_cselect_b32 s69, 0, s69
s_mul_i32 s68, s68, 7
s_add_u32 s68, s68, s69
s_lshr_b32 s69, s68, 1
s_lshl_b32 s69, s69, 6
s_and_b32 s68, s68, 1
s_lshl_b32 s68, s68, 3
s_add_u32 s69, s69, s68
s_mov_b32 s32, s46
s_mov_b32 s33, s47
s_mov_b32 s35, 0x20000
s_cmp_lt_u32 s83, 112
s_cselect_b32 s34, 268435456, 0
s_mul_i32 s71, s3, 640
s_mul_i32 s6, s3, 3072
s_add_u32 m0, s6, 151552
s_add_u32 s6, s6, 5120
buffer_load_dwordx4 v1, s[60:63], s6 offen sc1 lds
v_min_u32 v27, 1, v11
v_mul_u32_u24 v27, 2560, v27
v_sub_u32 v27, 156672, v27
v_add_u32 v27, v27, v9
v_add_u32 v95, s71, v27
v_lshrrev_b32 v28, 2, v11
v_lshl_add_u32 v28, v28, 2, v11
v_lshlrev_b32 v28, 1, v28
v_lshl_add_u32 v28, v26, 28, v28
s_waitcnt lgkmcnt(0)
s_mov_b32 s26, 2621440
s_mov_b32 s27, 0x20000
s_mov_b32 s30, 3456
s_mov_b32 s31, 0x20000
s_cmp_eq_u32 s3, 3
s_cselect_b32 s48, s64, s46
s_cselect_b32 s49, s65, s47
s_mov_b32 s50, 268435456
s_cmov_b32 s50, 1280
s_mov_b32 s51, 0x20000
s_cselect_b32 s6, -1024, s6
s_add_u32 s6, s6, 1024
s_add_u32 m0, m0, 1024
s_nop 0
buffer_load_dwordx4 v1, s[48:51], s6 offen offset:0 sc1 lds
buffer_load_dwordx4 v1, s[48:51], s6 offen offset:1024 sc1 lds
s_mul_i32 s6, s37, 1280
s_lshl_b32 s76, s44, 6
s_add_u32 s72, s6, s76
s_lshl_b32 s77, s45, 6
s_add_u32 s73, s6, s77
s_xor_b32 s96, s3, 1
s_mul_i32 s96, s96, 15360
s_add_u32 s96, s96, 90112
s_add_u32 s7, s72, 64
s_add_u32 m0, s96, 0
s_nop 0
buffer_load_dwordx4 v8, s[24:27], s72 offen lds
s_add_u32 m0, s96, 1024
s_nop 0
buffer_load_dwordx4 v8, s[24:27], s7 offen lds
s_add_u32 m0, s96, 2048
s_nop 0
buffer_load_dwordx4 v8, s[24:27], s73 offen lds
s_cmp_ge_u32 s83, 112
s_cbranch_scc1 L_tl_nouv1
buffer_load_dwordx4 v[32:35], v1, s[32:35], s70 offen sc1
s_add_u32 s70, s70, 7168
buffer_load_dwordx4 v[36:39], v1, s[32:35], s70 offen sc1
s_add_u32 s70, s70, 7168
buffer_load_dwordx4 v[40:43], v1, s[32:35], s70 offen sc1
s_add_u32 s70, s70, 7168
buffer_load_dwordx4 v[44:47], v1, s[32:35], s70 offen sc1
s_add_u32 s70, s70, 7168
buffer_load_dwordx4 v[48:51], v1, s[32:35], s70 offen sc1
s_add_u32 s70, s70, 7168
buffer_load_ushort v94, v28, s[28:31], s69 offen
L_tl_nouv1:
s_add_u32 m0, s56, 2048
s_nop 0
buffer_load_dwordx4 v1, s[60:63], s43 offen offset:2048 sc1 lds
s_add_u32 s43, s43, 163840
s_add_u32 m0, s56, 2048
s_nop 0
buffer_load_dwordx4 v1, s[60:63], s43 offen offset:3072 sc1 lds
s_add_u32 s43, s43, 4096
s_add_u32 m0, s56, 6144
s_nop 0
buffer_load_dwordx4 v1, s[60:63], s43 offen offset:0 sc1 lds
buffer_load_dwordx4 v1, s[60:63], s43 offen offset:1024 sc1 lds
buffer_load_dwordx4 v1, s[60:63], s43 offen offset:2048 sc1 lds
buffer_load_dwordx4 v1, s[60:63], s43 offen offset:3072 sc1 lds
s_add_u32 s43, s43, 65536
buffer_load_dword v0, v4, s[60:63], s52 offen offset:0 sc1
s_add_u32 m0, s56, 10240
s_nop 0
buffer_load_dwordx4 v1, s[60:63], s43 offen offset:0 sc1 lds
buffer_load_dwordx4 v1, s[60:63], s43 offen offset:1024 sc1 lds
buffer_load_dwordx4 v1, s[60:63], s43 offen offset:2048 sc1 lds
buffer_load_dwordx4 v1, s[60:63], s43 offen offset:3072 sc1 lds
s_add_u32 s43, s43, 4096
s_add_u32 m0, s56, 14336
s_nop 0
buffer_load_dwordx4 v1, s[60:63], s43 offen offset:0 sc1 lds
s_lshl_b32 s7, s36, 3
s_add_u32 s77, s77, s7
s_add_u32 s73, s73, s7
v_lshl_add_u32 v26, v11, 6, v10
v_add_u32 v26, s96, v26
v_add_u32 v27, s7, v26
s_waitcnt vmcnt(12)
ds_read_b128 v[16:19], v26
ds_read_b128 v[20:23], v26 offset:1024
ds_read_b64 v[24:25], v27 offset:2048
s_lshl_b32 s74, s76, 1
s_lshl_b32 s75, s77, 1
s_mul_i32 s6, s3, 136
v_min_u32 v93, 16, v2
v_lshlrev_b32 v93, 3, v93
v_add_u32 v93, 163072, v93
v_add_u32 v92, s6, v93
v_add_u32 v27, s56, v1
s_cmp_ge_u32 s83, 112
s_cbranch_scc1 L_tl_nouv2
s_barrier
ds_read_b128 v[52:55], v95 offset:0
ds_read_b128 v[56:59], v95 offset:16
ds_read_b128 v[60:63], v95 offset:128
ds_read_b128 v[64:67], v95 offset:144
ds_read_b128 v[68:71], v95 offset:256
ds_read_b128 v[72:75], v95 offset:272
ds_read_b128 v[76:79], v95 offset:384
ds_read_b128 v[80:83], v95 offset:400
ds_read_b128 v[84:87], v95 offset:512
ds_read_b128 v[88:91], v95 offset:528
s_waitcnt lgkmcnt(9)
v_cvt_pk_bf16_f32 v52, v52, v53
v_cvt_pk_bf16_f32 v53, v54, v55
s_waitcnt lgkmcnt(8)
v_cvt_pk_bf16_f32 v54, v56, v57
v_cvt_pk_bf16_f32 v55, v58, v59
s_waitcnt lgkmcnt(7)
v_cvt_pk_bf16_f32 v60, v60, v61
v_cvt_pk_bf16_f32 v61, v62, v63
s_waitcnt lgkmcnt(6)
v_cvt_pk_bf16_f32 v62, v64, v65
v_cvt_pk_bf16_f32 v63, v66, v67
s_waitcnt lgkmcnt(5)
v_cvt_pk_bf16_f32 v68, v68, v69
v_cvt_pk_bf16_f32 v69, v70, v71
s_waitcnt lgkmcnt(4)
v_cvt_pk_bf16_f32 v70, v72, v73
v_cvt_pk_bf16_f32 v71, v74, v75
s_waitcnt lgkmcnt(3)
v_cvt_pk_bf16_f32 v76, v76, v77
v_cvt_pk_bf16_f32 v77, v78, v79
s_waitcnt lgkmcnt(2)
v_cvt_pk_bf16_f32 v78, v80, v81
v_cvt_pk_bf16_f32 v79, v82, v83
s_waitcnt lgkmcnt(1)
v_cvt_pk_bf16_f32 v84, v84, v85
v_cvt_pk_bf16_f32 v85, v86, v87
s_waitcnt lgkmcnt(0)
v_cvt_pk_bf16_f32 v86, v88, v89
v_cvt_pk_bf16_f32 v87, v90, v91
s_waitcnt vmcnt(17)
v_mfma_f32_16x16x32_bf16 v[28:31], v[52:55], v[32:35], 0
s_waitcnt vmcnt(16)
v_mfma_f32_16x16x32_bf16 v[28:31], v[60:63], v[36:39], v[28:31]
s_waitcnt vmcnt(15)
v_mfma_f32_16x16x32_bf16 v[28:31], v[68:71], v[40:43], v[28:31]
s_waitcnt vmcnt(14)
v_mfma_f32_16x16x32_bf16 v[28:31], v[76:79], v[44:47], v[28:31]
s_waitcnt vmcnt(13)
v_mfma_f32_16x16x32_bf16 v[28:31], v[84:87], v[48:51], v[28:31]
s_nop 7
ds_write_b64 v92, v[28:29]
L_tl_nouv2:
s_waitcnt lgkmcnt(0)
s_waitcnt vmcnt(5)
v_cmp_gt_u32 vcc, s39, v0
s_nop 1
s_cbranch_vccnz L_tl_spinc
L_tl_goc:
s_barrier
s_add_u32 s87, s42, 0
buffer_load_dwordx4 a[76:79], v15, s[16:19], s87 offen sc1
s_add_u32 s87, s42, 4096
buffer_load_dwordx4 a[92:95], v15, s[16:19], s87 offen sc1
s_add_u32 s86, s42, 0
buffer_load_dwordx4 a[72:75], v14, s[16:19], s86 offen sc1
s_add_u32 s87, s42, 8192
buffer_load_dwordx4 a[140:143], v15, s[16:19], s87 offen sc1
s_add_u32 s86, s42, 4096
buffer_load_dwordx4 a[88:91], v14, s[16:19], s86 offen sc1
s_add_u32 s85, s42, 0
buffer_load_dwordx4 a[68:71], v13, s[16:19], s85 offen sc1
s_add_u32 s87, s42, 12288
buffer_load_dwordx4 a[156:159], v15, s[16:19], s87 offen sc1
s_add_u32 s86, s42, 8192
buffer_load_dwordx4 a[136:139], v14, s[16:19], s86 offen sc1
s_add_u32 s85, s42, 4096
buffer_load_dwordx4 a[84:87], v13, s[16:19], s85 offen sc1
s_add_u32 s84, s42, 0
buffer_load_dwordx4 a[64:67], v12, s[16:19], s84 offen sc1
s_waitcnt vmcnt(10)
ds_read_b128 v[48:51], v27 offset:0
ds_read_b128 v[52:55], v27 offset:1024
ds_read_b128 v[56:59], v27 offset:2048
ds_read_b128 v[60:63], v27 offset:3072
ds_read_b128 v[64:67], v27 offset:4096
s_waitcnt vmcnt(9)
v_mfma_f32_16x16x32_bf16 v[168:171], a[0:3], a[76:79], 0
s_add_u32 s86, s42, 12288
buffer_load_dwordx4 a[152:155], v14, s[16:19], s86 offen sc1
v_mfma_f32_16x16x32_bf16 v[172:175], a[4:7], a[76:79], 0
v_mfma_f32_16x16x32_bf16 v[176:179], a[8:11], a[76:79], 0
v_mfma_f32_16x16x32_bf16 v[180:183], a[12:15], a[76:79], 0
v_mfma_f32_16x16x32_bf16 v[184:187], a[16:19], a[76:79], 0
s_waitcnt vmcnt(9)
v_mfma_f32_16x16x32_bf16 v[168:171], a[20:23], a[92:95], v[168:171]
s_add_u32 s87, s42, 131072
buffer_load_dwordx4 a[76:79], v15, s[16:19], s87 offen sc1
v_mfma_f32_16x16x32_bf16 v[172:175], a[24:27], a[92:95], v[172:175]
v_mfma_f32_16x16x32_bf16 v[176:179], a[28:31], a[92:95], v[176:179]
v_mfma_f32_16x16x32_bf16 v[180:183], a[32:35], a[92:95], v[180:183]
v_mfma_f32_16x16x32_bf16 v[184:187], a[36:39], a[92:95], v[184:187]
s_waitcnt vmcnt(9)
v_mfma_f32_16x16x32_bf16 v[148:151], a[0:3], a[72:75], 0
s_add_u32 s85, s42, 8192
buffer_load_dwordx4 a[132:135], v13, s[16:19], s85 offen sc1
v_mfma_f32_16x16x32_bf16 v[152:155], a[4:7], a[72:75], 0
v_mfma_f32_16x16x32_bf16 v[156:159], a[8:11], a[72:75], 0
ds_read_b64 v[28:29], v93 offset:0
ds_read_b64 v[30:31], v93 offset:136
v_mfma_f32_16x16x32_bf16 v[160:163], a[12:15], a[72:75], 0
ds_read_b64 v[32:33], v93 offset:272
ds_read_b64 v[34:35], v93 offset:408
v_mfma_f32_16x16x32_bf16 v[164:167], a[16:19], a[72:75], 0
s_waitcnt vmcnt(9) lgkmcnt(2)
v_lshlrev_b32 v94, 16, v94
v_add_f32 v28, v28, v30
v_mfma_f32_16x16x32_bf16 v[168:171], v[48:51], a[140:143], v[168:171]
s_add_u32 s84, s42, 4096
buffer_load_dwordx4 a[80:83], v12, s[16:19], s84 offen sc1
v_mfma_f32_16x16x32_bf16 v[172:175], v[52:55], a[140:143], v[172:175]
buffer_load_dword v0, v4, s[60:63], s82 offen offset:0 sc1
v_mfma_f32_16x16x32_bf16 v[176:179], v[56:59], a[140:143], v[176:179]
s_waitcnt lgkmcnt(0)
v_add_f32 v29, v29, v31
v_add_f32 v32, v32, v34
v_mfma_f32_16x16x32_bf16 v[180:183], v[60:63], a[140:143], v[180:183]
v_add_f32 v33, v33, v35
v_add_f32 v29, v29, v94
v_mfma_f32_16x16x32_bf16 v[184:187], v[64:67], a[140:143], v[184:187]
s_waitcnt vmcnt(10)
v_add_f32 v28, v28, v32
v_add_f32 v29, v29, v33
v_mfma_f32_16x16x32_bf16 v[148:151], a[20:23], a[88:91], v[148:151]
s_add_u32 s87, s42, 135168
buffer_load_dwordx4 a[92:95], v15, s[16:19], s87 offen sc1
v_mfma_f32_16x16x32_bf16 v[152:155], a[24:27], a[88:91], v[152:155]
v_cmp_gt_u32 vcc, 16, v2
v_mov_b32 v39, 0
v_mfma_f32_16x16x32_bf16 v[156:159], a[28:31], a[88:91], v[156:159]
v_cndmask_b32 v28, 0, v28, vcc
v_cndmask_b32 v29, 0, v29, vcc
v_mfma_f32_16x16x32_bf16 v[160:163], a[32:35], a[88:91], v[160:163]
v_cvt_pk_bf16_f32 v36, v28, v28
v_cvt_pk_bf16_f32 v30, v29, v29
v_mfma_f32_16x16x32_bf16 v[164:167], a[36:39], a[88:91], v[164:167]
s_waitcnt vmcnt(10)
v_lshlrev_b32 v31, 16, v36
v_lshlrev_b32 v30, 16, v30
v_mfma_f32_16x16x32_bf16 v[128:131], a[0:3], a[68:71], 0
s_add_u32 s86, s42, 131072
buffer_load_dwordx4 a[72:75], v14, s[16:19], s86 offen sc1
v_mfma_f32_16x16x32_bf16 v[132:135], a[4:7], a[68:71], 0
v_sub_f32 v28, v28, v31
v_sub_f32 v29, v29, v30
v_mfma_f32_16x16x32_bf16 v[136:139], a[8:11], a[68:71], 0
v_cvt_pk_bf16_f32 v37, v28, v30
v_cvt_pk_bf16_f32 v38, v30, v29
v_mfma_f32_16x16x32_bf16 v[140:143], a[12:15], a[68:71], 0
s_lshl_b32 s6, s83, 10
v_mfma_f32_16x16x32_bf16 v[144:147], a[16:19], a[68:71], 0
s_waitcnt vmcnt(10)
s_add_u32 s6, s6, 524288
v_mfma_f32_16x16x32_bf16 v[168:171], a[40:43], a[156:159], v[168:171]
s_add_u32 s85, s42, 12288
buffer_load_dwordx4 a[148:151], v13, s[16:19], s85 offen sc1
v_mfma_f32_16x16x32_bf16 v[172:175], a[44:47], a[156:159], v[172:175]
s_cmp_eq_u32 s3, 0
s_cselect_b32 s6, s6, 268435456
v_mfma_f32_16x16x32_bf16 v[176:179], a[48:51], a[156:159], v[176:179]
buffer_store_dwordx4 v[36:39], v1, s[32:35], s6 offen sc1
v_mfma_f32_16x16x32_bf16 v[180:183], a[52:55], a[156:159], v[180:183]
v_mfma_f32_16x16x32_bf16 v[184:187], a[56:59], a[156:159], v[184:187]
s_waitcnt vmcnt(11)
v_mfma_f32_16x16x32_bf16 v[148:151], v[48:51], a[136:139], v[148:151]
s_add_u32 s84, s42, 8192
buffer_load_dwordx4 a[128:131], v12, s[16:19], s84 offen sc1
v_mfma_f32_16x16x32_bf16 v[152:155], v[52:55], a[136:139], v[152:155]
v_mfma_f32_16x16x32_bf16 v[156:159], v[56:59], a[136:139], v[156:159]
v_mfma_f32_16x16x32_bf16 v[160:163], v[60:63], a[136:139], v[160:163]
v_mfma_f32_16x16x32_bf16 v[164:167], v[64:67], a[136:139], v[164:167]
s_waitcnt vmcnt(11)
v_mfma_f32_16x16x32_bf16 v[128:131], a[20:23], a[84:87], v[128:131]
s_add_u32 s87, s42, 139264
buffer_load_dwordx4 a[140:143], v15, s[16:19], s87 offen sc1
v_mfma_f32_16x16x32_bf16 v[132:135], a[24:27], a[84:87], v[132:135]
v_mfma_f32_16x16x32_bf16 v[136:139], a[28:31], a[84:87], v[136:139]
v_mfma_f32_16x16x32_bf16 v[140:143], a[32:35], a[84:87], v[140:143]
v_mfma_f32_16x16x32_bf16 v[144:147], a[36:39], a[84:87], v[144:147]
s_waitcnt vmcnt(11)
v_mfma_f32_16x16x32_bf16 v[68:71], a[0:3], a[64:67], 0
s_add_u32 s86, s42, 135168
buffer_load_dwordx4 a[88:91], v14, s[16:19], s86 offen sc1
v_mfma_f32_16x16x32_bf16 v[72:75], a[4:7], a[64:67], 0
v_mfma_f32_16x16x32_bf16 v[76:79], a[8:11], a[64:67], 0
v_mfma_f32_16x16x32_bf16 v[80:83], a[12:15], a[64:67], 0
v_mfma_f32_16x16x32_bf16 v[84:87], a[16:19], a[64:67], 0
s_waitcnt vmcnt(10)
v_mfma_f32_16x16x32_bf16 v[168:171], a[180:183], a[76:79], v[168:171]
s_add_u32 s85, s42, 131072
buffer_load_dwordx4 a[68:71], v13, s[16:19], s85 offen sc1
v_mfma_f32_16x16x32_bf16 v[172:175], a[184:187], a[76:79], v[172:175]
v_mfma_f32_16x16x32_bf16 v[176:179], a[188:191], a[76:79], v[176:179]
v_mfma_f32_16x16x32_bf16 v[180:183], a[192:195], a[76:79], v[180:183]
v_mfma_f32_16x16x32_bf16 v[184:187], a[196:199], a[76:79], v[184:187]
v_mfma_f32_16x16x32_bf16 v[148:151], a[40:43], a[152:155], v[148:151]
s_add_u32 s84, s42, 12288
buffer_load_dwordx4 a[144:147], v12, s[16:19], s84 offen sc1
v_mfma_f32_16x16x32_bf16 v[152:155], a[44:47], a[152:155], v[152:155]
v_mfma_f32_16x16x32_bf16 v[156:159], a[48:51], a[152:155], v[156:159]
v_mfma_f32_16x16x32_bf16 v[160:163], a[52:55], a[152:155], v[160:163]
v_mfma_f32_16x16x32_bf16 v[164:167], a[56:59], a[152:155], v[164:167]
s_waitcnt vmcnt(11)
v_mfma_f32_16x16x32_bf16 v[128:131], v[48:51], a[132:135], v[128:131]
s_add_u32 s87, s42, 143360
buffer_load_dwordx4 a[156:159], v15, s[16:19], s87 offen sc1
v_mfma_f32_16x16x32_bf16 v[132:135], v[52:55], a[132:135], v[132:135]
v_mfma_f32_16x16x32_bf16 v[136:139], v[56:59], a[132:135], v[136:139]
v_mfma_f32_16x16x32_bf16 v[140:143], v[60:63], a[132:135], v[140:143]
v_mfma_f32_16x16x32_bf16 v[144:147], v[64:67], a[132:135], v[144:147]
s_waitcnt vmcnt(11)
v_mfma_f32_16x16x32_bf16 v[68:71], a[20:23], a[80:83], v[68:71]
s_add_u32 s86, s42, 139264
buffer_load_dwordx4 a[136:139], v14, s[16:19], s86 offen sc1
v_mfma_f32_16x16x32_bf16 v[72:75], a[24:27], a[80:83], v[72:75]
v_mfma_f32_16x16x32_bf16 v[76:79], a[28:31], a[80:83], v[76:79]
s_waitcnt vmcnt(11)
v_cmp_gt_u32 vcc, s39, v0
s_nop 1
s_cbranch_vccnz L_tl_spino
L_tl_goo:
v_mfma_f32_16x16x32_bf16 v[80:83], a[32:35], a[80:83], v[80:83]
v_mfma_f32_16x16x32_bf16 v[84:87], a[36:39], a[80:83], v[84:87]
s_waitcnt vmcnt(10)
s_barrier
v_mfma_f32_16x16x32_bf16 v[168:171], a[200:203], a[92:95], v[168:171]
s_add_u32 s85, s42, 135168
buffer_load_dwordx4 a[84:87], v13, s[16:19], s85 offen sc1
v_mfma_f32_16x16x32_bf16 v[172:175], a[204:207], a[92:95], v[172:175]
v_mfma_f32_16x16x32_bf16 v[176:179], a[208:211], a[92:95], v[176:179]
v_mfma_f32_16x16x32_bf16 v[180:183], a[212:215], a[92:95], v[180:183]
v_mfma_f32_16x16x32_bf16 v[184:187], a[216:219], a[92:95], v[184:187]
s_waitcnt vmcnt(10)
v_mfma_f32_16x16x32_bf16 v[148:151], a[180:183], a[72:75], v[148:151]
s_add_u32 s84, s42, 131072
buffer_load_dwordx4 a[64:67], v12, s[16:19], s84 offen sc1
v_mfma_f32_16x16x32_bf16 v[152:155], a[184:187], a[72:75], v[152:155]
v_mfma_f32_16x16x32_bf16 v[156:159], a[188:191], a[72:75], v[156:159]
v_mfma_f32_16x16x32_bf16 v[160:163], a[192:195], a[72:75], v[160:163]
v_mfma_f32_16x16x32_bf16 v[164:167], a[196:199], a[72:75], v[164:167]
s_waitcnt vmcnt(10)
v_mfma_f32_16x16x32_bf16 v[128:131], a[40:43], a[148:151], v[128:131]
s_add_u32 s87, s42, 65536
buffer_load_dwordx4 a[76:79], v15, s[16:19], s87 offen sc1
v_mfma_f32_16x16x32_bf16 v[132:135], a[44:47], a[148:151], v[132:135]
v_mfma_f32_16x16x32_bf16 v[136:139], a[48:51], a[148:151], v[136:139]
v_mfma_f32_16x16x32_bf16 v[140:143], a[52:55], a[148:151], v[140:143]
v_mfma_f32_16x16x32_bf16 v[144:147], a[56:59], a[148:151], v[144:147]
s_waitcnt vmcnt(9)
v_mfma_f32_16x16x32_bf16 v[68:71], v[48:51], a[128:131], v[68:71]
s_add_u32 s86, s42, 143360
buffer_load_dwordx4 a[152:155], v14, s[16:19], s86 offen sc1
v_mfma_f32_16x16x32_bf16 v[72:75], v[52:55], a[128:131], v[72:75]
v_mfma_f32_16x16x32_bf16 v[76:79], v[56:59], a[128:131], v[76:79]
v_mfma_f32_16x16x32_bf16 v[80:83], v[60:63], a[128:131], v[80:83]
v_mfma_f32_16x16x32_bf16 v[84:87], v[64:67], a[128:131], v[84:87]
s_waitcnt vmcnt(9)
v_mfma_f32_16x16x32_bf16 v[168:171], a[220:223], a[140:143], v[168:171]
s_add_u32 s85, s42, 139264
buffer_load_dwordx4 a[132:135], v13, s[16:19], s85 offen sc1
ds_read_b128 v[48:51], v27 offset:5120
v_mfma_f32_16x16x32_bf16 v[172:175], a[224:227], a[140:143], v[172:175]
ds_read_b128 v[52:55], v27 offset:6144
ds_read_b128 v[56:59], v27 offset:7168
ds_read_b128 v[60:63], v27 offset:8192
v_mfma_f32_16x16x32_bf16 v[176:179], a[228:231], a[140:143], v[176:179]
s_lshl_b32 s57, s2, 2
ds_read_b128 v[64:67], v27 offset:9216
v_mfma_f32_16x16x32_bf16 v[180:183], a[232:235], a[140:143], v[180:183]
s_add_u32 s57, s57, s3
v_mfma_f32_16x16x32_bf16 v[184:187], a[236:239], a[140:143], v[184:187]
s_waitcnt vmcnt(9)
s_xor_b32 s58, s57, 4
v_mfma_f32_16x16x32_bf16 v[148:151], a[200:203], a[88:91], v[148:151]
s_add_u32 s84, s42, 135168
buffer_load_dwordx4 a[80:83], v12, s[16:19], s84 offen sc1
v_mfma_f32_16x16x32_bf16 v[152:155], a[204:207], a[88:91], v[152:155]
s_mul_i32 s57, s57, 5120
v_mfma_f32_16x16x32_bf16 v[156:159], a[208:211], a[88:91], v[156:159]
s_mul_i32 s58, s58, 5120
v_mfma_f32_16x16x32_bf16 v[160:163], a[212:215], a[88:91], v[160:163]
s_add_u32 s57, s57, 100663296
v_mfma_f32_16x16x32_bf16 v[164:167], a[216:219], a[88:91], v[164:167]
s_waitcnt vmcnt(9)
s_add_u32 s58, s58, 100663296
v_mfma_f32_16x16x32_bf16 v[128:131], a[180:183], a[68:71], v[128:131]
s_add_u32 s87, s42, 69632
buffer_load_dwordx4 a[92:95], v15, s[16:19], s87 offen sc1
v_mfma_f32_16x16x32_bf16 v[132:135], a[184:187], a[68:71], v[132:135]
s_add_u32 s59, s57, 4096
v_mfma_f32_16x16x32_bf16 v[136:139], a[188:191], a[68:71], v[136:139]
s_add_u32 s68, s58, 4096
v_mfma_f32_16x16x32_bf16 v[140:143], a[192:195], a[68:71], v[140:143]
s_and_b32 s69, s2, 63
v_mfma_f32_16x16x32_bf16 v[144:147], a[196:199], a[68:71], v[144:147]
s_waitcnt vmcnt(9)
s_lshl_b32 s69, s69, 7
v_mfma_f32_16x16x32_bf16 v[68:71], a[40:43], a[144:147], v[68:71]
s_add_u32 s86, s42, 65536
buffer_load_dwordx4 a[72:75], v14, s[16:19], s86 offen sc1
v_mfma_f32_16x16x32_bf16 v[72:75], a[44:47], a[144:147], v[72:75]
s_lshr_b32 s70, s2, 4
v_mfma_f32_16x16x32_bf16 v[76:79], a[48:51], a[144:147], v[76:79]
s_and_b32 s70, s70, 12
v_mfma_f32_16x16x32_bf16 v[80:83], a[52:55], a[144:147], v[80:83]
s_add_u32 s69, s69, s70
v_mfma_f32_16x16x32_bf16 v[84:87], a[56:59], a[144:147], v[84:87]
s_waitcnt vmcnt(9) lgkmcnt(4)
s_add_u32 s69, s69, 409600
v_mfma_f32_16x16x32_bf16 v[168:171], v[48:51], a[156:159], v[168:171]
s_waitcnt lgkmcnt(3)
s_add_u32 s85, s42, 143360
buffer_load_dwordx4 a[148:151], v13, s[16:19], s85 offen sc1
v_mfma_f32_16x16x32_bf16 v[172:175], v[52:55], a[156:159], v[172:175]
s_waitcnt lgkmcnt(2)
s_xor_b32 s70, s69, 128
v_mfma_f32_16x16x32_bf16 v[176:179], v[56:59], a[156:159], v[176:179]
s_waitcnt lgkmcnt(1)
v_mfma_f32_16x16x32_bf16 v[180:183], v[60:63], a[156:159], v[180:183]
s_waitcnt lgkmcnt(0)
v_mfma_f32_16x16x32_bf16 v[184:187], v[64:67], a[156:159], v[184:187]
s_waitcnt vmcnt(9)
v_mfma_f32_16x16x32_bf16 v[148:151], a[220:223], a[136:139], v[148:151]
s_add_u32 s84, s42, 139264
buffer_load_dwordx4 a[128:131], v12, s[16:19], s84 offen sc1
v_mfma_f32_16x16x32_bf16 v[152:155], a[224:227], a[136:139], v[152:155]
v_mfma_f32_16x16x32_bf16 v[156:159], a[228:231], a[136:139], v[156:159]
v_mfma_f32_16x16x32_bf16 v[160:163], a[232:235], a[136:139], v[160:163]
v_mfma_f32_16x16x32_bf16 v[164:167], a[236:239], a[136:139], v[164:167]
s_waitcnt vmcnt(9)
v_mfma_f32_16x16x32_bf16 v[128:131], a[200:203], a[84:87], v[128:131]
s_add_u32 s87, s42, 73728
buffer_load_dwordx4 a[140:143], v15, s[16:19], s87 offen sc1
v_mfma_f32_16x16x32_bf16 v[132:135], a[204:207], a[84:87], v[132:135]
v_mfma_f32_16x16x32_bf16 v[136:139], a[208:211], a[84:87], v[136:139]
v_mfma_f32_16x16x32_bf16 v[140:143], a[212:215], a[84:87], v[140:143]
v_mfma_f32_16x16x32_bf16 v[144:147], a[216:219], a[84:87], v[144:147]
s_waitcnt vmcnt(9)
v_mfma_f32_16x16x32_bf16 v[68:71], a[180:183], a[64:67], v[68:71]
s_add_u32 s86, s42, 69632
buffer_load_dwordx4 a[88:91], v14, s[16:19], s86 offen sc1
v_mfma_f32_16x16x32_bf16 v[72:75], a[184:187], a[64:67], v[72:75]
v_mfma_f32_16x16x32_bf16 v[76:79], a[188:191], a[64:67], v[76:79]
v_mfma_f32_16x16x32_bf16 v[80:83], a[192:195], a[64:67], v[80:83]
v_mfma_f32_16x16x32_bf16 v[84:87], a[196:199], a[64:67], v[84:87]
s_waitcnt vmcnt(9)
v_mfma_f32_16x16x32_bf16 v[168:171], a[240:243], a[76:79], v[168:171]
s_add_u32 s85, s42, 65536
buffer_load_dwordx4 a[68:71], v13, s[16:19], s85 offen sc1
v_mfma_f32_16x16x32_bf16 v[172:175], a[244:247], a[76:79], v[172:175]
v_mfma_f32_16x16x32_bf16 v[176:179], a[248:251], a[76:79], v[176:179]
v_mfma_f32_16x16x32_bf16 v[180:183], a[252:255], a[76:79], v[180:183]
v_mfma_f32_16x16x32_bf16 v[184:187], a[60:63], a[76:79], v[184:187]
s_waitcnt vmcnt(9)
v_mfma_f32_16x16x32_bf16 v[148:151], v[48:51], a[152:155], v[148:151]
s_add_u32 s84, s42, 143360
buffer_load_dwordx4 a[144:147], v12, s[16:19], s84 offen sc1
v_mfma_f32_16x16x32_bf16 v[152:155], v[52:55], a[152:155], v[152:155]
v_mfma_f32_16x16x32_bf16 v[156:159], v[56:59], a[152:155], v[156:159]
v_mfma_f32_16x16x32_bf16 v[160:163], v[60:63], a[152:155], v[160:163]
v_mfma_f32_16x16x32_bf16 v[164:167], v[64:67], a[152:155], v[164:167]
s_waitcnt vmcnt(9)
v_mfma_f32_16x16x32_bf16 v[128:131], a[220:223], a[132:135], v[128:131]
s_add_u32 s87, s42, 77824
buffer_load_dwordx4 a[156:159], v15, s[16:19], s87 offen sc1
v_mfma_f32_16x16x32_bf16 v[132:135], a[224:227], a[132:135], v[132:135]
v_mfma_f32_16x16x32_bf16 v[136:139], a[228:231], a[132:135], v[136:139]
v_mfma_f32_16x16x32_bf16 v[140:143], a[232:235], a[132:135], v[140:143]
v_mfma_f32_16x16x32_bf16 v[144:147], a[236:239], a[132:135], v[144:147]
s_waitcnt vmcnt(9)
v_mfma_f32_16x16x32_bf16 v[68:71], a[200:203], a[80:83], v[68:71]
s_add_u32 s86, s42, 73728
buffer_load_dwordx4 a[136:139], v14, s[16:19], s86 offen sc1
v_mfma_f32_16x16x32_bf16 v[72:75], a[204:207], a[80:83], v[72:75]
v_mfma_f32_16x16x32_bf16 v[76:79], a[208:211], a[80:83], v[76:79]
v_mfma_f32_16x16x32_bf16 v[80:83], a[212:215], a[80:83], v[80:83]
v_mfma_f32_16x16x32_bf16 v[84:87], a[216:219], a[80:83], v[84:87]
s_waitcnt vmcnt(9)
v_mfma_f32_16x16x32_bf16 v[168:171], v[192:195], a[92:95], v[168:171]
s_add_u32 s85, s42, 69632
buffer_load_dwordx4 a[84:87], v13, s[16:19], s85 offen sc1
v_mfma_f32_16x16x32_bf16 v[172:175], v[196:199], a[92:95], v[172:175]
s_xor_b32 s88, s3, 1
v_mfma_f32_16x16x32_bf16 v[176:179], v[200:203], a[92:95], v[176:179]
s_mul_i32 s88, s88, 15360
v_mfma_f32_16x16x32_bf16 v[180:183], v[204:207], a[92:95], v[180:183]
s_add_u32 s88, s88, 90112
v_add_u32 v89, s88, v1
v_mfma_f32_16x16x32_bf16 v[184:187], v[208:211], a[92:95], v[184:187]
s_waitcnt vmcnt(9)
s_xor_b32 s88, s3, 2
v_mfma_f32_16x16x32_bf16 v[148:151], a[240:243], a[72:75], v[148:151]
s_add_u32 s84, s42, 65536
buffer_load_dwordx4 a[64:67], v12, s[16:19], s84 offen sc1
v_mfma_f32_16x16x32_bf16 v[152:155], a[244:247], a[72:75], v[152:155]
s_mul_i32 s88, s88, 15360
v_mfma_f32_16x16x32_bf16 v[156:159], a[248:251], a[72:75], v[156:159]
s_add_u32 s88, s88, 95232
v_add_u32 v90, s88, v1
v_mfma_f32_16x16x32_bf16 v[160:163], a[252:255], a[72:75], v[160:163]
s_xor_b32 s88, s3, 3
v_mfma_f32_16x16x32_bf16 v[164:167], a[60:63], a[72:75], v[164:167]
s_waitcnt vmcnt(9)
s_mul_i32 s88, s88, 15360
v_mfma_f32_16x16x32_bf16 v[128:131], v[48:51], a[148:151], v[128:131]
s_add_u32 s87, s42, 196608
buffer_load_dwordx4 a[76:79], v15, s[16:19], s87 offen sc1
v_mfma_f32_16x16x32_bf16 v[132:135], v[52:55], a[148:151], v[132:135]
s_add_u32 s88, s88, 100352
v_add_u32 v91, s88, v1
v_mfma_f32_16x16x32_bf16 v[136:139], v[56:59], a[148:151], v[136:139]
s_mul_i32 s88, s3, 15360
v_mfma_f32_16x16x32_bf16 v[140:143], v[60:63], a[148:151], v[140:143]
s_add_u32 s88, s88, 90112
v_add_u32 v88, s88, v1
v_mfma_f32_16x16x32_bf16 v[144:147], v[64:67], a[148:151], v[144:147]
s_waitcnt vmcnt(9)
v_mfma_f32_16x16x32_bf16 v[68:71], a[220:223], a[128:131], v[68:71]
s_add_u32 s86, s42, 77824
buffer_load_dwordx4 a[152:155], v14, s[16:19], s86 offen sc1
v_mfma_f32_16x16x32_bf16 v[72:75], a[224:227], a[128:131], v[72:75]
v_mfma_f32_16x16x32_bf16 v[76:79], a[228:231], a[128:131], v[76:79]
v_mfma_f32_16x16x32_bf16 v[80:83], a[232:235], a[128:131], v[80:83]
v_mfma_f32_16x16x32_bf16 v[84:87], a[236:239], a[128:131], v[84:87]
s_waitcnt vmcnt(9)
v_mfma_f32_16x16x32_bf16 v[168:171], v[212:215], a[140:143], v[168:171]
s_add_u32 s85, s42, 73728
buffer_load_dwordx4 a[132:135], v13, s[16:19], s85 offen sc1
v_mfma_f32_16x16x32_bf16 v[172:175], v[216:219], a[140:143], v[172:175]
v_mfma_f32_16x16x32_bf16 v[176:179], v[220:223], a[140:143], v[176:179]
v_mfma_f32_16x16x32_bf16 v[180:183], v[224:227], a[140:143], v[180:183]
v_mfma_f32_16x16x32_bf16 v[184:187], v[228:231], a[140:143], v[184:187]
s_waitcnt vmcnt(9)
v_mfma_f32_16x16x32_bf16 v[148:151], v[192:195], a[88:91], v[148:151]
s_add_u32 s84, s42, 69632
buffer_load_dwordx4 a[80:83], v12, s[16:19], s84 offen sc1
v_mfma_f32_16x16x32_bf16 v[152:155], v[196:199], a[88:91], v[152:155]
v_mfma_f32_16x16x32_bf16 v[156:159], v[200:203], a[88:91], v[156:159]
v_mfma_f32_16x16x32_bf16 v[160:163], v[204:207], a[88:91], v[160:163]
v_mfma_f32_16x16x32_bf16 v[164:167], v[208:211], a[88:91], v[164:167]
s_waitcnt vmcnt(9)
v_mfma_f32_16x16x32_bf16 v[128:131], a[240:243], a[68:71], v[128:131]
s_add_u32 s87, s42, 200704
buffer_load_dwordx4 a[92:95], v15, s[16:19], s87 offen sc1
v_mfma_f32_16x16x32_bf16 v[132:135], a[244:247], a[68:71], v[132:135]
v_mfma_f32_16x16x32_bf16 v[136:139], a[248:251], a[68:71], v[136:139]
v_mfma_f32_16x16x32_bf16 v[140:143], a[252:255], a[68:71], v[140:143]
v_mfma_f32_16x16x32_bf16 v[144:147], a[60:63], a[68:71], v[144:147]
s_waitcnt vmcnt(9)
v_mfma_f32_16x16x32_bf16 v[68:71], v[48:51], a[144:147], v[68:71]
s_add_u32 s86, s42, 196608
buffer_load_dwordx4 a[72:75], v14, s[16:19], s86 offen sc1
v_mfma_f32_16x16x32_bf16 v[72:75], v[52:55], a[144:147], v[72:75]
v_mfma_f32_16x16x32_bf16 v[76:79], v[56:59], a[144:147], v[76:79]
v_mfma_f32_16x16x32_bf16 v[80:83], v[60:63], a[144:147], v[80:83]
v_mfma_f32_16x16x32_bf16 v[84:87], v[64:67], a[144:147], v[84:87]
s_waitcnt vmcnt(9)
v_mfma_f32_16x16x32_bf16 v[168:171], v[232:235], a[156:159], v[168:171]
s_add_u32 s85, s42, 77824
buffer_load_dwordx4 a[148:151], v13, s[16:19], s85 offen sc1
ds_read_b128 v[48:51], v27 offset:10240
v_mfma_f32_16x16x32_bf16 v[172:175], v[236:239], a[156:159], v[172:175]
ds_read_b128 v[52:55], v27 offset:11264
ds_read_b128 v[56:59], v27 offset:12288
ds_read_b128 v[60:63], v27 offset:13312
v_mfma_f32_16x16x32_bf16 v[176:179], v[240:243], a[156:159], v[176:179]
ds_read_b128 v[64:67], v27 offset:14336
v_mfma_f32_16x16x32_bf16 v[180:183], v[244:247], a[156:159], v[180:183]
v_mfma_f32_16x16x32_bf16 v[184:187], v[248:251], a[156:159], v[184:187]
s_waitcnt vmcnt(9)
v_mfma_f32_16x16x32_bf16 v[148:151], v[212:215], a[136:139], v[148:151]
s_add_u32 s84, s42, 73728
buffer_load_dwordx4 a[128:131], v12, s[16:19], s84 offen sc1
v_mfma_f32_16x16x32_bf16 v[152:155], v[216:219], a[136:139], v[152:155]
v_mfma_f32_16x16x32_bf16 v[156:159], v[220:223], a[136:139], v[156:159]
v_mfma_f32_16x16x32_bf16 v[160:163], v[224:227], a[136:139], v[160:163]
v_mfma_f32_16x16x32_bf16 v[164:167], v[228:231], a[136:139], v[164:167]
s_waitcnt vmcnt(9)
v_mfma_f32_16x16x32_bf16 v[128:131], v[192:195], a[84:87], v[128:131]
s_add_u32 s87, s42, 204800
buffer_load_dwordx4 a[140:143], v15, s[16:19], s87 offen sc1
v_mfma_f32_16x16x32_bf16 v[132:135], v[196:199], a[84:87], v[132:135]
v_mfma_f32_16x16x32_bf16 v[136:139], v[200:203], a[84:87], v[136:139]
v_mfma_f32_16x16x32_bf16 v[140:143], v[204:207], a[84:87], v[140:143]
v_mfma_f32_16x16x32_bf16 v[144:147], v[208:211], a[84:87], v[144:147]
s_waitcnt vmcnt(9)
v_mfma_f32_16x16x32_bf16 v[68:71], a[240:243], a[64:67], v[68:71]
s_add_u32 s86, s42, 200704
buffer_load_dwordx4 a[88:91], v14, s[16:19], s86 offen sc1
v_mfma_f32_16x16x32_bf16 v[72:75], a[244:247], a[64:67], v[72:75]
v_mfma_f32_16x16x32_bf16 v[76:79], a[248:251], a[64:67], v[76:79]
v_mfma_f32_16x16x32_bf16 v[80:83], a[252:255], a[64:67], v[80:83]
v_mfma_f32_16x16x32_bf16 v[84:87], a[60:63], a[64:67], v[84:87]
s_waitcnt vmcnt(9) lgkmcnt(4)
v_mfma_f32_16x16x32_bf16 v[168:171], v[48:51], a[76:79], v[168:171]
s_waitcnt lgkmcnt(3)
s_add_u32 s85, s42, 196608
buffer_load_dwordx4 a[68:71], v13, s[16:19], s85 offen sc1
v_mfma_f32_16x16x32_bf16 v[172:175], v[52:55], a[76:79], v[172:175]
s_waitcnt lgkmcnt(2)
s_and_b32 s6, s83, 3
v_mfma_f32_16x16x32_bf16 v[176:179], v[56:59], a[76:79], v[176:179]
s_waitcnt lgkmcnt(1)
s_lshl_b32 s6, s6, 7
v_mfma_f32_16x16x32_bf16 v[180:183], v[60:63], a[76:79], v[180:183]
s_waitcnt lgkmcnt(0)
s_add_u32 s6, s6, 401408
v_mfma_f32_16x16x32_bf16 v[184:187], v[64:67], a[76:79], v[184:187]
s_waitcnt vmcnt(9)
s_cmp_eq_u32 s3, 0
s_cselect_b32 s6, s6, 268435456
v_mfma_f32_16x16x32_bf16 v[148:151], v[232:235], a[152:155], v[148:151]
s_add_u32 s84, s42, 77824
buffer_load_dwordx4 a[144:147], v12, s[16:19], s84 offen sc1
v_mfma_f32_16x16x32_bf16 v[152:155], v[236:239], a[152:155], v[152:155]
buffer_atomic_add v7, v6, s[32:35], s6 offen sc1
v_mfma_f32_16x16x32_bf16 v[156:159], v[240:243], a[152:155], v[156:159]
v_mfma_f32_16x16x32_bf16 v[160:163], v[244:247], a[152:155], v[160:163]
v_mfma_f32_16x16x32_bf16 v[164:167], v[248:251], a[152:155], v[164:167]
s_waitcnt vmcnt(10)
v_mfma_f32_16x16x32_bf16 v[128:131], v[212:215], a[132:135], v[128:131]
s_add_u32 s87, s42, 208896
buffer_load_dwordx4 a[156:159], v15, s[16:19], s87 offen sc1
v_mfma_f32_16x16x32_bf16 v[132:135], v[216:219], a[132:135], v[132:135]
v_mfma_f32_16x16x32_bf16 v[136:139], v[220:223], a[132:135], v[136:139]
v_mfma_f32_16x16x32_bf16 v[140:143], v[224:227], a[132:135], v[140:143]
v_mfma_f32_16x16x32_bf16 v[144:147], v[228:231], a[132:135], v[144:147]
s_waitcnt vmcnt(10)
v_mfma_f32_16x16x32_bf16 v[68:71], v[192:195], a[80:83], v[68:71]
s_add_u32 s86, s42, 204800
buffer_load_dwordx4 a[136:139], v14, s[16:19], s86 offen sc1
v_mfma_f32_16x16x32_bf16 v[72:75], v[196:199], a[80:83], v[72:75]
v_mfma_f32_16x16x32_bf16 v[76:79], v[200:203], a[80:83], v[76:79]
v_mfma_f32_16x16x32_bf16 v[80:83], v[204:207], a[80:83], v[80:83]
v_mfma_f32_16x16x32_bf16 v[84:87], v[208:211], a[80:83], v[84:87]
s_waitcnt vmcnt(10)
v_mfma_f32_16x16x32_bf16 v[168:171], v[252:255], a[92:95], v[168:171]
s_add_u32 s85, s42, 200704
buffer_load_dwordx4 a[84:87], v13, s[16:19], s85 offen sc1
v_mfma_f32_16x16x32_bf16 v[172:175], v[112:115], a[92:95], v[172:175]
v_mfma_f32_16x16x32_bf16 v[176:179], v[116:119], a[92:95], v[176:179]
v_mfma_f32_16x16x32_bf16 v[180:183], v[120:123], a[92:95], v[180:183]
v_mfma_f32_16x16x32_bf16 v[184:187], v[124:127], a[92:95], v[184:187]
s_waitcnt vmcnt(10)
v_mfma_f32_16x16x32_bf16 v[148:151], v[48:51], a[72:75], v[148:151]
s_add_u32 s84, s42, 196608
buffer_load_dwordx4 a[64:67], v12, s[16:19], s84 offen sc1
v_mfma_f32_16x16x32_bf16 v[152:155], v[52:55], a[72:75], v[152:155]
v_mfma_f32_16x16x32_bf16 v[156:159], v[56:59], a[72:75], v[156:159]
v_mfma_f32_16x16x32_bf16 v[160:163], v[60:63], a[72:75], v[160:163]
v_mfma_f32_16x16x32_bf16 v[164:167], v[64:67], a[72:75], v[164:167]
s_waitcnt vmcnt(10)
v_mfma_f32_16x16x32_bf16 v[128:131], v[232:235], a[148:151], v[128:131]
s_add_u32 s87, s100, 0
buffer_load_dwordx4 a[76:79], v15, s[16:19], s87 offen sc1
v_mfma_f32_16x16x32_bf16 v[132:135], v[236:239], a[148:151], v[132:135]
v_mfma_f32_16x16x32_bf16 v[136:139], v[240:243], a[148:151], v[136:139]
v_mfma_f32_16x16x32_bf16 v[140:143], v[244:247], a[148:151], v[140:143]
v_mfma_f32_16x16x32_bf16 v[144:147], v[248:251], a[148:151], v[144:147]
s_waitcnt vmcnt(10)
v_mfma_f32_16x16x32_bf16 v[68:71], v[212:215], a[128:131], v[68:71]
s_add_u32 s86, s42, 208896
buffer_load_dwordx4 a[152:155], v14, s[16:19], s86 offen sc1
v_mfma_f32_16x16x32_bf16 v[72:75], v[216:219], a[128:131], v[72:75]
v_mfma_f32_16x16x32_bf16 v[76:79], v[220:223], a[128:131], v[76:79]
v_mfma_f32_16x16x32_bf16 v[80:83], v[224:227], a[128:131], v[80:83]
v_mfma_f32_16x16x32_bf16 v[84:87], v[228:231], a[128:131], v[84:87]
s_waitcnt vmcnt(10)
v_mfma_f32_16x16x32_bf16 v[168:171], a[96:99], a[140:143], v[168:171]
s_add_u32 s85, s42, 204800
buffer_load_dwordx4 a[132:135], v13, s[16:19], s85 offen sc1
v_mfma_f32_16x16x32_bf16 v[172:175], a[100:103], a[140:143], v[172:175]
v_mfma_f32_16x16x32_bf16 v[176:179], a[104:107], a[140:143], v[176:179]
v_mfma_f32_16x16x32_bf16 v[180:183], a[108:111], a[140:143], v[180:183]
v_mfma_f32_16x16x32_bf16 v[184:187], a[112:115], a[140:143], v[184:187]
s_waitcnt vmcnt(10)
s_and_b32 s80, s40, 1
v_mfma_f32_16x16x32_bf16 v[148:151], v[252:255], a[88:91], v[148:151]
s_add_u32 s84, s42, 200704
buffer_load_dwordx4 a[80:83], v12, s[16:19], s84 offen sc1
v_mfma_f32_16x16x32_bf16 v[152:155], v[112:115], a[88:91], v[152:155]
s_lshl_b32 s80, s80, 3
v_mfma_f32_16x16x32_bf16 v[156:159], v[116:119], a[88:91], v[156:159]
s_add_u32 s80, s80, s41
v_mfma_f32_16x16x32_bf16 v[160:163], v[120:123], a[88:91], v[160:163]
s_mul_i32 s78, s3, 7168
v_mfma_f32_16x16x32_bf16 v[164:167], v[124:127], a[88:91], v[164:167]
s_waitcnt vmcnt(10)
s_mul_i32 s79, s80, 143360
v_mfma_f32_16x16x32_bf16 v[128:131], v[48:51], a[68:71], v[128:131]
s_add_u32 s87, s100, 4096
buffer_load_dwordx4 a[92:95], v15, s[16:19], s87 offen sc1
v_mfma_f32_16x16x32_bf16 v[132:135], v[52:55], a[68:71], v[132:135]
s_add_u32 s79, s79, 19922944
v_mfma_f32_16x16x32_bf16 v[136:139], v[56:59], a[68:71], v[136:139]
s_lshr_b32 s81, s40, 1
v_mfma_f32_16x16x32_bf16 v[140:143], v[60:63], a[68:71], v[140:143]
s_lshl_b32 s81, s81, 2
v_mfma_f32_16x16x32_bf16 v[144:147], v[64:67], a[68:71], v[144:147]
s_waitcnt vmcnt(10)
s_add_u32 s81, s81, s3
v_mfma_f32_16x16x32_bf16 v[68:71], v[232:235], a[144:147], v[68:71]
s_add_u32 s86, s100, 0
buffer_load_dwordx4 a[72:75], v14, s[16:19], s86 offen sc1
v_mfma_f32_16x16x32_bf16 v[72:75], v[236:239], a[144:147], v[72:75]
s_lshr_b32 s97, s40, 1
v_mfma_f32_16x16x32_bf16 v[76:79], v[240:243], a[144:147], v[76:79]
s_add_u32 s97, s41, s97
v_mfma_f32_16x16x32_bf16 v[80:83], v[244:247], a[144:147], v[80:83]
s_and_b32 s97, s97, 1
v_mfma_f32_16x16x32_bf16 v[84:87], v[248:251], a[144:147], v[84:87]
s_waitcnt vmcnt(9)
s_mul_i32 s97, s97, 5
v_mfma_f32_16x16x32_bf16 v[168:171], a[116:119], a[156:159], v[168:171]
s_add_u32 s85, s42, 208896
buffer_load_dwordx4 a[148:151], v13, s[16:19], s85 offen sc1
v_mfma_f32_16x16x32_bf16 v[172:175], a[120:123], a[156:159], v[172:175]
s_add_u32 s10, s97, s3
v_mfma_f32_16x16x32_bf16 v[176:179], a[124:127], a[156:159], v[176:179]
s_add_u32 s10, s10, 0
v_mfma_f32_16x16x32_bf16 v[180:183], a[160:163], a[156:159], v[180:183]
s_sub_u32 s9, s10, 20
v_mfma_f32_16x16x32_bf16 v[184:187], a[164:167], a[156:159], v[184:187]
s_waitcnt vmcnt(9)
s_min_u32 s10, s10, s9
v_mfma_f32_16x16x32_bf16 v[148:151], a[96:99], a[136:139], v[148:151]
s_add_u32 s84, s42, 204800
buffer_load_dwordx4 a[128:131], v12, s[16:19], s84 offen sc1
v_mfma_f32_16x16x32_bf16 v[152:155], a[100:103], a[136:139], v[152:155]
ds_write_b128 v91, v[168:171] offset:0
v_mfma_f32_16x16x32_bf16 v[156:159], a[104:107], a[136:139], v[156:159]
s_mul_i32 s10, s10, 7168
v_mfma_f32_16x16x32_bf16 v[160:163], a[108:111], a[136:139], v[160:163]
s_add_u32 s10, s10, s79
v_mfma_f32_16x16x32_bf16 v[164:167], a[112:115], a[136:139], v[164:167]
s_waitcnt vmcnt(9)
ds_write_b128 v91, v[172:175] offset:1024
v_mfma_f32_16x16x32_bf16 v[128:131], v[252:255], a[84:87], v[128:131]
s_add_u32 s87, s100, 8192
buffer_load_dwordx4 a[140:143], v15, s[16:19], s87 offen sc1
v_mfma_f32_16x16x32_bf16 v[132:135], v[112:115], a[84:87], v[132:135]
s_add_u32 s11, s97, s3
v_mfma_f32_16x16x32_bf16 v[136:139], v[116:119], a[84:87], v[136:139]
ds_write_b128 v91, v[176:179] offset:2048
v_mfma_f32_16x16x32_bf16 v[140:143], v[120:123], a[84:87], v[140:143]
s_add_u32 s11, s11, 4
v_mfma_f32_16x16x32_bf16 v[144:147], v[124:127], a[84:87], v[144:147]
s_waitcnt vmcnt(9)
s_sub_u32 s9, s11, 20
v_mfma_f32_16x16x32_bf16 v[68:71], v[48:51], a[64:67], v[68:71]
s_add_u32 s86, s100, 4096
buffer_load_dwordx4 a[88:91], v14, s[16:19], s86 offen sc1
v_mfma_f32_16x16x32_bf16 v[72:75], v[52:55], a[64:67], v[72:75]
ds_write_b128 v91, v[180:183] offset:3072
v_mfma_f32_16x16x32_bf16 v[76:79], v[56:59], a[64:67], v[76:79]
s_min_u32 s11, s11, s9
v_mfma_f32_16x16x32_bf16 v[80:83], v[60:63], a[64:67], v[80:83]
ds_write_b128 v91, v[184:187] offset:4096
v_mfma_f32_16x16x32_bf16 v[84:87], v[64:67], a[64:67], v[84:87]
s_waitcnt vmcnt(9)
s_mul_i32 s11, s11, 7168
v_mfma_f32_16x16x32_bf16 v[168:171], a[0:3], a[76:79], 0
s_add_u32 s85, s100, 0
buffer_load_dwordx4 a[68:71], v13, s[16:19], s85 offen sc1
v_mfma_f32_16x16x32_bf16 v[172:175], a[4:7], a[76:79], 0
s_add_u32 s11, s11, s79
v_mfma_f32_16x16x32_bf16 v[176:179], a[8:11], a[76:79], 0
s_add_u32 s12, s97, s3
v_mfma_f32_16x16x32_bf16 v[180:183], a[12:15], a[76:79], 0
s_add_u32 s12, s12, 8
v_mfma_f32_16x16x32_bf16 v[184:187], a[16:19], a[76:79], 0
s_waitcnt vmcnt(9)
s_sub_u32 s9, s12, 20
v_mfma_f32_16x16x32_bf16 v[148:151], a[116:119], a[152:155], v[148:151]
s_add_u32 s84, s42, 208896
buffer_load_dwordx4 a[144:147], v12, s[16:19], s84 offen sc1
v_mfma_f32_16x16x32_bf16 v[152:155], a[120:123], a[152:155], v[152:155]
s_min_u32 s12, s12, s9
v_mfma_f32_16x16x32_bf16 v[156:159], a[124:127], a[152:155], v[156:159]
s_mul_i32 s12, s12, 7168
v_mfma_f32_16x16x32_bf16 v[160:163], a[160:163], a[152:155], v[160:163]
s_add_u32 s12, s12, s79
v_mfma_f32_16x16x32_bf16 v[164:167], a[164:167], a[152:155], v[164:167]
s_waitcnt vmcnt(9)
s_add_u32 s14, s97, s3
v_mfma_f32_16x16x32_bf16 v[128:131], a[96:99], a[132:135], v[128:131]
s_add_u32 s87, s100, 12288
buffer_load_dwordx4 a[156:159], v15, s[16:19], s87 offen sc1
v_mfma_f32_16x16x32_bf16 v[132:135], a[100:103], a[132:135], v[132:135]
ds_write_b128 v90, v[148:151] offset:0
v_mfma_f32_16x16x32_bf16 v[136:139], a[104:107], a[132:135], v[136:139]
s_add_u32 s14, s14, 12
v_mfma_f32_16x16x32_bf16 v[140:143], a[108:111], a[132:135], v[140:143]
s_sub_u32 s9, s14, 20
v_mfma_f32_16x16x32_bf16 v[144:147], a[112:115], a[132:135], v[144:147]
s_waitcnt vmcnt(9)
ds_write_b128 v90, v[152:155] offset:1024
v_mfma_f32_16x16x32_bf16 v[68:71], v[252:255], a[80:83], v[68:71]
s_add_u32 s86, s100, 8192
buffer_load_dwordx4 a[136:139], v14, s[16:19], s86 offen sc1
v_mfma_f32_16x16x32_bf16 v[72:75], v[112:115], a[80:83], v[72:75]
s_min_u32 s14, s14, s9
v_mfma_f32_16x16x32_bf16 v[76:79], v[116:119], a[80:83], v[76:79]
ds_write_b128 v90, v[156:159] offset:2048
v_mfma_f32_16x16x32_bf16 v[80:83], v[120:123], a[80:83], v[80:83]
s_mul_i32 s14, s14, 7168
v_mfma_f32_16x16x32_bf16 v[84:87], v[124:127], a[80:83], v[84:87]
s_waitcnt vmcnt(9)
s_add_u32 s14, s14, s79
v_mfma_f32_16x16x32_bf16 v[168:171], a[20:23], a[92:95], v[168:171]
s_add_u32 s85, s100, 4096
buffer_load_dwordx4 a[84:87], v13, s[16:19], s85 offen sc1
ds_read_b128 v[48:51], v27 offset:0
ds_write_b128 v90, v[160:163] offset:3072
v_mfma_f32_16x16x32_bf16 v[172:175], a[24:27], a[92:95], v[172:175]
ds_read_b128 v[52:55], v27 offset:1024
ds_read_b128 v[56:59], v27 offset:2048
ds_read_b128 v[60:63], v27 offset:3072
v_mfma_f32_16x16x32_bf16 v[176:179], a[28:31], a[92:95], v[176:179]
s_add_u32 s15, s97, s3
ds_read_b128 v[64:67], v27 offset:4096
v_mfma_f32_16x16x32_bf16 v[180:183], a[32:35], a[92:95], v[180:183]
ds_write_b128 v90, v[164:167] offset:4096
v_mfma_f32_16x16x32_bf16 v[184:187], a[36:39], a[92:95], v[184:187]
s_waitcnt vmcnt(9)
s_add_u32 s15, s15, 16
v_mfma_f32_16x16x32_bf16 v[148:151], a[0:3], a[72:75], 0
s_add_u32 s84, s100, 0
buffer_load_dwordx4 a[64:67], v12, s[16:19], s84 offen sc1
v_mfma_f32_16x16x32_bf16 v[152:155], a[4:7], a[72:75], 0
s_sub_u32 s9, s15, 20
v_mfma_f32_16x16x32_bf16 v[156:159], a[8:11], a[72:75], 0
s_min_u32 s15, s15, s9
v_mfma_f32_16x16x32_bf16 v[160:163], a[12:15], a[72:75], 0
s_mul_i32 s15, s15, 7168
v_mfma_f32_16x16x32_bf16 v[164:167], a[16:19], a[72:75], 0
s_waitcnt vmcnt(9)
s_add_u32 s15, s15, s79
v_mfma_f32_16x16x32_bf16 v[128:131], a[116:119], a[148:151], v[128:131]
s_add_u32 s87, s100, 131072
buffer_load_dwordx4 a[76:79], v15, s[16:19], s87 offen sc1
v_mfma_f32_16x16x32_bf16 v[132:135], a[120:123], a[148:151], v[132:135]
s_mul_i32 s43, s41, 276480
v_mfma_f32_16x16x32_bf16 v[136:139], a[124:127], a[148:151], v[136:139]
s_add_u32 s43, s43, 23068672
v_mfma_f32_16x16x32_bf16 v[140:143], a[160:163], a[148:151], v[140:143]
s_add_u32 s20, s46, s43
s_addc_u32 s21, s47, 0
v_mfma_f32_16x16x32_bf16 v[144:147], a[164:167], a[148:151], v[144:147]
s_waitcnt vmcnt(9)
s_mov_b32 s22, 276480
v_mfma_f32_16x16x32_bf16 v[68:71], a[96:99], a[128:131], v[68:71]
s_add_u32 s86, s100, 12288
buffer_load_dwordx4 a[152:155], v14, s[16:19], s86 offen sc1
v_mfma_f32_16x16x32_bf16 v[72:75], a[100:103], a[128:131], v[72:75]
ds_write_b128 v89, v[128:131] offset:0
v_mfma_f32_16x16x32_bf16 v[76:79], a[104:107], a[128:131], v[76:79]
s_mov_b32 s23, 0x20000
v_mfma_f32_16x16x32_bf16 v[80:83], a[108:111], a[128:131], v[80:83]
s_mul_i32 s9, s3, 14
v_mfma_f32_16x16x32_bf16 v[84:87], a[112:115], a[128:131], v[84:87]
s_waitcnt vmcnt(9) lgkmcnt(7)
ds_write_b128 v89, v[132:135] offset:1024
v_mfma_f32_16x16x32_bf16 v[168:171], v[48:51], a[140:143], v[168:171]
s_waitcnt lgkmcnt(6)
s_add_u32 s85, s100, 8192
buffer_load_dwordx4 a[132:135], v13, s[16:19], s85 offen sc1
v_mfma_f32_16x16x32_bf16 v[172:175], v[52:55], a[140:143], v[172:175]
s_waitcnt lgkmcnt(5)
s_add_u32 s32, s9, 0
v_mfma_f32_16x16x32_bf16 v[176:179], v[56:59], a[140:143], v[176:179]
s_waitcnt lgkmcnt(4)
ds_write_b128 v89, v[136:139] offset:2048
v_mfma_f32_16x16x32_bf16 v[180:183], v[60:63], a[140:143], v[180:183]
s_waitcnt lgkmcnt(4)
s_add_u32 s33, s9, 1
v_mfma_f32_16x16x32_bf16 v[184:187], v[64:67], a[140:143], v[184:187]
s_waitcnt vmcnt(9)
s_add_u32 s34, s9, 4
v_mfma_f32_16x16x32_bf16 v[148:151], a[20:23], a[88:91], v[148:151]
s_add_u32 s84, s100, 4096
buffer_load_dwordx4 a[80:83], v12, s[16:19], s84 offen sc1
v_mfma_f32_16x16x32_bf16 v[152:155], a[24:27], a[88:91], v[152:155]
ds_write_b128 v89, v[140:143] offset:3072
v_mfma_f32_16x16x32_bf16 v[156:159], a[28:31], a[88:91], v[156:159]
s_add_u32 s35, s9, 5
v_mfma_f32_16x16x32_bf16 v[160:163], a[32:35], a[88:91], v[160:163]
ds_write_b128 v89, v[144:147] offset:4096
v_mfma_f32_16x16x32_bf16 v[164:167], a[36:39], a[88:91], v[164:167]
s_waitcnt vmcnt(9)
s_add_u32 s48, s9, 7
v_mfma_f32_16x16x32_bf16 v[128:131], a[0:3], a[68:71], 0
s_add_u32 s87, s100, 135168
buffer_load_dwordx4 a[92:95], v15, s[16:19], s87 offen sc1
v_mfma_f32_16x16x32_bf16 v[132:135], a[4:7], a[68:71], 0
s_add_u32 s49, s9, 8
v_mfma_f32_16x16x32_bf16 v[136:139], a[8:11], a[68:71], 0
s_add_u32 s50, s9, 11
v_mfma_f32_16x16x32_bf16 v[140:143], a[12:15], a[68:71], 0
s_add_u32 s51, s9, 12
v_mfma_f32_16x16x32_bf16 v[144:147], a[16:19], a[68:71], 0
s_waitcnt vmcnt(9) lgkmcnt(0)
v_mfma_f32_16x16x32_bf16 v[68:71], a[116:119], a[144:147], v[68:71]
s_add_u32 s86, s100, 131072
s_barrier
buffer_load_dwordx4 a[72:75], v14, s[16:19], s86 offen sc1
v_mfma_f32_16x16x32_bf16 v[72:75], a[120:123], a[144:147], v[72:75]
s_add_u32 s64, s9, 2
v_mfma_f32_16x16x32_bf16 v[76:79], a[124:127], a[144:147], v[76:79]
ds_read_b128 v[28:31], v88 offset:0
ds_read_b128 v[32:35], v88 offset:1024
ds_read_b128 v[36:39], v88 offset:2048
v_mfma_f32_16x16x32_bf16 v[80:83], a[160:163], a[144:147], v[80:83]
s_add_u32 s65, s9, 6
ds_read_b128 v[40:43], v88 offset:3072
ds_read_b128 v[44:47], v88 offset:4096
v_mfma_f32_16x16x32_bf16 v[84:87], a[164:167], a[144:147], v[84:87]
s_waitcnt vmcnt(9)
s_add_u32 s4, s9, 3
v_mfma_f32_16x16x32_bf16 v[168:171], a[40:43], a[156:159], v[168:171]
s_add_u32 s85, s100, 12288
buffer_load_dwordx4 a[148:151], v13, s[16:19], s85 offen sc1
v_mfma_f32_16x16x32_bf16 v[172:175], a[44:47], a[156:159], v[172:175]
s_add_u32 s5, s9, 9
v_mfma_f32_16x16x32_bf16 v[176:179], a[48:51], a[156:159], v[176:179]
s_add_u32 s13, s9, 13
v_mfma_f32_16x16x32_bf16 v[180:183], a[52:55], a[156:159], v[180:183]
s_add_u32 s71, s9, 10
v_mfma_f32_16x16x32_bf16 v[184:187], a[56:59], a[156:159], v[184:187]
s_waitcnt vmcnt(9) lgkmcnt(4)
v_add_f32 v68, v68, v28
v_add_f32 v69, v69, v29
v_add_f32 v70, v70, v30
v_mfma_f32_16x16x32_bf16 v[148:151], v[48:51], a[136:139], v[148:151]
s_add_u32 s84, s100, 8192
buffer_load_dwordx4 a[128:131], v12, s[16:19], s84 offen sc1
v_add_f32 v71, v71, v31
v_mfma_f32_16x16x32_bf16 v[152:155], v[52:55], a[136:139], v[152:155]
s_waitcnt lgkmcnt(3)
v_add_f32 v72, v72, v32
v_add_f32 v73, v73, v33
v_add_f32 v74, v74, v34
v_mfma_f32_16x16x32_bf16 v[156:159], v[56:59], a[136:139], v[156:159]
s_waitcnt lgkmcnt(2)
v_add_f32 v75, v75, v35
v_add_f32 v76, v76, v36
v_add_f32 v77, v77, v37
v_mfma_f32_16x16x32_bf16 v[160:163], v[60:63], a[136:139], v[160:163]
s_waitcnt lgkmcnt(1)
v_add_f32 v78, v78, v38
v_add_f32 v79, v79, v39
v_add_f32 v80, v80, v40
v_mfma_f32_16x16x32_bf16 v[164:167], v[64:67], a[136:139], v[164:167]
s_waitcnt vmcnt(9)
v_add_f32 v81, v81, v41
v_add_f32 v82, v82, v42
v_add_f32 v83, v83, v43
v_mfma_f32_16x16x32_bf16 v[128:131], a[20:23], a[84:87], v[128:131]
s_waitcnt lgkmcnt(0)
s_add_u32 s87, s100, 139264
buffer_load_dwordx4 a[140:143], v15, s[16:19], s87 offen sc1
v_add_f32 v84, v84, v44
v_mfma_f32_16x16x32_bf16 v[132:135], a[24:27], a[84:87], v[132:135]
v_add_f32 v85, v85, v45
v_add_f32 v86, v86, v46
v_add_f32 v87, v87, v47
v_mfma_f32_16x16x32_bf16 v[136:139], a[28:31], a[84:87], v[136:139]
ds_read_b128 v[28:31], v88 offset:5120
ds_read_b128 v[32:35], v88 offset:6144
ds_read_b128 v[36:39], v88 offset:7168
v_mfma_f32_16x16x32_bf16 v[140:143], a[32:35], a[84:87], v[140:143]
ds_read_b128 v[40:43], v88 offset:8192
ds_read_b128 v[44:47], v88 offset:9216
v_mfma_f32_16x16x32_bf16 v[144:147], a[36:39], a[84:87], v[144:147]
s_waitcnt vmcnt(9)
v_mfma_f32_16x16x32_bf16 v[96:99], a[0:3], a[64:67], 0
s_add_u32 s86, s100, 135168
buffer_load_dwordx4 a[88:91], v14, s[16:19], s86 offen sc1
v_mfma_f32_16x16x32_bf16 v[100:103], a[4:7], a[64:67], 0
v_mfma_f32_16x16x32_bf16 v[104:107], a[8:11], a[64:67], 0
s_waitcnt lgkmcnt(4)
v_add_f32 v68, v68, v28
v_add_f32 v69, v69, v29
v_add_f32 v70, v70, v30
v_mfma_f32_16x16x32_bf16 v[108:111], a[12:15], a[64:67], 0
s_waitcnt lgkmcnt(3)
v_add_f32 v71, v71, v31
v_add_f32 v72, v72, v32
v_add_f32 v73, v73, v33
v_mfma_f32_16x16x32_bf16 v[188:191], a[16:19], a[64:67], 0
s_waitcnt vmcnt(9) lgkmcnt(2)
v_add_f32 v74, v74, v34
v_add_f32 v75, v75, v35
v_add_f32 v76, v76, v36
v_mfma_f32_16x16x32_bf16 v[168:171], a[180:183], a[76:79], v[168:171]
s_add_u32 s85, s100, 131072
buffer_load_dwordx4 a[68:71], v13, s[16:19], s85 offen sc1
v_add_f32 v77, v77, v37
v_mfma_f32_16x16x32_bf16 v[172:175], a[184:187], a[76:79], v[172:175]
s_waitcnt lgkmcnt(1)
v_add_f32 v78, v78, v38
v_add_f32 v79, v79, v39
v_add_f32 v80, v80, v40
v_mfma_f32_16x16x32_bf16 v[176:179], a[188:191], a[76:79], v[176:179]
v_add_f32 v81, v81, v41
v_add_f32 v82, v82, v42
v_add_f32 v83, v83, v43
v_mfma_f32_16x16x32_bf16 v[180:183], a[192:195], a[76:79], v[180:183]
s_waitcnt lgkmcnt(0)
v_add_f32 v84, v84, v44
v_add_f32 v85, v85, v45
v_add_f32 v86, v86, v46
v_mfma_f32_16x16x32_bf16 v[184:187], a[196:199], a[76:79], v[184:187]
s_waitcnt vmcnt(9)
s_lshr_b32 s89, s37, 5
v_add_f32 v87, v87, v47
v_mfma_f32_16x16x32_bf16 v[148:151], a[40:43], a[152:155], v[148:151]
s_add_u32 s84, s100, 12288
buffer_load_dwordx4 a[144:147], v12, s[16:19], s84 offen sc1
ds_read_b128 v[28:31], v88 offset:10240
v_mfma_f32_16x16x32_bf16 v[152:155], a[44:47], a[152:155], v[152:155]
ds_read_b128 v[32:35], v88 offset:11264
ds_read_b128 v[36:39], v88 offset:12288
ds_read_b128 v[40:43], v88 offset:13312
v_mfma_f32_16x16x32_bf16 v[156:159], a[48:51], a[152:155], v[156:159]
s_mul_i32 s89, s89, 40960
ds_read_b128 v[44:47], v88 offset:14336
v_mfma_f32_16x16x32_bf16 v[160:163], a[52:55], a[152:155], v[160:163]
s_and_b32 s90, s3, 1
v_mfma_f32_16x16x32_bf16 v[164:167], a[56:59], a[152:155], v[164:167]
s_waitcnt vmcnt(9)
s_lshl_b32 s90, s90, 10
s_add_u32 s89, s89, s90
s_add_u32 s89, s89, 7340032
s_lshl_b32 s90, s44, 11
v_mfma_f32_16x16x32_bf16 v[128:131], v[48:51], a[132:135], v[128:131]
s_add_u32 s87, s100, 143360
s_add_u32 s90, s90, s89
s_lshl_b32 s91, s45, 11
buffer_load_dwordx4 a[156:159], v15, s[16:19], s87 offen sc1
v_mfma_f32_16x16x32_bf16 v[132:135], v[52:55], a[132:135], v[132:135]
s_waitcnt lgkmcnt(4)
s_add_u32 s91, s91, s89
s_lshl_b32 s89, s36, 9
v_add_f32 v68, v68, v28
v_add_f32 v69, v69, v29
v_add_f32 v70, v70, v30
v_mfma_f32_16x16x32_bf16 v[136:139], v[56:59], a[132:135], v[136:139]
s_waitcnt lgkmcnt(3)
s_add_u32 s91, s91, s89
s_lshl_b32 s89, s37, 6
v_add_f32 v71, v71, v31
v_add_f32 v72, v72, v32
v_add_f32 v73, v73, v33
v_mfma_f32_16x16x32_bf16 v[140:143], v[60:63], a[132:135], v[140:143]
s_waitcnt lgkmcnt(2)
s_lshl_b32 s96, s41, 7
v_add_f32 v74, v74, v34
v_add_f32 v75, v75, v35
v_add_f32 v76, v76, v36
v_mfma_f32_16x16x32_bf16 v[144:147], v[64:67], a[132:135], v[144:147]
s_waitcnt vmcnt(9)
v_add_f32 v77, v77, v37
v_add_f32 v78, v78, v38
v_add_f32 v79, v79, v39
v_mfma_f32_16x16x32_bf16 v[96:99], a[20:23], a[80:83], v[96:99]
s_waitcnt lgkmcnt(1)
s_add_u32 s86, s100, 139264
buffer_load_dwordx4 a[136:139], v14, s[16:19], s86 offen sc1
v_add_f32 v80, v80, v40
v_mfma_f32_16x16x32_bf16 v[100:103], a[24:27], a[80:83], v[100:103]
v_add_f32 v81, v81, v41
v_add_f32 v82, v82, v42
v_add_f32 v83, v83, v43
v_mfma_f32_16x16x32_bf16 v[104:107], a[28:31], a[80:83], v[104:107]
s_waitcnt lgkmcnt(0)
v_add_f32 v84, v84, v44
v_add_f32 v85, v85, v45
v_add_f32 v86, v86, v46
v_mfma_f32_16x16x32_bf16 v[108:111], a[32:35], a[80:83], v[108:111]
s_add_u32 s89, s89, s96
v_add_f32 v87, v87, v47
v_mfma_f32_16x16x32_bf16 v[188:191], a[36:39], a[80:83], v[188:191]
s_waitcnt vmcnt(9)
buffer_store_dwordx4 v[68:71], v1, s[60:63], s57 offen offset:0 sc1
v_mfma_f32_16x16x32_bf16 v[168:171], a[200:203], a[92:95], v[168:171]
s_add_u32 s85, s100, 135168
buffer_load_dwordx4 a[84:87], v13, s[16:19], s85 offen sc1
v_mfma_f32_16x16x32_bf16 v[172:175], a[204:207], a[92:95], v[172:175]
s_add_u32 s89, s89, 65536
v_mfma_f32_16x16x32_bf16 v[176:179], a[208:211], a[92:95], v[176:179]
buffer_store_dwordx4 v[72:75], v1, s[60:63], s57 offen offset:1024 sc1
v_mfma_f32_16x16x32_bf16 v[180:183], a[212:215], a[92:95], v[180:183]
v_mfma_f32_16x16x32_bf16 v[184:187], a[216:219], a[92:95], v[184:187]
s_waitcnt vmcnt(11)
v_mfma_f32_16x16x32_bf16 v[148:151], a[180:183], a[72:75], v[148:151]
s_add_u32 s84, s100, 131072
buffer_load_dwordx4 a[64:67], v12, s[16:19], s84 offen sc1
v_mfma_f32_16x16x32_bf16 v[152:155], a[184:187], a[72:75], v[152:155]
buffer_store_dwordx4 v[76:79], v1, s[60:63], s57 offen offset:2048 sc1
v_mfma_f32_16x16x32_bf16 v[156:159], a[188:191], a[72:75], v[156:159]
v_mfma_f32_16x16x32_bf16 v[160:163], a[192:195], a[72:75], v[160:163]
v_mfma_f32_16x16x32_bf16 v[164:167], a[196:199], a[72:75], v[164:167]
s_waitcnt vmcnt(12)
buffer_store_dwordx4 v[80:83], v1, s[60:63], s57 offen offset:3072 sc1
v_mfma_f32_16x16x32_bf16 v[128:131], a[40:43], a[148:151], v[128:131]
s_add_u32 s87, s100, 65536
buffer_load_dwordx4 a[76:79], v15, s[16:19], s87 offen sc1
v_mfma_f32_16x16x32_bf16 v[132:135], a[44:47], a[148:151], v[132:135]
v_mfma_f32_16x16x32_bf16 v[136:139], a[48:51], a[148:151], v[136:139]
buffer_store_dwordx4 v[84:87], v1, s[60:63], s59 offen offset:0 sc1
v_mfma_f32_16x16x32_bf16 v[140:143], a[52:55], a[148:151], v[140:143]
v_mfma_f32_16x16x32_bf16 v[144:147], a[56:59], a[148:151], v[144:147]
s_waitcnt vmcnt(14)
v_mfma_f32_16x16x32_bf16 v[96:99], v[48:51], a[128:131], v[96:99]
s_add_u32 s86, s100, 143360
buffer_load_dwordx4 a[152:155], v14, s[16:19], s86 offen sc1
v_mfma_f32_16x16x32_bf16 v[100:103], v[52:55], a[128:131], v[100:103]
v_mfma_f32_16x16x32_bf16 v[104:107], v[56:59], a[128:131], v[104:107]
v_mfma_f32_16x16x32_bf16 v[108:111], v[60:63], a[128:131], v[108:111]
v_mfma_f32_16x16x32_bf16 v[188:191], v[64:67], a[128:131], v[188:191]
s_waitcnt vmcnt(14)
v_mfma_f32_16x16x32_bf16 v[168:171], a[220:223], a[140:143], v[168:171]
s_add_u32 s85, s100, 139264
buffer_load_dwordx4 a[132:135], v13, s[16:19], s85 offen sc1
ds_read_b128 v[48:51], v27 offset:5120
v_mfma_f32_16x16x32_bf16 v[172:175], a[224:227], a[140:143], v[172:175]
ds_read_b128 v[52:55], v27 offset:6144
ds_read_b128 v[56:59], v27 offset:7168
ds_read_b128 v[60:63], v27 offset:8192
v_mfma_f32_16x16x32_bf16 v[176:179], a[228:231], a[140:143], v[176:179]
ds_read_b128 v[64:67], v27 offset:9216
v_mfma_f32_16x16x32_bf16 v[180:183], a[232:235], a[140:143], v[180:183]
v_mfma_f32_16x16x32_bf16 v[184:187], a[236:239], a[140:143], v[184:187]
s_waitcnt vmcnt(14)
v_mfma_f32_16x16x32_bf16 v[148:151], a[200:203], a[88:91], v[148:151]
s_add_u32 s84, s100, 135168
buffer_load_dwordx4 a[80:83], v12, s[16:19], s84 offen sc1
v_mfma_f32_16x16x32_bf16 v[152:155], a[204:207], a[88:91], v[152:155]
v_mfma_f32_16x16x32_bf16 v[156:159], a[208:211], a[88:91], v[156:159]
v_mfma_f32_16x16x32_bf16 v[160:163], a[212:215], a[88:91], v[160:163]
v_mfma_f32_16x16x32_bf16 v[164:167], a[216:219], a[88:91], v[164:167]
s_waitcnt vmcnt(14)
v_mfma_f32_16x16x32_bf16 v[128:131], a[180:183], a[68:71], v[128:131]
s_add_u32 s87, s100, 69632
buffer_load_dwordx4 a[92:95], v15, s[16:19], s87 offen sc1
v_mfma_f32_16x16x32_bf16 v[132:135], a[184:187], a[68:71], v[132:135]
v_mfma_f32_16x16x32_bf16 v[136:139], a[188:191], a[68:71], v[136:139]
v_mfma_f32_16x16x32_bf16 v[140:143], a[192:195], a[68:71], v[140:143]
v_mfma_f32_16x16x32_bf16 v[144:147], a[196:199], a[68:71], v[144:147]
s_waitcnt vmcnt(14)
v_mfma_f32_16x16x32_bf16 v[96:99], a[40:43], a[144:147], v[96:99]
s_add_u32 s86, s100, 65536
buffer_load_dwordx4 a[72:75], v14, s[16:19], s86 offen sc1
v_mfma_f32_16x16x32_bf16 v[100:103], a[44:47], a[144:147], v[100:103]
v_mfma_f32_16x16x32_bf16 v[104:107], a[48:51], a[144:147], v[104:107]
v_mfma_f32_16x16x32_bf16 v[108:111], a[52:55], a[144:147], v[108:111]
v_mfma_f32_16x16x32_bf16 v[188:191], a[56:59], a[144:147], v[188:191]
s_waitcnt vmcnt(14) lgkmcnt(4)
v_mfma_f32_16x16x32_bf16 v[168:171], v[48:51], a[156:159], v[168:171]
s_waitcnt lgkmcnt(3)
s_add_u32 s85, s100, 143360
buffer_load_dwordx4 a[148:151], v13, s[16:19], s85 offen sc1
v_mfma_f32_16x16x32_bf16 v[172:175], v[52:55], a[156:159], v[172:175]
s_waitcnt lgkmcnt(2)
v_mfma_f32_16x16x32_bf16 v[176:179], v[56:59], a[156:159], v[176:179]
s_waitcnt lgkmcnt(1)
v_mfma_f32_16x16x32_bf16 v[180:183], v[60:63], a[156:159], v[180:183]
s_waitcnt lgkmcnt(0)
v_mfma_f32_16x16x32_bf16 v[184:187], v[64:67], a[156:159], v[184:187]
s_waitcnt vmcnt(14)
v_mfma_f32_16x16x32_bf16 v[148:151], a[220:223], a[136:139], v[148:151]
s_add_u32 s84, s100, 139264
buffer_load_dwordx4 a[128:131], v12, s[16:19], s84 offen sc1
v_mfma_f32_16x16x32_bf16 v[152:155], a[224:227], a[136:139], v[152:155]
v_mfma_f32_16x16x32_bf16 v[156:159], a[228:231], a[136:139], v[156:159]
v_mfma_f32_16x16x32_bf16 v[160:163], a[232:235], a[136:139], v[160:163]
v_mfma_f32_16x16x32_bf16 v[164:167], a[236:239], a[136:139], v[164:167]
s_waitcnt vmcnt(13)
v_mfma_f32_16x16x32_bf16 v[128:131], a[200:203], a[84:87], v[128:131]
s_add_u32 s87, s100, 73728
buffer_load_dwordx4 a[140:143], v15, s[16:19], s87 offen sc1
v_mfma_f32_16x16x32_bf16 v[132:135], a[204:207], a[84:87], v[132:135]
v_mfma_f32_16x16x32_bf16 v[136:139], a[208:211], a[84:87], v[136:139]
v_mfma_f32_16x16x32_bf16 v[140:143], a[212:215], a[84:87], v[140:143]
v_mfma_f32_16x16x32_bf16 v[144:147], a[216:219], a[84:87], v[144:147]
s_waitcnt vmcnt(12)
v_mfma_f32_16x16x32_bf16 v[96:99], a[180:183], a[64:67], v[96:99]
s_add_u32 s86, s100, 69632
buffer_load_dwordx4 a[88:91], v14, s[16:19], s86 offen sc1
v_mfma_f32_16x16x32_bf16 v[100:103], a[184:187], a[64:67], v[100:103]
v_mfma_f32_16x16x32_bf16 v[104:107], a[188:191], a[64:67], v[104:107]
v_mfma_f32_16x16x32_bf16 v[108:111], a[192:195], a[64:67], v[108:111]
v_mfma_f32_16x16x32_bf16 v[188:191], a[196:199], a[64:67], v[188:191]
s_waitcnt vmcnt(10)
v_mfma_f32_16x16x32_bf16 v[168:171], a[240:243], a[76:79], v[168:171]
s_add_u32 s85, s100, 65536
buffer_load_dwordx4 a[68:71], v13, s[16:19], s85 offen sc1
v_mfma_f32_16x16x32_bf16 v[172:175], a[244:247], a[76:79], v[172:175]
s_waitcnt vmcnt(10)
buffer_atomic_add v7, v6, s[60:63], s69 offen sc1
v_mfma_f32_16x16x32_bf16 v[176:179], a[248:251], a[76:79], v[176:179]
v_and_b32 v4, 3, v2
v_lshlrev_b32 v4, 7, v4
v_mfma_f32_16x16x32_bf16 v[180:183], a[252:255], a[76:79], v[180:183]
s_mov_b32 s6, 401408
v_mfma_f32_16x16x32_bf16 v[184:187], a[60:63], a[76:79], v[184:187]
s_waitcnt vmcnt(10)
s_cmp_eq_u32 s3, 0
s_cselect_b32 s52, s6, 268435456
s_cselect_b32 s39, 28, 0
v_mfma_f32_16x16x32_bf16 v[148:151], v[48:51], a[152:155], v[148:151]
s_add_u32 s84, s100, 143360
buffer_load_dwordx4 a[144:147], v12, s[16:19], s84 offen sc1
v_mfma_f32_16x16x32_bf16 v[152:155], v[52:55], a[152:155], v[152:155]
buffer_load_dword v0, v4, s[60:63], s52 offen offset:0 sc1
v_mfma_f32_16x16x32_bf16 v[156:159], v[56:59], a[152:155], v[156:159]
v_mfma_f32_16x16x32_bf16 v[160:163], v[60:63], a[152:155], v[160:163]
v_mfma_f32_16x16x32_bf16 v[164:167], v[64:67], a[152:155], v[164:167]
s_waitcnt vmcnt(11)
v_mfma_f32_16x16x32_bf16 v[128:131], a[220:223], a[132:135], v[128:131]
s_add_u32 s87, s100, 77824
buffer_load_dwordx4 a[156:159], v15, s[16:19], s87 offen sc1
v_mfma_f32_16x16x32_bf16 v[132:135], a[224:227], a[132:135], v[132:135]
v_mfma_f32_16x16x32_bf16 v[136:139], a[228:231], a[132:135], v[136:139]
v_mfma_f32_16x16x32_bf16 v[140:143], a[232:235], a[132:135], v[140:143]
v_mfma_f32_16x16x32_bf16 v[144:147], a[236:239], a[132:135], v[144:147]
s_waitcnt vmcnt(11)
v_mfma_f32_16x16x32_bf16 v[96:99], a[200:203], a[80:83], v[96:99]
s_add_u32 s86, s100, 73728
buffer_load_dwordx4 a[136:139], v14, s[16:19], s86 offen sc1
v_mfma_f32_16x16x32_bf16 v[100:103], a[204:207], a[80:83], v[100:103]
v_mfma_f32_16x16x32_bf16 v[104:107], a[208:211], a[80:83], v[104:107]
v_mfma_f32_16x16x32_bf16 v[108:111], a[212:215], a[80:83], v[108:111]
v_mfma_f32_16x16x32_bf16 v[188:191], a[216:219], a[80:83], v[188:191]
s_waitcnt vmcnt(11)
v_mfma_f32_16x16x32_bf16 v[168:171], v[192:195], a[92:95], v[168:171]
s_add_u32 s85, s100, 69632
buffer_load_dwordx4 a[84:87], v13, s[16:19], s85 offen sc1
v_mfma_f32_16x16x32_bf16 v[172:175], v[196:199], a[92:95], v[172:175]
s_add_u32 s98, s74, 151552
v_mfma_f32_16x16x32_bf16 v[176:179], v[200:203], a[92:95], v[176:179]
s_add_u32 s99, s75, 151552
v_add_u32 v93, s98, v9
v_add_u32 v94, s99, v9
v_mfma_f32_16x16x32_bf16 v[180:183], v[204:207], a[92:95], v[180:183]
ds_read_b128 v[28:31], v93 offset:0
ds_read_b128 v[32:35], v93 offset:16
v_mfma_f32_16x16x32_bf16 v[184:187], v[208:211], a[92:95], v[184:187]
s_waitcnt vmcnt(11)
ds_read_b128 v[36:39], v93 offset:128
ds_read_b128 v[40:43], v93 offset:144
v_mfma_f32_16x16x32_bf16 v[148:151], a[240:243], a[72:75], v[148:151]
s_add_u32 s84, s100, 65536
buffer_load_dwordx4 a[64:67], v12, s[16:19], s84 offen sc1
v_mfma_f32_16x16x32_bf16 v[152:155], a[244:247], a[72:75], v[152:155]
ds_read_b128 v[44:47], v94 offset:0
v_lshlrev_b32 v26, 3, v2
v_mfma_f32_16x16x32_bf16 v[156:159], a[248:251], a[72:75], v[156:159]
v_mfma_f32_16x16x32_bf16 v[160:163], a[252:255], a[72:75], v[160:163]
v_mfma_f32_16x16x32_bf16 v[164:167], a[60:63], a[72:75], v[164:167]
s_waitcnt vmcnt(11)
v_mfma_f32_16x16x32_bf16 v[128:131], v[48:51], a[148:151], v[128:131]
s_add_u32 s87, s100, 196608
buffer_load_dwordx4 a[76:79], v15, s[16:19], s87 offen sc1
v_mfma_f32_16x16x32_bf16 v[132:135], v[52:55], a[148:151], v[132:135]
v_mfma_f32_16x16x32_bf16 v[136:139], v[56:59], a[148:151], v[136:139]
v_mfma_f32_16x16x32_bf16 v[140:143], v[60:63], a[148:151], v[140:143]
v_mfma_f32_16x16x32_bf16 v[144:147], v[64:67], a[148:151], v[144:147]
s_waitcnt vmcnt(11)
v_mfma_f32_16x16x32_bf16 v[96:99], a[220:223], a[128:131], v[96:99]
s_add_u32 s86, s100, 77824
buffer_load_dwordx4 a[152:155], v14, s[16:19], s86 offen sc1
v_mfma_f32_16x16x32_bf16 v[100:103], a[224:227], a[128:131], v[100:103]
v_mfma_f32_16x16x32_bf16 v[104:107], a[228:231], a[128:131], v[104:107]
v_mfma_f32_16x16x32_bf16 v[108:111], a[232:235], a[128:131], v[108:111]
v_mfma_f32_16x16x32_bf16 v[188:191], a[236:239], a[128:131], v[188:191]
s_waitcnt vmcnt(11)
v_mfma_f32_16x16x32_bf16 v[168:171], v[212:215], a[140:143], v[168:171]
s_add_u32 s85, s100, 73728
buffer_load_dwordx4 a[132:135], v13, s[16:19], s85 offen sc1
v_mfma_f32_16x16x32_bf16 v[172:175], v[216:219], a[140:143], v[172:175]
v_mfma_f32_16x16x32_bf16 v[176:179], v[220:223], a[140:143], v[176:179]
v_mfma_f32_16x16x32_bf16 v[180:183], v[224:227], a[140:143], v[180:183]
v_mfma_f32_16x16x32_bf16 v[184:187], v[228:231], a[140:143], v[184:187]
s_waitcnt vmcnt(11)
v_mfma_f32_16x16x32_bf16 v[148:151], v[192:195], a[88:91], v[148:151]
s_add_u32 s84, s100, 69632
buffer_load_dwordx4 a[80:83], v12, s[16:19], s84 offen sc1
v_mfma_f32_16x16x32_bf16 v[152:155], v[196:199], a[88:91], v[152:155]
v_mfma_f32_16x16x32_bf16 v[156:159], v[200:203], a[88:91], v[156:159]
v_mfma_f32_16x16x32_bf16 v[160:163], v[204:207], a[88:91], v[160:163]
v_mfma_f32_16x16x32_bf16 v[164:167], v[208:211], a[88:91], v[164:167]
s_waitcnt vmcnt(11)
v_mfma_f32_16x16x32_bf16 v[128:131], a[240:243], a[68:71], v[128:131]
s_add_u32 s87, s100, 200704
buffer_load_dwordx4 a[92:95], v15, s[16:19], s87 offen sc1
v_mfma_f32_16x16x32_bf16 v[132:135], a[244:247], a[68:71], v[132:135]
v_mfma_f32_16x16x32_bf16 v[136:139], a[248:251], a[68:71], v[136:139]
v_mfma_f32_16x16x32_bf16 v[140:143], a[252:255], a[68:71], v[140:143]
v_mfma_f32_16x16x32_bf16 v[144:147], a[60:63], a[68:71], v[144:147]
s_waitcnt vmcnt(10)
v_mfma_f32_16x16x32_bf16 v[96:99], v[48:51], a[144:147], v[96:99]
s_add_u32 s86, s100, 196608
buffer_load_dwordx4 a[72:75], v14, s[16:19], s86 offen sc1
v_mfma_f32_16x16x32_bf16 v[100:103], v[52:55], a[144:147], v[100:103]
v_mfma_f32_16x16x32_bf16 v[104:107], v[56:59], a[144:147], v[104:107]
v_mfma_f32_16x16x32_bf16 v[108:111], v[60:63], a[144:147], v[108:111]
v_mfma_f32_16x16x32_bf16 v[188:191], v[64:67], a[144:147], v[188:191]
s_waitcnt vmcnt(9)
v_mfma_f32_16x16x32_bf16 v[168:171], v[232:235], a[156:159], v[168:171]
s_add_u32 s85, s100, 77824
buffer_load_dwordx4 a[148:151], v13, s[16:19], s85 offen sc1
ds_read_b128 v[48:51], v27 offset:10240
v_mfma_f32_16x16x32_bf16 v[172:175], v[236:239], a[156:159], v[172:175]
ds_read_b128 v[52:55], v27 offset:11264
ds_read_b128 v[56:59], v27 offset:12288
ds_read_b128 v[60:63], v27 offset:13312
v_mfma_f32_16x16x32_bf16 v[176:179], v[240:243], a[156:159], v[176:179]
ds_read_b128 v[64:67], v27 offset:14336
v_mfma_f32_16x16x32_bf16 v[180:183], v[244:247], a[156:159], v[180:183]
v_mfma_f32_16x16x32_bf16 v[184:187], v[248:251], a[156:159], v[184:187]
s_waitcnt vmcnt(9)
v_mfma_f32_16x16x32_bf16 v[148:151], v[212:215], a[136:139], v[148:151]
s_add_u32 s84, s100, 73728
buffer_load_dwordx4 a[128:131], v12, s[16:19], s84 offen sc1
v_mfma_f32_16x16x32_bf16 v[152:155], v[216:219], a[136:139], v[152:155]
v_mfma_f32_16x16x32_bf16 v[156:159], v[220:223], a[136:139], v[156:159]
v_mfma_f32_16x16x32_bf16 v[160:163], v[224:227], a[136:139], v[160:163]
v_mfma_f32_16x16x32_bf16 v[164:167], v[228:231], a[136:139], v[164:167]
s_waitcnt vmcnt(9)
v_mfma_f32_16x16x32_bf16 v[128:131], v[192:195], a[84:87], v[128:131]
s_add_u32 s87, s100, 204800
buffer_load_dwordx4 a[140:143], v15, s[16:19], s87 offen sc1
v_mfma_f32_16x16x32_bf16 v[132:135], v[196:199], a[84:87], v[132:135]
v_mfma_f32_16x16x32_bf16 v[136:139], v[200:203], a[84:87], v[136:139]
v_mfma_f32_16x16x32_bf16 v[140:143], v[204:207], a[84:87], v[140:143]
v_mfma_f32_16x16x32_bf16 v[144:147], v[208:211], a[84:87], v[144:147]
s_waitcnt vmcnt(9)
v_mfma_f32_16x16x32_bf16 v[96:99], a[240:243], a[64:67], v[96:99]
s_add_u32 s86, s100, 200704
buffer_load_dwordx4 a[88:91], v14, s[16:19], s86 offen sc1
v_mfma_f32_16x16x32_bf16 v[100:103], a[244:247], a[64:67], v[100:103]
v_mfma_f32_16x16x32_bf16 v[104:107], a[248:251], a[64:67], v[104:107]
v_mfma_f32_16x16x32_bf16 v[108:111], a[252:255], a[64:67], v[108:111]
v_mfma_f32_16x16x32_bf16 v[188:191], a[60:63], a[64:67], v[188:191]
s_waitcnt vmcnt(9) lgkmcnt(4)
v_mfma_f32_16x16x32_bf16 v[168:171], v[48:51], a[76:79], v[168:171]
s_waitcnt lgkmcnt(3)
s_add_u32 s85, s100, 196608
buffer_load_dwordx4 a[68:71], v13, s[16:19], s85 offen sc1
v_mfma_f32_16x16x32_bf16 v[172:175], v[52:55], a[76:79], v[172:175]
s_waitcnt lgkmcnt(2)
v_mfma_f32_16x16x32_bf16 v[176:179], v[56:59], a[76:79], v[176:179]
s_waitcnt lgkmcnt(1)
v_mfma_f32_16x16x32_bf16 v[180:183], v[60:63], a[76:79], v[180:183]
s_waitcnt lgkmcnt(0)
v_mfma_f32_16x16x32_bf16 v[184:187], v[64:67], a[76:79], v[184:187]
s_waitcnt vmcnt(9)
v_mfma_f32_16x16x32_bf16 v[148:151], v[232:235], a[152:155], v[148:151]
s_add_u32 s84, s100, 77824
buffer_load_dwordx4 a[144:147], v12, s[16:19], s84 offen sc1
v_mfma_f32_16x16x32_bf16 v[152:155], v[236:239], a[152:155], v[152:155]
v_mfma_f32_16x16x32_bf16 v[156:159], v[240:243], a[152:155], v[156:159]
v_mfma_f32_16x16x32_bf16 v[160:163], v[244:247], a[152:155], v[160:163]
v_mfma_f32_16x16x32_bf16 v[164:167], v[248:251], a[152:155], v[164:167]
s_waitcnt vmcnt(9)
v_mfma_f32_16x16x32_bf16 v[128:131], v[212:215], a[132:135], v[128:131]
s_add_u32 s87, s100, 208896
buffer_load_dwordx4 a[156:159], v15, s[16:19], s87 offen sc1
v_mfma_f32_16x16x32_bf16 v[132:135], v[216:219], a[132:135], v[132:135]
v_mfma_f32_16x16x32_bf16 v[136:139], v[220:223], a[132:135], v[136:139]
v_mfma_f32_16x16x32_bf16 v[140:143], v[224:227], a[132:135], v[140:143]
v_mfma_f32_16x16x32_bf16 v[144:147], v[228:231], a[132:135], v[144:147]
s_waitcnt vmcnt(9)
v_mfma_f32_16x16x32_bf16 v[96:99], v[192:195], a[80:83], v[96:99]
s_add_u32 s86, s100, 204800
buffer_load_dwordx4 a[136:139], v14, s[16:19], s86 offen sc1
v_mfma_f32_16x16x32_bf16 v[100:103], v[196:199], a[80:83], v[100:103]
v_mfma_f32_16x16x32_bf16 v[104:107], v[200:203], a[80:83], v[104:107]
v_mfma_f32_16x16x32_bf16 v[108:111], v[204:207], a[80:83], v[108:111]
v_mfma_f32_16x16x32_bf16 v[188:191], v[208:211], a[80:83], v[188:191]
s_waitcnt vmcnt(9)
v_mfma_f32_16x16x32_bf16 v[168:171], v[252:255], a[92:95], v[168:171]
s_add_u32 s85, s100, 200704
buffer_load_dwordx4 a[84:87], v13, s[16:19], s85 offen sc1
v_cmp_gt_u32 vcc, s39, v0
s_nop 1
s_cbranch_vccnz L_tl_spinu
L_tl_gou:
v_mfma_f32_16x16x32_bf16 v[172:175], v[112:115], a[92:95], v[172:175]
v_mov_b32 v92, 0
v_mfma_f32_16x16x32_bf16 v[176:179], v[116:119], a[92:95], v[176:179]
s_barrier
buffer_load_dword v95, v92, s[60:63], s70 offen sc1
v_mfma_f32_16x16x32_bf16 v[180:183], v[120:123], a[92:95], v[180:183]
v_mfma_f32_16x16x32_bf16 v[184:187], v[124:127], a[92:95], v[184:187]
s_waitcnt vmcnt(10)
v_lshlrev_b32 v192, 16, v16
v_and_b32 v193, 0xffff0000, v16
v_mfma_f32_16x16x32_bf16 v[148:151], v[48:51], a[72:75], v[148:151]
s_add_u32 s84, s100, 196608
buffer_load_dwordx4 a[64:67], v12, s[16:19], s84 offen sc1
v_mfma_f32_16x16x32_bf16 v[152:155], v[52:55], a[72:75], v[152:155]
v_lshlrev_b32 v194, 16, v17
v_and_b32 v195, 0xffff0000, v17
v_mfma_f32_16x16x32_bf16 v[156:159], v[56:59], a[72:75], v[156:159]
v_lshlrev_b32 v196, 16, v18
v_and_b32 v197, 0xffff0000, v18
v_mfma_f32_16x16x32_bf16 v[160:163], v[60:63], a[72:75], v[160:163]
v_lshlrev_b32 v198, 16, v19
v_and_b32 v199, 0xffff0000, v19
v_mfma_f32_16x16x32_bf16 v[164:167], v[64:67], a[72:75], v[164:167]
s_waitcnt vmcnt(10)
v_lshlrev_b32 v200, 16, v20
v_and_b32 v201, 0xffff0000, v20
v_mfma_f32_16x16x32_bf16 v[128:131], v[232:235], a[148:151], v[128:131]
s_add_u32 s86, s100, 208896
buffer_load_dwordx4 a[152:155], v14, s[16:19], s86 offen sc1
v_mfma_f32_16x16x32_bf16 v[132:135], v[236:239], a[148:151], v[132:135]
v_lshlrev_b32 v202, 16, v21
v_and_b32 v203, 0xffff0000, v21
v_mfma_f32_16x16x32_bf16 v[136:139], v[240:243], a[148:151], v[136:139]
v_lshlrev_b32 v204, 16, v22
v_and_b32 v205, 0xffff0000, v22
v_mfma_f32_16x16x32_bf16 v[140:143], v[244:247], a[148:151], v[140:143]
v_lshlrev_b32 v206, 16, v23
v_and_b32 v207, 0xffff0000, v23
v_mfma_f32_16x16x32_bf16 v[144:147], v[248:251], a[148:151], v[144:147]
s_waitcnt vmcnt(10)
v_lshlrev_b32 v208, 16, v24
v_and_b32 v209, 0xffff0000, v24
v_mfma_f32_16x16x32_bf16 v[96:99], v[212:215], a[128:131], v[96:99]
s_add_u32 s85, s100, 204800
buffer_load_dwordx4 a[132:135], v13, s[16:19], s85 offen sc1
v_mfma_f32_16x16x32_bf16 v[100:103], v[216:219], a[128:131], v[100:103]
v_lshlrev_b32 v210, 16, v25
v_and_b32 v211, 0xffff0000, v25
v_mfma_f32_16x16x32_bf16 v[104:107], v[220:223], a[128:131], v[104:107]
v_mfma_f32_16x16x32_bf16 v[108:111], v[224:227], a[128:131], v[108:111]
v_mfma_f32_16x16x32_bf16 v[188:191], v[228:231], a[128:131], v[188:191]
s_waitcnt vmcnt(10)
v_mfma_f32_16x16x32_bf16 v[168:171], a[96:99], a[140:143], v[168:171]
s_add_u32 s84, s100, 200704
buffer_load_dwordx4 a[80:83], v12, s[16:19], s84 offen sc1
v_mfma_f32_16x16x32_bf16 v[172:175], a[100:103], a[140:143], v[172:175]
s_add_u32 m0, s78, 0
v_mfma_f32_16x16x32_bf16 v[176:179], a[104:107], a[140:143], v[176:179]
s_add_u32 s8, s10, 0
buffer_load_dwordx4 v1, s[60:63], s8 offen offset:0 sc1 lds
v_mfma_f32_16x16x32_bf16 v[180:183], a[108:111], a[140:143], v[180:183]
v_mfma_f32_16x16x32_bf16 v[184:187], a[112:115], a[140:143], v[184:187]
s_waitcnt vmcnt(11)
v_mfma_f32_16x16x32_bf16 v[148:151], v[252:255], a[88:91], v[148:151]
s_add_u32 s85, s100, 208896
buffer_load_dwordx4 a[148:151], v13, s[16:19], s85 offen sc1
v_mfma_f32_16x16x32_bf16 v[152:155], v[112:115], a[88:91], v[152:155]
buffer_load_dwordx4 v1, s[60:63], s8 offen offset:1024 sc1 lds
v_mfma_f32_16x16x32_bf16 v[156:159], v[116:119], a[88:91], v[156:159]
v_mfma_f32_16x16x32_bf16 v[160:163], v[120:123], a[88:91], v[160:163]
v_mfma_f32_16x16x32_bf16 v[164:167], v[124:127], a[88:91], v[164:167]
s_waitcnt vmcnt(12)
buffer_load_dwordx4 v1, s[60:63], s8 offen offset:2048 sc1 lds
v_mfma_f32_16x16x32_bf16 v[128:131], v[48:51], a[68:71], v[128:131]
s_add_u32 s84, s100, 204800
buffer_load_dwordx4 a[128:131], v12, s[16:19], s84 offen sc1
v_mfma_f32_16x16x32_bf16 v[132:135], v[52:55], a[68:71], v[132:135]
v_mfma_f32_16x16x32_bf16 v[136:139], v[56:59], a[68:71], v[136:139]
buffer_load_dwordx4 v1, s[60:63], s8 offen offset:3072 sc1 lds
v_mfma_f32_16x16x32_bf16 v[140:143], v[60:63], a[68:71], v[140:143]
v_mfma_f32_16x16x32_bf16 v[144:147], v[64:67], a[68:71], v[144:147]
s_waitcnt vmcnt(14)
v_mfma_f32_16x16x32_bf16 v[96:99], v[232:235], a[144:147], v[96:99]
v_mfma_f32_16x16x32_bf16 v[100:103], v[236:239], a[144:147], v[100:103]
s_add_u32 m0, s78, 4096
v_mfma_f32_16x16x32_bf16 v[104:107], v[240:243], a[144:147], v[104:107]
s_add_u32 s8, s10, 4096
buffer_load_dwordx4 v1, s[60:63], s8 offen offset:0 sc1 lds
v_mfma_f32_16x16x32_bf16 v[108:111], v[244:247], a[144:147], v[108:111]
v_mfma_f32_16x16x32_bf16 v[188:191], v[248:251], a[144:147], v[188:191]
s_waitcnt vmcnt(14)
v_mfma_f32_16x16x32_bf16 v[168:171], a[116:119], a[156:159], v[168:171]
s_add_u32 s84, s100, 208896
buffer_load_dwordx4 a[144:147], v12, s[16:19], s84 offen sc1
v_mfma_f32_16x16x32_bf16 v[172:175], a[120:123], a[156:159], v[172:175]
buffer_load_dwordx4 v1, s[60:63], s8 offen offset:1024 sc1 lds
v_mfma_f32_16x16x32_bf16 v[176:179], a[124:127], a[156:159], v[176:179]
v_mfma_f32_16x16x32_bf16 v[180:183], a[160:163], a[156:159], v[180:183]
v_mfma_f32_16x16x32_bf16 v[184:187], a[164:167], a[156:159], v[184:187]
s_waitcnt vmcnt(15)
buffer_load_dwordx4 v1, s[60:63], s8 offen offset:2048 sc1 lds
v_mfma_f32_16x16x32_bf16 v[148:151], a[96:99], a[136:139], v[148:151]
v_mfma_f32_16x16x32_bf16 v[152:155], a[100:103], a[136:139], v[152:155]
v_mfma_f32_16x16x32_bf16 v[156:159], a[104:107], a[136:139], v[156:159]
v_mfma_f32_16x16x32_bf16 v[160:163], a[108:111], a[136:139], v[160:163]
v_mfma_f32_16x16x32_bf16 v[164:167], a[112:115], a[136:139], v[164:167]
s_waitcnt vmcnt(15)
v_mfma_f32_16x16x32_bf16 v[128:131], v[252:255], a[84:87], v[128:131]
v_mfma_f32_16x16x32_bf16 v[132:135], v[112:115], a[84:87], v[132:135]
v_mfma_f32_16x16x32_bf16 v[136:139], v[116:119], a[84:87], v[136:139]
v_mfma_f32_16x16x32_bf16 v[140:143], v[120:123], a[84:87], v[140:143]
v_mfma_f32_16x16x32_bf16 v[144:147], v[124:127], a[84:87], v[144:147]
s_waitcnt vmcnt(13)
v_mfma_f32_16x16x32_bf16 v[96:99], v[48:51], a[64:67], v[96:99]
v_mfma_f32_16x16x32_bf16 v[100:103], v[52:55], a[64:67], v[100:103]
v_mfma_f32_16x16x32_bf16 v[104:107], v[56:59], a[64:67], v[104:107]
v_mfma_f32_16x16x32_bf16 v[108:111], v[60:63], a[64:67], v[108:111]
v_mfma_f32_16x16x32_bf16 v[188:191], v[64:67], a[64:67], v[188:191]
s_waitcnt vmcnt(12)
v_mfma_f32_16x16x32_bf16 v[148:151], a[116:119], a[152:155], v[148:151]
buffer_load_dwordx4 v[68:71], v1, s[60:63], s58 offen offset:0 sc1
ds_write_b128 v91, v[168:171] offset:0
v_mfma_f32_16x16x32_bf16 v[152:155], a[120:123], a[152:155], v[152:155]
ds_read_b128 v[48:51], v93 offset:5120
ds_read_b128 v[52:55], v93 offset:5136
ds_read_b128 v[56:59], v93 offset:5248
v_mfma_f32_16x16x32_bf16 v[156:159], a[124:127], a[152:155], v[156:159]
ds_read_b128 v[60:63], v93 offset:5264
ds_read_b128 v[64:67], v94 offset:5120
v_mfma_f32_16x16x32_bf16 v[160:163], a[160:163], a[152:155], v[160:163]
buffer_load_dwordx4 v[72:75], v1, s[60:63], s58 offen offset:1024 sc1
v_mfma_f32_16x16x32_bf16 v[164:167], a[164:167], a[152:155], v[164:167]
s_waitcnt vmcnt(13)
ds_write_b128 v91, v[172:175] offset:1024
v_mfma_f32_16x16x32_bf16 v[128:131], a[96:99], a[132:135], v[128:131]
v_mfma_f32_16x16x32_bf16 v[132:135], a[100:103], a[132:135], v[132:135]
buffer_load_dwordx4 v[76:79], v1, s[60:63], s58 offen offset:2048 sc1
v_mfma_f32_16x16x32_bf16 v[136:139], a[104:107], a[132:135], v[136:139]
ds_write_b128 v91, v[176:179] offset:2048
v_mfma_f32_16x16x32_bf16 v[140:143], a[108:111], a[132:135], v[140:143]
v_mfma_f32_16x16x32_bf16 v[144:147], a[112:115], a[132:135], v[144:147]
s_waitcnt vmcnt(13)
buffer_load_dwordx4 v[80:83], v1, s[60:63], s58 offen offset:3072 sc1
v_mfma_f32_16x16x32_bf16 v[96:99], v[252:255], a[80:83], v[96:99]
ds_write_b128 v91, v[180:183] offset:3072
v_mfma_f32_16x16x32_bf16 v[100:103], v[112:115], a[80:83], v[100:103]
v_mfma_f32_16x16x32_bf16 v[104:107], v[116:119], a[80:83], v[104:107]
buffer_load_dwordx4 v[84:87], v1, s[60:63], s68 offen offset:0 sc1
v_mfma_f32_16x16x32_bf16 v[108:111], v[120:123], a[80:83], v[108:111]
ds_write_b128 v91, v[184:187] offset:4096
v_mfma_f32_16x16x32_bf16 v[188:191], v[124:127], a[80:83], v[188:191]
s_waitcnt vmcnt(13)
v_mfma_f32_16x16x32_bf16 v[128:131], a[116:119], a[148:151], v[128:131]
ds_write_b128 v90, v[148:151] offset:0
v_mfma_f32_16x16x32_bf16 v[132:135], a[120:123], a[148:151], v[132:135]
v_mfma_f32_16x16x32_bf16 v[136:139], a[124:127], a[148:151], v[136:139]
ds_write_b128 v90, v[152:155] offset:1024
v_mfma_f32_16x16x32_bf16 v[140:143], a[160:163], a[148:151], v[140:143]
v_mfma_f32_16x16x32_bf16 v[144:147], a[164:167], a[148:151], v[144:147]
s_waitcnt vmcnt(10)
ds_write_b128 v90, v[156:159] offset:2048
v_mfma_f32_16x16x32_bf16 v[96:99], a[96:99], a[128:131], v[96:99]
v_mfma_f32_16x16x32_bf16 v[100:103], a[100:103], a[128:131], v[100:103]
ds_write_b128 v90, v[160:163] offset:3072
v_mfma_f32_16x16x32_bf16 v[104:107], a[104:107], a[128:131], v[104:107]
v_mfma_f32_16x16x32_bf16 v[108:111], a[108:111], a[128:131], v[108:111]
ds_write_b128 v90, v[164:167] offset:4096
v_mfma_f32_16x16x32_bf16 v[188:191], a[112:115], a[128:131], v[188:191]
s_waitcnt vmcnt(7)
v_mfma_f32_16x16x32_bf16 v[96:99], a[116:119], a[144:147], v[96:99]
ds_write_b128 v89, v[128:131] offset:0
v_mfma_f32_16x16x32_bf16 v[100:103], a[120:123], a[144:147], v[100:103]
ds_write_b128 v89, v[132:135] offset:1024
v_mfma_f32_16x16x32_bf16 v[104:107], a[124:127], a[144:147], v[104:107]
ds_write_b128 v89, v[136:139] offset:2048
v_mfma_f32_16x16x32_bf16 v[108:111], a[160:163], a[144:147], v[108:111]
ds_write_b128 v89, v[140:143] offset:3072
v_mfma_f32_16x16x32_bf16 v[188:191], a[164:167], a[144:147], v[188:191]
ds_write_b128 v89, v[144:147] offset:4096
s_waitcnt lgkmcnt(0)
s_barrier
ds_read_b128 v[128:131], v88 offset:0
ds_read_b128 v[132:135], v88 offset:1024
ds_read_b128 v[136:139], v88 offset:2048
ds_read_b128 v[140:143], v88 offset:3072
ds_read_b128 v[144:147], v88 offset:4096
ds_read_b128 v[148:151], v88 offset:5120
ds_read_b128 v[152:155], v88 offset:6144
ds_read_b128 v[156:159], v88 offset:7168
ds_read_b128 v[160:163], v88 offset:8192
ds_read_b128 v[164:167], v88 offset:9216
ds_read_b128 v[168:171], v88 offset:10240
ds_read_b128 v[172:175], v88 offset:11264
ds_read_b128 v[176:179], v88 offset:12288
ds_read_b128 v[180:183], v88 offset:13312
ds_read_b128 v[184:187], v88 offset:14336
s_add_u32 m0, s78, 28672
s_add_u32 s8, s11, 0
buffer_load_dwordx4 v1, s[60:63], s8 offen offset:0 sc1 lds
buffer_load_dwordx4 v1, s[60:63], s8 offen offset:1024 sc1 lds
buffer_load_dwordx4 v1, s[60:63], s8 offen offset:2048 sc1 lds
buffer_load_dwordx4 v1, s[60:63], s8 offen offset:3072 sc1 lds
s_add_u32 m0, s78, 32768
s_add_u32 s8, s11, 4096
buffer_load_dwordx4 v1, s[60:63], s8 offen offset:0 sc1 lds
buffer_load_dwordx4 v1, s[60:63], s8 offen offset:1024 sc1 lds
buffer_load_dwordx4 v1, s[60:63], s8 offen offset:2048 sc1 lds
v_cmp_gt_u32 vcc, 4, v95
s_nop 1
s_cbranch_vccnz L_tl_spinx
L_tl_gox:
s_waitcnt lgkmcnt(9)
v_pk_add_f32 v[128:129], v[128:129], v[148:149]
v_pk_add_f32 v[130:131], v[130:131], v[150:151]
s_waitcnt lgkmcnt(8)
v_pk_add_f32 v[132:133], v[132:133], v[152:153]
v_pk_add_f32 v[134:135], v[134:135], v[154:155]
s_waitcnt lgkmcnt(7)
v_pk_add_f32 v[136:137], v[136:137], v[156:157]
v_pk_add_f32 v[138:139], v[138:139], v[158:159]
s_waitcnt lgkmcnt(6)
v_pk_add_f32 v[140:141], v[140:141], v[160:161]
v_pk_add_f32 v[142:143], v[142:143], v[162:163]
s_waitcnt lgkmcnt(5)
v_pk_add_f32 v[144:145], v[144:145], v[164:165]
v_pk_add_f32 v[146:147], v[146:147], v[166:167]
s_waitcnt vmcnt(11) lgkmcnt(4)
v_pk_add_f32 v[168:169], v[168:169], v[68:69]
v_pk_add_f32 v[170:171], v[170:171], v[70:71]
s_waitcnt vmcnt(10) lgkmcnt(3)
v_pk_add_f32 v[172:173], v[172:173], v[72:73]
v_pk_add_f32 v[174:175], v[174:175], v[74:75]
s_waitcnt vmcnt(9) lgkmcnt(2)
v_pk_add_f32 v[176:177], v[176:177], v[76:77]
v_pk_add_f32 v[178:179], v[178:179], v[78:79]
s_waitcnt vmcnt(8) lgkmcnt(1)
v_pk_add_f32 v[180:181], v[180:181], v[80:81]
v_pk_add_f32 v[182:183], v[182:183], v[82:83]
s_waitcnt vmcnt(7) lgkmcnt(0)
v_pk_add_f32 v[184:185], v[184:185], v[84:85]
v_pk_add_f32 v[186:187], v[186:187], v[86:87]
v_pk_add_f32 v[128:129], v[128:129], v[168:169]
v_pk_add_f32 v[130:131], v[130:131], v[170:171]
v_pk_add_f32 v[132:133], v[132:133], v[172:173]
v_pk_add_f32 v[134:135], v[134:135], v[174:175]
v_pk_add_f32 v[136:137], v[136:137], v[176:177]
v_pk_add_f32 v[138:139], v[138:139], v[178:179]
v_pk_add_f32 v[140:141], v[140:141], v[180:181]
v_pk_add_f32 v[142:143], v[142:143], v[182:183]
v_pk_add_f32 v[144:145], v[144:145], v[184:185]
v_pk_add_f32 v[146:147], v[146:147], v[186:187]
v_pk_add_f32 v[96:97], v[96:97], v[128:129]
v_pk_add_f32 v[98:99], v[98:99], v[130:131]
v_pk_add_f32 v[100:101], v[100:101], v[132:133]
v_pk_add_f32 v[102:103], v[102:103], v[134:135]
v_pk_add_f32 v[104:105], v[104:105], v[136:137]
v_pk_add_f32 v[106:107], v[106:107], v[138:139]
v_pk_add_f32 v[108:109], v[108:109], v[140:141]
v_pk_add_f32 v[110:111], v[110:111], v[142:143]
v_pk_add_f32 v[188:189], v[188:189], v[144:145]
v_pk_add_f32 v[190:191], v[190:191], v[146:147]
v_pk_fma_f32 v[192:193], v[96:97], v[28:29], v[192:193]
v_pk_fma_f32 v[194:195], v[98:99], v[30:31], v[194:195]
v_pk_fma_f32 v[196:197], v[100:101], v[32:33], v[196:197]
v_pk_fma_f32 v[198:199], v[102:103], v[34:35], v[198:199]
v_pk_fma_f32 v[200:201], v[104:105], v[36:37], v[200:201]
v_pk_fma_f32 v[202:203], v[106:107], v[38:39], v[202:203]
v_pk_fma_f32 v[204:205], v[108:109], v[40:41], v[204:205]
v_pk_fma_f32 v[206:207], v[110:111], v[42:43], v[206:207]
v_pk_fma_f32 v[208:209], v[188:189], v[44:45], v[208:209]
v_pk_fma_f32 v[210:211], v[190:191], v[46:47], v[210:211]
v_pk_mul_f32 v[96:97], v[192:193], v[48:49]
v_pk_mul_f32 v[98:99], v[194:195], v[50:51]
v_pk_mul_f32 v[100:101], v[196:197], v[52:53]
v_pk_mul_f32 v[102:103], v[198:199], v[54:55]
v_pk_mul_f32 v[104:105], v[200:201], v[56:57]
v_pk_mul_f32 v[106:107], v[202:203], v[58:59]
v_pk_mul_f32 v[108:109], v[204:205], v[60:61]
v_pk_mul_f32 v[110:111], v[206:207], v[62:63]
v_pk_mul_f32 v[188:189], v[208:209], v[64:65]
v_pk_mul_f32 v[190:191], v[210:211], v[66:67]
v_cvt_pk_bf16_f32 v128, v96, v97
v_cvt_pk_bf16_f32 v129, v98, v99
v_cvt_pk_bf16_f32 v130, v100, v101
v_cvt_pk_bf16_f32 v131, v102, v103
v_cvt_pk_bf16_f32 v132, v104, v105
v_cvt_pk_bf16_f32 v133, v106, v107
v_cvt_pk_bf16_f32 v134, v108, v109
v_cvt_pk_bf16_f32 v135, v110, v111
v_cvt_pk_bf16_f32 v136, v188, v189
v_cvt_pk_bf16_f32 v137, v190, v191
buffer_store_dwordx4 v[128:131], v1, s[60:63], s90 offen sc1
buffer_store_dwordx4 v[132:135], v1, s[60:63], s90 offen offset:2048 sc1
buffer_store_dwordx2 v[136:137], v26, s[60:63], s91 offen sc1
v_pk_add_f32 v[28:29], v[192:193], v[194:195]
v_pk_add_f32 v[28:29], v[28:29], v[196:197]
v_pk_add_f32 v[28:29], v[28:29], v[198:199]
v_pk_add_f32 v[28:29], v[28:29], v[200:201]
v_pk_add_f32 v[28:29], v[28:29], v[202:203]
v_pk_add_f32 v[28:29], v[28:29], v[204:205]
v_pk_add_f32 v[28:29], v[28:29], v[206:207]
v_pk_add_f32 v[28:29], v[28:29], v[208:209]
v_pk_add_f32 v[28:29], v[28:29], v[210:211]
v_add_f32 v28, v28, v29
v_mov_b32 v31, v28
s_nop 1
v_permlane16_swap_b32 v28, v31
v_add_f32 v28, v28, v31
v_mov_b32 v31, v28
s_nop 1
v_permlane32_swap_b32 v28, v31
v_add_f32 v28, v28, v31
v_mul_f32 v28, 0x3c4ccccd, v28
v_pk_add_f32 v[48:49], v[192:193], v[28:29] op_sel_hi:[1,0] neg_lo:[0,1] neg_hi:[0,1]
v_pk_add_f32 v[50:51], v[194:195], v[28:29] op_sel_hi:[1,0] neg_lo:[0,1] neg_hi:[0,1]
v_pk_add_f32 v[52:53], v[196:197], v[28:29] op_sel_hi:[1,0] neg_lo:[0,1] neg_hi:[0,1]
v_pk_add_f32 v[54:55], v[198:199], v[28:29] op_sel_hi:[1,0] neg_lo:[0,1] neg_hi:[0,1]
v_pk_add_f32 v[56:57], v[200:201], v[28:29] op_sel_hi:[1,0] neg_lo:[0,1] neg_hi:[0,1]
v_pk_add_f32 v[58:59], v[202:203], v[28:29] op_sel_hi:[1,0] neg_lo:[0,1] neg_hi:[0,1]
v_pk_add_f32 v[60:61], v[204:205], v[28:29] op_sel_hi:[1,0] neg_lo:[0,1] neg_hi:[0,1]
v_pk_add_f32 v[62:63], v[206:207], v[28:29] op_sel_hi:[1,0] neg_lo:[0,1] neg_hi:[0,1]
v_pk_add_f32 v[64:65], v[208:209], v[28:29] op_sel_hi:[1,0] neg_lo:[0,1] neg_hi:[0,1]
v_pk_add_f32 v[66:67], v[210:211], v[28:29] op_sel_hi:[1,0] neg_lo:[0,1] neg_hi:[0,1]
v_pk_mul_f32 v[32:33], v[48:49], v[48:49]
v_pk_fma_f32 v[32:33], v[50:51], v[50:51], v[32:33]
v_pk_fma_f32 v[32:33], v[52:53], v[52:53], v[32:33]
v_pk_fma_f32 v[32:33], v[54:55], v[54:55], v[32:33]
v_pk_fma_f32 v[32:33], v[56:57], v[56:57], v[32:33]
v_pk_fma_f32 v[32:33], v[58:59], v[58:59], v[32:33]
v_pk_fma_f32 v[32:33], v[60:61], v[60:61], v[32:33]
v_pk_fma_f32 v[32:33], v[62:63], v[62:63], v[32:33]
v_pk_fma_f32 v[32:33], v[64:65], v[64:65], v[32:33]
v_pk_fma_f32 v[32:33], v[66:67], v[66:67], v[32:33]
v_add_f32 v29, v32, v33
v_mov_b32 v31, v29
s_nop 1
v_permlane16_swap_b32 v29, v31
v_add_f32 v29, v29, v31
v_mov_b32 v31, v29
s_nop 1
v_permlane32_swap_b32 v29, v31
v_add_f32 v29, v29, v31
v_lshl_add_u32 v30, v10, 24, v26
v_and_b32 v4, 0, v4
buffer_store_dwordx2 v[28:29], v30, s[60:63], s89 offen sc1
s_add_u32 m0, s78, 57344
s_add_u32 s8, s12, 0
buffer_load_dwordx4 v1, s[60:63], s8 offen offset:0 sc1 lds
buffer_load_dwordx4 v1, s[60:63], s8 offen offset:1024 sc1 lds
buffer_load_dwordx4 v1, s[60:63], s8 offen offset:2048 sc1 lds
buffer_load_dwordx4 v1, s[60:63], s8 offen offset:3072 sc1 lds
s_add_u32 m0, s78, 61440
s_add_u32 s8, s12, 4096
buffer_load_dwordx4 v1, s[60:63], s8 offen offset:0 sc1 lds
buffer_load_dwordx4 v1, s[60:63], s8 offen offset:1024 sc1 lds
buffer_load_dwordx4 v1, s[60:63], s8 offen offset:2048 sc1 lds
v_cvt_pk_bf16_f32 v16, v192, v193
v_cvt_pk_bf16_f32 v17, v194, v195
v_cvt_pk_bf16_f32 v18, v196, v197
v_cvt_pk_bf16_f32 v19, v198, v199
v_cvt_pk_bf16_f32 v20, v200, v201
v_cvt_pk_bf16_f32 v21, v202, v203
v_cvt_pk_bf16_f32 v22, v204, v205
v_cvt_pk_bf16_f32 v23, v206, v207
v_cvt_pk_bf16_f32 v24, v208, v209
v_cvt_pk_bf16_f32 v25, v210, v211
s_cmp_eq_u32 s3, 0
s_cselect_b32 s39, 16, 0
s_waitcnt vmcnt(7)
s_barrier
buffer_atomic_add v7, v6, s[60:63], s55 offen offset:0 sc1
s_add_u32 m0, s78, 86016
s_add_u32 s8, s14, 0
buffer_load_dwordx4 v1, s[60:63], s8 offen offset:0 sc1 lds
buffer_load_dwordx4 v1, s[60:63], s8 offen offset:1024 sc1 lds
buffer_load_dwordx4 v1, s[60:63], s8 offen offset:2048 sc1 lds
buffer_load_dwordx4 v1, s[60:63], s8 offen offset:3072 sc1 lds
s_add_u32 m0, s78, 90112
s_add_u32 s8, s14, 4096
buffer_load_dwordx4 v1, s[60:63], s8 offen offset:0 sc1 lds
buffer_load_dwordx4 v1, s[60:63], s8 offen offset:1024 sc1 lds
buffer_load_dwordx4 v1, s[60:63], s8 offen offset:2048 sc1 lds
s_add_u32 m0, s78, 114688
s_add_u32 s8, s15, 0
buffer_load_dwordx4 v1, s[60:63], s8 offen offset:0 sc1 lds
buffer_load_dwordx4 v1, s[60:63], s8 offen offset:1024 sc1 lds
buffer_load_dwordx4 v1, s[60:63], s8 offen offset:2048 sc1 lds
buffer_load_dwordx4 v1, s[60:63], s8 offen offset:3072 sc1 lds
s_add_u32 m0, s78, 118784
s_add_u32 s8, s15, 4096
buffer_load_dwordx4 v1, s[60:63], s8 offen offset:0 sc1 lds
buffer_load_dwordx4 v1, s[60:63], s8 offen offset:1024 sc1 lds
buffer_load_dwordx4 v1, s[60:63], s8 offen offset:2048 sc1 lds
s_lshl_b32 s9, s3, 11
s_add_u32 m0, s9, 143360
s_mul_i32 s8, s80, 7168
s_add_u32 s8, s8, s9
s_add_u32 s8, s8, 524288
buffer_load_dwordx4 v1, s[60:63], s8 offen offset:0 sc1 lds
buffer_load_dwordx4 v1, s[60:63], s8 offen offset:1024 sc1 lds
s_mul_i32 s43, s32, 5120
buffer_load_dwordx4 a[0:3], v1, s[20:23], s43 offen offset:0 sc1
buffer_load_dwordx4 a[4:7], v1, s[20:23], s43 offen offset:1024 sc1
buffer_load_dwordx4 a[8:11], v1, s[20:23], s43 offen offset:2048 sc1
buffer_load_dwordx4 a[12:15], v1, s[20:23], s43 offen offset:3072 sc1
s_add_u32 s43, s43, 4096
buffer_load_dwordx4 a[16:19], v1, s[20:23], s43 offen offset:0 sc1
s_mul_i32 s43, s33, 5120
buffer_load_dwordx4 a[20:23], v1, s[20:23], s43 offen offset:0 sc1
buffer_load_dwordx4 a[24:27], v1, s[20:23], s43 offen offset:1024 sc1
buffer_load_dwordx4 a[28:31], v1, s[20:23], s43 offen offset:2048 sc1
buffer_load_dword v0, v4, s[60:63], s54 offen offset:0 sc1
buffer_load_dwordx4 a[32:35], v1, s[20:23], s43 offen offset:3072 sc1
s_add_u32 s43, s43, 4096
buffer_load_dwordx4 a[36:39], v1, s[20:23], s43 offen offset:0 sc1
s_mul_i32 s43, s34, 5120
buffer_load_dwordx4 a[40:43], v1, s[20:23], s43 offen offset:0 sc1
buffer_load_dwordx4 a[44:47], v1, s[20:23], s43 offen offset:1024 sc1
s_mul_i32 s42, s81, 40960
s_add_u32 s42, s42, 7340032
s_lshl_b32 s9, s81, 11
s_add_u32 s9, s9, 65536
s_add_u32 s6, s97, 0
s_sub_u32 s7, s6, 20
s_min_u32 s6, s6, s7
s_lshl_b32 s6, s6, 11
s_add_u32 s84, s42, s6
s_add_u32 s6, s97, 5
s_sub_u32 s7, s6, 20
s_min_u32 s6, s6, s7
s_lshl_b32 s6, s6, 11
s_add_u32 s85, s42, s6
s_add_u32 s6, s97, 10
s_sub_u32 s7, s6, 20
s_min_u32 s6, s6, s7
s_lshl_b32 s6, s6, 11
s_add_u32 s86, s42, s6
s_add_u32 s6, s97, 15
s_sub_u32 s7, s6, 20
s_min_u32 s6, s6, s7
s_lshl_b32 s6, s6, 11
s_add_u32 s87, s42, s6
v_lshlrev_b32 v27, 3, v11
v_lshl_add_u32 v27, v10, 4, v27
s_waitcnt vmcnt(13)
s_waitcnt vmcnt(4)
v_cmp_gt_u32 vcc, s39, v0
s_nop 1
s_cbranch_vccnz L_tl_spin1
L_tl_go1:
s_barrier
s_add_u32 s7, s84, 0
buffer_load_dwordx4 v[96:99], v1, s[60:63], s7 offen offset:0 sc1
buffer_load_dwordx4 v[100:103], v1, s[60:63], s7 offen offset:1024 sc1
s_add_u32 s7, s84, 2048
buffer_load_dwordx4 v[104:107], v1, s[60:63], s7 offen offset:0 sc1
buffer_load_dwordx4 v[108:111], v1, s[60:63], s7 offen offset:1024 sc1
s_add_u32 s7, s84, 4096
buffer_load_dwordx2 v[112:113], v26, s[60:63], s7 offen offset:0 sc1
buffer_load_dwordx2 v[114:115], v26, s[60:63], s7 offen offset:512 sc1
buffer_load_dwordx2 v[116:117], v26, s[60:63], s7 offen offset:1024 sc1
buffer_load_dwordx2 v[118:119], v26, s[60:63], s7 offen offset:1536 sc1
s_add_u32 s7, s84, 6144
buffer_load_dwordx4 v[120:123], v1, s[60:63], s7 offen offset:0 sc1
buffer_load_dwordx4 v[124:127], v1, s[60:63], s7 offen offset:1024 sc1
s_add_u32 s7, s84, 8192
buffer_load_dwordx4 v[128:131], v1, s[60:63], s7 offen offset:0 sc1
buffer_load_dwordx4 v[132:135], v1, s[60:63], s7 offen offset:1024 sc1
s_add_u32 s7, s85, 0
buffer_load_dwordx4 v[136:139], v1, s[60:63], s7 offen offset:0 sc1
buffer_load_dwordx4 v[140:143], v1, s[60:63], s7 offen offset:1024 sc1
v_add_u32 v4, 0xe000, v1
v_add_u32 v5, 0xe000, v4
ds_read_b128 a[240:243], v1 offset:0
ds_read_b128 a[244:247], v1 offset:7168
ds_read_b128 a[248:251], v1 offset:1024
ds_read_b128 a[252:255], v1 offset:8192
ds_read_b128 v[84:87], v1 offset:2048
s_waitcnt vmcnt(13) lgkmcnt(4)
v_mfma_f32_16x16x32_bf16 v[28:31], a[240:243], v[96:99], 0
s_waitcnt vmcnt(11) lgkmcnt(3)
s_add_u32 s7, s85, 2048
ds_read_b128 v[88:91], v1 offset:9216
v_mfma_f32_16x16x32_bf16 v[28:31], a[244:247], v[104:107], v[28:31]
buffer_load_dwordx4 v[144:147], v1, s[60:63], s7 offen offset:0 sc1
v_mfma_f32_16x16x32_bf16 v[32:35], a[240:243], v[100:103], 0
s_waitcnt vmcnt(11)
ds_read_b128 v[92:95], v1 offset:3072
v_mfma_f32_16x16x32_bf16 v[32:35], a[244:247], v[108:111], v[32:35]
s_waitcnt lgkmcnt(4)
v_mfma_f32_16x16x32_bf16 v[40:43], a[248:251], v[100:103], 0
s_waitcnt lgkmcnt(3)
ds_read_b128 a[240:243], v1 offset:10240
v_mfma_f32_16x16x32_bf16 v[40:43], a[252:255], v[108:111], v[40:43]
buffer_load_dwordx4 v[148:151], v1, s[60:63], s7 offen offset:1024 sc1
v_mfma_f32_16x16x32_bf16 v[36:39], a[248:251], v[96:99], 0
ds_read_b128 a[244:247], v1 offset:4096
v_mfma_f32_16x16x32_bf16 v[36:39], a[252:255], v[104:107], v[36:39]
s_waitcnt lgkmcnt(4)
v_mfma_f32_16x16x32_bf16 v[44:47], v[84:87], v[96:99], 0
s_waitcnt lgkmcnt(3)
ds_read_b128 a[248:251], v1 offset:11264
v_mfma_f32_16x16x32_bf16 v[44:47], v[88:91], v[104:107], v[44:47]
v_mfma_f32_16x16x32_bf16 v[48:51], v[84:87], v[100:103], 0
s_add_u32 s7, s85, 4096
ds_read_b128 a[252:255], v1 offset:5120
v_mfma_f32_16x16x32_bf16 v[48:51], v[88:91], v[108:111], v[48:51]
s_waitcnt lgkmcnt(4)
buffer_load_dwordx2 v[152:153], v26, s[60:63], s7 offen offset:0 sc1
v_mfma_f32_16x16x32_bf16 v[56:59], v[92:95], v[100:103], 0
s_waitcnt lgkmcnt(3)
ds_read_b128 v[84:87], v1 offset:12288
v_mfma_f32_16x16x32_bf16 v[56:59], a[240:243], v[108:111], v[56:59]
v_mfma_f32_16x16x32_bf16 v[52:55], v[92:95], v[96:99], 0
ds_read_b128 v[88:91], v1 offset:6144
v_mfma_f32_16x16x32_bf16 v[52:55], a[240:243], v[104:107], v[52:55]
s_waitcnt lgkmcnt(4)
buffer_load_dwordx2 v[154:155], v26, s[60:63], s7 offen offset:512 sc1
v_mfma_f32_16x16x32_bf16 v[60:63], a[244:247], v[96:99], 0
s_waitcnt lgkmcnt(3)
ds_read_b128 v[92:95], v1 offset:13312
v_mfma_f32_16x16x32_bf16 v[60:63], a[248:251], v[104:107], v[60:63]
v_mfma_f32_16x16x32_bf16 v[64:67], a[244:247], v[100:103], 0
ds_read_b128 a[240:243], v1 offset:14336
v_mfma_f32_16x16x32_bf16 v[64:67], a[248:251], v[108:111], v[64:67]
s_waitcnt lgkmcnt(4)
buffer_load_dwordx2 v[156:157], v26, s[60:63], s7 offen offset:1024 sc1
v_mfma_f32_16x16x32_bf16 v[72:75], a[252:255], v[100:103], 0
s_waitcnt lgkmcnt(3)
s_and_b32 s82, s80, 1
ds_read_b128 a[244:247], v1 offset:21504
v_mfma_f32_16x16x32_bf16 v[72:75], v[84:87], v[108:111], v[72:75]
v_mfma_f32_16x16x32_bf16 v[68:71], a[252:255], v[96:99], 0
s_mul_i32 s8, s80, 7
ds_read_b128 a[248:251], v1 offset:15360
v_mfma_f32_16x16x32_bf16 v[68:71], v[84:87], v[104:107], v[68:71]
s_waitcnt lgkmcnt(4)
buffer_load_dwordx2 v[158:159], v26, s[60:63], s7 offen offset:1536 sc1
v_mfma_f32_16x16x32_bf16 v[76:79], v[88:91], v[96:99], 0
s_waitcnt lgkmcnt(3)
s_add_u32 s83, s8, s82
ds_read_b128 a[252:255], v1 offset:22528
v_mfma_f32_16x16x32_bf16 v[76:79], v[92:95], v[104:107], v[76:79]
v_mfma_f32_16x16x32_bf16 v[80:83], v[88:91], v[100:103], 0
s_lshr_b32 s83, s83, 1
ds_read_b128 v[84:87], v1 offset:16384
v_mfma_f32_16x16x32_bf16 v[80:83], v[92:95], v[108:111], v[80:83]
s_waitcnt vmcnt(12) lgkmcnt(4)
v_mfma_f32_16x16x32_bf16 v[32:35], a[240:243], v[116:119], v[32:35]
s_waitcnt vmcnt(10) lgkmcnt(3)
s_add_u32 s7, s85, 6144
ds_read_b128 v[88:91], v1 offset:23552
v_mfma_f32_16x16x32_bf16 v[32:35], a[244:247], v[124:127], v[32:35]
buffer_load_dwordx4 v[160:163], v1, s[60:63], s7 offen offset:0 sc1
v_mfma_f32_16x16x32_bf16 v[28:31], a[244:247], v[120:123], v[28:31]
s_lshl_b32 s8, s82, 2
ds_read_b128 v[92:95], v1 offset:17408
v_mfma_f32_16x16x32_bf16 v[28:31], a[240:243], v[112:115], v[28:31]
s_waitcnt lgkmcnt(4)
v_mfma_f32_16x16x32_bf16 v[36:39], a[248:251], v[112:115], v[36:39]
s_waitcnt lgkmcnt(3)
s_add_u32 s88, s83, 3
ds_read_b128 a[240:243], v1 offset:24576
v_mfma_f32_16x16x32_bf16 v[36:39], a[252:255], v[120:123], v[36:39]
buffer_load_dwordx4 v[164:167], v1, s[60:63], s7 offen offset:1024 sc1
v_mfma_f32_16x16x32_bf16 v[40:43], a[252:255], v[124:127], v[40:43]
s_sub_u32 s88, s88, s8
ds_read_b128 a[244:247], v1 offset:18432
v_mfma_f32_16x16x32_bf16 v[40:43], a[248:251], v[116:119], v[40:43]
s_waitcnt lgkmcnt(4)
v_mfma_f32_16x16x32_bf16 v[48:51], v[84:87], v[116:119], v[48:51]
s_waitcnt lgkmcnt(3)
s_lshr_b32 s6, s81, 1
ds_read_b128 a[248:251], v1 offset:25600
v_mfma_f32_16x16x32_bf16 v[48:51], v[88:91], v[124:127], v[48:51]
v_mfma_f32_16x16x32_bf16 v[44:47], v[88:91], v[120:123], v[44:47]
s_add_u32 s7, s85, 8192
ds_read_b128 a[252:255], v1 offset:19456
v_mfma_f32_16x16x32_bf16 v[44:47], v[84:87], v[112:115], v[44:47]
s_waitcnt lgkmcnt(4)
buffer_load_dwordx4 v[168:171], v1, s[60:63], s7 offen offset:0 sc1
v_mfma_f32_16x16x32_bf16 v[52:55], v[92:95], v[112:115], v[52:55]
s_waitcnt lgkmcnt(3)
s_mul_i32 s6, s6, 221184
ds_read_b128 v[84:87], v1 offset:26624
v_mfma_f32_16x16x32_bf16 v[52:55], a[240:243], v[120:123], v[52:55]
v_mfma_f32_16x16x32_bf16 v[56:59], a[240:243], v[124:127], v[56:59]
s_and_b32 s8, s81, 1
ds_read_b128 v[88:91], v1 offset:20480
v_mfma_f32_16x16x32_bf16 v[56:59], v[92:95], v[116:119], v[56:59]
s_waitcnt lgkmcnt(4)
buffer_load_dwordx4 v[172:175], v1, s[60:63], s7 offen offset:1024 sc1
v_mfma_f32_16x16x32_bf16 v[64:67], a[244:247], v[116:119], v[64:67]
s_waitcnt lgkmcnt(3)
s_lshl_b32 s8, s8, 11
ds_read_b128 v[92:95], v1 offset:27648
v_mfma_f32_16x16x32_bf16 v[64:67], a[248:251], v[124:127], v[64:67]
v_mfma_f32_16x16x32_bf16 v[60:63], a[248:251], v[120:123], v[60:63]
s_add_u32 s6, s6, s8
ds_read_b128 a[240:243], v1 offset:28672
v_mfma_f32_16x16x32_bf16 v[60:63], a[244:247], v[112:115], v[60:63]
s_waitcnt lgkmcnt(4)
buffer_load_dwordx2 v[96:97], v27, s[60:63], s9 offen offset:0 sc1
v_mfma_f32_16x16x32_bf16 v[68:71], a[252:255], v[112:115], v[68:71]
s_waitcnt lgkmcnt(3)
s_add_u32 s6, s6, 26214400
ds_read_b128 a[244:247], v1 offset:35840
v_mfma_f32_16x16x32_bf16 v[68:71], v[84:87], v[120:123], v[68:71]
buffer_load_dwordx2 v[98:99], v27, s[60:63], s9 offen offset:128 sc1
v_mfma_f32_16x16x32_bf16 v[72:75], v[84:87], v[124:127], v[72:75]
s_add_u32 s8, s83, 0
ds_read_b128 a[248:251], v1 offset:29696
v_mfma_f32_16x16x32_bf16 v[72:75], a[252:255], v[116:119], v[72:75]
s_waitcnt lgkmcnt(4)
buffer_load_dwordx2 v[100:101], v27, s[60:63], s9 offen offset:1024 sc1
v_mfma_f32_16x16x32_bf16 v[80:83], v[88:91], v[116:119], v[80:83]
s_waitcnt lgkmcnt(3)
s_lshl_b32 s89, s8, 12
ds_read_b128 a[252:255], v1 offset:36864
v_mfma_f32_16x16x32_bf16 v[80:83], v[92:95], v[124:127], v[80:83]
buffer_load_dwordx2 v[102:103], v27, s[60:63], s9 offen offset:1152 sc1
v_mfma_f32_16x16x32_bf16 v[76:79], v[92:95], v[120:123], v[76:79]
s_add_u32 s89, s89, s6
ds_read_b128 v[84:87], v1 offset:30720
v_mfma_f32_16x16x32_bf16 v[76:79], v[88:91], v[112:115], v[76:79]
s_waitcnt vmcnt(17) lgkmcnt(4)
v_mfma_f32_16x16x32_bf16 v[28:31], a[240:243], v[128:131], v[28:31]
s_waitcnt vmcnt(15) lgkmcnt(3)
s_add_u32 s7, s86, 0
ds_read_b128 v[88:91], v1 offset:37888
v_mfma_f32_16x16x32_bf16 v[28:31], a[244:247], v[136:139], v[28:31]
s_waitcnt vmcnt(14)
buffer_load_dwordx4 v[176:179], v1, s[60:63], s7 offen offset:0 sc1
v_mfma_f32_16x16x32_bf16 v[32:35], a[244:247], v[140:143], v[32:35]
s_cmp_lt_u32 s8, 54
s_cselect_b32 s89, s89, 268435456
ds_read_b128 v[92:95], v1 offset:31744
v_mfma_f32_16x16x32_bf16 v[32:35], a[240:243], v[132:135], v[32:35]
s_waitcnt lgkmcnt(4)
v_mfma_f32_16x16x32_bf16 v[40:43], a[248:251], v[132:135], v[40:43]
s_waitcnt lgkmcnt(3)
s_add_u32 s8, s83, 1
ds_read_b128 a[240:243], v1 offset:38912
v_mfma_f32_16x16x32_bf16 v[40:43], a[252:255], v[140:143], v[40:43]
buffer_load_dwordx4 v[180:183], v1, s[60:63], s7 offen offset:1024 sc1
v_mfma_f32_16x16x32_bf16 v[36:39], a[252:255], v[136:139], v[36:39]
s_lshl_b32 s90, s8, 12
ds_read_b128 a[244:247], v1 offset:32768
v_mfma_f32_16x16x32_bf16 v[36:39], a[248:251], v[128:131], v[36:39]
s_waitcnt lgkmcnt(4)
v_mfma_f32_16x16x32_bf16 v[44:47], v[84:87], v[128:131], v[44:47]
s_waitcnt lgkmcnt(3)
s_add_u32 s90, s90, s6
ds_read_b128 a[248:251], v1 offset:39936
v_mfma_f32_16x16x32_bf16 v[44:47], v[88:91], v[136:139], v[44:47]
v_mfma_f32_16x16x32_bf16 v[48:51], v[88:91], v[140:143], v[48:51]
s_add_u32 s7, s86, 2048
ds_read_b128 a[252:255], v1 offset:33792
v_mfma_f32_16x16x32_bf16 v[48:51], v[84:87], v[132:135], v[48:51]
s_waitcnt lgkmcnt(4)
buffer_load_dwordx4 v[184:187], v1, s[60:63], s7 offen offset:0 sc1
v_mfma_f32_16x16x32_bf16 v[56:59], v[92:95], v[132:135], v[56:59]
s_waitcnt lgkmcnt(3)
s_cmp_lt_u32 s8, 54
s_cselect_b32 s90, s90, 268435456
ds_read_b128 v[84:87], v1 offset:40960
v_mfma_f32_16x16x32_bf16 v[56:59], a[240:243], v[140:143], v[56:59]
v_mfma_f32_16x16x32_bf16 v[52:55], a[240:243], v[136:139], v[52:55]
s_add_u32 s8, s83, 2
ds_read_b128 v[88:91], v1 offset:34816
v_mfma_f32_16x16x32_bf16 v[52:55], v[92:95], v[128:131], v[52:55]
s_waitcnt lgkmcnt(4)
buffer_load_dwordx4 v[188:191], v1, s[60:63], s7 offen offset:1024 sc1
v_mfma_f32_16x16x32_bf16 v[60:63], a[244:247], v[128:131], v[60:63]
s_waitcnt lgkmcnt(3)
s_lshl_b32 s91, s8, 12
ds_read_b128 v[92:95], v1 offset:41984
v_mfma_f32_16x16x32_bf16 v[60:63], a[248:251], v[136:139], v[60:63]
v_mfma_f32_16x16x32_bf16 v[64:67], a[248:251], v[140:143], v[64:67]
s_add_u32 s91, s91, s6
ds_read_b128 a[240:243], v1 offset:43008
v_mfma_f32_16x16x32_bf16 v[64:67], a[244:247], v[132:135], v[64:67]
s_waitcnt lgkmcnt(4)
v_mfma_f32_16x16x32_bf16 v[72:75], a[252:255], v[132:135], v[72:75]
s_waitcnt lgkmcnt(3)
s_add_u32 s7, s86, 4096
ds_read_b128 a[244:247], v1 offset:50176
v_mfma_f32_16x16x32_bf16 v[72:75], v[84:87], v[140:143], v[72:75]
buffer_load_dwordx2 v[192:193], v26, s[60:63], s7 offen offset:0 sc1
v_mfma_f32_16x16x32_bf16 v[68:71], v[84:87], v[136:139], v[68:71]
s_cmp_lt_u32 s8, 54
s_cselect_b32 s91, s91, 268435456
ds_read_b128 a[248:251], v1 offset:44032
v_mfma_f32_16x16x32_bf16 v[68:71], a[252:255], v[128:131], v[68:71]
s_waitcnt lgkmcnt(4)
v_mfma_f32_16x16x32_bf16 v[76:79], v[88:91], v[128:131], v[76:79]
s_waitcnt lgkmcnt(3)
s_mov_b32 s8, s88
ds_read_b128 a[252:255], v1 offset:51200
v_mfma_f32_16x16x32_bf16 v[76:79], v[92:95], v[136:139], v[76:79]
buffer_load_dwordx2 v[194:195], v26, s[60:63], s7 offen offset:512 sc1
v_mfma_f32_16x16x32_bf16 v[80:83], v[92:95], v[140:143], v[80:83]
s_lshl_b32 s82, s82, 9
ds_read_b128 v[84:87], v1 offset:45056
v_mfma_f32_16x16x32_bf16 v[80:83], v[88:91], v[132:135], v[80:83]
s_waitcnt vmcnt(18) lgkmcnt(4)
v_mfma_f32_16x16x32_bf16 v[32:35], a[240:243], v[148:151], v[32:35]
s_waitcnt vmcnt(14) lgkmcnt(3)
s_add_u32 s6, s6, s82
ds_read_b128 v[88:91], v1 offset:52224
v_mfma_f32_16x16x32_bf16 v[32:35], a[244:247], v[156:159], v[32:35]
buffer_load_dwordx2 v[196:197], v26, s[60:63], s7 offen offset:1024 sc1
v_mfma_f32_16x16x32_bf16 v[28:31], a[244:247], v[152:155], v[28:31]
s_lshl_b32 s96, s8, 12
ds_read_b128 v[92:95], v1 offset:46080
v_mfma_f32_16x16x32_bf16 v[28:31], a[240:243], v[144:147], v[28:31]
s_waitcnt lgkmcnt(4)
v_mfma_f32_16x16x32_bf16 v[36:39], a[248:251], v[144:147], v[36:39]
s_waitcnt lgkmcnt(3)
s_add_u32 s96, s96, s6
ds_read_b128 a[240:243], v1 offset:53248
v_mfma_f32_16x16x32_bf16 v[36:39], a[252:255], v[152:155], v[36:39]
buffer_load_dwordx2 v[198:199], v26, s[60:63], s7 offen offset:1536 sc1
v_mfma_f32_16x16x32_bf16 v[40:43], a[252:255], v[156:159], v[40:43]
s_cmp_lt_u32 s8, 54
s_cselect_b32 s96, s96, 268435456
ds_read_b128 a[244:247], v1 offset:47104
v_mfma_f32_16x16x32_bf16 v[40:43], a[248:251], v[148:151], v[40:43]
s_waitcnt lgkmcnt(4)
v_mfma_f32_16x16x32_bf16 v[48:51], v[84:87], v[148:151], v[48:51]
s_waitcnt lgkmcnt(3)
ds_read_b128 a[248:251], v1 offset:54272
v_mfma_f32_16x16x32_bf16 v[48:51], v[88:91], v[156:159], v[48:51]
v_mfma_f32_16x16x32_bf16 v[44:47], v[88:91], v[152:155], v[44:47]
s_add_u32 s7, s86, 6144
ds_read_b128 a[252:255], v1 offset:48128
v_mfma_f32_16x16x32_bf16 v[44:47], v[84:87], v[144:147], v[44:47]
s_waitcnt lgkmcnt(4)
buffer_load_dwordx4 v[200:203], v1, s[60:63], s7 offen offset:0 sc1
v_mfma_f32_16x16x32_bf16 v[52:55], v[92:95], v[144:147], v[52:55]
s_waitcnt lgkmcnt(3)
ds_read_b128 v[84:87], v1 offset:55296
v_mfma_f32_16x16x32_bf16 v[52:55], a[240:243], v[152:155], v[52:55]
v_mfma_f32_16x16x32_bf16 v[56:59], a[240:243], v[156:159], v[56:59]
ds_read_b128 v[88:91], v1 offset:49152
v_mfma_f32_16x16x32_bf16 v[56:59], v[92:95], v[148:151], v[56:59]
s_waitcnt lgkmcnt(4)
buffer_load_dwordx4 v[204:207], v1, s[60:63], s7 offen offset:1024 sc1
v_mfma_f32_16x16x32_bf16 v[64:67], a[244:247], v[148:151], v[64:67]
s_waitcnt lgkmcnt(3)
ds_read_b128 v[92:95], v1 offset:56320
v_mfma_f32_16x16x32_bf16 v[64:67], a[248:251], v[156:159], v[64:67]
v_mfma_f32_16x16x32_bf16 v[60:63], a[248:251], v[152:155], v[60:63]
ds_read_b128 a[240:243], v4 offset:0
v_mfma_f32_16x16x32_bf16 v[60:63], a[244:247], v[144:147], v[60:63]
s_waitcnt lgkmcnt(4)
v_mfma_f32_16x16x32_bf16 v[68:71], a[252:255], v[144:147], v[68:71]
s_waitcnt lgkmcnt(3)
s_add_u32 s7, s86, 8192
ds_read_b128 a[244:247], v4 offset:7168
v_mfma_f32_16x16x32_bf16 v[68:71], v[84:87], v[152:155], v[68:71]
buffer_load_dwordx4 v[208:211], v1, s[60:63], s7 offen offset:0 sc1
v_mfma_f32_16x16x32_bf16 v[72:75], v[84:87], v[156:159], v[72:75]
ds_read_b128 a[248:251], v4 offset:1024
v_mfma_f32_16x16x32_bf16 v[72:75], a[252:255], v[148:151], v[72:75]
s_waitcnt lgkmcnt(4)
v_mfma_f32_16x16x32_bf16 v[80:83], v[88:91], v[148:151], v[80:83]
s_waitcnt lgkmcnt(3)
ds_read_b128 a[252:255], v4 offset:8192
v_mfma_f32_16x16x32_bf16 v[80:83], v[92:95], v[156:159], v[80:83]
buffer_load_dwordx4 v[212:215], v1, s[60:63], s7 offen offset:1024 sc1
v_mfma_f32_16x16x32_bf16 v[76:79], v[92:95], v[152:155], v[76:79]
ds_read_b128 v[84:87], v4 offset:2048
v_mfma_f32_16x16x32_bf16 v[76:79], v[88:91], v[144:147], v[76:79]
s_waitcnt vmcnt(19) lgkmcnt(4)
v_mfma_f32_16x16x32_bf16 v[28:31], a[240:243], v[160:163], v[28:31]
s_waitcnt vmcnt(14) lgkmcnt(3)
ds_read_b128 v[88:91], v4 offset:9216
v_add_f32 v154, v96, v98
v_mfma_f32_16x16x32_bf16 v[28:31], a[244:247], v[168:171], v[28:31]
s_waitcnt vmcnt(12)
v_add_f32 v155, v100, v102
v_mov_b32 v152, v154
v_mfma_f32_16x16x32_bf16 v[32:35], a[244:247], v[172:175], v[32:35]
s_add_u32 s7, s87, 0
ds_read_b128 v[92:95], v4 offset:3072
v_mov_b32 v153, v155
v_mfma_f32_16x16x32_bf16 v[32:35], a[240:243], v[164:167], v[32:35]
s_waitcnt lgkmcnt(4)
buffer_load_dwordx4 v[216:219], v1, s[60:63], s7 offen offset:0 sc1
v_mfma_f32_16x16x32_bf16 v[40:43], a[248:251], v[164:167], v[40:43]
s_waitcnt lgkmcnt(3)
ds_read_b128 a[240:243], v4 offset:10240
v_permlane16_swap_b32 v154, v152
v_mfma_f32_16x16x32_bf16 v[40:43], a[252:255], v[172:175], v[40:43]
v_permlane16_swap_b32 v155, v153
v_add_f32 v154, v154, v152
v_mfma_f32_16x16x32_bf16 v[36:39], a[252:255], v[168:171], v[36:39]
ds_read_b128 a[244:247], v4 offset:14336
v_add_f32 v155, v155, v153
v_mfma_f32_16x16x32_bf16 v[36:39], a[248:251], v[160:163], v[36:39]
s_waitcnt lgkmcnt(4)
buffer_load_dwordx4 v[220:223], v1, s[60:63], s7 offen offset:1024 sc1
v_mfma_f32_16x16x32_bf16 v[44:47], v[84:87], v[160:163], v[44:47]
s_waitcnt lgkmcnt(3)
ds_read_b128 a[248:251], v4 offset:21504
v_mov_b32 v152, v154
v_mfma_f32_16x16x32_bf16 v[44:47], v[88:91], v[168:171], v[44:47]
v_mov_b32 v153, v155
v_permlane32_swap_b32 v154, v152
v_mfma_f32_16x16x32_bf16 v[48:51], v[88:91], v[172:175], v[48:51]
ds_read_b128 a[252:255], v4 offset:15360
v_permlane32_swap_b32 v155, v153
v_mfma_f32_16x16x32_bf16 v[48:51], v[84:87], v[164:167], v[48:51]
s_waitcnt lgkmcnt(4)
v_add_f32 v154, v154, v152
v_add_f32 v155, v155, v153
v_mfma_f32_16x16x32_bf16 v[56:59], v[92:95], v[164:167], v[56:59]
s_waitcnt lgkmcnt(3)
s_add_u32 s7, s87, 2048
ds_read_b128 v[84:87], v4 offset:22528
v_mul_f32 v154, 0x3e000000, v154
v_mfma_f32_16x16x32_bf16 v[56:59], a[240:243], v[172:175], v[56:59]
buffer_load_dwordx4 v[224:227], v1, s[60:63], s7 offen offset:0 sc1
v_mfma_f32_16x16x32_bf16 v[52:55], a[240:243], v[168:171], v[52:55]
ds_read_b128 v[88:91], v4 offset:16384
v_mul_f32 v155, 0x3e000000, v155
v_mfma_f32_16x16x32_bf16 v[52:55], v[92:95], v[160:163], v[52:55]
s_waitcnt vmcnt(14) lgkmcnt(4)
v_sub_f32 v96, v96, v154
v_sub_f32 v98, v98, v154
v_mfma_f32_16x16x32_bf16 v[28:31], a[244:247], v[176:179], v[28:31]
s_waitcnt vmcnt(12) lgkmcnt(3)
ds_read_b128 v[92:95], v4 offset:23552
v_mul_f32 v96, v96, v96
v_mfma_f32_16x16x32_bf16 v[28:31], a[248:251], v[184:187], v[28:31]
s_waitcnt vmcnt(11)
buffer_load_dwordx4 v[228:231], v1, s[60:63], s7 offen offset:1024 sc1
v_mfma_f32_16x16x32_bf16 v[32:35], a[248:251], v[188:191], v[32:35]
ds_read_b128 a[240:243], v4 offset:17408
v_fmac_f32 v96, v98, v98
v_mfma_f32_16x16x32_bf16 v[32:35], a[244:247], v[180:183], v[32:35]
s_waitcnt lgkmcnt(4)
v_add_f32 v156, v97, v99
v_fmac_f32 v156, 0x42a00000, v96
v_mfma_f32_16x16x32_bf16 v[40:43], a[252:255], v[180:183], v[40:43]
s_waitcnt lgkmcnt(3)
ds_read_b128 a[244:247], v4 offset:24576
v_sub_f32 v100, v100, v155
v_mfma_f32_16x16x32_bf16 v[40:43], v[84:87], v[188:191], v[40:43]
v_sub_f32 v102, v102, v155
v_mul_f32 v100, v100, v100
v_mfma_f32_16x16x32_bf16 v[36:39], v[84:87], v[184:187], v[36:39]
s_add_u32 s7, s87, 4096
ds_read_b128 a[248:251], v4 offset:28672
v_fmac_f32 v100, v102, v102
v_mfma_f32_16x16x32_bf16 v[36:39], a[252:255], v[176:179], v[36:39]
s_waitcnt lgkmcnt(4)
buffer_load_dwordx2 v[232:233], v26, s[60:63], s7 offen offset:0 sc1
v_mfma_f32_16x16x32_bf16 v[44:47], v[88:91], v[176:179], v[44:47]
s_waitcnt lgkmcnt(3)
ds_read_b128 a[252:255], v4 offset:35840
v_add_f32 v157, v101, v103
v_mfma_f32_16x16x32_bf16 v[44:47], v[92:95], v[184:187], v[44:47]
v_fmac_f32 v157, 0x42a00000, v100
v_mov_b32 v152, v156
v_mfma_f32_16x16x32_bf16 v[48:51], v[92:95], v[188:191], v[48:51]
ds_read_b128 v[84:87], v4 offset:29696
v_mov_b32 v153, v157
v_mfma_f32_16x16x32_bf16 v[48:51], v[88:91], v[180:183], v[48:51]
s_waitcnt lgkmcnt(4)
buffer_load_dwordx2 v[234:235], v26, s[60:63], s7 offen offset:512 sc1
v_mfma_f32_16x16x32_bf16 v[56:59], a[240:243], v[180:183], v[56:59]
s_waitcnt lgkmcnt(3)
ds_read_b128 v[88:91], v4 offset:36864
v_permlane16_swap_b32 v156, v152
v_mfma_f32_16x16x32_bf16 v[56:59], a[244:247], v[188:191], v[56:59]
v_permlane16_swap_b32 v157, v153
v_add_f32 v156, v156, v152
v_mfma_f32_16x16x32_bf16 v[52:55], a[244:247], v[184:187], v[52:55]
ds_read_b128 v[92:95], v4 offset:30720
v_add_f32 v157, v157, v153
v_mfma_f32_16x16x32_bf16 v[52:55], a[240:243], v[176:179], v[52:55]
s_waitcnt vmcnt(12) lgkmcnt(4)
buffer_load_dwordx2 v[236:237], v26, s[60:63], s7 offen offset:1024 sc1
v_mfma_f32_16x16x32_bf16 v[28:31], a[248:251], v[192:195], v[28:31]
s_waitcnt vmcnt(10) lgkmcnt(3)
ds_read_b128 a[240:243], v4 offset:37888
v_mov_b32 v152, v156
v_mfma_f32_16x16x32_bf16 v[28:31], a[252:255], v[200:203], v[28:31]
s_waitcnt vmcnt(9)
v_mov_b32 v153, v157
v_permlane32_swap_b32 v156, v152
v_mfma_f32_16x16x32_bf16 v[32:35], a[252:255], v[204:207], v[32:35]
ds_read_b128 a[244:247], v4 offset:31744
v_permlane32_swap_b32 v157, v153
v_mfma_f32_16x16x32_bf16 v[32:35], a[248:251], v[196:199], v[32:35]
s_waitcnt lgkmcnt(4)
buffer_load_dwordx2 v[238:239], v26, s[60:63], s7 offen offset:1536 sc1
v_mfma_f32_16x16x32_bf16 v[40:43], v[84:87], v[196:199], v[40:43]
s_waitcnt lgkmcnt(3)
ds_read_b128 a[248:251], v4 offset:38912
v_add_f32 v156, v156, v152
v_mfma_f32_16x16x32_bf16 v[40:43], v[88:91], v[204:207], v[40:43]
v_add_f32 v157, v157, v153
v_mov_b32 v158, 0x3727c5ac
v_mfma_f32_16x16x32_bf16 v[36:39], v[88:91], v[200:203], v[36:39]
ds_read_b128 a[252:255], v4 offset:43008
v_fmac_f32 v158, 0x3acccccd, v156
v_mfma_f32_16x16x32_bf16 v[36:39], v[84:87], v[192:195], v[36:39]
s_waitcnt lgkmcnt(4)
v_mov_b32 v159, 0x3727c5ac
v_fmac_f32 v159, 0x3acccccd, v157
v_mfma_f32_16x16x32_bf16 v[44:47], v[92:95], v[192:195], v[44:47]
s_waitcnt lgkmcnt(3)
s_add_u32 s7, s87, 6144
ds_read_b128 v[84:87], v4 offset:50176
v_mfma_f32_16x16x32_bf16 v[44:47], a[240:243], v[200:203], v[44:47]
buffer_load_dwordx4 v[240:243], v1, s[60:63], s7 offen offset:0 sc1
v_mfma_f32_16x16x32_bf16 v[48:51], a[240:243], v[204:207], v[48:51]
ds_read_b128 v[88:91], v4 offset:44032
v_mfma_f32_16x16x32_bf16 v[48:51], v[92:95], v[196:199], v[48:51]
s_waitcnt lgkmcnt(4)
v_sqrt_f32 v156, v158
v_mfma_f32_16x16x32_bf16 v[56:59], a[244:247], v[196:199], v[56:59]
s_waitcnt lgkmcnt(3)
ds_read_b128 v[92:95], v4 offset:51200
v_mfma_f32_16x16x32_bf16 v[56:59], a[248:251], v[204:207], v[56:59]
buffer_load_dwordx4 v[244:247], v1, s[60:63], s7 offen offset:1024 sc1
v_mfma_f32_16x16x32_bf16 v[52:55], a[248:251], v[200:203], v[52:55]
ds_read_b128 a[240:243], v4 offset:45056
v_mfma_f32_16x16x32_bf16 v[52:55], a[244:247], v[192:195], v[52:55]
s_waitcnt vmcnt(11) lgkmcnt(4)
v_sqrt_f32 v157, v159
v_mfma_f32_16x16x32_bf16 v[28:31], a[252:255], v[208:211], v[28:31]
s_waitcnt vmcnt(9) lgkmcnt(3)
ds_read_b128 a[244:247], v4 offset:52224
v_mfma_f32_16x16x32_bf16 v[28:31], v[84:87], v[216:219], v[28:31]
s_waitcnt vmcnt(8)
v_rcp_f32 v158, v158
v_mfma_f32_16x16x32_bf16 v[32:35], v[84:87], v[220:223], v[32:35]
s_add_u32 s7, s87, 8192
ds_read_b128 a[248:251], v4 offset:46080
v_mfma_f32_16x16x32_bf16 v[32:35], a[252:255], v[212:215], v[32:35]
s_waitcnt lgkmcnt(4)
buffer_load_dwordx4 v[248:251], v1, s[60:63], s7 offen offset:0 sc1
v_mfma_f32_16x16x32_bf16 v[40:43], v[88:91], v[212:215], v[40:43]
s_waitcnt lgkmcnt(3)
ds_read_b128 a[252:255], v4 offset:53248
v_mfma_f32_16x16x32_bf16 v[40:43], v[92:95], v[220:223], v[40:43]
v_rcp_f32 v159, v159
v_mfma_f32_16x16x32_bf16 v[36:39], v[92:95], v[216:219], v[36:39]
ds_read_b128 v[84:87], v5 offset:0
v_cvt_pk_bf16_f32 v137, -v154, v156
v_mfma_f32_16x16x32_bf16 v[36:39], v[88:91], v[208:211], v[36:39]
s_waitcnt lgkmcnt(4)
buffer_load_dwordx4 v[252:255], v1, s[60:63], s7 offen offset:1024 sc1
v_mfma_f32_16x16x32_bf16 v[44:47], a[240:243], v[208:211], v[44:47]
s_waitcnt lgkmcnt(3)
ds_read_b128 v[88:91], v5 offset:7168
v_lshlrev_b32 v152, 16, v137
v_mfma_f32_16x16x32_bf16 v[44:47], a[244:247], v[216:219], v[44:47]
v_and_b32 v153, 0xffff0000, v137
v_add_f32 v154, v154, v152
v_mfma_f32_16x16x32_bf16 v[48:51], a[244:247], v[220:223], v[48:51]
ds_read_b128 v[92:95], v5 offset:1024
v_sub_f32 v156, v156, v153
v_mfma_f32_16x16x32_bf16 v[48:51], a[240:243], v[212:215], v[48:51]
s_waitcnt lgkmcnt(4)
buffer_load_dwordx4 a[48:51], v1, s[20:23], s43 offen offset:2048 sc1
v_mfma_f32_16x16x32_bf16 v[56:59], a[248:251], v[212:215], v[56:59]
s_waitcnt lgkmcnt(3)
ds_read_b128 a[240:243], v5 offset:8192
v_cvt_pk_bf16_f32 v136, v152, -v154
v_mfma_f32_16x16x32_bf16 v[56:59], a[252:255], v[220:223], v[56:59]
v_cvt_pk_bf16_f32 v138, v156, v153
v_mov_b32 v139, 0
v_mfma_f32_16x16x32_bf16 v[52:55], a[252:255], v[216:219], v[52:55]
ds_read_b128 a[244:247], v5 offset:2048
v_cvt_pk_bf16_f32 v141, -v155, v157
v_mfma_f32_16x16x32_bf16 v[52:55], a[248:251], v[208:211], v[52:55]
s_waitcnt vmcnt(10) lgkmcnt(4)
buffer_load_dwordx4 a[52:55], v1, s[20:23], s43 offen offset:3072 sc1
v_mfma_f32_16x16x32_bf16 v[28:31], v[84:87], v[224:227], v[28:31]
s_waitcnt vmcnt(8) lgkmcnt(3)
ds_read_b128 a[248:251], v5 offset:9216
v_lshlrev_b32 v152, 16, v141
v_mfma_f32_16x16x32_bf16 v[28:31], v[88:91], v[232:235], v[28:31]
s_waitcnt vmcnt(6)
v_and_b32 v153, 0xffff0000, v141
v_add_f32 v155, v155, v152
v_mfma_f32_16x16x32_bf16 v[32:35], v[88:91], v[236:239], v[32:35]
ds_read_b128 a[252:255], v5 offset:3072
v_sub_f32 v157, v157, v153
v_mfma_f32_16x16x32_bf16 v[32:35], v[84:87], v[228:231], v[32:35]
s_waitcnt lgkmcnt(4)
v_cvt_pk_bf16_f32 v140, v152, -v155
v_cvt_pk_bf16_f32 v142, v157, v153
v_mfma_f32_16x16x32_bf16 v[40:43], v[92:95], v[228:231], v[40:43]
s_waitcnt lgkmcnt(3)
s_add_u32 s43, s43, 4096
ds_read_b128 v[84:87], v5 offset:10240
v_mov_b32 v143, 0
v_mfma_f32_16x16x32_bf16 v[40:43], a[240:243], v[236:239], v[40:43]
buffer_load_dwordx4 a[56:59], v1, s[20:23], s43 offen offset:0 sc1
v_mfma_f32_16x16x32_bf16 v[36:39], a[240:243], v[232:235], v[36:39]
ds_read_b128 v[88:91], v5 offset:14336
v_mfma_f32_16x16x32_bf16 v[36:39], v[92:95], v[224:227], v[36:39]
s_waitcnt lgkmcnt(4)
v_mfma_f32_16x16x32_bf16 v[44:47], a[244:247], v[224:227], v[44:47]
s_waitcnt lgkmcnt(3)
ds_read_b128 v[92:95], v5 offset:21504
v_mfma_f32_16x16x32_bf16 v[44:47], a[248:251], v[232:235], v[44:47]
v_mfma_f32_16x16x32_bf16 v[48:51], a[248:251], v[236:239], v[48:51]
s_mul_i32 s43, s35, 5120
ds_read_b128 a[240:243], v5 offset:15360
v_mfma_f32_16x16x32_bf16 v[48:51], a[244:247], v[228:231], v[48:51]
s_waitcnt lgkmcnt(4)
buffer_load_dwordx4 a[60:63], v1, s[20:23], s43 offen offset:0 sc1
v_mfma_f32_16x16x32_bf16 v[56:59], a[252:255], v[228:231], v[56:59]
s_waitcnt lgkmcnt(3)
ds_read_b128 a[244:247], v5 offset:22528
v_mfma_f32_16x16x32_bf16 v[56:59], v[84:87], v[236:239], v[56:59]
v_mfma_f32_16x16x32_bf16 v[52:55], v[84:87], v[232:235], v[52:55]
ds_read_b128 a[248:251], v5 offset:16384
v_mfma_f32_16x16x32_bf16 v[52:55], a[252:255], v[224:227], v[52:55]
s_waitcnt vmcnt(7) lgkmcnt(4)
buffer_load_dwordx4 a[64:67], v1, s[20:23], s43 offen offset:1024 sc1
v_mfma_f32_16x16x32_bf16 v[28:31], v[88:91], v[240:243], v[28:31]
s_waitcnt vmcnt(6) lgkmcnt(3)
ds_read_b128 a[252:255], v5 offset:23552
v_mfma_f32_16x16x32_bf16 v[28:31], v[92:95], v[248:251], v[28:31]
s_waitcnt vmcnt(5)
v_mfma_f32_16x16x32_bf16 v[32:35], v[92:95], v[252:255], v[32:35]
ds_read_b128 v[84:87], v5 offset:17408
v_mfma_f32_16x16x32_bf16 v[32:35], v[88:91], v[244:247], v[32:35]
s_waitcnt lgkmcnt(4)
buffer_load_dwordx4 a[68:71], v1, s[20:23], s43 offen offset:2048 sc1
v_mfma_f32_16x16x32_bf16 v[40:43], a[240:243], v[244:247], v[40:43]
s_waitcnt lgkmcnt(3)
ds_read_b128 v[88:91], v5 offset:24576
v_mfma_f32_16x16x32_bf16 v[40:43], a[244:247], v[252:255], v[40:43]
v_mfma_f32_16x16x32_bf16 v[36:39], a[244:247], v[248:251], v[36:39]
ds_read_b128 v[92:95], v5 offset:28672
v_mfma_f32_16x16x32_bf16 v[36:39], a[240:243], v[240:243], v[36:39]
s_waitcnt lgkmcnt(4)
buffer_load_dwordx4 a[72:75], v1, s[20:23], s43 offen offset:3072 sc1
v_mfma_f32_16x16x32_bf16 v[44:47], a[248:251], v[240:243], v[44:47]
s_waitcnt lgkmcnt(3)
ds_read_b128 a[240:243], v5 offset:29696
v_mfma_f32_16x16x32_bf16 v[44:47], a[252:255], v[248:251], v[44:47]
v_mfma_f32_16x16x32_bf16 v[48:51], a[252:255], v[252:255], v[48:51]
ds_read_b128 a[244:247], v5 offset:30720
v_mfma_f32_16x16x32_bf16 v[48:51], a[248:251], v[244:247], v[48:51]
s_waitcnt lgkmcnt(4)
v_mfma_f32_16x16x32_bf16 v[56:59], v[84:87], v[244:247], v[56:59]
s_waitcnt lgkmcnt(3)
s_add_u32 s43, s43, 4096
ds_read_b128 a[248:251], v5 offset:31744
v_mfma_f32_16x16x32_bf16 v[56:59], v[88:91], v[252:255], v[56:59]
buffer_load_dwordx4 a[76:79], v1, s[20:23], s43 offen offset:0 sc1
v_mfma_f32_16x16x32_bf16 v[52:55], v[88:91], v[248:251], v[52:55]
ds_read_b128 a[252:255], v4 offset:4096
v_mfma_f32_16x16x32_bf16 v[52:55], v[84:87], v[240:243], v[52:55]
s_waitcnt lgkmcnt(4)
v_mfma_f32_16x16x32_bf16 v[28:31], v[92:95], v[136:139], v[28:31]
ds_read_b128 v[84:87], v4 offset:11264
v_mfma_f32_16x16x32_bf16 v[32:35], v[92:95], v[140:143], v[32:35]
s_waitcnt lgkmcnt(4)
v_mfma_f32_16x16x32_bf16 v[40:43], a[240:243], v[140:143], v[40:43]
s_mul_i32 s43, s48, 5120
ds_read_b128 v[88:91], v4 offset:5120
v_mfma_f32_16x16x32_bf16 v[36:39], a[240:243], v[136:139], v[36:39]
s_waitcnt lgkmcnt(4)
buffer_load_dwordx4 a[80:83], v1, s[20:23], s43 offen offset:0 sc1
v_mfma_f32_16x16x32_bf16 v[44:47], a[244:247], v[136:139], v[44:47]
ds_read_b128 v[92:95], v4 offset:12288
v_mfma_f32_16x16x32_bf16 v[48:51], a[244:247], v[140:143], v[48:51]
s_waitcnt lgkmcnt(4)
v_mfma_f32_16x16x32_bf16 v[56:59], a[248:251], v[140:143], v[56:59]
ds_read_b128 a[240:243], v4 offset:6144
v_mfma_f32_16x16x32_bf16 v[52:55], a[248:251], v[136:139], v[52:55]
s_waitcnt lgkmcnt(4)
buffer_load_dwordx4 a[84:87], v1, s[20:23], s43 offen offset:1024 sc1
v_mfma_f32_16x16x32_bf16 v[60:63], a[252:255], v[160:163], v[60:63]
s_waitcnt lgkmcnt(3)
ds_read_b128 a[244:247], v4 offset:13312
v_mfma_f32_16x16x32_bf16 v[60:63], v[84:87], v[168:171], v[60:63]
v_mfma_f32_16x16x32_bf16 v[64:67], v[84:87], v[172:175], v[64:67]
ds_read_b128 a[248:251], v4 offset:18432
v_mfma_f32_16x16x32_bf16 v[64:67], a[252:255], v[164:167], v[64:67]
s_waitcnt lgkmcnt(4)
v_max_f32 v144, 0, v28
v_max_f32 v145, 0, v29
v_max_f32 v146, 0, v30
v_max_f32 v147, 0, v31
v_pk_mul_f32 v[28:29], v[28:29], v[158:159] op_sel_hi:[1,0]
v_pk_mul_f32 v[30:31], v[30:31], v[158:159] op_sel_hi:[1,0]
v_pk_mul_f32 v[28:29], v[28:29], v[144:145]
v_pk_mul_f32 v[30:31], v[30:31], v[146:147]
v_cvt_pk_bf16_f32 v104, v28, v29
v_cvt_pk_bf16_f32 v105, v30, v31
v_max_f32 v144, 0, v36
v_max_f32 v145, 0, v37
v_max_f32 v146, 0, v38
v_max_f32 v147, 0, v39
v_pk_mul_f32 v[36:37], v[36:37], v[158:159] op_sel_hi:[1,0]
v_pk_mul_f32 v[38:39], v[38:39], v[158:159] op_sel_hi:[1,0]
v_pk_mul_f32 v[36:37], v[36:37], v[144:145]
v_pk_mul_f32 v[38:39], v[38:39], v[146:147]
v_cvt_pk_bf16_f32 v106, v36, v37
v_cvt_pk_bf16_f32 v107, v38, v39
buffer_store_dwordx4 v[104:107], v1, s[60:63], s89 offen offset:0 sc1
v_max_f32 v144, 0, v32
v_max_f32 v145, 0, v33
v_max_f32 v146, 0, v34
v_max_f32 v147, 0, v35
v_pk_mul_f32 v[32:33], v[32:33], v[158:159] op_sel:[0,1]
v_pk_mul_f32 v[34:35], v[34:35], v[158:159] op_sel:[0,1]
v_pk_mul_f32 v[32:33], v[32:33], v[144:145]
v_pk_mul_f32 v[34:35], v[34:35], v[146:147]
v_cvt_pk_bf16_f32 v108, v32, v33
v_cvt_pk_bf16_f32 v109, v34, v35
v_max_f32 v144, 0, v40
v_max_f32 v145, 0, v41
v_max_f32 v146, 0, v42
v_max_f32 v147, 0, v43
v_pk_mul_f32 v[40:41], v[40:41], v[158:159] op_sel:[0,1]
v_pk_mul_f32 v[42:43], v[42:43], v[158:159] op_sel:[0,1]
v_pk_mul_f32 v[40:41], v[40:41], v[144:145]
v_pk_mul_f32 v[42:43], v[42:43], v[146:147]
v_cvt_pk_bf16_f32 v110, v40, v41
v_cvt_pk_bf16_f32 v111, v42, v43
buffer_store_dwordx4 v[108:111], v1, s[60:63], s89 offen offset:1024 sc1
v_max_f32 v144, 0, v44
v_max_f32 v145, 0, v45
v_max_f32 v146, 0, v46
v_max_f32 v147, 0, v47
v_pk_mul_f32 v[44:45], v[44:45], v[158:159] op_sel_hi:[1,0]
v_pk_mul_f32 v[46:47], v[46:47], v[158:159] op_sel_hi:[1,0]
v_pk_mul_f32 v[44:45], v[44:45], v[144:145]
v_pk_mul_f32 v[46:47], v[46:47], v[146:147]
v_cvt_pk_bf16_f32 v112, v44, v45
v_cvt_pk_bf16_f32 v113, v46, v47
v_max_f32 v144, 0, v52
v_max_f32 v145, 0, v53
v_max_f32 v146, 0, v54
v_max_f32 v147, 0, v55
v_pk_mul_f32 v[52:53], v[52:53], v[158:159] op_sel_hi:[1,0]
v_pk_mul_f32 v[54:55], v[54:55], v[158:159] op_sel_hi:[1,0]
v_pk_mul_f32 v[52:53], v[52:53], v[144:145]
v_pk_mul_f32 v[54:55], v[54:55], v[146:147]
v_cvt_pk_bf16_f32 v114, v52, v53
v_cvt_pk_bf16_f32 v115, v54, v55
buffer_store_dwordx4 v[112:115], v1, s[60:63], s90 offen offset:0 sc1
v_max_f32 v144, 0, v48
v_max_f32 v145, 0, v49
v_max_f32 v146, 0, v50
v_max_f32 v147, 0, v51
v_pk_mul_f32 v[48:49], v[48:49], v[158:159] op_sel:[0,1]
v_pk_mul_f32 v[50:51], v[50:51], v[158:159] op_sel:[0,1]
v_pk_mul_f32 v[48:49], v[48:49], v[144:145]
v_pk_mul_f32 v[50:51], v[50:51], v[146:147]
v_cvt_pk_bf16_f32 v116, v48, v49
v_cvt_pk_bf16_f32 v117, v50, v51
v_max_f32 v144, 0, v56
v_max_f32 v145, 0, v57
v_max_f32 v146, 0, v58
v_max_f32 v147, 0, v59
v_pk_mul_f32 v[56:57], v[56:57], v[158:159] op_sel:[0,1]
v_pk_mul_f32 v[58:59], v[58:59], v[158:159] op_sel:[0,1]
v_pk_mul_f32 v[56:57], v[56:57], v[144:145]
v_pk_mul_f32 v[58:59], v[58:59], v[146:147]
v_cvt_pk_bf16_f32 v118, v56, v57
v_cvt_pk_bf16_f32 v119, v58, v59
buffer_store_dwordx4 v[116:119], v1, s[60:63], s90 offen offset:1024 sc1
v_mfma_f32_16x16x32_bf16 v[72:75], v[88:91], v[164:167], v[72:75]
s_waitcnt lgkmcnt(3)
ds_read_b128 a[252:255], v4 offset:25600
v_mfma_f32_16x16x32_bf16 v[72:75], v[92:95], v[172:175], v[72:75]
buffer_load_dwordx4 a[88:91], v1, s[20:23], s43 offen offset:2048 sc1
v_mfma_f32_16x16x32_bf16 v[68:71], v[92:95], v[168:171], v[68:71]
ds_read_b128 v[84:87], v4 offset:19456
v_mfma_f32_16x16x32_bf16 v[68:71], v[88:91], v[160:163], v[68:71]
s_waitcnt lgkmcnt(4)
v_mfma_f32_16x16x32_bf16 v[76:79], a[240:243], v[160:163], v[76:79]
s_waitcnt lgkmcnt(3)
ds_read_b128 v[88:91], v4 offset:26624
v_mfma_f32_16x16x32_bf16 v[76:79], a[244:247], v[168:171], v[76:79]
buffer_load_dwordx4 a[92:95], v1, s[20:23], s43 offen offset:3072 sc1
v_mfma_f32_16x16x32_bf16 v[80:83], a[244:247], v[172:175], v[80:83]
ds_read_b128 v[92:95], v4 offset:20480
v_mfma_f32_16x16x32_bf16 v[80:83], a[240:243], v[164:167], v[80:83]
s_waitcnt lgkmcnt(4)
v_mfma_f32_16x16x32_bf16 v[64:67], a[248:251], v[180:183], v[64:67]
s_waitcnt lgkmcnt(3)
ds_read_b128 a[240:243], v4 offset:27648
v_mfma_f32_16x16x32_bf16 v[64:67], a[252:255], v[188:191], v[64:67]
v_mfma_f32_16x16x32_bf16 v[60:63], a[252:255], v[184:187], v[60:63]
s_add_u32 s43, s43, 4096
ds_read_b128 a[244:247], v4 offset:32768
v_mfma_f32_16x16x32_bf16 v[60:63], a[248:251], v[176:179], v[60:63]
s_waitcnt lgkmcnt(4)
buffer_load_dwordx4 a[96:99], v1, s[20:23], s43 offen offset:0 sc1
v_mfma_f32_16x16x32_bf16 v[68:71], v[84:87], v[176:179], v[68:71]
s_waitcnt lgkmcnt(3)
ds_read_b128 a[248:251], v4 offset:39936
v_mfma_f32_16x16x32_bf16 v[68:71], v[88:91], v[184:187], v[68:71]
v_mfma_f32_16x16x32_bf16 v[72:75], v[88:91], v[188:191], v[72:75]
ds_read_b128 a[252:255], v4 offset:33792
v_mfma_f32_16x16x32_bf16 v[72:75], v[84:87], v[180:183], v[72:75]
s_waitcnt lgkmcnt(4)
v_mfma_f32_16x16x32_bf16 v[80:83], v[92:95], v[180:183], v[80:83]
s_waitcnt lgkmcnt(3)
s_mul_i32 s43, s49, 5120
ds_read_b128 v[84:87], v4 offset:40960
v_mfma_f32_16x16x32_bf16 v[80:83], a[240:243], v[188:191], v[80:83]
buffer_load_dwordx4 a[100:103], v1, s[20:23], s43 offen offset:0 sc1
v_mfma_f32_16x16x32_bf16 v[76:79], a[240:243], v[184:187], v[76:79]
ds_read_b128 v[88:91], v4 offset:34816
v_mfma_f32_16x16x32_bf16 v[76:79], v[92:95], v[176:179], v[76:79]
s_waitcnt lgkmcnt(4)
v_mfma_f32_16x16x32_bf16 v[60:63], a[244:247], v[192:195], v[60:63]
s_waitcnt lgkmcnt(3)
ds_read_b128 v[92:95], v4 offset:41984
v_mfma_f32_16x16x32_bf16 v[60:63], a[248:251], v[200:203], v[60:63]
buffer_load_dwordx4 a[104:107], v1, s[20:23], s43 offen offset:1024 sc1
v_mfma_f32_16x16x32_bf16 v[64:67], a[248:251], v[204:207], v[64:67]
ds_read_b128 a[240:243], v4 offset:47104
v_mfma_f32_16x16x32_bf16 v[64:67], a[244:247], v[196:199], v[64:67]
s_waitcnt lgkmcnt(4)
v_mfma_f32_16x16x32_bf16 v[72:75], a[252:255], v[196:199], v[72:75]
s_waitcnt lgkmcnt(3)
ds_read_b128 a[244:247], v4 offset:54272
v_mfma_f32_16x16x32_bf16 v[72:75], v[84:87], v[204:207], v[72:75]
buffer_load_dwordx4 a[108:111], v1, s[20:23], s43 offen offset:2048 sc1
v_mfma_f32_16x16x32_bf16 v[68:71], v[84:87], v[200:203], v[68:71]
ds_read_b128 a[248:251], v4 offset:48128
v_mfma_f32_16x16x32_bf16 v[68:71], a[252:255], v[192:195], v[68:71]
s_waitcnt lgkmcnt(4)
v_mfma_f32_16x16x32_bf16 v[76:79], v[88:91], v[192:195], v[76:79]
s_waitcnt lgkmcnt(3)
ds_read_b128 a[252:255], v4 offset:55296
v_mfma_f32_16x16x32_bf16 v[76:79], v[92:95], v[200:203], v[76:79]
buffer_load_dwordx4 a[112:115], v1, s[20:23], s43 offen offset:3072 sc1
v_mfma_f32_16x16x32_bf16 v[80:83], v[92:95], v[204:207], v[80:83]
ds_read_b128 v[84:87], v4 offset:49152
v_mfma_f32_16x16x32_bf16 v[80:83], v[88:91], v[196:199], v[80:83]
s_waitcnt lgkmcnt(4)
v_mfma_f32_16x16x32_bf16 v[64:67], a[240:243], v[212:215], v[64:67]
s_waitcnt lgkmcnt(3)
ds_read_b128 v[88:91], v4 offset:56320
v_mfma_f32_16x16x32_bf16 v[64:67], a[244:247], v[220:223], v[64:67]
v_mfma_f32_16x16x32_bf16 v[60:63], a[244:247], v[216:219], v[60:63]
s_add_u32 s43, s43, 4096
ds_read_b128 v[92:95], v5 offset:4096
v_mfma_f32_16x16x32_bf16 v[60:63], a[240:243], v[208:211], v[60:63]
s_waitcnt lgkmcnt(4)
buffer_load_dwordx4 a[116:119], v1, s[20:23], s43 offen offset:0 sc1
v_mfma_f32_16x16x32_bf16 v[68:71], a[248:251], v[208:211], v[68:71]
s_waitcnt lgkmcnt(3)
ds_read_b128 a[240:243], v5 offset:11264
v_mfma_f32_16x16x32_bf16 v[68:71], a[252:255], v[216:219], v[68:71]
v_mfma_f32_16x16x32_bf16 v[72:75], a[252:255], v[220:223], v[72:75]
ds_read_b128 a[244:247], v5 offset:5120
v_mfma_f32_16x16x32_bf16 v[72:75], a[248:251], v[212:215], v[72:75]
s_waitcnt lgkmcnt(4)
v_mfma_f32_16x16x32_bf16 v[80:83], v[84:87], v[212:215], v[80:83]
s_waitcnt lgkmcnt(3)
s_mul_i32 s43, s50, 5120
ds_read_b128 a[248:251], v5 offset:12288
v_mfma_f32_16x16x32_bf16 v[80:83], v[88:91], v[220:223], v[80:83]
buffer_load_dwordx4 a[120:123], v1, s[20:23], s43 offen offset:0 sc1
v_mfma_f32_16x16x32_bf16 v[76:79], v[88:91], v[216:219], v[76:79]
ds_read_b128 a[252:255], v5 offset:6144
v_mfma_f32_16x16x32_bf16 v[76:79], v[84:87], v[208:211], v[76:79]
s_waitcnt lgkmcnt(4)
v_mfma_f32_16x16x32_bf16 v[60:63], v[92:95], v[224:227], v[60:63]
s_waitcnt lgkmcnt(3)
ds_read_b128 v[84:87], v5 offset:13312
v_mfma_f32_16x16x32_bf16 v[60:63], a[240:243], v[232:235], v[60:63]
buffer_load_dwordx4 a[124:127], v1, s[20:23], s43 offen offset:1024 sc1
v_mfma_f32_16x16x32_bf16 v[64:67], a[240:243], v[236:239], v[64:67]
ds_read_b128 v[88:91], v5 offset:18432
v_mfma_f32_16x16x32_bf16 v[64:67], v[92:95], v[228:231], v[64:67]
s_waitcnt lgkmcnt(4)
v_mfma_f32_16x16x32_bf16 v[72:75], a[244:247], v[228:231], v[72:75]
s_waitcnt lgkmcnt(3)
ds_read_b128 v[92:95], v5 offset:25600
v_mfma_f32_16x16x32_bf16 v[72:75], a[248:251], v[236:239], v[72:75]
buffer_load_dwordx4 a[128:131], v1, s[20:23], s43 offen offset:2048 sc1
v_mfma_f32_16x16x32_bf16 v[68:71], a[248:251], v[232:235], v[68:71]
ds_read_b128 a[240:243], v5 offset:19456
v_mfma_f32_16x16x32_bf16 v[68:71], a[244:247], v[224:227], v[68:71]
s_waitcnt lgkmcnt(4)
v_mfma_f32_16x16x32_bf16 v[76:79], a[252:255], v[224:227], v[76:79]
s_waitcnt lgkmcnt(3)
ds_read_b128 a[244:247], v5 offset:26624
v_mfma_f32_16x16x32_bf16 v[76:79], v[84:87], v[232:235], v[76:79]
buffer_load_dwordx4 a[132:135], v1, s[20:23], s43 offen offset:3072 sc1
v_mfma_f32_16x16x32_bf16 v[80:83], v[84:87], v[236:239], v[80:83]
ds_read_b128 a[248:251], v5 offset:20480
v_mfma_f32_16x16x32_bf16 v[80:83], a[252:255], v[228:231], v[80:83]
s_waitcnt lgkmcnt(4)
v_mfma_f32_16x16x32_bf16 v[64:67], v[88:91], v[244:247], v[64:67]
s_waitcnt lgkmcnt(3)
ds_read_b128 a[252:255], v5 offset:27648
v_mfma_f32_16x16x32_bf16 v[64:67], v[92:95], v[252:255], v[64:67]
v_mfma_f32_16x16x32_bf16 v[60:63], v[92:95], v[248:251], v[60:63]
s_add_u32 s43, s43, 4096
ds_read_b128 v[84:87], v5 offset:32768
v_mfma_f32_16x16x32_bf16 v[60:63], v[88:91], v[240:243], v[60:63]
s_waitcnt lgkmcnt(4)
buffer_load_dwordx4 a[136:139], v1, s[20:23], s43 offen offset:0 sc1
v_mfma_f32_16x16x32_bf16 v[68:71], a[240:243], v[240:243], v[68:71]
s_waitcnt lgkmcnt(3)
ds_read_b128 v[88:91], v5 offset:33792
v_mfma_f32_16x16x32_bf16 v[68:71], a[244:247], v[248:251], v[68:71]
v_mfma_f32_16x16x32_bf16 v[72:75], a[244:247], v[252:255], v[72:75]
ds_read_b128 v[92:95], v5 offset:34816
v_mfma_f32_16x16x32_bf16 v[72:75], a[240:243], v[244:247], v[72:75]
s_waitcnt lgkmcnt(4)
v_mfma_f32_16x16x32_bf16 v[80:83], a[248:251], v[244:247], v[80:83]
s_waitcnt lgkmcnt(3)
s_mul_i32 s43, s51, 5120
buffer_load_dwordx4 a[140:143], v1, s[20:23], s43 offen offset:0 sc1
v_mfma_f32_16x16x32_bf16 v[80:83], a[252:255], v[252:255], v[80:83]
v_mfma_f32_16x16x32_bf16 v[76:79], a[252:255], v[248:251], v[76:79]
v_mfma_f32_16x16x32_bf16 v[76:79], a[248:251], v[240:243], v[76:79]
s_waitcnt lgkmcnt(2)
buffer_load_dwordx4 a[144:147], v1, s[20:23], s43 offen offset:1024 sc1
v_mfma_f32_16x16x32_bf16 v[60:63], v[84:87], v[136:139], v[60:63]
s_waitcnt vmcnt(15)
v_mfma_f32_16x16x32_bf16 v[64:67], v[84:87], v[140:143], v[64:67]
s_waitcnt lgkmcnt(1)
v_mfma_f32_16x16x32_bf16 v[72:75], v[88:91], v[140:143], v[72:75]
s_barrier
v_mfma_f32_16x16x32_bf16 v[68:71], v[88:91], v[136:139], v[68:71]
s_waitcnt lgkmcnt(0)
buffer_atomic_add v7, v6, s[60:63], s55 offen offset:128 sc1
v_mfma_f32_16x16x32_bf16 v[76:79], v[92:95], v[136:139], v[76:79]
v_mfma_f32_16x16x32_bf16 v[80:83], v[92:95], v[140:143], v[80:83]
v_max_f32 v144, 0, v60
v_max_f32 v145, 0, v61
v_max_f32 v146, 0, v62
v_max_f32 v147, 0, v63
v_pk_mul_f32 v[60:61], v[60:61], v[158:159] op_sel_hi:[1,0]
v_pk_mul_f32 v[62:63], v[62:63], v[158:159] op_sel_hi:[1,0]
v_pk_mul_f32 v[60:61], v[60:61], v[144:145]
v_pk_mul_f32 v[62:63], v[62:63], v[146:147]
v_cvt_pk_bf16_f32 v120, v60, v61
v_cvt_pk_bf16_f32 v121, v62, v63
v_max_f32 v144, 0, v68
v_max_f32 v145, 0, v69
v_max_f32 v146, 0, v70
v_max_f32 v147, 0, v71
v_pk_mul_f32 v[68:69], v[68:69], v[158:159] op_sel_hi:[1,0]
v_pk_mul_f32 v[70:71], v[70:71], v[158:159] op_sel_hi:[1,0]
v_pk_mul_f32 v[68:69], v[68:69], v[144:145]
v_pk_mul_f32 v[70:71], v[70:71], v[146:147]
v_cvt_pk_bf16_f32 v122, v68, v69
v_cvt_pk_bf16_f32 v123, v70, v71
buffer_store_dwordx4 v[120:123], v1, s[60:63], s91 offen offset:0 sc1
v_max_f32 v144, 0, v64
v_max_f32 v145, 0, v65
v_max_f32 v146, 0, v66
v_max_f32 v147, 0, v67
v_pk_mul_f32 v[64:65], v[64:65], v[158:159] op_sel:[0,1]
v_pk_mul_f32 v[66:67], v[66:67], v[158:159] op_sel:[0,1]
v_pk_mul_f32 v[64:65], v[64:65], v[144:145]
v_pk_mul_f32 v[66:67], v[66:67], v[146:147]
v_cvt_pk_bf16_f32 v124, v64, v65
v_cvt_pk_bf16_f32 v125, v66, v67
v_max_f32 v144, 0, v72
v_max_f32 v145, 0, v73
v_max_f32 v146, 0, v74
v_max_f32 v147, 0, v75
v_pk_mul_f32 v[72:73], v[72:73], v[158:159] op_sel:[0,1]
v_pk_mul_f32 v[74:75], v[74:75], v[158:159] op_sel:[0,1]
v_pk_mul_f32 v[72:73], v[72:73], v[144:145]
v_pk_mul_f32 v[74:75], v[74:75], v[146:147]
v_cvt_pk_bf16_f32 v126, v72, v73
v_cvt_pk_bf16_f32 v127, v74, v75
buffer_store_dwordx4 v[124:127], v1, s[60:63], s91 offen offset:1024 sc1
v_max_f32 v144, 0, v76
v_max_f32 v145, 0, v77
v_max_f32 v146, 0, v78
v_max_f32 v147, 0, v79
v_pk_mul_f32 v[76:77], v[76:77], v[158:159] op_sel_hi:[1,0]
v_pk_mul_f32 v[78:79], v[78:79], v[158:159] op_sel_hi:[1,0]
v_pk_mul_f32 v[76:77], v[76:77], v[144:145]
v_pk_mul_f32 v[78:79], v[78:79], v[146:147]
v_cvt_pk_bf16_f32 v128, v76, v77
v_cvt_pk_bf16_f32 v129, v78, v79
buffer_store_dwordx2 v[128:129], v26, s[60:63], s96 offen offset:0 sc1
v_max_f32 v144, 0, v80
v_max_f32 v145, 0, v81
v_max_f32 v146, 0, v82
v_max_f32 v147, 0, v83
v_pk_mul_f32 v[80:81], v[80:81], v[158:159] op_sel:[0,1]
v_pk_mul_f32 v[82:83], v[82:83], v[158:159] op_sel:[0,1]
v_pk_mul_f32 v[80:81], v[80:81], v[144:145]
v_pk_mul_f32 v[82:83], v[82:83], v[146:147]
v_cvt_pk_bf16_f32 v132, v80, v81
v_cvt_pk_bf16_f32 v133, v82, v83
buffer_store_dwordx2 v[132:133], v26, s[60:63], s96 offen offset:1024 sc1
buffer_load_dwordx4 a[148:151], v1, s[20:23], s43 offen offset:2048 sc1
buffer_load_dwordx4 a[152:155], v1, s[20:23], s43 offen offset:3072 sc1
s_add_u32 s43, s43, 4096
buffer_load_dwordx4 a[156:159], v1, s[20:23], s43 offen offset:0 sc1
s_mul_i32 s43, s64, 5120
buffer_load_dwordx4 a[160:163], v1, s[20:23], s43 offen offset:0 sc1
buffer_load_dwordx4 a[164:167], v1, s[20:23], s43 offen offset:1024 sc1
buffer_load_dwordx4 a[168:171], v1, s[20:23], s43 offen offset:2048 sc1
buffer_load_dwordx4 a[172:175], v1, s[20:23], s43 offen offset:3072 sc1
s_add_u32 s43, s43, 4096
buffer_load_dwordx4 a[176:179], v1, s[20:23], s43 offen offset:0 sc1
s_mul_i32 s6, s40, 221184
s_add_u32 s6, s6, 26214400
s_add_u32 s16, s46, s6
s_addc_u32 s17, s47, 0
s_mov_b32 s18, 221184
s_mul_i32 s42, s3, 57344
s_mov_b32 s24, s66
s_mov_b32 s25, s67
v_and_b32 v4, 0, v2
v_lshlrev_b32 v4, 7, v4
v_sub_u32 v168, v12, v26
v_sub_u32 v169, v13, v26
v_sub_u32 v170, v14, v26
v_sub_u32 v171, v15, v26
s_waitcnt vmcnt(8)
s_barrier
buffer_atomic_add v7, v6, s[60:63], s55 offen offset:256 sc1
s_mul_i32 s43, s65, 5120
buffer_load_dwordx4 a[180:183], v1, s[20:23], s43 offen offset:0 sc1
buffer_load_dwordx4 a[184:187], v1, s[20:23], s43 offen offset:1024 sc1
buffer_load_dwordx4 a[188:191], v1, s[20:23], s43 offen offset:2048 sc1
buffer_load_dwordx4 a[192:195], v1, s[20:23], s43 offen offset:3072 sc1
buffer_load_dword v0, v4, s[60:63], s54 offen offset:128 sc1
s_add_u32 s43, s43, 4096
buffer_load_dwordx4 a[196:199], v1, s[20:23], s43 offen offset:0 sc1
s_mul_i32 s43, s4, 5120
buffer_load_dwordx4 a[200:203], v1, s[20:23], s43 offen offset:0 sc1
buffer_load_dwordx4 a[204:207], v1, s[20:23], s43 offen offset:1024 sc1
buffer_load_dwordx4 a[208:211], v1, s[20:23], s43 offen offset:2048 sc1
s_add_u32 s98, s74, 151552
s_add_u32 s99, s75, 151552
v_add_u32 v92, s98, v9
v_add_u32 v93, s99, v9
ds_read_b128 v[136:139], v92 offset:7680
ds_read_b128 v[140:143], v92 offset:7696
ds_read_b128 v[144:147], v92 offset:7808
ds_read_b128 v[148:151], v92 offset:7824
ds_read_b128 v[152:155], v93 offset:7680
s_add_u32 s98, s76, 161792
s_add_u32 s99, s77, 161792
v_add_u32 v94, s98, v10
v_add_u32 v95, s99, v10
ds_read_b128 v[28:31], v94
ds_read_b128 v[32:35], v94 offset:64
ds_read_b64 v[36:37], v95
s_waitcnt lgkmcnt(2)
v_lshlrev_b32 v40, 16, v28
v_and_b32 v41, 0xffff0000, v28
v_lshlrev_b32 v42, 16, v29
v_and_b32 v43, 0xffff0000, v29
v_lshlrev_b32 v44, 16, v30
v_and_b32 v45, 0xffff0000, v30
v_lshlrev_b32 v46, 16, v31
v_and_b32 v47, 0xffff0000, v31
s_waitcnt lgkmcnt(1)
v_lshlrev_b32 v48, 16, v32
v_and_b32 v49, 0xffff0000, v32
v_lshlrev_b32 v50, 16, v33
v_and_b32 v51, 0xffff0000, v33
v_lshlrev_b32 v52, 16, v34
v_and_b32 v53, 0xffff0000, v34
v_lshlrev_b32 v54, 16, v35
v_and_b32 v55, 0xffff0000, v35
s_waitcnt lgkmcnt(0)
v_lshlrev_b32 v56, 16, v36
v_and_b32 v57, 0xffff0000, v36
v_lshlrev_b32 v58, 16, v37
v_and_b32 v59, 0xffff0000, v37
v_lshlrev_b32 v60, 16, v16
v_and_b32 v61, 0xffff0000, v16
v_lshlrev_b32 v62, 16, v17
v_and_b32 v63, 0xffff0000, v17
v_lshlrev_b32 v64, 16, v18
v_and_b32 v65, 0xffff0000, v18
v_lshlrev_b32 v66, 16, v19
v_and_b32 v67, 0xffff0000, v19
v_lshlrev_b32 v68, 16, v20
v_and_b32 v69, 0xffff0000, v20
v_lshlrev_b32 v70, 16, v21
v_and_b32 v71, 0xffff0000, v21
v_lshlrev_b32 v72, 16, v22
v_and_b32 v73, 0xffff0000, v22
v_lshlrev_b32 v74, 16, v23
v_and_b32 v75, 0xffff0000, v23
v_lshlrev_b32 v76, 16, v24
v_and_b32 v77, 0xffff0000, v24
v_lshlrev_b32 v78, 16, v25
v_and_b32 v79, 0xffff0000, v25
v_pk_fma_f32 v[156:157], v[40:41], v[136:137], v[60:61]
v_pk_fma_f32 v[158:159], v[42:43], v[138:139], v[62:63]
v_pk_fma_f32 v[160:161], v[44:45], v[140:141], v[64:65]
v_pk_fma_f32 v[162:163], v[46:47], v[142:143], v[66:67]
v_pk_fma_f32 v[164:165], v[48:49], v[144:145], v[68:69]
v_pk_fma_f32 v[166:167], v[50:51], v[146:147], v[70:71]
v_pk_fma_f32 v[172:173], v[52:53], v[148:149], v[72:73]
v_pk_fma_f32 v[174:175], v[54:55], v[150:151], v[74:75]
v_pk_fma_f32 v[16:17], v[56:57], v[152:153], v[76:77]
v_pk_fma_f32 v[18:19], v[58:59], v[154:155], v[78:79]
s_waitcnt vmcnt(4)
v_cmp_gt_u32 vcc, s39, v0
s_nop 1
s_cbranch_vccnz L_tl_spin2
L_tl_go2:
s_barrier
s_lshl_b32 s6, s3, 12
v_lshl_add_u32 v27, v11, 6, v10
v_add_u32 v27, s6, v27
v_add_u32 v5, s6, v1
s_lshl_b32 s87, s32, 12
buffer_load_dwordx4 v[40:43], v15, s[16:19], s87 offen sc1
s_lshl_b32 s87, s33, 12
buffer_load_dwordx4 v[56:59], v15, s[16:19], s87 offen sc1
s_lshl_b32 s87, s34, 12
buffer_load_dwordx4 v[72:75], v15, s[16:19], s87 offen sc1
s_lshl_b32 s86, s32, 12
buffer_load_dwordx4 v[36:39], v14, s[16:19], s86 offen sc1
s_lshl_b32 s87, s35, 12
buffer_load_dwordx4 v[88:91], v15, s[16:19], s87 offen sc1
s_lshl_b32 s86, s33, 12
buffer_load_dwordx4 v[52:55], v14, s[16:19], s86 offen sc1
s_lshl_b32 s86, s34, 12
buffer_load_dwordx4 v[68:71], v14, s[16:19], s86 offen sc1
s_lshl_b32 s85, s32, 12
buffer_load_dwordx4 v[32:35], v13, s[16:19], s85 offen sc1
s_lshl_b32 s86, s35, 12
buffer_load_dwordx4 v[84:87], v14, s[16:19], s86 offen sc1
s_lshl_b32 s85, s33, 12
buffer_load_dwordx4 v[48:51], v13, s[16:19], s85 offen sc1
s_waitcnt vmcnt(9)
v_mfma_f32_16x16x32_bf16 v[236:239], a[0:3], v[40:43], 0
s_lshl_b32 s85, s34, 12
buffer_load_dwordx4 v[64:67], v13, s[16:19], s85 offen sc1
v_mfma_f32_16x16x32_bf16 v[240:243], a[4:7], v[40:43], 0
v_mfma_f32_16x16x32_bf16 v[244:247], a[8:11], v[40:43], 0
v_mfma_f32_16x16x32_bf16 v[248:251], a[12:15], v[40:43], 0
v_mfma_f32_16x16x32_bf16 v[252:255], a[16:19], v[40:43], 0
s_waitcnt vmcnt(9)
v_mfma_f32_16x16x32_bf16 v[236:239], a[20:23], v[56:59], v[236:239]
s_lshl_b32 s87, s48, 12
buffer_load_dwordx4 v[40:43], v15, s[16:19], s87 offen sc1
v_mfma_f32_16x16x32_bf16 v[240:243], a[24:27], v[56:59], v[240:243]
buffer_load_dwordx4 a[212:215], v1, s[20:23], s43 offen offset:3072 sc1
v_mfma_f32_16x16x32_bf16 v[244:247], a[28:31], v[56:59], v[244:247]
buffer_load_dword v0, v4, s[60:63], s54 offen offset:256 sc1
v_mfma_f32_16x16x32_bf16 v[248:251], a[32:35], v[56:59], v[248:251]
s_add_u32 s43, s43, 4096
buffer_load_dwordx4 a[216:219], v1, s[20:23], s43 offen offset:0 sc1
v_mfma_f32_16x16x32_bf16 v[252:255], a[36:39], v[56:59], v[252:255]
s_waitcnt vmcnt(12)
v_mfma_f32_16x16x32_bf16 v[236:239], a[40:43], v[72:75], v[236:239]
s_lshl_b32 s87, s49, 12
buffer_load_dwordx4 v[56:59], v15, s[16:19], s87 offen sc1
v_mfma_f32_16x16x32_bf16 v[240:243], a[44:47], v[72:75], v[240:243]
v_mfma_f32_16x16x32_bf16 v[244:247], a[48:51], v[72:75], v[244:247]
v_mfma_f32_16x16x32_bf16 v[248:251], a[52:55], v[72:75], v[248:251]
s_lshl_b32 s84, s32, 12
buffer_load_dwordx4 v[28:31], v12, s[16:19], s84 offen sc1
v_mfma_f32_16x16x32_bf16 v[252:255], a[56:59], v[72:75], v[252:255]
s_waitcnt vmcnt(13)
v_mfma_f32_16x16x32_bf16 v[216:219], a[0:3], v[36:39], 0
v_mfma_f32_16x16x32_bf16 v[220:223], a[4:7], v[36:39], 0
s_mul_i32 s43, s5, 5120
buffer_load_dwordx4 a[220:223], v1, s[20:23], s43 offen offset:0 sc1
v_mfma_f32_16x16x32_bf16 v[224:227], a[8:11], v[36:39], 0
v_mfma_f32_16x16x32_bf16 v[228:231], a[12:15], v[36:39], 0
buffer_load_dwordx4 a[224:227], v1, s[20:23], s43 offen offset:1024 sc1
v_mfma_f32_16x16x32_bf16 v[232:235], a[16:19], v[36:39], 0
s_waitcnt vmcnt(14)
v_mfma_f32_16x16x32_bf16 v[236:239], a[60:63], v[88:91], v[236:239]
s_lshl_b32 s87, s50, 12
buffer_load_dwordx4 v[72:75], v15, s[16:19], s87 offen sc1
v_mfma_f32_16x16x32_bf16 v[240:243], a[64:67], v[88:91], v[240:243]
v_mfma_f32_16x16x32_bf16 v[244:247], a[68:71], v[88:91], v[244:247]
v_mfma_f32_16x16x32_bf16 v[248:251], a[72:75], v[88:91], v[248:251]
s_lshl_b32 s86, s48, 12
buffer_load_dwordx4 v[36:39], v14, s[16:19], s86 offen sc1
v_mfma_f32_16x16x32_bf16 v[252:255], a[76:79], v[88:91], v[252:255]
s_waitcnt vmcnt(15)
v_mfma_f32_16x16x32_bf16 v[216:219], a[20:23], v[52:55], v[216:219]
buffer_load_dwordx4 a[228:231], v1, s[20:23], s43 offen offset:2048 sc1
v_mfma_f32_16x16x32_bf16 v[220:223], a[24:27], v[52:55], v[220:223]
v_mfma_f32_16x16x32_bf16 v[224:227], a[28:31], v[52:55], v[224:227]
buffer_load_dwordx4 a[232:235], v1, s[20:23], s43 offen offset:3072 sc1
v_mfma_f32_16x16x32_bf16 v[228:231], a[32:35], v[52:55], v[228:231]
v_mfma_f32_16x16x32_bf16 v[232:235], a[36:39], v[52:55], v[232:235]
s_waitcnt vmcnt(11)
v_mfma_f32_16x16x32_bf16 v[236:239], a[80:83], v[40:43], v[236:239]
s_lshl_b32 s87, s51, 12
buffer_load_dwordx4 v[88:91], v15, s[16:19], s87 offen sc1
v_mfma_f32_16x16x32_bf16 v[240:243], a[84:87], v[40:43], v[240:243]
v_mfma_f32_16x16x32_bf16 v[244:247], a[88:91], v[40:43], v[244:247]
v_mfma_f32_16x16x32_bf16 v[248:251], a[92:95], v[40:43], v[248:251]
s_lshl_b32 s86, s49, 12
buffer_load_dwordx4 v[52:55], v14, s[16:19], s86 offen sc1
v_mfma_f32_16x16x32_bf16 v[252:255], a[96:99], v[40:43], v[252:255]
v_mfma_f32_16x16x32_bf16 v[216:219], a[40:43], v[68:71], v[216:219]
v_mfma_f32_16x16x32_bf16 v[220:223], a[44:47], v[68:71], v[220:223]
s_lshl_b32 s85, s35, 12
buffer_load_dwordx4 v[80:83], v13, s[16:19], s85 offen sc1
v_mfma_f32_16x16x32_bf16 v[224:227], a[48:51], v[68:71], v[224:227]
v_mfma_f32_16x16x32_bf16 v[228:231], a[52:55], v[68:71], v[228:231]
v_mfma_f32_16x16x32_bf16 v[232:235], a[56:59], v[68:71], v[232:235]
s_add_u32 s43, s43, 4096
buffer_load_dwordx4 a[236:239], v1, s[20:23], s43 offen offset:0 sc1
v_mfma_f32_16x16x32_bf16 v[196:199], a[0:3], v[32:35], 0
v_mfma_f32_16x16x32_bf16 v[200:203], a[4:7], v[32:35], 0
v_mfma_f32_16x16x32_bf16 v[204:207], a[8:11], v[32:35], 0
s_waitcnt vmcnt(13)
s_mul_i32 s43, s13, 5120
buffer_load_dwordx4 v[96:99], v1, s[20:23], s43 offen offset:0 sc1
v_cmp_gt_u32 vcc, s39, v0
s_nop 1
s_cbranch_vccnz L_tl_spin3
L_tl_go3:
v_mfma_f32_16x16x32_bf16 v[208:211], a[12:15], v[32:35], 0
v_mfma_f32_16x16x32_bf16 v[212:215], a[16:19], v[32:35], 0
s_waitcnt vmcnt(12)
s_barrier
v_mfma_f32_16x16x32_bf16 v[236:239], a[100:103], v[56:59], v[236:239]
s_lshl_b32 s84, s33, 12
buffer_load_dwordx4 v[44:47], v12, s[16:19], s84 offen sc1
v_mfma_f32_16x16x32_bf16 v[240:243], a[104:107], v[56:59], v[240:243]
v_mfma_f32_16x16x32_bf16 v[244:247], a[108:111], v[56:59], v[244:247]
v_mfma_f32_16x16x32_bf16 v[248:251], a[112:115], v[56:59], v[248:251]
s_lshl_b32 s87, s64, 12
buffer_load_dwordx4 v[40:43], v15, s[16:19], s87 offen sc1
v_mfma_f32_16x16x32_bf16 v[252:255], a[116:119], v[56:59], v[252:255]
v_mfma_f32_16x16x32_bf16 v[216:219], a[60:63], v[84:87], v[216:219]
v_mfma_f32_16x16x32_bf16 v[220:223], a[64:67], v[84:87], v[220:223]
s_lshl_b32 s86, s50, 12
buffer_load_dwordx4 v[68:71], v14, s[16:19], s86 offen sc1
v_mfma_f32_16x16x32_bf16 v[224:227], a[68:71], v[84:87], v[224:227]
v_mfma_f32_16x16x32_bf16 v[228:231], a[72:75], v[84:87], v[228:231]
buffer_load_dwordx4 v[100:103], v1, s[20:23], s43 offen offset:1024 sc1
v_mfma_f32_16x16x32_bf16 v[232:235], a[76:79], v[84:87], v[232:235]
v_mfma_f32_16x16x32_bf16 v[196:199], a[20:23], v[48:51], v[196:199]
buffer_load_dwordx4 v[104:107], v1, s[20:23], s43 offen offset:2048 sc1
v_mfma_f32_16x16x32_bf16 v[200:203], a[24:27], v[48:51], v[200:203]
v_mfma_f32_16x16x32_bf16 v[204:207], a[28:31], v[48:51], v[204:207]
v_mfma_f32_16x16x32_bf16 v[208:211], a[32:35], v[48:51], v[208:211]
v_mfma_f32_16x16x32_bf16 v[212:215], a[36:39], v[48:51], v[212:215]
s_waitcnt vmcnt(13)
v_mfma_f32_16x16x32_bf16 v[236:239], a[120:123], v[72:75], v[236:239]
s_lshl_b32 s85, s48, 12
buffer_load_dwordx4 v[32:35], v13, s[16:19], s85 offen sc1
v_mfma_f32_16x16x32_bf16 v[240:243], a[124:127], v[72:75], v[240:243]
v_mfma_f32_16x16x32_bf16 v[244:247], a[128:131], v[72:75], v[244:247]
v_mfma_f32_16x16x32_bf16 v[248:251], a[132:135], v[72:75], v[248:251]
s_lshl_b32 s84, s34, 12
buffer_load_dwordx4 v[60:63], v12, s[16:19], s84 offen sc1
v_mfma_f32_16x16x32_bf16 v[252:255], a[136:139], v[72:75], v[252:255]
s_waitcnt vmcnt(14)
v_mfma_f32_16x16x32_bf16 v[216:219], a[80:83], v[36:39], v[216:219]
v_mfma_f32_16x16x32_bf16 v[220:223], a[84:87], v[36:39], v[220:223]
s_lshl_b32 s87, s65, 12
buffer_load_dwordx4 v[56:59], v15, s[16:19], s87 offen sc1
v_mfma_f32_16x16x32_bf16 v[224:227], a[88:91], v[36:39], v[224:227]
v_mfma_f32_16x16x32_bf16 v[228:231], a[92:95], v[36:39], v[228:231]
v_mfma_f32_16x16x32_bf16 v[232:235], a[96:99], v[36:39], v[232:235]
s_lshl_b32 s86, s51, 12
buffer_load_dwordx4 v[84:87], v14, s[16:19], s86 offen sc1
v_mfma_f32_16x16x32_bf16 v[196:199], a[40:43], v[64:67], v[196:199]
v_mfma_f32_16x16x32_bf16 v[200:203], a[44:47], v[64:67], v[200:203]
buffer_load_dwordx4 v[108:111], v1, s[20:23], s43 offen offset:3072 sc1
v_mfma_f32_16x16x32_bf16 v[204:207], a[48:51], v[64:67], v[204:207]
v_mfma_f32_16x16x32_bf16 v[208:211], a[52:55], v[64:67], v[208:211]
v_mfma_f32_16x16x32_bf16 v[212:215], a[56:59], v[64:67], v[212:215]
s_add_u32 s43, s43, 4096
buffer_load_dwordx4 v[112:115], v1, s[20:23], s43 offen offset:0 sc1
v_mfma_f32_16x16x32_bf16 v[176:179], a[0:3], v[28:31], 0
v_mfma_f32_16x16x32_bf16 v[180:183], a[4:7], v[28:31], 0
v_mfma_f32_16x16x32_bf16 v[184:187], a[8:11], v[28:31], 0
v_mfma_f32_16x16x32_bf16 v[188:191], a[12:15], v[28:31], 0
v_mfma_f32_16x16x32_bf16 v[192:195], a[16:19], v[28:31], 0
s_waitcnt vmcnt(15)
v_mfma_f32_16x16x32_bf16 v[236:239], a[140:143], v[88:91], v[236:239]
s_lshl_b32 s85, s49, 12
buffer_load_dwordx4 v[48:51], v13, s[16:19], s85 offen sc1
v_mfma_f32_16x16x32_bf16 v[240:243], a[144:147], v[88:91], v[240:243]
v_mfma_f32_16x16x32_bf16 v[244:247], a[148:151], v[88:91], v[244:247]
v_mfma_f32_16x16x32_bf16 v[248:251], a[152:155], v[88:91], v[248:251]
s_lshl_b32 s84, s35, 12
buffer_load_dwordx4 v[76:79], v12, s[16:19], s84 offen sc1
v_mfma_f32_16x16x32_bf16 v[252:255], a[156:159], v[88:91], v[252:255]
s_waitcnt vmcnt(16)
v_mfma_f32_16x16x32_bf16 v[216:219], a[100:103], v[52:55], v[216:219]
v_mfma_f32_16x16x32_bf16 v[220:223], a[104:107], v[52:55], v[220:223]
s_lshl_b32 s87, s4, 12
buffer_load_dwordx2 v[72:73], v171, s[16:19], s87 offen offset:0 sc1
v_mfma_f32_16x16x32_bf16 v[224:227], a[108:111], v[52:55], v[224:227]
v_mfma_f32_16x16x32_bf16 v[228:231], a[112:115], v[52:55], v[228:231]
buffer_load_dwordx2 v[74:75], v171, s[16:19], s87 offen offset:512 sc1
v_mfma_f32_16x16x32_bf16 v[232:235], a[116:119], v[52:55], v[232:235]
s_waitcnt vmcnt(17)
v_mfma_f32_16x16x32_bf16 v[196:199], a[60:63], v[80:83], v[196:199]
v_mfma_f32_16x16x32_bf16 v[200:203], a[64:67], v[80:83], v[200:203]
s_lshl_b32 s86, s64, 12
buffer_load_dwordx4 v[36:39], v14, s[16:19], s86 offen sc1
v_mfma_f32_16x16x32_bf16 v[204:207], a[68:71], v[80:83], v[204:207]
v_mfma_f32_16x16x32_bf16 v[208:211], a[72:75], v[80:83], v[208:211]
v_mfma_f32_16x16x32_bf16 v[212:215], a[76:79], v[80:83], v[212:215]
s_waitcnt vmcnt(15)
s_mul_i32 s43, s71, 5120
buffer_load_dwordx4 v[116:119], v1, s[20:23], s43 offen offset:0 sc1
v_mfma_f32_16x16x32_bf16 v[176:179], a[20:23], v[44:47], v[176:179]
v_mfma_f32_16x16x32_bf16 v[180:183], a[24:27], v[44:47], v[180:183]
buffer_load_dwordx4 v[120:123], v1, s[20:23], s43 offen offset:1024 sc1
v_mfma_f32_16x16x32_bf16 v[184:187], a[28:31], v[44:47], v[184:187]
v_mfma_f32_16x16x32_bf16 v[188:191], a[32:35], v[44:47], v[188:191]
v_mfma_f32_16x16x32_bf16 v[192:195], a[36:39], v[44:47], v[192:195]
s_waitcnt vmcnt(16)
v_mfma_f32_16x16x32_bf16 v[236:239], a[160:163], v[40:43], v[236:239]
s_lshl_b32 s85, s50, 12
buffer_load_dwordx4 v[64:67], v13, s[16:19], s85 offen sc1
v_mfma_f32_16x16x32_bf16 v[240:243], a[164:167], v[40:43], v[240:243]
v_mfma_f32_16x16x32_bf16 v[244:247], a[168:171], v[40:43], v[244:247]
v_mfma_f32_16x16x32_bf16 v[248:251], a[172:175], v[40:43], v[248:251]
s_lshl_b32 s84, s48, 12
buffer_load_dwordx4 v[28:31], v12, s[16:19], s84 offen sc1
v_mfma_f32_16x16x32_bf16 v[252:255], a[176:179], v[40:43], v[252:255]
s_waitcnt vmcnt(17)
v_mfma_f32_16x16x32_bf16 v[216:219], a[120:123], v[68:71], v[216:219]
v_mfma_f32_16x16x32_bf16 v[220:223], a[124:127], v[68:71], v[220:223]
s_lshl_b32 s87, s5, 12
buffer_load_dwordx4 v[88:91], v15, s[16:19], s87 offen sc1
v_mfma_f32_16x16x32_bf16 v[224:227], a[128:131], v[68:71], v[224:227]
v_mfma_f32_16x16x32_bf16 v[228:231], a[132:135], v[68:71], v[228:231]
v_mfma_f32_16x16x32_bf16 v[232:235], a[136:139], v[68:71], v[232:235]
s_waitcnt vmcnt(15)
s_lshl_b32 s86, s65, 12
buffer_load_dwordx4 v[52:55], v14, s[16:19], s86 offen sc1
v_mfma_f32_16x16x32_bf16 v[196:199], a[80:83], v[32:35], v[196:199]
v_mfma_f32_16x16x32_bf16 v[200:203], a[84:87], v[32:35], v[200:203]
buffer_load_dwordx4 v[124:127], v1, s[20:23], s43 offen offset:2048 sc1
v_mfma_f32_16x16x32_bf16 v[204:207], a[88:91], v[32:35], v[204:207]
v_mfma_f32_16x16x32_bf16 v[208:211], a[92:95], v[32:35], v[208:211]
buffer_load_dwordx4 v[128:131], v1, s[20:23], s43 offen offset:3072 sc1
v_mfma_f32_16x16x32_bf16 v[212:215], a[96:99], v[32:35], v[212:215]
s_waitcnt vmcnt(17)
v_mfma_f32_16x16x32_bf16 v[176:179], a[40:43], v[60:63], v[176:179]
v_mfma_f32_16x16x32_bf16 v[180:183], a[44:47], v[60:63], v[180:183]
v_mfma_f32_16x16x32_bf16 v[184:187], a[48:51], v[60:63], v[184:187]
v_mfma_f32_16x16x32_bf16 v[188:191], a[52:55], v[60:63], v[188:191]
v_mfma_f32_16x16x32_bf16 v[192:195], a[56:59], v[60:63], v[192:195]
s_waitcnt vmcnt(16)
v_mfma_f32_16x16x32_bf16 v[236:239], a[180:183], v[56:59], v[236:239]
s_lshl_b32 s85, s51, 12
buffer_load_dwordx4 v[80:83], v13, s[16:19], s85 offen sc1
v_mfma_f32_16x16x32_bf16 v[240:243], a[184:187], v[56:59], v[240:243]
v_mfma_f32_16x16x32_bf16 v[244:247], a[188:191], v[56:59], v[244:247]
v_mfma_f32_16x16x32_bf16 v[248:251], a[192:195], v[56:59], v[248:251]
s_lshl_b32 s84, s49, 12
buffer_load_dwordx4 v[44:47], v12, s[16:19], s84 offen sc1
v_mfma_f32_16x16x32_bf16 v[252:255], a[196:199], v[56:59], v[252:255]
s_waitcnt vmcnt(17)
v_mfma_f32_16x16x32_bf16 v[216:219], a[140:143], v[84:87], v[216:219]
v_mfma_f32_16x16x32_bf16 v[220:223], a[144:147], v[84:87], v[220:223]
s_lshl_b32 s87, s13, 12
buffer_load_dwordx4 v[40:43], v15, s[16:19], s87 offen sc1
v_mfma_f32_16x16x32_bf16 v[224:227], a[148:151], v[84:87], v[224:227]
v_mfma_f32_16x16x32_bf16 v[228:231], a[152:155], v[84:87], v[228:231]
v_mfma_f32_16x16x32_bf16 v[232:235], a[156:159], v[84:87], v[232:235]
s_waitcnt vmcnt(15)
s_lshl_b32 s86, s4, 12
buffer_load_dwordx2 v[68:69], v170, s[16:19], s86 offen offset:0 sc1
v_mfma_f32_16x16x32_bf16 v[196:199], a[100:103], v[48:51], v[196:199]
v_mfma_f32_16x16x32_bf16 v[200:203], a[104:107], v[48:51], v[200:203]
buffer_load_dwordx2 v[70:71], v170, s[16:19], s86 offen offset:512 sc1
v_mfma_f32_16x16x32_bf16 v[204:207], a[108:111], v[48:51], v[204:207]
v_mfma_f32_16x16x32_bf16 v[208:211], a[112:115], v[48:51], v[208:211]
v_mfma_f32_16x16x32_bf16 v[212:215], a[116:119], v[48:51], v[212:215]
s_waitcnt vmcnt(16)
s_add_u32 s43, s43, 4096
buffer_load_dwordx4 v[132:135], v1, s[20:23], s43 offen offset:0 sc1
v_mfma_f32_16x16x32_bf16 v[176:179], a[60:63], v[76:79], v[176:179]
v_mfma_f32_16x16x32_bf16 v[180:183], a[64:67], v[76:79], v[180:183]
v_mfma_f32_16x16x32_bf16 v[184:187], a[68:71], v[76:79], v[184:187]
v_mfma_f32_16x16x32_bf16 v[188:191], a[72:75], v[76:79], v[188:191]
v_mfma_f32_16x16x32_bf16 v[192:195], a[76:79], v[76:79], v[192:195]
s_waitcnt vmcnt(15)
v_mfma_f32_16x16x32_bf16 v[236:239], a[200:203], v[72:75], v[236:239]
s_lshl_b32 s85, s64, 12
buffer_load_dwordx4 v[32:35], v13, s[16:19], s85 offen sc1
v_mfma_f32_16x16x32_bf16 v[240:243], a[204:207], v[72:75], v[240:243]
s_xor_b32 s88, s3, 1
v_mfma_f32_16x16x32_bf16 v[244:247], a[208:211], v[72:75], v[244:247]
s_mul_i32 s88, s88, 15360
v_mfma_f32_16x16x32_bf16 v[248:251], a[212:215], v[72:75], v[248:251]
s_add_u32 s88, s88, 90112
v_add_u32 v93, s88, v1
v_mfma_f32_16x16x32_bf16 v[252:255], a[216:219], v[72:75], v[252:255]
s_waitcnt vmcnt(15)
s_lshl_b32 s84, s50, 12
buffer_load_dwordx4 v[60:63], v12, s[16:19], s84 offen sc1
v_mfma_f32_16x16x32_bf16 v[216:219], a[160:163], v[36:39], v[216:219]
s_xor_b32 s88, s3, 2
v_mfma_f32_16x16x32_bf16 v[220:223], a[164:167], v[36:39], v[220:223]
s_mul_i32 s88, s88, 15360
v_mfma_f32_16x16x32_bf16 v[224:227], a[168:171], v[36:39], v[224:227]
s_add_u32 s88, s88, 95232
v_add_u32 v94, s88, v1
v_mfma_f32_16x16x32_bf16 v[228:231], a[172:175], v[36:39], v[228:231]
s_lshl_b32 s87, s71, 12
buffer_load_dwordx2 v[56:57], v171, s[16:19], s87 offen offset:0 sc1
v_mfma_f32_16x16x32_bf16 v[232:235], a[176:179], v[36:39], v[232:235]
s_waitcnt vmcnt(14)
s_xor_b32 s88, s3, 3
v_mfma_f32_16x16x32_bf16 v[196:199], a[120:123], v[64:67], v[196:199]
s_mul_i32 s88, s88, 15360
v_mfma_f32_16x16x32_bf16 v[200:203], a[124:127], v[64:67], v[200:203]
s_add_u32 s88, s88, 100352
buffer_load_dwordx2 v[58:59], v171, s[16:19], s87 offen offset:512 sc1
v_mfma_f32_16x16x32_bf16 v[204:207], a[128:131], v[64:67], v[204:207]
v_add_u32 v95, s88, v1
v_mfma_f32_16x16x32_bf16 v[208:211], a[132:135], v[64:67], v[208:211]
s_mul_i32 s88, s3, 15360
v_mfma_f32_16x16x32_bf16 v[212:215], a[136:139], v[64:67], v[212:215]
s_waitcnt vmcnt(14)
s_add_u32 s88, s88, 90112
v_add_u32 v92, s88, v1
v_mfma_f32_16x16x32_bf16 v[176:179], a[80:83], v[28:31], v[176:179]
s_lshl_b32 s86, s5, 12
buffer_load_dwordx4 v[84:87], v14, s[16:19], s86 offen sc1
v_mfma_f32_16x16x32_bf16 v[180:183], a[84:87], v[28:31], v[180:183]
v_mfma_f32_16x16x32_bf16 v[184:187], a[88:91], v[28:31], v[184:187]
v_mfma_f32_16x16x32_bf16 v[188:191], a[92:95], v[28:31], v[188:191]
v_mfma_f32_16x16x32_bf16 v[192:195], a[96:99], v[28:31], v[192:195]
s_waitcnt vmcnt(14)
v_mfma_f32_16x16x32_bf16 v[236:239], a[220:223], v[88:91], v[236:239]
s_lshl_b32 s85, s65, 12
buffer_load_dwordx4 v[48:51], v13, s[16:19], s85 offen sc1
v_mfma_f32_16x16x32_bf16 v[240:243], a[224:227], v[88:91], v[240:243]
v_mfma_f32_16x16x32_bf16 v[244:247], a[228:231], v[88:91], v[244:247]
v_mfma_f32_16x16x32_bf16 v[248:251], a[232:235], v[88:91], v[248:251]
v_mfma_f32_16x16x32_bf16 v[252:255], a[236:239], v[88:91], v[252:255]
s_waitcnt vmcnt(14)
s_lshl_b32 s84, s51, 12
buffer_load_dwordx4 v[76:79], v12, s[16:19], s84 offen sc1
v_mfma_f32_16x16x32_bf16 v[216:219], a[180:183], v[52:55], v[216:219]
v_mfma_f32_16x16x32_bf16 v[220:223], a[184:187], v[52:55], v[220:223]
v_mfma_f32_16x16x32_bf16 v[224:227], a[188:191], v[52:55], v[224:227]
v_mfma_f32_16x16x32_bf16 v[228:231], a[192:195], v[52:55], v[228:231]
s_lshl_b32 s86, s13, 12
buffer_load_dwordx4 v[36:39], v14, s[16:19], s86 offen sc1
v_mfma_f32_16x16x32_bf16 v[232:235], a[196:199], v[52:55], v[232:235]
s_waitcnt vmcnt(13)
v_mfma_f32_16x16x32_bf16 v[196:199], a[140:143], v[80:83], v[196:199]
v_mfma_f32_16x16x32_bf16 v[200:203], a[144:147], v[80:83], v[200:203]
v_mfma_f32_16x16x32_bf16 v[204:207], a[148:151], v[80:83], v[204:207]
s_lshl_b32 s85, s4, 12
buffer_load_dwordx2 v[64:65], v169, s[16:19], s85 offen offset:0 sc1
v_mfma_f32_16x16x32_bf16 v[208:211], a[152:155], v[80:83], v[208:211]
v_mfma_f32_16x16x32_bf16 v[212:215], a[156:159], v[80:83], v[212:215]
s_waitcnt vmcnt(13)
v_mfma_f32_16x16x32_bf16 v[176:179], a[100:103], v[44:47], v[176:179]
buffer_load_dwordx2 v[66:67], v169, s[16:19], s85 offen offset:512 sc1
v_mfma_f32_16x16x32_bf16 v[180:183], a[104:107], v[44:47], v[180:183]
v_mfma_f32_16x16x32_bf16 v[184:187], a[108:111], v[44:47], v[184:187]
v_mfma_f32_16x16x32_bf16 v[188:191], a[112:115], v[44:47], v[188:191]
v_mfma_f32_16x16x32_bf16 v[192:195], a[116:119], v[44:47], v[192:195]
s_waitcnt vmcnt(13)
v_mfma_f32_16x16x32_bf16 v[236:239], v[96:99], v[40:43], v[236:239]
s_lshl_b32 s84, s64, 12
buffer_load_dwordx4 v[28:31], v12, s[16:19], s84 offen sc1
v_mfma_f32_16x16x32_bf16 v[240:243], v[100:103], v[40:43], v[240:243]
v_mfma_f32_16x16x32_bf16 v[244:247], v[104:107], v[40:43], v[244:247]
v_mfma_f32_16x16x32_bf16 v[248:251], v[108:111], v[40:43], v[248:251]
v_mfma_f32_16x16x32_bf16 v[252:255], v[112:115], v[40:43], v[252:255]
s_waitcnt vmcnt(12)
s_lshl_b32 s86, s71, 12
buffer_load_dwordx2 v[52:53], v170, s[16:19], s86 offen offset:0 sc1
v_mfma_f32_16x16x32_bf16 v[216:219], a[200:203], v[68:71], v[216:219]
v_mfma_f32_16x16x32_bf16 v[220:223], a[204:207], v[68:71], v[220:223]
v_mfma_f32_16x16x32_bf16 v[224:227], a[208:211], v[68:71], v[224:227]
buffer_load_dwordx2 v[54:55], v170, s[16:19], s86 offen offset:512 sc1
v_mfma_f32_16x16x32_bf16 v[228:231], a[212:215], v[68:71], v[228:231]
v_mfma_f32_16x16x32_bf16 v[232:235], a[216:219], v[68:71], v[232:235]
s_waitcnt vmcnt(12)
v_mfma_f32_16x16x32_bf16 v[196:199], a[160:163], v[32:35], v[196:199]
v_mfma_f32_16x16x32_bf16 v[200:203], a[164:167], v[32:35], v[200:203]
s_lshl_b32 s85, s5, 12
buffer_load_dwordx4 v[80:83], v13, s[16:19], s85 offen sc1
v_mfma_f32_16x16x32_bf16 v[204:207], a[168:171], v[32:35], v[204:207]
v_mfma_f32_16x16x32_bf16 v[208:211], a[172:175], v[32:35], v[208:211]
v_mfma_f32_16x16x32_bf16 v[212:215], a[176:179], v[32:35], v[212:215]
s_waitcnt vmcnt(12)
v_mfma_f32_16x16x32_bf16 v[176:179], a[120:123], v[60:63], v[176:179]
s_lshl_b32 s84, s65, 12
buffer_load_dwordx4 v[44:47], v12, s[16:19], s84 offen sc1
v_mfma_f32_16x16x32_bf16 v[180:183], a[124:127], v[60:63], v[180:183]
v_mfma_f32_16x16x32_bf16 v[184:187], a[128:131], v[60:63], v[184:187]
v_mfma_f32_16x16x32_bf16 v[188:191], a[132:135], v[60:63], v[188:191]
v_mfma_f32_16x16x32_bf16 v[192:195], a[136:139], v[60:63], v[192:195]
s_waitcnt vmcnt(11)
v_mfma_f32_16x16x32_bf16 v[236:239], v[116:119], v[56:59], v[236:239]
s_lshl_b32 s85, s13, 12
buffer_load_dwordx4 v[32:35], v13, s[16:19], s85 offen sc1
v_mfma_f32_16x16x32_bf16 v[240:243], v[120:123], v[56:59], v[240:243]
v_mfma_f32_16x16x32_bf16 v[244:247], v[124:127], v[56:59], v[244:247]
v_mfma_f32_16x16x32_bf16 v[248:251], v[128:131], v[56:59], v[248:251]
v_mfma_f32_16x16x32_bf16 v[252:255], v[132:135], v[56:59], v[252:255]
s_waitcnt vmcnt(11)
v_mfma_f32_16x16x32_bf16 v[216:219], a[220:223], v[84:87], v[216:219]
s_lshl_b32 s84, s4, 12
buffer_load_dwordx2 v[60:61], v168, s[16:19], s84 offen offset:0 sc1
v_mfma_f32_16x16x32_bf16 v[220:223], a[224:227], v[84:87], v[220:223]
v_mfma_f32_16x16x32_bf16 v[224:227], a[228:231], v[84:87], v[224:227]
v_mfma_f32_16x16x32_bf16 v[228:231], a[232:235], v[84:87], v[228:231]
v_mfma_f32_16x16x32_bf16 v[232:235], a[236:239], v[84:87], v[232:235]
s_waitcnt vmcnt(11)
buffer_load_dwordx2 v[62:63], v168, s[16:19], s84 offen offset:512 sc1
v_mfma_f32_16x16x32_bf16 v[196:199], a[180:183], v[48:51], v[196:199]
v_mfma_f32_16x16x32_bf16 v[200:203], a[184:187], v[48:51], v[200:203]
v_mfma_f32_16x16x32_bf16 v[204:207], a[188:191], v[48:51], v[204:207]
v_mfma_f32_16x16x32_bf16 v[208:211], a[192:195], v[48:51], v[208:211]
v_mfma_f32_16x16x32_bf16 v[212:215], a[196:199], v[48:51], v[212:215]
s_waitcnt vmcnt(11)
v_mfma_f32_16x16x32_bf16 v[176:179], a[140:143], v[76:79], v[176:179]
v_mfma_f32_16x16x32_bf16 v[180:183], a[144:147], v[76:79], v[180:183]
v_mfma_f32_16x16x32_bf16 v[184:187], a[148:151], v[76:79], v[184:187]
v_mfma_f32_16x16x32_bf16 v[188:191], a[152:155], v[76:79], v[188:191]
v_mfma_f32_16x16x32_bf16 v[192:195], a[156:159], v[76:79], v[192:195]
s_waitcnt vmcnt(10)
v_mfma_f32_16x16x32_bf16 v[216:219], v[96:99], v[36:39], v[216:219]
s_lshl_b32 s85, s71, 12
buffer_load_dwordx2 v[48:49], v169, s[16:19], s85 offen offset:0 sc1
v_mfma_f32_16x16x32_bf16 v[220:223], v[100:103], v[36:39], v[220:223]
ds_write_b128 v95, v[236:239] offset:0
v_mfma_f32_16x16x32_bf16 v[224:227], v[104:107], v[36:39], v[224:227]
v_mfma_f32_16x16x32_bf16 v[228:231], v[108:111], v[36:39], v[228:231]
v_mfma_f32_16x16x32_bf16 v[232:235], v[112:115], v[36:39], v[232:235]
s_waitcnt vmcnt(9)
buffer_load_dwordx2 v[50:51], v169, s[16:19], s85 offen offset:512 sc1
v_mfma_f32_16x16x32_bf16 v[196:199], a[200:203], v[64:67], v[196:199]
v_mfma_f32_16x16x32_bf16 v[200:203], a[204:207], v[64:67], v[200:203]
ds_write_b128 v95, v[240:243] offset:1024
v_mfma_f32_16x16x32_bf16 v[204:207], a[208:211], v[64:67], v[204:207]
v_mfma_f32_16x16x32_bf16 v[208:211], a[212:215], v[64:67], v[208:211]
v_mfma_f32_16x16x32_bf16 v[212:215], a[216:219], v[64:67], v[212:215]
s_waitcnt vmcnt(9)
s_lshl_b32 s84, s5, 12
buffer_load_dwordx4 v[76:79], v12, s[16:19], s84 offen sc1
v_mfma_f32_16x16x32_bf16 v[176:179], a[160:163], v[28:31], v[176:179]
v_mfma_f32_16x16x32_bf16 v[180:183], a[164:167], v[28:31], v[180:183]
v_mfma_f32_16x16x32_bf16 v[184:187], a[168:171], v[28:31], v[184:187]
ds_write_b128 v95, v[244:247] offset:2048
v_mfma_f32_16x16x32_bf16 v[188:191], a[172:175], v[28:31], v[188:191]
v_mfma_f32_16x16x32_bf16 v[192:195], a[176:179], v[28:31], v[192:195]
s_waitcnt vmcnt(8)
v_mfma_f32_16x16x32_bf16 v[216:219], v[116:119], v[52:55], v[216:219]
s_lshl_b32 s84, s13, 12
buffer_load_dwordx4 v[28:31], v12, s[16:19], s84 offen sc1
v_mfma_f32_16x16x32_bf16 v[220:223], v[120:123], v[52:55], v[220:223]
v_mfma_f32_16x16x32_bf16 v[224:227], v[124:127], v[52:55], v[224:227]
v_mfma_f32_16x16x32_bf16 v[228:231], v[128:131], v[52:55], v[228:231]
ds_write_b128 v95, v[248:251] offset:3072
v_mfma_f32_16x16x32_bf16 v[232:235], v[132:135], v[52:55], v[232:235]
s_waitcnt vmcnt(8)
v_mfma_f32_16x16x32_bf16 v[196:199], a[220:223], v[80:83], v[196:199]
v_mfma_f32_16x16x32_bf16 v[200:203], a[224:227], v[80:83], v[200:203]
v_mfma_f32_16x16x32_bf16 v[204:207], a[228:231], v[80:83], v[204:207]
v_mfma_f32_16x16x32_bf16 v[208:211], a[232:235], v[80:83], v[208:211]
v_mfma_f32_16x16x32_bf16 v[212:215], a[236:239], v[80:83], v[212:215]
s_waitcnt vmcnt(7)
ds_write_b128 v95, v[252:255] offset:4096
v_mfma_f32_16x16x32_bf16 v[176:179], a[180:183], v[44:47], v[176:179]
v_mfma_f32_16x16x32_bf16 v[180:183], a[184:187], v[44:47], v[180:183]
v_mfma_f32_16x16x32_bf16 v[184:187], a[188:191], v[44:47], v[184:187]
v_mfma_f32_16x16x32_bf16 v[188:191], a[192:195], v[44:47], v[188:191]
v_mfma_f32_16x16x32_bf16 v[192:195], a[196:199], v[44:47], v[192:195]
s_waitcnt vmcnt(6)
v_mfma_f32_16x16x32_bf16 v[196:199], v[96:99], v[32:35], v[196:199]
s_lshl_b32 s84, s71, 12
buffer_load_dwordx2 v[44:45], v168, s[16:19], s84 offen offset:0 sc1
v_mfma_f32_16x16x32_bf16 v[200:203], v[100:103], v[32:35], v[200:203]
ds_write_b128 v94, v[216:219] offset:0
v_mfma_f32_16x16x32_bf16 v[204:207], v[104:107], v[32:35], v[204:207]
v_mfma_f32_16x16x32_bf16 v[208:211], v[108:111], v[32:35], v[208:211]
v_mfma_f32_16x16x32_bf16 v[212:215], v[112:115], v[32:35], v[212:215]
s_waitcnt vmcnt(5)
buffer_load_dwordx2 v[46:47], v168, s[16:19], s84 offen offset:512 sc1
v_mfma_f32_16x16x32_bf16 v[176:179], a[200:203], v[60:63], v[176:179]
ds_write_b128 v94, v[220:223] offset:1024
v_mfma_f32_16x16x32_bf16 v[180:183], a[204:207], v[60:63], v[180:183]
v_mfma_f32_16x16x32_bf16 v[184:187], a[208:211], v[60:63], v[184:187]
v_mfma_f32_16x16x32_bf16 v[188:191], a[212:215], v[60:63], v[188:191]
ds_write_b128 v94, v[224:227] offset:2048
v_mfma_f32_16x16x32_bf16 v[192:195], a[216:219], v[60:63], v[192:195]
s_waitcnt vmcnt(4)
v_mfma_f32_16x16x32_bf16 v[196:199], v[116:119], v[48:51], v[196:199]
v_mfma_f32_16x16x32_bf16 v[200:203], v[120:123], v[48:51], v[200:203]
v_mfma_f32_16x16x32_bf16 v[204:207], v[124:127], v[48:51], v[204:207]
ds_write_b128 v94, v[228:231] offset:3072
v_mfma_f32_16x16x32_bf16 v[208:211], v[128:131], v[48:51], v[208:211]
v_mfma_f32_16x16x32_bf16 v[212:215], v[132:135], v[48:51], v[212:215]
s_waitcnt vmcnt(3)
v_mfma_f32_16x16x32_bf16 v[176:179], a[220:223], v[76:79], v[176:179]
v_mfma_f32_16x16x32_bf16 v[180:183], a[224:227], v[76:79], v[180:183]
ds_write_b128 v94, v[232:235] offset:4096
v_mfma_f32_16x16x32_bf16 v[184:187], a[228:231], v[76:79], v[184:187]
v_mfma_f32_16x16x32_bf16 v[188:191], a[232:235], v[76:79], v[188:191]
v_mfma_f32_16x16x32_bf16 v[192:195], a[236:239], v[76:79], v[192:195]
s_waitcnt vmcnt(2)
v_mfma_f32_16x16x32_bf16 v[176:179], v[96:99], v[28:31], v[176:179]
ds_write_b128 v93, v[196:199] offset:0
v_mfma_f32_16x16x32_bf16 v[180:183], v[100:103], v[28:31], v[180:183]
v_mfma_f32_16x16x32_bf16 v[184:187], v[104:107], v[28:31], v[184:187]
ds_write_b128 v93, v[200:203] offset:1024
v_mfma_f32_16x16x32_bf16 v[188:191], v[108:111], v[28:31], v[188:191]
v_mfma_f32_16x16x32_bf16 v[192:195], v[112:115], v[28:31], v[192:195]
s_waitcnt vmcnt(0)
ds_write_b128 v93, v[204:207] offset:2048
v_mfma_f32_16x16x32_bf16 v[176:179], v[116:119], v[44:47], v[176:179]
v_mfma_f32_16x16x32_bf16 v[180:183], v[120:123], v[44:47], v[180:183]
ds_write_b128 v93, v[208:211] offset:3072
v_mfma_f32_16x16x32_bf16 v[184:187], v[124:127], v[44:47], v[184:187]
v_mfma_f32_16x16x32_bf16 v[188:191], v[128:131], v[44:47], v[188:191]
ds_write_b128 v93, v[212:215] offset:4096
v_mfma_f32_16x16x32_bf16 v[192:195], v[132:135], v[44:47], v[192:195]
s_waitcnt lgkmcnt(0)
s_barrier
ds_read_b128 v[196:199], v92 offset:0
ds_read_b128 v[200:203], v92 offset:1024
ds_read_b128 v[204:207], v92 offset:2048
ds_read_b128 v[208:211], v92 offset:3072
ds_read_b128 v[212:215], v92 offset:4096
ds_read_b128 v[216:219], v92 offset:5120
ds_read_b128 v[220:223], v92 offset:6144
ds_read_b128 v[224:227], v92 offset:7168
ds_read_b128 v[228:231], v92 offset:8192
ds_read_b128 v[232:235], v92 offset:9216
ds_read_b128 v[236:239], v92 offset:10240
ds_read_b128 v[240:243], v92 offset:11264
ds_read_b128 v[244:247], v92 offset:12288
ds_read_b128 v[248:251], v92 offset:13312
ds_read_b128 v[252:255], v92 offset:14336
s_waitcnt lgkmcnt(9)
v_pk_add_f32 v[196:197], v[196:197], v[216:217]
v_pk_add_f32 v[198:199], v[198:199], v[218:219]
s_waitcnt lgkmcnt(8)
v_pk_add_f32 v[200:201], v[200:201], v[220:221]
v_pk_add_f32 v[202:203], v[202:203], v[222:223]
s_waitcnt lgkmcnt(7)
v_pk_add_f32 v[204:205], v[204:205], v[224:225]
v_pk_add_f32 v[206:207], v[206:207], v[226:227]
s_waitcnt lgkmcnt(6)
v_pk_add_f32 v[208:209], v[208:209], v[228:229]
v_pk_add_f32 v[210:211], v[210:211], v[230:231]
s_waitcnt lgkmcnt(5)
v_pk_add_f32 v[212:213], v[212:213], v[232:233]
v_pk_add_f32 v[214:215], v[214:215], v[234:235]
s_waitcnt lgkmcnt(4)
v_pk_add_f32 v[196:197], v[196:197], v[236:237]
v_pk_add_f32 v[198:199], v[198:199], v[238:239]
s_waitcnt lgkmcnt(3)
v_pk_add_f32 v[200:201], v[200:201], v[240:241]
v_pk_add_f32 v[202:203], v[202:203], v[242:243]
s_waitcnt lgkmcnt(2)
v_pk_add_f32 v[204:205], v[204:205], v[244:245]
v_pk_add_f32 v[206:207], v[206:207], v[246:247]
s_waitcnt lgkmcnt(1)
v_pk_add_f32 v[208:209], v[208:209], v[248:249]
v_pk_add_f32 v[210:211], v[210:211], v[250:251]
s_waitcnt lgkmcnt(0)
v_pk_add_f32 v[212:213], v[212:213], v[252:253]
v_pk_add_f32 v[214:215], v[214:215], v[254:255]
v_pk_add_f32 v[176:177], v[176:177], v[196:197]
v_pk_add_f32 v[178:179], v[178:179], v[198:199]
v_pk_add_f32 v[180:181], v[180:181], v[200:201]
v_pk_add_f32 v[182:183], v[182:183], v[202:203]
v_pk_fma_f32 v[176:177], v[176:177], v[136:137], v[156:157]
v_pk_fma_f32 v[178:179], v[178:179], v[138:139], v[158:159]
v_pk_fma_f32 v[180:181], v[180:181], v[140:141], v[160:161]
v_pk_fma_f32 v[182:183], v[182:183], v[142:143], v[162:163]
v_cvt_pk_bf16_f32 v28, v176, v177
v_cvt_pk_bf16_f32 v29, v178, v179
v_cvt_pk_bf16_f32 v30, v180, v181
v_cvt_pk_bf16_f32 v31, v182, v183
ds_write_b128 v27, v[28:31]
ds_read_b128 v[40:43], v5
v_pk_add_f32 v[184:185], v[184:185], v[204:205]
v_pk_add_f32 v[186:187], v[186:187], v[206:207]
v_pk_add_f32 v[188:189], v[188:189], v[208:209]
v_pk_add_f32 v[190:191], v[190:191], v[210:211]
v_pk_fma_f32 v[184:185], v[184:185], v[144:145], v[164:165]
v_pk_fma_f32 v[186:187], v[186:187], v[146:147], v[166:167]
v_pk_fma_f32 v[188:189], v[188:189], v[148:149], v[172:173]
v_pk_fma_f32 v[190:191], v[190:191], v[150:151], v[174:175]
v_cvt_pk_bf16_f32 v32, v184, v185
v_cvt_pk_bf16_f32 v33, v186, v187
v_cvt_pk_bf16_f32 v34, v188, v189
v_cvt_pk_bf16_f32 v35, v190, v191
ds_write_b128 v27, v[32:35] offset:1024
ds_read_b128 v[44:47], v5 offset:1024
v_pk_add_f32 v[192:193], v[192:193], v[212:213]
v_pk_add_f32 v[194:195], v[194:195], v[214:215]
v_pk_fma_f32 v[192:193], v[192:193], v[152:153], v[16:17]
v_pk_fma_f32 v[194:195], v[194:195], v[154:155], v[18:19]
v_cvt_pk_bf16_f32 v36, v192, v193
v_cvt_pk_bf16_f32 v37, v194, v195
ds_write_b64 v27, v[36:37] offset:2048
ds_read_b64 v[48:49], v5 offset:2048
s_waitcnt lgkmcnt(4)
buffer_store_dwordx4 v[40:43], v8, s[24:27], s72 offen
s_waitcnt lgkmcnt(2)
buffer_store_dwordx4 v[44:47], v8, s[24:27], s72 offen offset:64
s_waitcnt lgkmcnt(0)
buffer_store_dwordx2 v[48:49], v8, s[24:27], s73 offen
L_fr_end:
s_endpgm
L_at_vis:
v_and_b32 v13, 7, v2
v_lshlrev_b32 v13, 7, v13
s_mov_b32 s8, 399360
buffer_load_dword v12, v13, s[60:63], s8 offen sc1
s_getpc_b64 s[64:65]
L_at_pc2:
s_sub_u32 s64, s64, L_at_pc2-L_at_last
s_subb_u32 s65, s65, 0
s_lshr_b32 s6, s2, 3
s_and_b32 s6, s6, 7
s_lshl_b32 s6, s6, 13
s_lshr_b32 s9, s13, 1
s_add_u32 s6, s6, s9
v_and_b32 v14, 15, v2
v_lshl_add_u32 v14, v14, 7, s6
v_min_u32 v14, L_fr_codeend-L_at_last-4, v14
global_load_dword v14, v14, s[64:65]
L_at_shp:
v_mfma_f32_16x16x32_bf16 v[64:67], a[96:99], a[64:67], v[112:115]
s_add_u32 s86, s86, 16384
v_exp_f32 v48, v48
v_mfma_f32_16x16x32_bf16 v[64:67], a[100:103], a[68:71], v[64:67]
s_cmp_eq_u32 s86, 163840
v_mfma_f32_16x16x32_bf16 v[64:67], a[104:107], a[72:75], v[64:67]
s_cselect_b32 s86, 0, s86
v_exp_f32 v49, v49
v_mfma_f32_16x16x32_bf16 v[64:67], a[108:111], a[76:79], v[64:67]
s_add_u32 m0, s86, s13
v_cvt_pk_bf16_f32 v80, v48, v49
v_mfma_f32_16x16x32_bf16 v[72:75], a[108:111], a[92:95], v[120:123]
s_add_u32 s87, s87, 17408
v_exp_f32 v50, v50
v_mfma_f32_16x16x32_bf16 v[72:75], a[104:107], a[88:91], v[72:75]
s_and_b32 s40, s2, 6
buffer_load_dwordx4 v1, s[48:51], s87 offen offset:0 sc1 lds
v_mfma_f32_16x16x32_bf16 v[72:75], a[100:103], a[84:87], v[72:75]
s_lshr_b32 s41, s2, 6
v_exp_f32 v51, v51
v_mfma_f32_16x16x32_bf16 v[72:75], a[96:99], a[80:83], v[72:75]
v_cvt_pk_bf16_f32 v81, v50, v51
v_mfma_f32_16x16x32_bf16 v[68:71], a[112:115], a[64:67], v[116:119]
s_lshl1_add_u32 s40, s40, s41
v_exp_f32 v52, v52
v_mfma_f32_16x16x32_bf16 v[68:71], a[116:119], a[68:71], v[68:71]
s_and_b32 s42, s2, 1
v_mfma_f32_16x16x32_bf16 v[68:71], a[120:123], a[72:75], v[68:71]
s_lshl1_add_u32 s40, s40, s42
v_exp_f32 v53, v53
v_mfma_f32_16x16x32_bf16 v[68:71], a[124:127], a[76:79], v[68:71]
s_lshr_b32 s41, s2, 3
v_cvt_pk_bf16_f32 v82, v52, v53
v_mfma_f32_16x16x32_bf16 v[76:79], a[124:127], a[92:95], v[124:127]
s_and_b32 s41, s41, 7
v_exp_f32 v54, v54
v_mfma_f32_16x16x32_bf16 v[76:79], a[120:123], a[88:91], v[76:79]
s_lshl1_add_u32 s43, s41, s42
buffer_load_dwordx4 v1, s[48:51], s87 offen offset:1024 sc1 lds
v_mfma_f32_16x16x32_bf16 v[76:79], a[116:119], a[84:87], v[76:79]
v_exp_f32 v55, v55
v_mfma_f32_16x16x32_bf16 v[76:79], a[112:115], a[80:83], v[76:79]
v_cvt_pk_bf16_f32 v83, v54, v55
v_mfma_f32_16x16x32_bf16 v[192:195], a[128:131], v[88:91], v[192:195]
v_exp_f32 v56, v56
v_mfma_f32_16x16x32_bf16 v[196:199], a[128:131], v[92:95], v[196:199]
ds_read_b128 a[96:99], v4 offset:0
ds_read_b128 a[100:103], v4 offset:1024
v_mfma_f32_16x16x32_bf16 v[204:207], a[132:135], v[92:95], v[204:207]
v_exp_f32 v57, v57
v_mfma_f32_16x16x32_bf16 v[200:203], a[132:135], v[88:91], v[200:203]
ds_read_b128 a[104:107], v4 offset:2048
v_cvt_pk_bf16_f32 v84, v56, v57
v_mfma_f32_16x16x32_bf16 v[208:211], a[136:139], v[88:91], v[208:211]
v_exp_f32 v58, v58
v_mfma_f32_16x16x32_bf16 v[212:215], a[136:139], v[92:95], v[212:215]
buffer_load_dwordx4 v1, s[48:51], s87 offen offset:2048 sc1 lds
v_mfma_f32_16x16x32_bf16 v[220:223], a[140:143], v[92:95], v[220:223]
v_exp_f32 v59, v59
v_mfma_f32_16x16x32_bf16 v[216:219], a[140:143], v[88:91], v[216:219]
ds_read_b128 a[108:111], v4 offset:3072
v_cvt_pk_bf16_f32 v85, v58, v59
v_mfma_f32_16x16x32_bf16 v[224:227], a[144:147], v[88:91], v[224:227]
s_add_u32 s84, s84, 16384
v_exp_f32 v60, v60
v_mfma_f32_16x16x32_bf16 v[228:231], a[144:147], v[92:95], v[228:231]
s_cmp_eq_u32 s84, 163840
ds_read_b128 a[112:115], v4 offset:4096
ds_read_b128 a[116:119], v4 offset:5120
v_mfma_f32_16x16x32_bf16 v[236:239], a[148:151], v[92:95], v[236:239]
s_cselect_b32 s84, 0, s84
v_exp_f32 v61, v61
v_mfma_f32_16x16x32_bf16 v[232:235], a[148:151], v[88:91], v[232:235]
s_lshl4_add_u32 s43, s43, s3
ds_read_b128 a[120:123], v4 offset:6144
v_cvt_pk_bf16_f32 v86, v60, v61
v_mfma_f32_16x16x32_bf16 v[240:243], a[152:155], v[88:91], v[240:243]
s_mul_i32 s43, s43, 20480
v_exp_f32 v62, v62
v_mfma_f32_16x16x32_bf16 v[244:247], a[152:155], v[92:95], v[244:247]
s_add_u32 s43, s43, 13631488
buffer_load_dwordx4 v1, s[48:51], s87 offen offset:3072 sc1 lds
v_mfma_f32_16x16x32_bf16 v[252:255], a[156:159], v[92:95], v[252:255]
v_exp_f32 v63, v63
v_mfma_f32_16x16x32_bf16 v[248:251], a[156:159], v[88:91], v[248:251]
ds_read_b128 a[124:127], v4 offset:7168
v_cvt_pk_bf16_f32 v87, v62, v63
v_mfma_f32_16x16x32_bf16 a[168:171], a[176:179], v[88:91], a[168:171]
v_add_u32 v4, s84, v1
v_mfma_f32_16x16x32_bf16 a[172:175], a[176:179], v[92:95], a[172:175]
s_waitcnt vmcnt(5) lgkmcnt(2)
v_cmp_gt_u32 vcc, 80, v12
s_nop 1
s_cbranch_vccnz L_at_spinq
L_at_goq:
v_mfma_f32_16x16x32_bf16 v[48:51], a[96:99], v[16:19], v[96:99]
v_exp_f32 v64, v64
v_mfma_f32_16x16x32_bf16 v[48:51], a[100:103], v[20:23], v[48:51]
ds_read_b128 a[128:131], v5 offset:8192
ds_read_b128 a[132:135], v5 offset:9216
v_mfma_f32_16x16x32_bf16 v[48:51], a[104:107], v[24:27], v[48:51]
v_exp_f32 v65, v65
v_mfma_f32_16x16x32_bf16 v[48:51], a[108:111], v[28:31], v[48:51]
ds_read_b128 a[136:139], v5 offset:10240
v_cvt_pk_bf16_f32 v88, v64, v65
v_mfma_f32_16x16x32_bf16 v[56:59], a[108:111], v[44:47], v[104:107]
v_exp_f32 v66, v66
v_mfma_f32_16x16x32_bf16 v[56:59], a[104:107], v[40:43], v[56:59]
buffer_load_dwordx4 a[0:3], v1, s[60:63], s43 offen offset:0 sc1
v_mfma_f32_16x16x32_bf16 v[56:59], a[100:103], v[36:39], v[56:59]
v_exp_f32 v67, v67
v_mfma_f32_16x16x32_bf16 v[56:59], a[96:99], v[32:35], v[56:59]
s_waitcnt lgkmcnt(3)
ds_read_b128 a[140:143], v5 offset:11264
v_cvt_pk_bf16_f32 v89, v66, v67
v_mfma_f32_16x16x32_bf16 v[52:55], a[112:115], v[16:19], v[100:103]
v_exp_f32 v68, v68
v_mfma_f32_16x16x32_bf16 v[52:55], a[116:119], v[20:23], v[52:55]
ds_read_b128 a[144:147], v5 offset:12288
ds_read_b128 a[148:151], v5 offset:13312
v_mfma_f32_16x16x32_bf16 v[52:55], a[120:123], v[24:27], v[52:55]
v_exp_f32 v69, v69
v_mfma_f32_16x16x32_bf16 v[52:55], a[124:127], v[28:31], v[52:55]
ds_read_b128 a[152:155], v5 offset:14336
v_cvt_pk_bf16_f32 v90, v68, v69
v_mfma_f32_16x16x32_bf16 v[60:63], a[124:127], v[44:47], v[108:111]
v_exp_f32 v70, v70
v_mfma_f32_16x16x32_bf16 v[60:63], a[120:123], v[40:43], v[60:63]
buffer_load_dwordx4 a[4:7], v1, s[60:63], s43 offen offset:1024 sc1
v_mfma_f32_16x16x32_bf16 v[60:63], a[116:119], v[36:39], v[60:63]
v_exp_f32 v71, v71
v_mfma_f32_16x16x32_bf16 v[60:63], a[112:115], v[32:35], v[60:63]
s_waitcnt lgkmcnt(1)
ds_read_b128 a[156:159], v5 offset:15360
v_cvt_pk_bf16_f32 v91, v70, v71
v_mfma_f32_16x16x32_bf16 v[128:131], a[128:131], v[80:83], v[128:131]
v_exp_f32 v72, v72
v_mfma_f32_16x16x32_bf16 v[132:135], a[128:131], v[84:87], v[132:135]
s_barrier
v_mfma_f32_16x16x32_bf16 v[140:143], a[132:135], v[84:87], v[140:143]
s_add_u32 s85, s85, 16384
v_exp_f32 v73, v73
v_mfma_f32_16x16x32_bf16 v[136:139], a[132:135], v[80:83], v[136:139]
v_cvt_pk_bf16_f32 v92, v72, v73
v_mfma_f32_16x16x32_bf16 v[144:147], a[136:139], v[80:83], v[144:147]
s_cmp_eq_u32 s85, 163840
v_exp_f32 v74, v74
v_mfma_f32_16x16x32_bf16 v[148:151], a[136:139], v[84:87], v[148:151]
v_mfma_f32_16x16x32_bf16 v[156:159], a[140:143], v[84:87], v[156:159]
s_cselect_b32 s85, 0, s85
v_exp_f32 v75, v75
v_mfma_f32_16x16x32_bf16 v[152:155], a[140:143], v[80:83], v[152:155]
s_waitcnt lgkmcnt(0)
v_cvt_pk_bf16_f32 v93, v74, v75
v_mfma_f32_16x16x32_bf16 v[160:163], a[144:147], v[80:83], v[160:163]
v_exp_f32 v76, v76
v_mfma_f32_16x16x32_bf16 v[164:167], a[144:147], v[84:87], v[164:167]
buffer_load_dwordx4 a[8:11], v1, s[60:63], s43 offen offset:2048 sc1
v_mfma_f32_16x16x32_bf16 v[172:175], a[148:151], v[84:87], v[172:175]
v_exp_f32 v77, v77
v_mfma_f32_16x16x32_bf16 v[168:171], a[148:151], v[80:83], v[168:171]
v_cvt_pk_bf16_f32 v94, v76, v77
v_mfma_f32_16x16x32_bf16 v[176:179], a[152:155], v[80:83], v[176:179]
v_exp_f32 v78, v78
v_mfma_f32_16x16x32_bf16 v[180:183], a[152:155], v[84:87], v[180:183]
buffer_load_dwordx4 a[12:15], v1, s[60:63], s43 offen offset:3072 sc1
v_mfma_f32_16x16x32_bf16 v[188:191], a[156:159], v[84:87], v[188:191]
s_add_u32 s43, s43, 4096
v_exp_f32 v79, v79
v_mfma_f32_16x16x32_bf16 v[184:187], a[156:159], v[80:83], v[184:187]
buffer_load_dwordx4 a[16:19], v1, s[60:63], s43 offen offset:0 sc1
v_cvt_pk_bf16_f32 v95, v78, v79
v_mfma_f32_16x16x32_bf16 a[160:163], a[176:179], v[80:83], a[160:163]
v_add_u32 v5, s85, v1
v_mfma_f32_16x16x32_bf16 a[164:167], a[176:179], v[84:87], a[164:167]
buffer_load_dwordx4 a[20:23], v1, s[60:63], s43 offen offset:1024 sc1
v_mfma_f32_16x16x32_bf16 v[64:67], a[96:99], a[64:67], v[112:115]
s_add_u32 s86, s86, 16384
v_exp_f32 v48, v48
v_mfma_f32_16x16x32_bf16 v[64:67], a[100:103], a[68:71], v[64:67]
s_cmp_eq_u32 s86, 163840
buffer_load_dwordx4 a[24:27], v1, s[60:63], s43 offen offset:2048 sc1
v_mfma_f32_16x16x32_bf16 v[64:67], a[104:107], a[72:75], v[64:67]
s_cselect_b32 s86, 0, s86
v_exp_f32 v49, v49
v_mfma_f32_16x16x32_bf16 v[64:67], a[108:111], a[76:79], v[64:67]
s_add_u32 m0, s86, s13
v_cvt_pk_bf16_f32 v80, v48, v49
v_mfma_f32_16x16x32_bf16 v[72:75], a[108:111], a[92:95], v[120:123]
s_add_u32 s87, s87, 17408
v_exp_f32 v50, v50
v_mfma_f32_16x16x32_bf16 v[72:75], a[104:107], a[88:91], v[72:75]
buffer_load_dwordx4 v1, s[48:51], s87 offen offset:0 sc1 lds
v_mfma_f32_16x16x32_bf16 v[72:75], a[100:103], a[84:87], v[72:75]
v_exp_f32 v51, v51
v_mfma_f32_16x16x32_bf16 v[72:75], a[96:99], a[80:83], v[72:75]
v_cvt_pk_bf16_f32 v81, v50, v51
v_mfma_f32_16x16x32_bf16 v[68:71], a[112:115], a[64:67], v[116:119]
v_exp_f32 v52, v52
v_mfma_f32_16x16x32_bf16 v[68:71], a[116:119], a[68:71], v[68:71]
buffer_load_dwordx4 a[28:31], v1, s[60:63], s43 offen offset:3072 sc1
v_mfma_f32_16x16x32_bf16 v[68:71], a[120:123], a[72:75], v[68:71]
s_add_u32 s43, s43, 4096
v_exp_f32 v53, v53
v_mfma_f32_16x16x32_bf16 v[68:71], a[124:127], a[76:79], v[68:71]
v_cvt_pk_bf16_f32 v82, v52, v53
v_mfma_f32_16x16x32_bf16 v[76:79], a[124:127], a[92:95], v[124:127]
v_exp_f32 v54, v54
v_mfma_f32_16x16x32_bf16 v[76:79], a[120:123], a[88:91], v[76:79]
buffer_load_dwordx4 v1, s[48:51], s87 offen offset:1024 sc1 lds
v_mfma_f32_16x16x32_bf16 v[76:79], a[116:119], a[84:87], v[76:79]
v_exp_f32 v55, v55
v_mfma_f32_16x16x32_bf16 v[76:79], a[112:115], a[80:83], v[76:79]
v_cvt_pk_bf16_f32 v83, v54, v55
v_mfma_f32_16x16x32_bf16 v[192:195], a[128:131], v[88:91], v[192:195]
v_exp_f32 v56, v56
v_mfma_f32_16x16x32_bf16 v[196:199], a[128:131], v[92:95], v[196:199]
ds_read_b128 a[96:99], v4 offset:0
ds_read_b128 a[100:103], v4 offset:1024
v_mfma_f32_16x16x32_bf16 v[204:207], a[132:135], v[92:95], v[204:207]
v_exp_f32 v57, v57
v_mfma_f32_16x16x32_bf16 v[200:203], a[132:135], v[88:91], v[200:203]
ds_read_b128 a[104:107], v4 offset:2048
v_cvt_pk_bf16_f32 v84, v56, v57
v_mfma_f32_16x16x32_bf16 v[208:211], a[136:139], v[88:91], v[208:211]
v_exp_f32 v58, v58
v_mfma_f32_16x16x32_bf16 v[212:215], a[136:139], v[92:95], v[212:215]
buffer_load_dwordx4 v1, s[48:51], s87 offen offset:2048 sc1 lds
v_mfma_f32_16x16x32_bf16 v[220:223], a[140:143], v[92:95], v[220:223]
v_exp_f32 v59, v59
v_mfma_f32_16x16x32_bf16 v[216:219], a[140:143], v[88:91], v[216:219]
ds_read_b128 a[108:111], v4 offset:3072
v_cvt_pk_bf16_f32 v85, v58, v59
v_mfma_f32_16x16x32_bf16 v[224:227], a[144:147], v[88:91], v[224:227]
s_add_u32 s84, s84, 16384
v_exp_f32 v60, v60
v_mfma_f32_16x16x32_bf16 v[228:231], a[144:147], v[92:95], v[228:231]
s_cmp_eq_u32 s84, 163840
ds_read_b128 a[112:115], v4 offset:4096
ds_read_b128 a[116:119], v4 offset:5120
v_mfma_f32_16x16x32_bf16 v[236:239], a[148:151], v[92:95], v[236:239]
s_cselect_b32 s84, 0, s84
v_exp_f32 v61, v61
v_mfma_f32_16x16x32_bf16 v[232:235], a[148:151], v[88:91], v[232:235]
ds_read_b128 a[120:123], v4 offset:6144
v_cvt_pk_bf16_f32 v86, v60, v61
v_mfma_f32_16x16x32_bf16 v[240:243], a[152:155], v[88:91], v[240:243]
v_exp_f32 v62, v62
v_mfma_f32_16x16x32_bf16 v[244:247], a[152:155], v[92:95], v[244:247]
buffer_load_dwordx4 v1, s[48:51], s87 offen offset:3072 sc1 lds
v_mfma_f32_16x16x32_bf16 v[252:255], a[156:159], v[92:95], v[252:255]
v_exp_f32 v63, v63
v_mfma_f32_16x16x32_bf16 v[248:251], a[156:159], v[88:91], v[248:251]
ds_read_b128 a[124:127], v4 offset:7168
v_cvt_pk_bf16_f32 v87, v62, v63
v_mfma_f32_16x16x32_bf16 a[168:171], a[176:179], v[88:91], a[168:171]
v_add_u32 v4, s84, v1
v_mfma_f32_16x16x32_bf16 a[172:175], a[176:179], v[92:95], a[172:175]
s_waitcnt lgkmcnt(2)
buffer_load_dwordx4 a[32:35], v1, s[60:63], s43 offen offset:0 sc1
v_mfma_f32_16x16x32_bf16 v[48:51], a[96:99], v[16:19], v[96:99]
v_exp_f32 v64, v64
v_mfma_f32_16x16x32_bf16 v[48:51], a[100:103], v[20:23], v[48:51]
ds_read_b128 a[128:131], v5 offset:8192
ds_read_b128 a[132:135], v5 offset:9216
v_mfma_f32_16x16x32_bf16 v[48:51], a[104:107], v[24:27], v[48:51]
v_exp_f32 v65, v65
v_mfma_f32_16x16x32_bf16 v[48:51], a[108:111], v[28:31], v[48:51]
ds_read_b128 a[136:139], v5 offset:10240
v_cvt_pk_bf16_f32 v88, v64, v65
v_mfma_f32_16x16x32_bf16 v[56:59], a[108:111], v[44:47], v[104:107]
v_exp_f32 v66, v66
v_mfma_f32_16x16x32_bf16 v[56:59], a[104:107], v[40:43], v[56:59]
buffer_load_dwordx4 a[36:39], v1, s[60:63], s43 offen offset:1024 sc1
v_mfma_f32_16x16x32_bf16 v[56:59], a[100:103], v[36:39], v[56:59]
s_add_u32 s43, s43, 4096
v_exp_f32 v67, v67
v_mfma_f32_16x16x32_bf16 v[56:59], a[96:99], v[32:35], v[56:59]
s_waitcnt lgkmcnt(3)
ds_read_b128 a[140:143], v5 offset:11264
v_cvt_pk_bf16_f32 v89, v66, v67
v_mfma_f32_16x16x32_bf16 v[52:55], a[112:115], v[16:19], v[100:103]
v_exp_f32 v68, v68
v_mfma_f32_16x16x32_bf16 v[52:55], a[116:119], v[20:23], v[52:55]
ds_read_b128 a[144:147], v5 offset:12288
ds_read_b128 a[148:151], v5 offset:13312
v_mfma_f32_16x16x32_bf16 v[52:55], a[120:123], v[24:27], v[52:55]
v_exp_f32 v69, v69
v_mfma_f32_16x16x32_bf16 v[52:55], a[124:127], v[28:31], v[52:55]
ds_read_b128 a[152:155], v5 offset:14336
v_cvt_pk_bf16_f32 v90, v68, v69
v_mfma_f32_16x16x32_bf16 v[60:63], a[124:127], v[44:47], v[108:111]
v_exp_f32 v70, v70
v_mfma_f32_16x16x32_bf16 v[60:63], a[120:123], v[40:43], v[60:63]
buffer_load_dwordx4 a[40:43], v1, s[60:63], s43 offen offset:3072 sc1
v_mfma_f32_16x16x32_bf16 v[60:63], a[116:119], v[36:39], v[60:63]
v_exp_f32 v71, v71
v_mfma_f32_16x16x32_bf16 v[60:63], a[112:115], v[32:35], v[60:63]
s_waitcnt lgkmcnt(1)
ds_read_b128 a[156:159], v5 offset:15360
v_cvt_pk_bf16_f32 v91, v70, v71
v_mfma_f32_16x16x32_bf16 v[128:131], a[128:131], v[80:83], v[128:131]
s_add_u32 s43, s43, 4096
v_exp_f32 v72, v72
v_mfma_f32_16x16x32_bf16 v[132:135], a[128:131], v[84:87], v[132:135]
s_barrier
v_mfma_f32_16x16x32_bf16 v[140:143], a[132:135], v[84:87], v[140:143]
s_add_u32 s85, s85, 16384
v_exp_f32 v73, v73
v_mfma_f32_16x16x32_bf16 v[136:139], a[132:135], v[80:83], v[136:139]
v_cvt_pk_bf16_f32 v92, v72, v73
v_mfma_f32_16x16x32_bf16 v[144:147], a[136:139], v[80:83], v[144:147]
s_cmp_eq_u32 s85, 163840
v_exp_f32 v74, v74
v_mfma_f32_16x16x32_bf16 v[148:151], a[136:139], v[84:87], v[148:151]
v_mfma_f32_16x16x32_bf16 v[156:159], a[140:143], v[84:87], v[156:159]
s_cselect_b32 s85, 0, s85
v_exp_f32 v75, v75
v_mfma_f32_16x16x32_bf16 v[152:155], a[140:143], v[80:83], v[152:155]
s_waitcnt lgkmcnt(0)
v_cvt_pk_bf16_f32 v93, v74, v75
v_mfma_f32_16x16x32_bf16 v[160:163], a[144:147], v[80:83], v[160:163]
v_exp_f32 v76, v76
v_mfma_f32_16x16x32_bf16 v[164:167], a[144:147], v[84:87], v[164:167]
buffer_load_dwordx4 a[44:47], v1, s[60:63], s43 offen offset:0 sc1
v_mfma_f32_16x16x32_bf16 v[172:175], a[148:151], v[84:87], v[172:175]
v_exp_f32 v77, v77
v_mfma_f32_16x16x32_bf16 v[168:171], a[148:151], v[80:83], v[168:171]
v_cvt_pk_bf16_f32 v94, v76, v77
v_mfma_f32_16x16x32_bf16 v[176:179], a[152:155], v[80:83], v[176:179]
v_exp_f32 v78, v78
v_mfma_f32_16x16x32_bf16 v[180:183], a[152:155], v[84:87], v[180:183]
buffer_load_dwordx4 a[48:51], v1, s[60:63], s43 offen offset:1024 sc1
v_mfma_f32_16x16x32_bf16 v[188:191], a[156:159], v[84:87], v[188:191]
v_exp_f32 v79, v79
v_mfma_f32_16x16x32_bf16 v[184:187], a[156:159], v[80:83], v[184:187]
buffer_load_dwordx4 a[52:55], v1, s[60:63], s43 offen offset:2048 sc1
v_cvt_pk_bf16_f32 v95, v78, v79
v_mfma_f32_16x16x32_bf16 a[160:163], a[176:179], v[80:83], a[160:163]
v_add_u32 v5, s85, v1
v_mfma_f32_16x16x32_bf16 a[164:167], a[176:179], v[84:87], a[164:167]
buffer_load_dwordx4 a[56:59], v1, s[60:63], s43 offen offset:3072 sc1
s_add_u32 s43, s43, 147456
v_mfma_f32_16x16x32_bf16 v[64:67], a[96:99], a[64:67], v[112:115]
s_add_u32 s86, s86, 16384
v_exp_f32 v48, v48
v_mfma_f32_16x16x32_bf16 v[64:67], a[100:103], a[68:71], v[64:67]
s_cmp_eq_u32 s86, 163840
buffer_load_dwordx4 a[180:183], v1, s[60:63], s43 offen offset:0 sc1
v_mfma_f32_16x16x32_bf16 v[64:67], a[104:107], a[72:75], v[64:67]
s_cselect_b32 s86, 0, s86
v_exp_f32 v49, v49
v_mfma_f32_16x16x32_bf16 v[64:67], a[108:111], a[76:79], v[64:67]
s_add_u32 m0, s86, s13
v_cvt_pk_bf16_f32 v80, v48, v49
v_mfma_f32_16x16x32_bf16 v[72:75], a[108:111], a[92:95], v[120:123]
s_add_u32 s87, s87, 17408
v_exp_f32 v50, v50
v_mfma_f32_16x16x32_bf16 v[72:75], a[104:107], a[88:91], v[72:75]
buffer_load_dwordx4 v1, s[48:51], s87 offen offset:0 sc1 lds
v_mfma_f32_16x16x32_bf16 v[72:75], a[100:103], a[84:87], v[72:75]
v_exp_f32 v51, v51
v_mfma_f32_16x16x32_bf16 v[72:75], a[96:99], a[80:83], v[72:75]
v_cvt_pk_bf16_f32 v81, v50, v51
v_mfma_f32_16x16x32_bf16 v[68:71], a[112:115], a[64:67], v[116:119]
v_exp_f32 v52, v52
v_mfma_f32_16x16x32_bf16 v[68:71], a[116:119], a[68:71], v[68:71]
buffer_load_dwordx4 a[184:187], v1, s[60:63], s43 offen offset:1024 sc1
v_mfma_f32_16x16x32_bf16 v[68:71], a[120:123], a[72:75], v[68:71]
v_exp_f32 v53, v53
v_mfma_f32_16x16x32_bf16 v[68:71], a[124:127], a[76:79], v[68:71]
v_cvt_pk_bf16_f32 v82, v52, v53
v_mfma_f32_16x16x32_bf16 v[76:79], a[124:127], a[92:95], v[124:127]
v_exp_f32 v54, v54
v_mfma_f32_16x16x32_bf16 v[76:79], a[120:123], a[88:91], v[76:79]
buffer_load_dwordx4 v1, s[48:51], s87 offen offset:1024 sc1 lds
v_mfma_f32_16x16x32_bf16 v[76:79], a[116:119], a[84:87], v[76:79]
v_exp_f32 v55, v55
v_mfma_f32_16x16x32_bf16 v[76:79], a[112:115], a[80:83], v[76:79]
v_cvt_pk_bf16_f32 v83, v54, v55
v_mfma_f32_16x16x32_bf16 v[192:195], a[128:131], v[88:91], v[192:195]
v_exp_f32 v56, v56
v_mfma_f32_16x16x32_bf16 v[196:199], a[128:131], v[92:95], v[196:199]
ds_read_b128 a[96:99], v4 offset:0
ds_read_b128 a[100:103], v4 offset:1024
v_mfma_f32_16x16x32_bf16 v[204:207], a[132:135], v[92:95], v[204:207]
v_exp_f32 v57, v57
v_mfma_f32_16x16x32_bf16 v[200:203], a[132:135], v[88:91], v[200:203]
ds_read_b128 a[104:107], v4 offset:2048
v_cvt_pk_bf16_f32 v84, v56, v57
v_mfma_f32_16x16x32_bf16 v[208:211], a[136:139], v[88:91], v[208:211]
v_exp_f32 v58, v58
v_mfma_f32_16x16x32_bf16 v[212:215], a[136:139], v[92:95], v[212:215]
buffer_load_dwordx4 v1, s[48:51], s87 offen offset:2048 sc1 lds
v_mfma_f32_16x16x32_bf16 v[220:223], a[140:143], v[92:95], v[220:223]
v_exp_f32 v59, v59
v_mfma_f32_16x16x32_bf16 v[216:219], a[140:143], v[88:91], v[216:219]
ds_read_b128 a[108:111], v4 offset:3072
v_cvt_pk_bf16_f32 v85, v58, v59
v_mfma_f32_16x16x32_bf16 v[224:227], a[144:147], v[88:91], v[224:227]
s_add_u32 s84, s84, 16384
v_exp_f32 v60, v60
v_mfma_f32_16x16x32_bf16 v[228:231], a[144:147], v[92:95], v[228:231]
s_cmp_eq_u32 s84, 163840
ds_read_b128 a[112:115], v4 offset:4096
ds_read_b128 a[116:119], v4 offset:5120
v_mfma_f32_16x16x32_bf16 v[236:239], a[148:151], v[92:95], v[236:239]
s_cselect_b32 s84, 0, s84
v_exp_f32 v61, v61
v_mfma_f32_16x16x32_bf16 v[232:235], a[148:151], v[88:91], v[232:235]
ds_read_b128 a[120:123], v4 offset:6144
v_cvt_pk_bf16_f32 v86, v60, v61
v_mfma_f32_16x16x32_bf16 v[240:243], a[152:155], v[88:91], v[240:243]
v_exp_f32 v62, v62
v_mfma_f32_16x16x32_bf16 v[244:247], a[152:155], v[92:95], v[244:247]
buffer_load_dwordx4 v1, s[48:51], s87 offen offset:3072 sc1 lds
v_mfma_f32_16x16x32_bf16 v[252:255], a[156:159], v[92:95], v[252:255]
v_exp_f32 v63, v63
v_mfma_f32_16x16x32_bf16 v[248:251], a[156:159], v[88:91], v[248:251]
ds_read_b128 a[124:127], v4 offset:7168
v_cvt_pk_bf16_f32 v87, v62, v63
v_mfma_f32_16x16x32_bf16 a[168:171], a[176:179], v[88:91], a[168:171]
v_add_u32 v4, s84, v1
v_mfma_f32_16x16x32_bf16 a[172:175], a[176:179], v[92:95], a[172:175]
s_waitcnt lgkmcnt(2)
buffer_load_dwordx4 a[188:191], v1, s[60:63], s43 offen offset:2048 sc1
v_mfma_f32_16x16x32_bf16 v[48:51], a[96:99], v[16:19], v[96:99]
v_exp_f32 v64, v64
v_mfma_f32_16x16x32_bf16 v[48:51], a[100:103], v[20:23], v[48:51]
ds_read_b128 a[128:131], v5 offset:8192
ds_read_b128 a[132:135], v5 offset:9216
v_mfma_f32_16x16x32_bf16 v[48:51], a[104:107], v[24:27], v[48:51]
v_exp_f32 v65, v65
v_mfma_f32_16x16x32_bf16 v[48:51], a[108:111], v[28:31], v[48:51]
ds_read_b128 a[136:139], v5 offset:10240
v_cvt_pk_bf16_f32 v88, v64, v65
v_mfma_f32_16x16x32_bf16 v[56:59], a[108:111], v[44:47], v[104:107]
v_exp_f32 v66, v66
v_mfma_f32_16x16x32_bf16 v[56:59], a[104:107], v[40:43], v[56:59]
buffer_load_dwordx4 a[192:195], v1, s[60:63], s43 offen offset:3072 sc1
v_mfma_f32_16x16x32_bf16 v[56:59], a[100:103], v[36:39], v[56:59]
s_add_u32 s43, s43, 4096
v_exp_f32 v67, v67
v_mfma_f32_16x16x32_bf16 v[56:59], a[96:99], v[32:35], v[56:59]
s_waitcnt lgkmcnt(3)
ds_read_b128 a[140:143], v5 offset:11264
v_cvt_pk_bf16_f32 v89, v66, v67
v_mfma_f32_16x16x32_bf16 v[52:55], a[112:115], v[16:19], v[100:103]
v_exp_f32 v68, v68
v_mfma_f32_16x16x32_bf16 v[52:55], a[116:119], v[20:23], v[52:55]
ds_read_b128 a[144:147], v5 offset:12288
ds_read_b128 a[148:151], v5 offset:13312
v_mfma_f32_16x16x32_bf16 v[52:55], a[120:123], v[24:27], v[52:55]
v_exp_f32 v69, v69
v_mfma_f32_16x16x32_bf16 v[52:55], a[124:127], v[28:31], v[52:55]
ds_read_b128 a[152:155], v5 offset:14336
v_cvt_pk_bf16_f32 v90, v68, v69
v_mfma_f32_16x16x32_bf16 v[60:63], a[124:127], v[44:47], v[108:111]
v_exp_f32 v70, v70
v_mfma_f32_16x16x32_bf16 v[60:63], a[120:123], v[40:43], v[60:63]
buffer_load_dwordx4 a[196:199], v1, s[60:63], s43 offen offset:0 sc1
v_mfma_f32_16x16x32_bf16 v[60:63], a[116:119], v[36:39], v[60:63]
s_waitcnt vmcnt(28)
v_exp_f32 v71, v71
v_mfma_f32_16x16x32_bf16 v[60:63], a[112:115], v[32:35], v[60:63]
s_waitcnt lgkmcnt(1)
ds_read_b128 a[156:159], v5 offset:15360
v_cvt_pk_bf16_f32 v91, v70, v71
v_mfma_f32_16x16x32_bf16 v[128:131], a[128:131], v[80:83], v[128:131]
v_exp_f32 v72, v72
v_mfma_f32_16x16x32_bf16 v[132:135], a[128:131], v[84:87], v[132:135]
s_barrier
v_mfma_f32_16x16x32_bf16 v[140:143], a[132:135], v[84:87], v[140:143]
s_add_u32 s85, s85, 16384
v_exp_f32 v73, v73
v_mfma_f32_16x16x32_bf16 v[136:139], a[132:135], v[80:83], v[136:139]
v_cvt_pk_bf16_f32 v92, v72, v73
v_mfma_f32_16x16x32_bf16 v[144:147], a[136:139], v[80:83], v[144:147]
s_cmp_eq_u32 s85, 163840
v_exp_f32 v74, v74
v_mfma_f32_16x16x32_bf16 v[148:151], a[136:139], v[84:87], v[148:151]
v_mfma_f32_16x16x32_bf16 v[156:159], a[140:143], v[84:87], v[156:159]
s_cselect_b32 s85, 0, s85
v_exp_f32 v75, v75
v_mfma_f32_16x16x32_bf16 v[152:155], a[140:143], v[80:83], v[152:155]
s_waitcnt lgkmcnt(0)
v_cvt_pk_bf16_f32 v93, v74, v75
v_mfma_f32_16x16x32_bf16 v[160:163], a[144:147], v[80:83], v[160:163]
v_exp_f32 v76, v76
v_mfma_f32_16x16x32_bf16 v[164:167], a[144:147], v[84:87], v[164:167]
buffer_load_dwordx4 a[200:203], v1, s[60:63], s43 offen offset:1024 sc1
v_mfma_f32_16x16x32_bf16 v[172:175], a[148:151], v[84:87], v[172:175]
v_exp_f32 v77, v77
v_mfma_f32_16x16x32_bf16 v[168:171], a[148:151], v[80:83], v[168:171]
v_cvt_pk_bf16_f32 v94, v76, v77
v_mfma_f32_16x16x32_bf16 v[176:179], a[152:155], v[80:83], v[176:179]
v_exp_f32 v78, v78
v_mfma_f32_16x16x32_bf16 v[180:183], a[152:155], v[84:87], v[180:183]
buffer_load_dwordx4 a[204:207], v1, s[60:63], s43 offen offset:2048 sc1
v_mfma_f32_16x16x32_bf16 v[188:191], a[156:159], v[84:87], v[188:191]
v_exp_f32 v79, v79
v_mfma_f32_16x16x32_bf16 v[184:187], a[156:159], v[80:83], v[184:187]
buffer_load_dwordx4 a[208:211], v1, s[60:63], s43 offen offset:3072 sc1
v_cvt_pk_bf16_f32 v95, v78, v79
v_mfma_f32_16x16x32_bf16 a[160:163], a[176:179], v[80:83], a[160:163]
s_add_u32 s43, s43, 4096
v_add_u32 v5, s85, v1
v_mfma_f32_16x16x32_bf16 a[164:167], a[176:179], v[84:87], a[164:167]
buffer_load_dwordx4 a[212:215], v1, s[60:63], s43 offen offset:0 sc1
v_mfma_f32_16x16x32_bf16 v[64:67], a[96:99], a[64:67], v[112:115]
s_add_u32 s86, s86, 16384
v_exp_f32 v48, v48
v_mfma_f32_16x16x32_bf16 v[64:67], a[100:103], a[68:71], v[64:67]
s_cmp_eq_u32 s86, 163840
buffer_load_dwordx4 a[216:219], v1, s[60:63], s43 offen offset:1024 sc1
v_mfma_f32_16x16x32_bf16 v[64:67], a[104:107], a[72:75], v[64:67]
s_cselect_b32 s86, 0, s86
v_exp_f32 v49, v49
v_mfma_f32_16x16x32_bf16 v[64:67], a[108:111], a[76:79], v[64:67]
s_add_u32 m0, s86, s13
v_cvt_pk_bf16_f32 v80, v48, v49
v_mfma_f32_16x16x32_bf16 v[72:75], a[108:111], a[92:95], v[120:123]
s_add_u32 s87, s87, 17408
v_exp_f32 v50, v50
v_mfma_f32_16x16x32_bf16 v[72:75], a[104:107], a[88:91], v[72:75]
buffer_load_dwordx4 v1, s[48:51], s87 offen offset:0 sc1 lds
v_mfma_f32_16x16x32_bf16 v[72:75], a[100:103], a[84:87], v[72:75]
v_exp_f32 v51, v51
v_mfma_f32_16x16x32_bf16 v[72:75], a[96:99], a[80:83], v[72:75]
v_cvt_pk_bf16_f32 v81, v50, v51
v_mfma_f32_16x16x32_bf16 v[68:71], a[112:115], a[64:67], v[116:119]
v_exp_f32 v52, v52
v_mfma_f32_16x16x32_bf16 v[68:71], a[116:119], a[68:71], v[68:71]
buffer_load_dwordx4 a[220:223], v1, s[60:63], s43 offen offset:2048 sc1
v_mfma_f32_16x16x32_bf16 v[68:71], a[120:123], a[72:75], v[68:71]
v_exp_f32 v53, v53
v_mfma_f32_16x16x32_bf16 v[68:71], a[124:127], a[76:79], v[68:71]
v_cvt_pk_bf16_f32 v82, v52, v53
v_mfma_f32_16x16x32_bf16 v[76:79], a[124:127], a[92:95], v[124:127]
v_exp_f32 v54, v54
v_mfma_f32_16x16x32_bf16 v[76:79], a[120:123], a[88:91], v[76:79]
buffer_load_dwordx4 v1, s[48:51], s87 offen offset:1024 sc1 lds
v_mfma_f32_16x16x32_bf16 v[76:79], a[116:119], a[84:87], v[76:79]
v_exp_f32 v55, v55
v_mfma_f32_16x16x32_bf16 v[76:79], a[112:115], a[80:83], v[76:79]
v_cvt_pk_bf16_f32 v83, v54, v55
v_mfma_f32_16x16x32_bf16 v[192:195], a[128:131], v[88:91], v[192:195]
v_exp_f32 v56, v56
v_mfma_f32_16x16x32_bf16 v[196:199], a[128:131], v[92:95], v[196:199]
ds_read_b128 a[96:99], v4 offset:0
ds_read_b128 a[100:103], v4 offset:1024
v_mfma_f32_16x16x32_bf16 v[204:207], a[132:135], v[92:95], v[204:207]
v_exp_f32 v57, v57
v_mfma_f32_16x16x32_bf16 v[200:203], a[132:135], v[88:91], v[200:203]
ds_read_b128 a[104:107], v4 offset:2048
v_cvt_pk_bf16_f32 v84, v56, v57
v_mfma_f32_16x16x32_bf16 v[208:211], a[136:139], v[88:91], v[208:211]
v_exp_f32 v58, v58
v_mfma_f32_16x16x32_bf16 v[212:215], a[136:139], v[92:95], v[212:215]
buffer_load_dwordx4 v1, s[48:51], s87 offen offset:2048 sc1 lds
v_mfma_f32_16x16x32_bf16 v[220:223], a[140:143], v[92:95], v[220:223]
v_exp_f32 v59, v59
v_mfma_f32_16x16x32_bf16 v[216:219], a[140:143], v[88:91], v[216:219]
ds_read_b128 a[108:111], v4 offset:3072
v_cvt_pk_bf16_f32 v85, v58, v59
v_mfma_f32_16x16x32_bf16 v[224:227], a[144:147], v[88:91], v[224:227]
s_add_u32 s84, s84, 16384
v_exp_f32 v60, v60
v_mfma_f32_16x16x32_bf16 v[228:231], a[144:147], v[92:95], v[228:231]
s_cmp_eq_u32 s84, 163840
ds_read_b128 a[112:115], v4 offset:4096
ds_read_b128 a[116:119], v4 offset:5120
v_mfma_f32_16x16x32_bf16 v[236:239], a[148:151], v[92:95], v[236:239]
s_cselect_b32 s84, 0, s84
v_exp_f32 v61, v61
v_mfma_f32_16x16x32_bf16 v[232:235], a[148:151], v[88:91], v[232:235]
ds_read_b128 a[120:123], v4 offset:6144
v_cvt_pk_bf16_f32 v86, v60, v61
v_mfma_f32_16x16x32_bf16 v[240:243], a[152:155], v[88:91], v[240:243]
v_exp_f32 v62, v62
v_mfma_f32_16x16x32_bf16 v[244:247], a[152:155], v[92:95], v[244:247]
buffer_load_dwordx4 v1, s[48:51], s87 offen offset:3072 sc1 lds
v_mfma_f32_16x16x32_bf16 v[252:255], a[156:159], v[92:95], v[252:255]
v_exp_f32 v63, v63
v_mfma_f32_16x16x32_bf16 v[248:251], a[156:159], v[88:91], v[248:251]
ds_read_b128 a[124:127], v4 offset:7168
v_cvt_pk_bf16_f32 v87, v62, v63
v_mfma_f32_16x16x32_bf16 a[168:171], a[176:179], v[88:91], a[168:171]
v_add_u32 v4, s84, v1
v_mfma_f32_16x16x32_bf16 a[172:175], a[176:179], v[92:95], a[172:175]
s_waitcnt lgkmcnt(2)
buffer_load_dwordx4 a[224:227], v1, s[60:63], s43 offen offset:3072 sc1
s_add_u32 s43, s43, 4096
v_mfma_f32_16x16x32_bf16 v[48:51], a[96:99], v[16:19], v[96:99]
v_exp_f32 v64, v64
v_mfma_f32_16x16x32_bf16 v[48:51], a[100:103], v[20:23], v[48:51]
ds_read_b128 a[128:131], v5 offset:8192
ds_read_b128 a[132:135], v5 offset:9216
v_mfma_f32_16x16x32_bf16 v[48:51], a[104:107], v[24:27], v[48:51]
v_exp_f32 v65, v65
v_mfma_f32_16x16x32_bf16 v[48:51], a[108:111], v[28:31], v[48:51]
ds_read_b128 a[136:139], v5 offset:10240
v_cvt_pk_bf16_f32 v88, v64, v65
v_mfma_f32_16x16x32_bf16 v[56:59], a[108:111], v[44:47], v[104:107]
v_exp_f32 v66, v66
v_mfma_f32_16x16x32_bf16 v[56:59], a[104:107], v[40:43], v[56:59]
buffer_load_dwordx4 a[228:231], v1, s[60:63], s43 offen offset:0 sc1
v_mfma_f32_16x16x32_bf16 v[56:59], a[100:103], v[36:39], v[56:59]
v_exp_f32 v67, v67
v_mfma_f32_16x16x32_bf16 v[56:59], a[96:99], v[32:35], v[56:59]
s_waitcnt lgkmcnt(3)
ds_read_b128 a[140:143], v5 offset:11264
v_cvt_pk_bf16_f32 v89, v66, v67
v_mfma_f32_16x16x32_bf16 v[52:55], a[112:115], v[16:19], v[100:103]
v_exp_f32 v68, v68
v_mfma_f32_16x16x32_bf16 v[52:55], a[116:119], v[20:23], v[52:55]
ds_read_b128 a[144:147], v5 offset:12288
ds_read_b128 a[148:151], v5 offset:13312
v_mfma_f32_16x16x32_bf16 v[52:55], a[120:123], v[24:27], v[52:55]
v_exp_f32 v69, v69
v_mfma_f32_16x16x32_bf16 v[52:55], a[124:127], v[28:31], v[52:55]
ds_read_b128 a[152:155], v5 offset:14336
v_cvt_pk_bf16_f32 v90, v68, v69
v_mfma_f32_16x16x32_bf16 v[60:63], a[124:127], v[44:47], v[108:111]
v_exp_f32 v70, v70
v_mfma_f32_16x16x32_bf16 v[60:63], a[120:123], v[40:43], v[60:63]
buffer_load_dwordx4 a[232:235], v1, s[60:63], s43 offen offset:1024 sc1
v_mfma_f32_16x16x32_bf16 v[60:63], a[116:119], v[36:39], v[60:63]
s_waitcnt vmcnt(29)
v_exp_f32 v71, v71
v_mfma_f32_16x16x32_bf16 v[60:63], a[112:115], v[32:35], v[60:63]
s_waitcnt lgkmcnt(1)
ds_read_b128 a[156:159], v5 offset:15360
v_cvt_pk_bf16_f32 v91, v70, v71
v_mfma_f32_16x16x32_bf16 v[128:131], a[128:131], v[80:83], v[128:131]
v_exp_f32 v72, v72
v_mfma_f32_16x16x32_bf16 v[132:135], a[128:131], v[84:87], v[132:135]
s_barrier
v_mfma_f32_16x16x32_bf16 v[140:143], a[132:135], v[84:87], v[140:143]
s_add_u32 s85, s85, 16384
v_exp_f32 v73, v73
v_mfma_f32_16x16x32_bf16 v[136:139], a[132:135], v[80:83], v[136:139]
v_cvt_pk_bf16_f32 v92, v72, v73
v_mfma_f32_16x16x32_bf16 v[144:147], a[136:139], v[80:83], v[144:147]
s_cmp_eq_u32 s85, 163840
v_exp_f32 v74, v74
v_mfma_f32_16x16x32_bf16 v[148:151], a[136:139], v[84:87], v[148:151]
v_mfma_f32_16x16x32_bf16 v[156:159], a[140:143], v[84:87], v[156:159]
s_cselect_b32 s85, 0, s85
v_exp_f32 v75, v75
v_mfma_f32_16x16x32_bf16 v[152:155], a[140:143], v[80:83], v[152:155]
s_waitcnt lgkmcnt(0)
v_cvt_pk_bf16_f32 v93, v74, v75
v_mfma_f32_16x16x32_bf16 v[160:163], a[144:147], v[80:83], v[160:163]
v_exp_f32 v76, v76
v_mfma_f32_16x16x32_bf16 v[164:167], a[144:147], v[84:87], v[164:167]
buffer_load_dwordx4 a[236:239], v1, s[60:63], s43 offen offset:2048 sc1
v_mfma_f32_16x16x32_bf16 v[172:175], a[148:151], v[84:87], v[172:175]
v_exp_f32 v77, v77
v_mfma_f32_16x16x32_bf16 v[168:171], a[148:151], v[80:83], v[168:171]
s_add_u32 s43, s43, 4294873088
v_cvt_pk_bf16_f32 v94, v76, v77
v_mfma_f32_16x16x32_bf16 v[176:179], a[152:155], v[80:83], v[176:179]
v_exp_f32 v78, v78
v_mfma_f32_16x16x32_bf16 v[180:183], a[152:155], v[84:87], v[180:183]
buffer_load_dwordx4 a[240:243], v1, s[60:63], s43 offen offset:0 sc1
v_mfma_f32_16x16x32_bf16 v[188:191], a[156:159], v[84:87], v[188:191]
v_exp_f32 v79, v79
v_mfma_f32_16x16x32_bf16 v[184:187], a[156:159], v[80:83], v[184:187]
buffer_load_dwordx4 a[244:247], v1, s[60:63], s43 offen offset:1024 sc1
v_cvt_pk_bf16_f32 v95, v78, v79
v_mfma_f32_16x16x32_bf16 a[160:163], a[176:179], v[80:83], a[160:163]
v_add_u32 v5, s85, v1
v_mfma_f32_16x16x32_bf16 a[164:167], a[176:179], v[84:87], a[164:167]
buffer_load_dwordx4 a[248:251], v1, s[60:63], s43 offen offset:2048 sc1
v_mfma_f32_16x16x32_bf16 v[64:67], a[96:99], a[64:67], v[112:115]
s_add_u32 s86, s86, 16384
v_exp_f32 v48, v48
v_mfma_f32_16x16x32_bf16 v[64:67], a[100:103], a[68:71], v[64:67]
s_cmp_eq_u32 s86, 163840
buffer_load_dwordx4 a[252:255], v1, s[60:63], s43 offen offset:3072 sc1
v_mfma_f32_16x16x32_bf16 v[64:67], a[104:107], a[72:75], v[64:67]
s_cselect_b32 s86, 0, s86
v_exp_f32 v49, v49
v_mfma_f32_16x16x32_bf16 v[64:67], a[108:111], a[76:79], v[64:67]
s_add_u32 m0, s86, s13
v_cvt_pk_bf16_f32 v80, v48, v49
v_mfma_f32_16x16x32_bf16 v[72:75], a[108:111], a[92:95], v[120:123]
s_add_u32 s87, s87, 17408
v_exp_f32 v50, v50
v_mfma_f32_16x16x32_bf16 v[72:75], a[104:107], a[88:91], v[72:75]
buffer_load_dwordx4 v1, s[48:51], s87 offen offset:0 sc1 lds
v_mfma_f32_16x16x32_bf16 v[72:75], a[100:103], a[84:87], v[72:75]
s_add_u32 s43, s43, 4096
v_exp_f32 v51, v51
v_mfma_f32_16x16x32_bf16 v[72:75], a[96:99], a[80:83], v[72:75]
v_cvt_pk_bf16_f32 v81, v50, v51
v_mfma_f32_16x16x32_bf16 v[68:71], a[112:115], a[64:67], v[116:119]
v_exp_f32 v52, v52
v_mfma_f32_16x16x32_bf16 v[68:71], a[116:119], a[68:71], v[68:71]
buffer_load_dwordx4 a[60:63], v1, s[60:63], s43 offen offset:0 sc1
v_mfma_f32_16x16x32_bf16 v[68:71], a[120:123], a[72:75], v[68:71]
v_exp_f32 v53, v53
v_mfma_f32_16x16x32_bf16 v[68:71], a[124:127], a[76:79], v[68:71]
v_cvt_pk_bf16_f32 v82, v52, v53
v_mfma_f32_16x16x32_bf16 v[76:79], a[124:127], a[92:95], v[124:127]
v_exp_f32 v54, v54
v_mfma_f32_16x16x32_bf16 v[76:79], a[120:123], a[88:91], v[76:79]
buffer_load_dwordx4 v1, s[48:51], s87 offen offset:1024 sc1 lds
v_mfma_f32_16x16x32_bf16 v[76:79], a[116:119], a[84:87], v[76:79]
v_exp_f32 v55, v55
v_mfma_f32_16x16x32_bf16 v[76:79], a[112:115], a[80:83], v[76:79]
v_cvt_pk_bf16_f32 v83, v54, v55
v_mfma_f32_16x16x32_bf16 v[192:195], a[128:131], v[88:91], v[192:195]
v_exp_f32 v56, v56
v_mfma_f32_16x16x32_bf16 v[196:199], a[128:131], v[92:95], v[196:199]
ds_read_b128 a[96:99], v4 offset:0
ds_read_b128 a[100:103], v4 offset:1024
v_mfma_f32_16x16x32_bf16 v[204:207], a[132:135], v[92:95], v[204:207]
v_exp_f32 v57, v57
v_mfma_f32_16x16x32_bf16 v[200:203], a[132:135], v[88:91], v[200:203]
ds_read_b128 a[104:107], v4 offset:2048
v_cvt_pk_bf16_f32 v84, v56, v57
v_mfma_f32_16x16x32_bf16 v[208:211], a[136:139], v[88:91], v[208:211]
v_exp_f32 v58, v58
v_mfma_f32_16x16x32_bf16 v[212:215], a[136:139], v[92:95], v[212:215]
buffer_load_dwordx4 v1, s[48:51], s87 offen offset:2048 sc1 lds
v_mfma_f32_16x16x32_bf16 v[220:223], a[140:143], v[92:95], v[220:223]
v_exp_f32 v59, v59
v_mfma_f32_16x16x32_bf16 v[216:219], a[140:143], v[88:91], v[216:219]
ds_read_b128 a[108:111], v4 offset:3072
v_cvt_pk_bf16_f32 v85, v58, v59
v_mfma_f32_16x16x32_bf16 v[224:227], a[144:147], v[88:91], v[224:227]
s_add_u32 s84, s84, 16384
v_exp_f32 v60, v60
v_mfma_f32_16x16x32_bf16 v[228:231], a[144:147], v[92:95], v[228:231]
s_cmp_eq_u32 s84, 163840
ds_read_b128 a[112:115], v4 offset:4096
ds_read_b128 a[116:119], v4 offset:5120
v_mfma_f32_16x16x32_bf16 v[236:239], a[148:151], v[92:95], v[236:239]
s_cselect_b32 s84, 0, s84
v_exp_f32 v61, v61
v_mfma_f32_16x16x32_bf16 v[232:235], a[148:151], v[88:91], v[232:235]
ds_read_b128 a[120:123], v4 offset:6144
v_cvt_pk_bf16_f32 v86, v60, v61
v_mfma_f32_16x16x32_bf16 v[240:243], a[152:155], v[88:91], v[240:243]
v_exp_f32 v62, v62
v_mfma_f32_16x16x32_bf16 v[244:247], a[152:155], v[92:95], v[244:247]
buffer_load_dwordx4 v1, s[48:51], s87 offen offset:3072 sc1 lds
v_mfma_f32_16x16x32_bf16 v[252:255], a[156:159], v[92:95], v[252:255]
v_exp_f32 v63, v63
v_mfma_f32_16x16x32_bf16 v[248:251], a[156:159], v[88:91], v[248:251]
ds_read_b128 a[124:127], v4 offset:7168
v_cvt_pk_bf16_f32 v87, v62, v63
v_mfma_f32_16x16x32_bf16 a[168:171], a[176:179], v[88:91], a[168:171]
v_add_u32 v4, s84, v1
v_mfma_f32_16x16x32_bf16 a[172:175], a[176:179], v[92:95], a[172:175]
s_waitcnt lgkmcnt(2)
s_sub_u32 s89, s89, 5
s_mov_b32 s101, 0
s_branch L_at_shared
L_at_sgx:
s_add_u32 s43, s43, 90112
s_cmp_eq_u32 s5, 6
s_cbranch_scc1 L_at_sg4
s_add_u32 s43, s43, 73728
s_branch L_at_last
L_tl_late:
s_mov_b32 s7, s43
s_add_u32 s43, s43, 73728
buffer_load_dwordx4 v[192:195], v1, s[60:63], s43 offen offset:1024 sc1
buffer_load_dwordx4 v[196:199], v1, s[60:63], s43 offen offset:2048 sc1
buffer_load_dwordx4 v[200:203], v1, s[60:63], s43 offen offset:3072 sc1
s_add_u32 s43, s43, 4096
buffer_load_dwordx4 v[204:207], v1, s[60:63], s43 offen offset:0 sc1
buffer_load_dwordx4 v[208:211], v1, s[60:63], s43 offen offset:1024 sc1
buffer_load_dwordx4 v[212:215], v1, s[60:63], s43 offen offset:2048 sc1
buffer_load_dwordx4 v[216:219], v1, s[60:63], s43 offen offset:3072 sc1
s_add_u32 s43, s43, 4096
buffer_load_dwordx4 v[220:223], v1, s[60:63], s43 offen offset:0 sc1
buffer_load_dwordx4 v[224:227], v1, s[60:63], s43 offen offset:1024 sc1
buffer_load_dwordx4 v[228:231], v1, s[60:63], s43 offen offset:2048 sc1
buffer_load_dwordx4 v[232:235], v1, s[60:63], s43 offen offset:3072 sc1
s_add_u32 s43, s43, 4096
buffer_load_dwordx4 v[236:239], v1, s[60:63], s43 offen offset:0 sc1
buffer_load_dwordx4 v[240:243], v1, s[60:63], s43 offen offset:1024 sc1
buffer_load_dwordx4 v[244:247], v1, s[60:63], s43 offen offset:2048 sc1
buffer_load_dwordx4 v[248:251], v1, s[60:63], s43 offen offset:3072 sc1
s_add_u32 s43, s43, 151552
buffer_load_dwordx4 v[252:255], v1, s[60:63], s43 offen offset:1024 sc1
buffer_load_dwordx4 v[112:115], v1, s[60:63], s43 offen offset:2048 sc1
buffer_load_dwordx4 v[116:119], v1, s[60:63], s43 offen offset:3072 sc1
s_add_u32 s43, s43, 4096
buffer_load_dwordx4 v[120:123], v1, s[60:63], s43 offen offset:0 sc1
buffer_load_dwordx4 v[124:127], v1, s[60:63], s43 offen offset:1024 sc1
s_mov_b32 s43, s7
s_branch L_tl_lated
L_at_short:
v_cndmask_b32 v96, v96, v11, s[76:77]
v_cndmask_b32 v97, v97, v11, s[78:79]
v_cndmask_b32 v98, v98, v11, s[80:81]
v_cndmask_b32 v99, v99, v11, s[82:83]
v_mov_b32 v100, v11
v_mov_b32 v101, v11
v_mov_b32 v102, v11
v_mov_b32 v103, v11
v_cndmask_b32 v108, v108, v11, s[76:77]
v_cndmask_b32 v109, v109, v11, s[78:79]
v_cndmask_b32 v110, v110, v11, s[80:81]
v_cndmask_b32 v111, v111, v11, s[82:83]
v_mfma_f32_16x16x32_bf16 v[48:51], a[96:99], v[16:19], v[96:99]
v_exp_f32 v64, v64
v_mfma_f32_16x16x32_bf16 v[48:51], a[100:103], v[20:23], v[48:51]
ds_read_b128 a[128:131], v5 offset:8192
ds_read_b128 a[132:135], v5 offset:9216
v_mfma_f32_16x16x32_bf16 v[48:51], a[104:107], v[24:27], v[48:51]
v_exp_f32 v65, v65
v_mfma_f32_16x16x32_bf16 v[48:51], a[108:111], v[28:31], v[48:51]
ds_read_b128 a[136:139], v5 offset:10240
v_cvt_pk_bf16_f32 v88, v64, v65
v_mfma_f32_16x16x32_bf16 v[56:59], a[108:111], v[44:47], v[104:107]
v_exp_f32 v66, v66
v_mfma_f32_16x16x32_bf16 v[56:59], a[104:107], v[40:43], v[56:59]
v_mfma_f32_16x16x32_bf16 v[56:59], a[100:103], v[36:39], v[56:59]
v_exp_f32 v67, v67
v_mfma_f32_16x16x32_bf16 v[56:59], a[96:99], v[32:35], v[56:59]
s_waitcnt lgkmcnt(3)
ds_read_b128 a[140:143], v5 offset:11264
v_cvt_pk_bf16_f32 v89, v66, v67
v_mfma_f32_16x16x32_bf16 v[52:55], a[112:115], v[16:19], v[100:103]
v_exp_f32 v68, v68
v_mfma_f32_16x16x32_bf16 v[52:55], a[116:119], v[20:23], v[52:55]
ds_read_b128 a[144:147], v5 offset:12288
ds_read_b128 a[148:151], v5 offset:13312
v_mfma_f32_16x16x32_bf16 v[52:55], a[120:123], v[24:27], v[52:55]
v_exp_f32 v69, v69
v_mfma_f32_16x16x32_bf16 v[52:55], a[124:127], v[28:31], v[52:55]
ds_read_b128 a[152:155], v5 offset:14336
v_cvt_pk_bf16_f32 v90, v68, v69
v_mfma_f32_16x16x32_bf16 v[60:63], a[124:127], v[44:47], v[108:111]
v_exp_f32 v70, v70
v_mfma_f32_16x16x32_bf16 v[60:63], a[120:123], v[40:43], v[60:63]
v_mfma_f32_16x16x32_bf16 v[60:63], a[116:119], v[36:39], v[60:63]
s_waitcnt vmcnt(12)
v_exp_f32 v71, v71
v_mfma_f32_16x16x32_bf16 v[60:63], a[112:115], v[32:35], v[60:63]
s_waitcnt lgkmcnt(1)
ds_read_b128 a[156:159], v5 offset:15360
v_cvt_pk_bf16_f32 v91, v70, v71
v_mfma_f32_16x16x32_bf16 v[128:131], a[128:131], v[80:83], v[128:131]
v_exp_f32 v72, v72
v_mfma_f32_16x16x32_bf16 v[132:135], a[128:131], v[84:87], v[132:135]
s_barrier
v_mfma_f32_16x16x32_bf16 v[140:143], a[132:135], v[84:87], v[140:143]
s_add_u32 s85, s85, 16384
v_exp_f32 v73, v73
v_mfma_f32_16x16x32_bf16 v[136:139], a[132:135], v[80:83], v[136:139]
v_cvt_pk_bf16_f32 v92, v72, v73
v_mfma_f32_16x16x32_bf16 v[144:147], a[136:139], v[80:83], v[144:147]
s_cmp_eq_u32 s85, 163840
v_exp_f32 v74, v74
v_mfma_f32_16x16x32_bf16 v[148:151], a[136:139], v[84:87], v[148:151]
v_mfma_f32_16x16x32_bf16 v[156:159], a[140:143], v[84:87], v[156:159]
s_cselect_b32 s85, 0, s85
v_exp_f32 v75, v75
v_mfma_f32_16x16x32_bf16 v[152:155], a[140:143], v[80:83], v[152:155]
s_waitcnt lgkmcnt(0)
v_cvt_pk_bf16_f32 v93, v74, v75
v_mfma_f32_16x16x32_bf16 v[160:163], a[144:147], v[80:83], v[160:163]
v_exp_f32 v76, v76
v_mfma_f32_16x16x32_bf16 v[164:167], a[144:147], v[84:87], v[164:167]
v_mfma_f32_16x16x32_bf16 v[172:175], a[148:151], v[84:87], v[172:175]
v_exp_f32 v77, v77
v_mfma_f32_16x16x32_bf16 v[168:171], a[148:151], v[80:83], v[168:171]
v_cvt_pk_bf16_f32 v94, v76, v77
v_mfma_f32_16x16x32_bf16 v[176:179], a[152:155], v[80:83], v[176:179]
v_exp_f32 v78, v78
v_mfma_f32_16x16x32_bf16 v[180:183], a[152:155], v[84:87], v[180:183]
v_mfma_f32_16x16x32_bf16 v[188:191], a[156:159], v[84:87], v[188:191]
v_exp_f32 v79, v79
v_mfma_f32_16x16x32_bf16 v[184:187], a[156:159], v[80:83], v[184:187]
v_cvt_pk_bf16_f32 v95, v78, v79
v_mfma_f32_16x16x32_bf16 a[160:163], a[176:179], v[80:83], a[160:163]
v_add_u32 v5, s85, v1
v_mfma_f32_16x16x32_bf16 a[164:167], a[176:179], v[84:87], a[164:167]
v_mfma_f32_16x16x32_bf16 v[192:195], a[128:131], v[88:91], v[192:195]
v_exp_f32 v48, v48
v_mfma_f32_16x16x32_bf16 v[196:199], a[128:131], v[92:95], v[196:199]
v_exp_f32 v49, v49
v_mfma_f32_16x16x32_bf16 v[204:207], a[132:135], v[92:95], v[204:207]
v_exp_f32 v50, v50
v_mfma_f32_16x16x32_bf16 v[200:203], a[132:135], v[88:91], v[200:203]
v_exp_f32 v51, v51
v_mfma_f32_16x16x32_bf16 v[208:211], a[136:139], v[88:91], v[208:211]
v_exp_f32 v52, v52
v_mfma_f32_16x16x32_bf16 v[212:215], a[136:139], v[92:95], v[212:215]
v_exp_f32 v53, v53
v_mfma_f32_16x16x32_bf16 v[220:223], a[140:143], v[92:95], v[220:223]
v_exp_f32 v54, v54
v_mfma_f32_16x16x32_bf16 v[216:219], a[140:143], v[88:91], v[216:219]
v_exp_f32 v55, v55
v_mfma_f32_16x16x32_bf16 v[224:227], a[144:147], v[88:91], v[224:227]
v_exp_f32 v56, v56
v_cvt_pk_bf16_f32 v80, v48, v49
v_mfma_f32_16x16x32_bf16 v[228:231], a[144:147], v[92:95], v[228:231]
v_exp_f32 v57, v57
v_mfma_f32_16x16x32_bf16 v[236:239], a[148:151], v[92:95], v[236:239]
v_exp_f32 v58, v58
v_cvt_pk_bf16_f32 v81, v50, v51
v_mfma_f32_16x16x32_bf16 v[232:235], a[148:151], v[88:91], v[232:235]
v_exp_f32 v59, v59
v_mfma_f32_16x16x32_bf16 v[240:243], a[152:155], v[88:91], v[240:243]
v_exp_f32 v60, v60
v_cvt_pk_bf16_f32 v82, v52, v53
v_mfma_f32_16x16x32_bf16 v[244:247], a[152:155], v[92:95], v[244:247]
v_exp_f32 v61, v61
v_mfma_f32_16x16x32_bf16 v[252:255], a[156:159], v[92:95], v[252:255]
v_exp_f32 v62, v62
v_cvt_pk_bf16_f32 v83, v54, v55
v_mfma_f32_16x16x32_bf16 v[248:251], a[156:159], v[88:91], v[248:251]
v_exp_f32 v63, v63
v_mfma_f32_16x16x32_bf16 a[168:171], a[176:179], v[88:91], a[168:171]
v_cvt_pk_bf16_f32 v84, v56, v57
v_cvt_pk_bf16_f32 v85, v58, v59
v_mfma_f32_16x16x32_bf16 a[172:175], a[176:179], v[92:95], a[172:175]
v_cvt_pk_bf16_f32 v86, v60, v61
v_cvt_pk_bf16_f32 v87, v62, v63
s_nop 2
v_accvgpr_read_b32 v6, a168
s_nop 1
v_accvgpr_read_b32 v7, a172
v_rcp_f32 v8, v6
v_rcp_f32 v9, v7
v_add_f32 v6, v6, v7
v_cmp_nge_f32 vcc, 0x5d800000, v6
s_add_u32 s6, s96, 0
s_nop 0
s_cmp_lg_u64 vcc, 0
s_cselect_b32 s7, 2, 0
s_or_b32 s97, s97, s7
v_pk_mul_f32 v[192:193], v[192:193], v[8:9] op_sel_hi:[1,0]
v_pk_mul_f32 v[194:195], v[194:195], v[8:9] op_sel_hi:[1,0]
v_pk_mul_f32 v[200:201], v[200:201], v[8:9] op_sel_hi:[1,0]
v_pk_mul_f32 v[202:203], v[202:203], v[8:9] op_sel_hi:[1,0]
v_cvt_pk_bf16_f32 v192, v192, v193
v_cvt_pk_bf16_f32 v193, v194, v195
v_cvt_pk_bf16_f32 v194, v200, v201
v_cvt_pk_bf16_f32 v195, v202, v203
v_pk_mul_f32 v[196:197], v[196:197], v[8:9] op_sel:[0,1]
v_pk_mul_f32 v[198:199], v[198:199], v[8:9] op_sel:[0,1]
v_pk_mul_f32 v[204:205], v[204:205], v[8:9] op_sel:[0,1]
v_pk_mul_f32 v[206:207], v[206:207], v[8:9] op_sel:[0,1]
v_cvt_pk_bf16_f32 v196, v196, v197
v_cvt_pk_bf16_f32 v197, v198, v199
v_cvt_pk_bf16_f32 v198, v204, v205
v_cvt_pk_bf16_f32 v199, v206, v207
buffer_store_dwordx4 v[192:195], v1, s[60:63], s6 offen offset:0 sc1
buffer_store_dwordx4 v[196:199], v1, s[60:63], s6 offen offset:1024 sc1
s_add_u32 s6, s6, 4096
v_pk_mul_f32 v[208:209], v[208:209], v[8:9] op_sel_hi:[1,0]
v_pk_mul_f32 v[210:211], v[210:211], v[8:9] op_sel_hi:[1,0]
v_pk_mul_f32 v[216:217], v[216:217], v[8:9] op_sel_hi:[1,0]
v_pk_mul_f32 v[218:219], v[218:219], v[8:9] op_sel_hi:[1,0]
v_cvt_pk_bf16_f32 v208, v208, v209
v_cvt_pk_bf16_f32 v209, v210, v211
v_cvt_pk_bf16_f32 v210, v216, v217
v_cvt_pk_bf16_f32 v211, v218, v219
v_pk_mul_f32 v[212:213], v[212:213], v[8:9] op_sel:[0,1]
v_pk_mul_f32 v[214:215], v[214:215], v[8:9] op_sel:[0,1]
v_pk_mul_f32 v[220:221], v[220:221], v[8:9] op_sel:[0,1]
v_pk_mul_f32 v[222:223], v[222:223], v[8:9] op_sel:[0,1]
v_cvt_pk_bf16_f32 v212, v212, v213
v_cvt_pk_bf16_f32 v213, v214, v215
v_cvt_pk_bf16_f32 v214, v220, v221
v_cvt_pk_bf16_f32 v215, v222, v223
buffer_store_dwordx4 v[208:211], v1, s[60:63], s6 offen offset:0 sc1
buffer_store_dwordx4 v[212:215], v1, s[60:63], s6 offen offset:1024 sc1
s_add_u32 s6, s6, 4096
s_waitcnt vmcnt(4) lgkmcnt(0)
s_barrier
ds_read_b128 a[128:131], v5 offset:8192
ds_read_b128 a[132:135], v5 offset:9216
ds_read_b128 a[136:139], v5 offset:10240
ds_read_b128 a[140:143], v5 offset:11264
ds_read_b128 a[144:147], v5 offset:12288
ds_read_b128 a[148:151], v5 offset:13312
ds_read_b128 a[152:155], v5 offset:14336
ds_read_b128 a[156:159], v5 offset:15360
v_pk_mul_f32 v[224:225], v[224:225], v[8:9] op_sel_hi:[1,0]
v_pk_mul_f32 v[226:227], v[226:227], v[8:9] op_sel_hi:[1,0]
v_pk_mul_f32 v[232:233], v[232:233], v[8:9] op_sel_hi:[1,0]
v_pk_mul_f32 v[234:235], v[234:235], v[8:9] op_sel_hi:[1,0]
v_cvt_pk_bf16_f32 v224, v224, v225
v_cvt_pk_bf16_f32 v225, v226, v227
v_cvt_pk_bf16_f32 v226, v232, v233
v_cvt_pk_bf16_f32 v227, v234, v235
v_pk_mul_f32 v[228:229], v[228:229], v[8:9] op_sel:[0,1]
v_pk_mul_f32 v[230:231], v[230:231], v[8:9] op_sel:[0,1]
v_pk_mul_f32 v[236:237], v[236:237], v[8:9] op_sel:[0,1]
v_pk_mul_f32 v[238:239], v[238:239], v[8:9] op_sel:[0,1]
v_cvt_pk_bf16_f32 v228, v228, v229
v_cvt_pk_bf16_f32 v229, v230, v231
v_cvt_pk_bf16_f32 v230, v236, v237
v_cvt_pk_bf16_f32 v231, v238, v239
buffer_store_dwordx4 v[224:227], v1, s[60:63], s6 offen offset:0 sc1
buffer_store_dwordx4 v[228:231], v1, s[60:63], s6 offen offset:1024 sc1
s_add_u32 s6, s6, 4096
v_pk_mul_f32 v[240:241], v[240:241], v[8:9] op_sel_hi:[1,0]
v_pk_mul_f32 v[242:243], v[242:243], v[8:9] op_sel_hi:[1,0]
v_pk_mul_f32 v[248:249], v[248:249], v[8:9] op_sel_hi:[1,0]
v_pk_mul_f32 v[250:251], v[250:251], v[8:9] op_sel_hi:[1,0]
v_cvt_pk_bf16_f32 v240, v240, v241
v_cvt_pk_bf16_f32 v241, v242, v243
v_cvt_pk_bf16_f32 v242, v248, v249
v_cvt_pk_bf16_f32 v243, v250, v251
v_pk_mul_f32 v[244:245], v[244:245], v[8:9] op_sel:[0,1]
v_pk_mul_f32 v[246:247], v[246:247], v[8:9] op_sel:[0,1]
v_pk_mul_f32 v[252:253], v[252:253], v[8:9] op_sel:[0,1]
v_pk_mul_f32 v[254:255], v[254:255], v[8:9] op_sel:[0,1]
v_cvt_pk_bf16_f32 v244, v244, v245
v_cvt_pk_bf16_f32 v245, v246, v247
v_cvt_pk_bf16_f32 v246, v252, v253
v_cvt_pk_bf16_f32 v247, v254, v255
buffer_store_dwordx4 v[240:243], v1, s[60:63], s6 offen offset:0 sc1
buffer_store_dwordx4 v[244:247], v1, s[60:63], s6 offen offset:1024 sc1
s_add_u32 s43, s43, 167936
s_waitcnt lgkmcnt(0)
s_branch L_at_u65
L_fr_spinm:
s_sleep 8
buffer_load_dword v122, v123, s[72:75], 0 offen sc1
s_add_u32 s38, s38, 1
s_cmp_gt_u32 s38, 200000
s_cbranch_scc1 L_fr_gom
s_waitcnt vmcnt(0)
v_cmp_gt_u32 vcc, s39, v122
s_nop 1
s_cbranch_vccnz L_fr_spinm
s_branch L_fr_gom
L_fr_spinh:
s_sleep 8
buffer_load_dword v122, v123, s[60:63], s29 offen sc1
s_add_u32 s38, s38, 1
s_cmp_gt_u32 s38, 200000
s_cbranch_scc1 L_fr_goh
s_waitcnt vmcnt(0)
v_cmp_gt_u32 vcc, s39, v122
s_nop 1
s_cbranch_vccnz L_fr_spinh
s_branch L_fr_goh
L_fr_spinf:
s_sleep 8
buffer_load_dword v122, v123, s[60:63], s29 offen sc1
s_add_u32 s38, s38, 1
s_cmp_gt_u32 s38, 200000
s_cbranch_scc1 L_fr_gof
s_waitcnt vmcnt(0)
v_cmp_gt_u32 vcc, s39, v122
s_nop 1
s_cbranch_vccnz L_fr_spinf
s_branch L_fr_gof
L_fr_spink:
s_sleep 8
buffer_load_dword v122, v123, s[60:63], s28 offen sc1
s_add_u32 s38, s38, 1
s_cmp_gt_u32 s38, 200000
s_cbranch_scc1 L_fr_gok
s_waitcnt vmcnt(0)
v_cmp_gt_u32 vcc, s39, v122
s_nop 1
s_cbranch_vccnz L_fr_spink
s_branch L_fr_gok
L_fr_chkf:
s_waitcnt vmcnt(10)
v_cmp_gt_u32 vcc, s39, v122
s_nop 1
s_cbranch_vccnz L_fr_spinf
s_branch L_fr_gof
L_at_spinq:
s_sleep 8
buffer_load_dword v12, v13, s[60:63], s8 offen sc1
s_add_u32 s38, s38, 1
s_cmp_gt_u32 s38, 200000
s_cbranch_scc1 L_at_goq
s_waitcnt vmcnt(0)
v_cmp_gt_u32 vcc, 80, v12
s_nop 1
s_cbranch_vccnz L_at_spinq
s_branch L_at_goq
L_at_spinr:
s_sleep 8
buffer_load_dword v12, v13, s[60:63], s8 offen sc1
s_add_u32 s38, s38, 1
s_cmp_gt_u32 s38, 200000
s_cbranch_scc1 L_at_gor
s_waitcnt vmcnt(0)
v_cmp_gt_u32 vcc, 80, v12
s_nop 1
s_cbranch_vccnz L_at_spinr
s_branch L_at_gor
L_tl_spinc:
s_sleep 2
buffer_load_dword v0, v4, s[60:63], s52 offen offset:0 sc1
s_add_u32 s38, s38, 1
s_cmp_gt_u32 s38, 200000
s_cbranch_scc1 L_tl_goc
s_waitcnt vmcnt(0)
v_cmp_gt_u32 vcc, s39, v0
s_nop 1
s_cbranch_vccnz L_tl_spinc
s_branch L_tl_goc
L_tl_spino:
s_sleep 2
buffer_load_dword v0, v4, s[60:63], s82 offen offset:0 sc1
s_add_u32 s38, s38, 1
s_cmp_gt_u32 s38, 200000
s_cbranch_scc1 L_tl_goo
s_waitcnt vmcnt(0)
v_cmp_gt_u32 vcc, s39, v0
s_nop 1
s_cbranch_vccnz L_tl_spino
s_branch L_tl_goo
L_tl_spinu:
s_sleep 2
buffer_load_dword v0, v4, s[60:63], s52 offen offset:0 sc1
s_add_u32 s38, s38, 1
s_cmp_gt_u32 s38, 200000
s_cbranch_scc1 L_tl_gou
s_waitcnt vmcnt(0)
v_cmp_gt_u32 vcc, s39, v0
s_nop 1
s_cbranch_vccnz L_tl_spinu
s_branch L_tl_gou
L_tl_spinx:
s_sleep 2
buffer_load_dword v95, v92, s[60:63], s70 offen sc1
s_add_u32 s38, s38, 1
s_cmp_gt_u32 s38, 200000
s_cbranch_scc1 L_tl_gox
s_waitcnt vmcnt(0)
v_cmp_gt_u32 vcc, 4, v95
s_nop 1
s_cbranch_vccnz L_tl_spinx
buffer_load_dwordx4 v[68:71], v1, s[60:63], s58 offen offset:0 sc1
buffer_load_dwordx4 v[72:75], v1, s[60:63], s58 offen offset:1024 sc1
buffer_load_dwordx4 v[76:79], v1, s[60:63], s58 offen offset:2048 sc1
buffer_load_dwordx4 v[80:83], v1, s[60:63], s58 offen offset:3072 sc1
buffer_load_dwordx4 v[84:87], v1, s[60:63], s68 offen offset:0 sc1
s_waitcnt vmcnt(0)
s_branch L_tl_gox
L_tl_spin1:
s_sleep 2
buffer_load_dword v0, v4, s[60:63], s54 offen offset:0 sc1
s_add_u32 s38, s38, 1
s_cmp_gt_u32 s38, 200000
s_cbranch_scc1 L_tl_go1
s_waitcnt vmcnt(0)
v_cmp_gt_u32 vcc, s39, v0
s_nop 1
s_cbranch_vccnz L_tl_spin1
s_branch L_tl_go1
L_tl_spin2:
s_sleep 2
buffer_load_dword v0, v4, s[60:63], s54 offen offset:128 sc1
s_add_u32 s38, s38, 1
s_cmp_gt_u32 s38, 200000
s_cbranch_scc1 L_tl_go2
s_waitcnt vmcnt(0)
v_cmp_gt_u32 vcc, s39, v0
s_nop 1
s_cbranch_vccnz L_tl_spin2
s_branch L_tl_go2
L_tl_spin3:
s_sleep 2
buffer_load_dword v0, v4, s[60:63], s54 offen offset:256 sc1
s_add_u32 s38, s38, 1
s_cmp_gt_u32 s38, 200000
s_cbranch_scc1 L_tl_go3
s_waitcnt vmcnt(0)
v_cmp_gt_u32 vcc, s39, v0
s_nop 1
s_cbranch_vccnz L_tl_spin3
s_branch L_tl_go3
L_fr_codeend:
L_at_slow:
s_mov_b32 s50, 1148928
s_bitcmp1_b32 s97, 0
s_cbranch_scc0 L_at_sdoneB
v_mov_b32 v96, 0
v_mov_b32 v97, 0
v_mov_b32 v98, 0
v_mov_b32 v99, 0
v_mov_b32 v100, 0
v_mov_b32 v101, 0
v_mov_b32 v102, 0
v_mov_b32 v103, 0
v_mov_b32 v104, 0
v_mov_b32 v105, 0
v_mov_b32 v106, 0
v_mov_b32 v107, 0
v_mov_b32 v108, 0
v_mov_b32 v109, 0
v_mov_b32 v110, 0
v_mov_b32 v111, 0
v_mov_b32 v4, v11
v_mov_b32 v5, v11
s_mov_b32 s89, s98
s_mov_b32 s6, 0
L_at_p1B:
s_add_u32 s7, s6, 4096
buffer_load_dwordx4 a[96:99], v1, s[48:51], s6 offen offset:0 sc1
buffer_load_dwordx4 a[100:103], v1, s[48:51], s6 offen offset:1024 sc1
buffer_load_dwordx4 a[104:107], v1, s[48:51], s6 offen offset:2048 sc1
buffer_load_dwordx4 a[108:111], v1, s[48:51], s6 offen offset:3072 sc1
buffer_load_dwordx4 a[112:115], v1, s[48:51], s7 offen offset:0 sc1
buffer_load_dwordx4 a[116:119], v1, s[48:51], s7 offen offset:1024 sc1
buffer_load_dwordx4 a[120:123], v1, s[48:51], s7 offen offset:2048 sc1
buffer_load_dwordx4 a[124:127], v1, s[48:51], s7 offen offset:3072 sc1
s_cmp_lg_u32 s89, 1
s_cbranch_scc1 L_at_p1nB
v_cndmask_b32 v96, v96, v11, s[76:77]
v_cndmask_b32 v97, v97, v11, s[78:79]
v_cndmask_b32 v98, v98, v11, s[80:81]
v_cndmask_b32 v99, v99, v11, s[82:83]
v_mov_b32 v100, v11
v_mov_b32 v101, v11
v_mov_b32 v102, v11
v_mov_b32 v103, v11
v_cndmask_b32 v108, v108, v11, s[76:77]
v_cndmask_b32 v109, v109, v11, s[78:79]
v_cndmask_b32 v110, v110, v11, s[80:81]
v_cndmask_b32 v111, v111, v11, s[82:83]
L_at_p1nB:
s_waitcnt vmcnt(7)
v_mfma_f32_16x16x32_bf16 v[48:51], a[96:99], v[16:19], v[96:99]
s_waitcnt vmcnt(6)
v_mfma_f32_16x16x32_bf16 v[48:51], a[100:103], v[20:23], v[48:51]
s_waitcnt vmcnt(5)
v_mfma_f32_16x16x32_bf16 v[48:51], a[104:107], v[24:27], v[48:51]
s_waitcnt vmcnt(4)
v_mfma_f32_16x16x32_bf16 v[48:51], a[108:111], v[28:31], v[48:51]
v_mfma_f32_16x16x32_bf16 v[56:59], a[108:111], v[44:47], v[104:107]
v_mfma_f32_16x16x32_bf16 v[56:59], a[104:107], v[40:43], v[56:59]
v_mfma_f32_16x16x32_bf16 v[56:59], a[100:103], v[36:39], v[56:59]
v_mfma_f32_16x16x32_bf16 v[56:59], a[96:99], v[32:35], v[56:59]
s_waitcnt vmcnt(3)
v_mfma_f32_16x16x32_bf16 v[52:55], a[112:115], v[16:19], v[100:103]
s_waitcnt vmcnt(2)
v_mfma_f32_16x16x32_bf16 v[52:55], a[116:119], v[20:23], v[52:55]
s_waitcnt vmcnt(1)
v_mfma_f32_16x16x32_bf16 v[52:55], a[120:123], v[24:27], v[52:55]
s_waitcnt vmcnt(0)
v_mfma_f32_16x16x32_bf16 v[52:55], a[124:127], v[28:31], v[52:55]
v_mfma_f32_16x16x32_bf16 v[60:63], a[124:127], v[44:47], v[108:111]
v_mfma_f32_16x16x32_bf16 v[60:63], a[120:123], v[40:43], v[60:63]
v_mfma_f32_16x16x32_bf16 v[60:63], a[116:119], v[36:39], v[60:63]
v_mfma_f32_16x16x32_bf16 v[60:63], a[112:115], v[32:35], v[60:63]
v_max3_f32 v6, v48, v49, v50
s_nop 2
v_max3_f32 v6, v6, v51, v52
v_max3_f32 v6, v6, v53, v54
v_max_f32 v6, v6, v55
v_max3_f32 v7, v56, v57, v58
v_max3_f32 v7, v7, v59, v60
v_max3_f32 v7, v7, v61, v62
v_max_f32 v7, v7, v63
v_max_f32 v4, v4, v6
v_max_f32 v5, v5, v7
s_add_u32 s6, s6, 17408
s_sub_u32 s89, s89, 1
s_cmp_lg_u32 s89, 0
s_cbranch_scc1 L_at_p1B
v_mov_b32 v8, v4
v_mov_b32 v9, v5
s_nop 0
v_permlane16_swap_b32 v4, v8
v_permlane16_swap_b32 v5, v9
v_max_f32 v4, v4, v8
v_max_f32 v5, v5, v9
v_mov_b32 v8, v4
v_mov_b32 v9, v5
s_nop 0
v_permlane32_swap_b32 v4, v8
v_permlane32_swap_b32 v5, v9
v_max_f32 v4, v4, v8
v_max_f32 v5, v5, v9
v_sub_f32 v96, 0, v4
v_sub_f32 v97, 0, v4
v_sub_f32 v98, 0, v4
v_sub_f32 v99, 0, v4
v_sub_f32 v100, 0, v4
v_sub_f32 v101, 0, v4
v_sub_f32 v102, 0, v4
v_sub_f32 v103, 0, v4
v_sub_f32 v104, 0, v5
v_sub_f32 v105, 0, v5
v_sub_f32 v106, 0, v5
v_sub_f32 v107, 0, v5
v_sub_f32 v108, 0, v5
v_sub_f32 v109, 0, v5
v_sub_f32 v110, 0, v5
v_sub_f32 v111, 0, v5
s_waitcnt vmcnt(0)
v_mov_b32 v128, 0
v_mov_b32 v129, 0
v_mov_b32 v130, 0
v_mov_b32 v131, 0
v_mov_b32 v132, 0
v_mov_b32 v133, 0
v_mov_b32 v134, 0
v_mov_b32 v135, 0
v_mov_b32 v136, 0
v_mov_b32 v137, 0
v_mov_b32 v138, 0
v_mov_b32 v139, 0
v_mov_b32 v140, 0
v_mov_b32 v141, 0
v_mov_b32 v142, 0
v_mov_b32 v143, 0
v_mov_b32 v144, 0
v_mov_b32 v145, 0
v_mov_b32 v146, 0
v_mov_b32 v147, 0
v_mov_b32 v148, 0
v_mov_b32 v149, 0
v_mov_b32 v150, 0
v_mov_b32 v151, 0
v_mov_b32 v152, 0
v_mov_b32 v153, 0
v_mov_b32 v154, 0
v_mov_b32 v155, 0
v_mov_b32 v156, 0
v_mov_b32 v157, 0
v_mov_b32 v158, 0
v_mov_b32 v159, 0
v_mov_b32 v160, 0
v_mov_b32 v161, 0
v_mov_b32 v162, 0
v_mov_b32 v163, 0
v_mov_b32 v164, 0
v_mov_b32 v165, 0
v_mov_b32 v166, 0
v_mov_b32 v167, 0
v_mov_b32 v168, 0
v_mov_b32 v169, 0
v_mov_b32 v170, 0
v_mov_b32 v171, 0
v_mov_b32 v172, 0
v_mov_b32 v173, 0
v_mov_b32 v174, 0
v_mov_b32 v175, 0
v_mov_b32 v176, 0
v_mov_b32 v177, 0
v_mov_b32 v178, 0
v_mov_b32 v179, 0
v_mov_b32 v180, 0
v_mov_b32 v181, 0
v_mov_b32 v182, 0
v_mov_b32 v183, 0
v_mov_b32 v184, 0
v_mov_b32 v185, 0
v_mov_b32 v186, 0
v_mov_b32 v187, 0
v_mov_b32 v188, 0
v_mov_b32 v189, 0
v_mov_b32 v190, 0
v_mov_b32 v191, 0
v_accvgpr_write_b32 a160, 0
v_accvgpr_write_b32 a161, 0
v_accvgpr_write_b32 a162, 0
v_accvgpr_write_b32 a163, 0
v_accvgpr_write_b32 a164, 0
v_accvgpr_write_b32 a165, 0
v_accvgpr_write_b32 a166, 0
v_accvgpr_write_b32 a167, 0
s_mov_b32 s89, s98
s_mov_b32 s6, 0
L_at_p2B:
s_add_u32 s7, s6, 4096
buffer_load_dwordx4 a[96:99], v1, s[48:51], s6 offen offset:0 sc1
buffer_load_dwordx4 a[100:103], v1, s[48:51], s6 offen offset:1024 sc1
buffer_load_dwordx4 a[104:107], v1, s[48:51], s6 offen offset:2048 sc1
buffer_load_dwordx4 a[108:111], v1, s[48:51], s6 offen offset:3072 sc1
buffer_load_dwordx4 a[112:115], v1, s[48:51], s7 offen offset:0 sc1
buffer_load_dwordx4 a[116:119], v1, s[48:51], s7 offen offset:1024 sc1
buffer_load_dwordx4 a[120:123], v1, s[48:51], s7 offen offset:2048 sc1
buffer_load_dwordx4 a[124:127], v1, s[48:51], s7 offen offset:3072 sc1
s_add_u32 s7, s6, 43008
s_add_u32 s8, s7, 4096
buffer_load_dwordx4 a[128:131], v1, s[48:51], s7 offen offset:0 sc1
buffer_load_dwordx4 a[132:135], v1, s[48:51], s7 offen offset:1024 sc1
buffer_load_dwordx4 a[136:139], v1, s[48:51], s7 offen offset:2048 sc1
buffer_load_dwordx4 a[140:143], v1, s[48:51], s7 offen offset:3072 sc1
buffer_load_dwordx4 a[144:147], v1, s[48:51], s8 offen offset:0 sc1
buffer_load_dwordx4 a[148:151], v1, s[48:51], s8 offen offset:1024 sc1
buffer_load_dwordx4 a[152:155], v1, s[48:51], s8 offen offset:2048 sc1
buffer_load_dwordx4 a[156:159], v1, s[48:51], s8 offen offset:3072 sc1
s_cmp_lg_u32 s89, 1
s_cbranch_scc1 L_at_p2nB
v_cndmask_b32 v96, v96, v11, s[76:77]
v_cndmask_b32 v97, v97, v11, s[78:79]
v_cndmask_b32 v98, v98, v11, s[80:81]
v_cndmask_b32 v99, v99, v11, s[82:83]
v_mov_b32 v100, v11
v_mov_b32 v101, v11
v_mov_b32 v102, v11
v_mov_b32 v103, v11
v_cndmask_b32 v108, v108, v11, s[76:77]
v_cndmask_b32 v109, v109, v11, s[78:79]
v_cndmask_b32 v110, v110, v11, s[80:81]
v_cndmask_b32 v111, v111, v11, s[82:83]
L_at_p2nB:
s_waitcnt vmcnt(15)
v_mfma_f32_16x16x32_bf16 v[48:51], a[96:99], v[16:19], v[96:99]
s_waitcnt vmcnt(14)
v_mfma_f32_16x16x32_bf16 v[48:51], a[100:103], v[20:23], v[48:51]
s_waitcnt vmcnt(13)
v_mfma_f32_16x16x32_bf16 v[48:51], a[104:107], v[24:27], v[48:51]
s_waitcnt vmcnt(12)
v_mfma_f32_16x16x32_bf16 v[48:51], a[108:111], v[28:31], v[48:51]
v_mfma_f32_16x16x32_bf16 v[56:59], a[108:111], v[44:47], v[104:107]
v_mfma_f32_16x16x32_bf16 v[56:59], a[104:107], v[40:43], v[56:59]
v_mfma_f32_16x16x32_bf16 v[56:59], a[100:103], v[36:39], v[56:59]
v_mfma_f32_16x16x32_bf16 v[56:59], a[96:99], v[32:35], v[56:59]
s_waitcnt vmcnt(11)
v_mfma_f32_16x16x32_bf16 v[52:55], a[112:115], v[16:19], v[100:103]
s_waitcnt vmcnt(10)
v_mfma_f32_16x16x32_bf16 v[52:55], a[116:119], v[20:23], v[52:55]
s_waitcnt vmcnt(9)
v_mfma_f32_16x16x32_bf16 v[52:55], a[120:123], v[24:27], v[52:55]
s_waitcnt vmcnt(8)
v_mfma_f32_16x16x32_bf16 v[52:55], a[124:127], v[28:31], v[52:55]
v_mfma_f32_16x16x32_bf16 v[60:63], a[124:127], v[44:47], v[108:111]
v_mfma_f32_16x16x32_bf16 v[60:63], a[120:123], v[40:43], v[60:63]
v_mfma_f32_16x16x32_bf16 v[60:63], a[116:119], v[36:39], v[60:63]
v_mfma_f32_16x16x32_bf16 v[60:63], a[112:115], v[32:35], v[60:63]
s_waitcnt vmcnt(7)
v_exp_f32 v48, v48
v_exp_f32 v49, v49
v_exp_f32 v50, v50
v_exp_f32 v51, v51
v_exp_f32 v52, v52
v_exp_f32 v53, v53
v_exp_f32 v54, v54
v_exp_f32 v55, v55
v_exp_f32 v56, v56
v_exp_f32 v57, v57
v_exp_f32 v58, v58
v_exp_f32 v59, v59
v_exp_f32 v60, v60
v_exp_f32 v61, v61
v_exp_f32 v62, v62
v_exp_f32 v63, v63
v_cvt_pk_bf16_f32 v80, v48, v49
v_cvt_pk_bf16_f32 v81, v50, v51
v_cvt_pk_bf16_f32 v82, v52, v53
v_cvt_pk_bf16_f32 v83, v54, v55
v_cvt_pk_bf16_f32 v84, v56, v57
v_cvt_pk_bf16_f32 v85, v58, v59
v_cvt_pk_bf16_f32 v86, v60, v61
v_cvt_pk_bf16_f32 v87, v62, v63
v_mfma_f32_16x16x32_bf16 v[128:131], a[128:131], v[80:83], v[128:131]
s_nop 0
v_mfma_f32_16x16x32_bf16 v[132:135], a[128:131], v[84:87], v[132:135]
s_waitcnt vmcnt(6)
v_mfma_f32_16x16x32_bf16 v[136:139], a[132:135], v[80:83], v[136:139]
v_mfma_f32_16x16x32_bf16 v[140:143], a[132:135], v[84:87], v[140:143]
s_waitcnt vmcnt(5)
v_mfma_f32_16x16x32_bf16 v[144:147], a[136:139], v[80:83], v[144:147]
v_mfma_f32_16x16x32_bf16 v[148:151], a[136:139], v[84:87], v[148:151]
s_waitcnt vmcnt(4)
v_mfma_f32_16x16x32_bf16 v[152:155], a[140:143], v[80:83], v[152:155]
v_mfma_f32_16x16x32_bf16 v[156:159], a[140:143], v[84:87], v[156:159]
s_waitcnt vmcnt(3)
v_mfma_f32_16x16x32_bf16 v[160:163], a[144:147], v[80:83], v[160:163]
v_mfma_f32_16x16x32_bf16 v[164:167], a[144:147], v[84:87], v[164:167]
s_waitcnt vmcnt(2)
v_mfma_f32_16x16x32_bf16 v[168:171], a[148:151], v[80:83], v[168:171]
v_mfma_f32_16x16x32_bf16 v[172:175], a[148:151], v[84:87], v[172:175]
s_waitcnt vmcnt(1)
v_mfma_f32_16x16x32_bf16 v[176:179], a[152:155], v[80:83], v[176:179]
v_mfma_f32_16x16x32_bf16 v[180:183], a[152:155], v[84:87], v[180:183]
s_waitcnt vmcnt(0)
v_mfma_f32_16x16x32_bf16 v[184:187], a[156:159], v[80:83], v[184:187]
v_mfma_f32_16x16x32_bf16 v[188:191], a[156:159], v[84:87], v[188:191]
v_mfma_f32_16x16x32_bf16 a[160:163], a[176:179], v[80:83], a[160:163]
v_mfma_f32_16x16x32_bf16 a[164:167], a[176:179], v[84:87], a[164:167]
s_add_u32 s6, s6, 17408
s_sub_u32 s89, s89, 1
s_cmp_lg_u32 s89, 0
s_cbranch_scc1 L_at_p2B
s_nop 2
v_accvgpr_read_b32 v6, a160
v_accvgpr_read_b32 v7, a164
v_rcp_f32 v8, v6
v_rcp_f32 v9, v7
v_add_f32 v6, v6, v7
v_cmp_nge_f32 vcc, 0x5d800000, v6
s_add_u32 s6, s91, 0
s_nop 0
s_cmp_lg_u64 vcc, 0
s_cselect_b32 s7, 1, 0
s_or_b32 s97, s97, s7
v_pk_mul_f32 v[128:129], v[128:129], v[8:9] op_sel_hi:[1,0]
v_pk_mul_f32 v[130:131], v[130:131], v[8:9] op_sel_hi:[1,0]
v_pk_mul_f32 v[136:137], v[136:137], v[8:9] op_sel_hi:[1,0]
v_pk_mul_f32 v[138:139], v[138:139], v[8:9] op_sel_hi:[1,0]
v_cvt_pk_bf16_f32 v128, v128, v129
v_cvt_pk_bf16_f32 v129, v130, v131
v_cvt_pk_bf16_f32 v130, v136, v137
v_cvt_pk_bf16_f32 v131, v138, v139
v_pk_mul_f32 v[132:133], v[132:133], v[8:9] op_sel:[0,1]
v_pk_mul_f32 v[134:135], v[134:135], v[8:9] op_sel:[0,1]
v_pk_mul_f32 v[140:141], v[140:141], v[8:9] op_sel:[0,1]
v_pk_mul_f32 v[142:143], v[142:143], v[8:9] op_sel:[0,1]
v_cvt_pk_bf16_f32 v132, v132, v133
v_cvt_pk_bf16_f32 v133, v134, v135
v_cvt_pk_bf16_f32 v134, v140, v141
v_cvt_pk_bf16_f32 v135, v142, v143
buffer_store_dwordx4 v[128:131], v1, s[60:63], s6 offen offset:0 sc1
buffer_store_dwordx4 v[132:135], v1, s[60:63], s6 offen offset:1024 sc1
s_add_u32 s6, s6, 4096
v_pk_mul_f32 v[144:145], v[144:145], v[8:9] op_sel_hi:[1,0]
v_pk_mul_f32 v[146:147], v[146:147], v[8:9] op_sel_hi:[1,0]
v_pk_mul_f32 v[152:153], v[152:153], v[8:9] op_sel_hi:[1,0]
v_pk_mul_f32 v[154:155], v[154:155], v[8:9] op_sel_hi:[1,0]
v_cvt_pk_bf16_f32 v144, v144, v145
v_cvt_pk_bf16_f32 v145, v146, v147
v_cvt_pk_bf16_f32 v146, v152, v153
v_cvt_pk_bf16_f32 v147, v154, v155
v_pk_mul_f32 v[148:149], v[148:149], v[8:9] op_sel:[0,1]
v_pk_mul_f32 v[150:151], v[150:151], v[8:9] op_sel:[0,1]
v_pk_mul_f32 v[156:157], v[156:157], v[8:9] op_sel:[0,1]
v_pk_mul_f32 v[158:159], v[158:159], v[8:9] op_sel:[0,1]
v_cvt_pk_bf16_f32 v148, v148, v149
v_cvt_pk_bf16_f32 v149, v150, v151
v_cvt_pk_bf16_f32 v150, v156, v157
v_cvt_pk_bf16_f32 v151, v158, v159
buffer_store_dwordx4 v[144:147], v1, s[60:63], s6 offen offset:0 sc1
buffer_store_dwordx4 v[148:151], v1, s[60:63], s6 offen offset:1024 sc1
s_add_u32 s6, s6, 4096
v_pk_mul_f32 v[160:161], v[160:161], v[8:9] op_sel_hi:[1,0]
v_pk_mul_f32 v[162:163], v[162:163], v[8:9] op_sel_hi:[1,0]
v_pk_mul_f32 v[168:169], v[168:169], v[8:9] op_sel_hi:[1,0]
v_pk_mul_f32 v[170:171], v[170:171], v[8:9] op_sel_hi:[1,0]
v_cvt_pk_bf16_f32 v160, v160, v161
v_cvt_pk_bf16_f32 v161, v162, v163
v_cvt_pk_bf16_f32 v162, v168, v169
v_cvt_pk_bf16_f32 v163, v170, v171
v_pk_mul_f32 v[164:165], v[164:165], v[8:9] op_sel:[0,1]
v_pk_mul_f32 v[166:167], v[166:167], v[8:9] op_sel:[0,1]
v_pk_mul_f32 v[172:173], v[172:173], v[8:9] op_sel:[0,1]
v_pk_mul_f32 v[174:175], v[174:175], v[8:9] op_sel:[0,1]
v_cvt_pk_bf16_f32 v164, v164, v165
v_cvt_pk_bf16_f32 v165, v166, v167
v_cvt_pk_bf16_f32 v166, v172, v173
v_cvt_pk_bf16_f32 v167, v174, v175
buffer_store_dwordx4 v[160:163], v1, s[60:63], s6 offen offset:0 sc1
buffer_store_dwordx4 v[164:167], v1, s[60:63], s6 offen offset:1024 sc1
s_add_u32 s6, s6, 4096
v_pk_mul_f32 v[176:177], v[176:177], v[8:9] op_sel_hi:[1,0]
v_pk_mul_f32 v[178:179], v[178:179], v[8:9] op_sel_hi:[1,0]
v_pk_mul_f32 v[184:185], v[184:185], v[8:9] op_sel_hi:[1,0]
v_pk_mul_f32 v[186:187], v[186:187], v[8:9] op_sel_hi:[1,0]
v_cvt_pk_bf16_f32 v176, v176, v177
v_cvt_pk_bf16_f32 v177, v178, v179
v_cvt_pk_bf16_f32 v178, v184, v185
v_cvt_pk_bf16_f32 v179, v186, v187
v_pk_mul_f32 v[180:181], v[180:181], v[8:9] op_sel:[0,1]
v_pk_mul_f32 v[182:183], v[182:183], v[8:9] op_sel:[0,1]
v_pk_mul_f32 v[188:189], v[188:189], v[8:9] op_sel:[0,1]
v_pk_mul_f32 v[190:191], v[190:191], v[8:9] op_sel:[0,1]
v_cvt_pk_bf16_f32 v180, v180, v181
v_cvt_pk_bf16_f32 v181, v182, v183
v_cvt_pk_bf16_f32 v182, v188, v189
v_cvt_pk_bf16_f32 v183, v190, v191
buffer_store_dwordx4 v[176:179], v1, s[60:63], s6 offen offset:0 sc1
buffer_store_dwordx4 v[180:183], v1, s[60:63], s6 offen offset:1024 sc1
L_at_sdoneB:
s_bitcmp1_b32 s97, 1
s_cbranch_scc0 L_at_sdoneA
s_waitcnt vmcnt(15)
v_mov_b32 v112, 0
v_mov_b32 v113, 0
v_mov_b32 v114, 0
v_mov_b32 v115, 0
s_waitcnt vmcnt(14)
v_mov_b32 v116, 0
v_mov_b32 v117, 0
v_mov_b32 v118, 0
v_mov_b32 v119, 0
s_waitcnt vmcnt(13)
v_mov_b32 v120, 0
v_mov_b32 v121, 0
v_mov_b32 v122, 0
v_mov_b32 v123, 0
s_waitcnt vmcnt(12)
v_mov_b32 v124, 0
v_mov_b32 v125, 0
v_mov_b32 v126, 0
v_mov_b32 v127, 0
v_mov_b32 v4, v11
v_mov_b32 v5, v11
s_mov_b32 s89, s88
s_mov_b32 s6, 0
L_at_p1A:
s_add_u32 s7, s6, 4096
buffer_load_dwordx4 a[96:99], v1, s[48:51], s6 offen offset:0 sc1
buffer_load_dwordx4 a[100:103], v1, s[48:51], s6 offen offset:1024 sc1
buffer_load_dwordx4 a[104:107], v1, s[48:51], s6 offen offset:2048 sc1
buffer_load_dwordx4 a[108:111], v1, s[48:51], s6 offen offset:3072 sc1
buffer_load_dwordx4 a[112:115], v1, s[48:51], s7 offen offset:0 sc1
buffer_load_dwordx4 a[116:119], v1, s[48:51], s7 offen offset:1024 sc1
buffer_load_dwordx4 a[120:123], v1, s[48:51], s7 offen offset:2048 sc1
buffer_load_dwordx4 a[124:127], v1, s[48:51], s7 offen offset:3072 sc1
s_cmp_lg_u32 s89, 1
s_cbranch_scc1 L_at_p1nA
v_cndmask_b32 v112, v112, v11, s[76:77]
v_cndmask_b32 v113, v113, v11, s[78:79]
v_cndmask_b32 v114, v114, v11, s[80:81]
v_cndmask_b32 v115, v115, v11, s[82:83]
v_mov_b32 v116, v11
v_mov_b32 v117, v11
v_mov_b32 v118, v11
v_mov_b32 v119, v11
v_cndmask_b32 v124, v124, v11, s[76:77]
v_cndmask_b32 v125, v125, v11, s[78:79]
v_cndmask_b32 v126, v126, v11, s[80:81]
v_cndmask_b32 v127, v127, v11, s[82:83]
L_at_p1nA:
s_waitcnt vmcnt(7)
v_mfma_f32_16x16x32_bf16 v[48:51], a[96:99], a[64:67], v[112:115]
s_waitcnt vmcnt(6)
v_mfma_f32_16x16x32_bf16 v[48:51], a[100:103], a[68:71], v[48:51]
s_waitcnt vmcnt(5)
v_mfma_f32_16x16x32_bf16 v[48:51], a[104:107], a[72:75], v[48:51]
s_waitcnt vmcnt(4)
v_mfma_f32_16x16x32_bf16 v[48:51], a[108:111], a[76:79], v[48:51]
v_mfma_f32_16x16x32_bf16 v[56:59], a[108:111], a[92:95], v[120:123]
v_mfma_f32_16x16x32_bf16 v[56:59], a[104:107], a[88:91], v[56:59]
v_mfma_f32_16x16x32_bf16 v[56:59], a[100:103], a[84:87], v[56:59]
v_mfma_f32_16x16x32_bf16 v[56:59], a[96:99], a[80:83], v[56:59]
s_waitcnt vmcnt(3)
v_mfma_f32_16x16x32_bf16 v[52:55], a[112:115], a[64:67], v[116:119]
s_waitcnt vmcnt(2)
v_mfma_f32_16x16x32_bf16 v[52:55], a[116:119], a[68:71], v[52:55]
s_waitcnt vmcnt(1)
v_mfma_f32_16x16x32_bf16 v[52:55], a[120:123], a[72:75], v[52:55]
s_waitcnt vmcnt(0)
v_mfma_f32_16x16x32_bf16 v[52:55], a[124:127], a[76:79], v[52:55]
v_mfma_f32_16x16x32_bf16 v[60:63], a[124:127], a[92:95], v[124:127]
v_mfma_f32_16x16x32_bf16 v[60:63], a[120:123], a[88:91], v[60:63]
v_mfma_f32_16x16x32_bf16 v[60:63], a[116:119], a[84:87], v[60:63]
v_mfma_f32_16x16x32_bf16 v[60:63], a[112:115], a[80:83], v[60:63]
v_max3_f32 v6, v48, v49, v50
s_nop 2
v_max3_f32 v6, v6, v51, v52
v_max3_f32 v6, v6, v53, v54
v_max_f32 v6, v6, v55
v_max3_f32 v7, v56, v57, v58
v_max3_f32 v7, v7, v59, v60
v_max3_f32 v7, v7, v61, v62
v_max_f32 v7, v7, v63
v_max_f32 v4, v4, v6
v_max_f32 v5, v5, v7
s_add_u32 s6, s6, 17408
s_sub_u32 s89, s89, 1
s_cmp_lg_u32 s89, 0
s_cbranch_scc1 L_at_p1A
v_mov_b32 v8, v4
v_mov_b32 v9, v5
s_nop 0
v_permlane16_swap_b32 v4, v8
v_permlane16_swap_b32 v5, v9
v_max_f32 v4, v4, v8
v_max_f32 v5, v5, v9
v_mov_b32 v8, v4
v_mov_b32 v9, v5
s_nop 0
v_permlane32_swap_b32 v4, v8
v_permlane32_swap_b32 v5, v9
v_max_f32 v4, v4, v8
v_max_f32 v5, v5, v9
v_sub_f32 v112, 0, v4
v_sub_f32 v113, 0, v4
v_sub_f32 v114, 0, v4
v_sub_f32 v115, 0, v4
v_sub_f32 v116, 0, v4
v_sub_f32 v117, 0, v4
v_sub_f32 v118, 0, v4
v_sub_f32 v119, 0, v4
v_sub_f32 v120, 0, v5
v_sub_f32 v121, 0, v5
v_sub_f32 v122, 0, v5
v_sub_f32 v123, 0, v5
v_sub_f32 v124, 0, v5
v_sub_f32 v125, 0, v5
v_sub_f32 v126, 0, v5
v_sub_f32 v127, 0, v5
s_waitcnt vmcnt(0)
v_mov_b32 v192, 0
v_mov_b32 v193, 0
v_mov_b32 v194, 0
v_mov_b32 v195, 0
v_mov_b32 v196, 0
v_mov_b32 v197, 0
v_mov_b32 v198, 0
v_mov_b32 v199, 0
v_mov_b32 v200, 0
v_mov_b32 v201, 0
v_mov_b32 v202, 0
v_mov_b32 v203, 0
v_mov_b32 v204, 0
v_mov_b32 v205, 0
v_mov_b32 v206, 0
v_mov_b32 v207, 0
v_mov_b32 v208, 0
v_mov_b32 v209, 0
v_mov_b32 v210, 0
v_mov_b32 v211, 0
v_mov_b32 v212, 0
v_mov_b32 v213, 0
v_mov_b32 v214, 0
v_mov_b32 v215, 0
v_mov_b32 v216, 0
v_mov_b32 v217, 0
v_mov_b32 v218, 0
v_mov_b32 v219, 0
v_mov_b32 v220, 0
v_mov_b32 v221, 0
v_mov_b32 v222, 0
v_mov_b32 v223, 0
v_mov_b32 v224, 0
v_mov_b32 v225, 0
v_mov_b32 v226, 0
v_mov_b32 v227, 0
v_mov_b32 v228, 0
v_mov_b32 v229, 0
v_mov_b32 v230, 0
v_mov_b32 v231, 0
v_mov_b32 v232, 0
v_mov_b32 v233, 0
v_mov_b32 v234, 0
v_mov_b32 v235, 0
v_mov_b32 v236, 0
v_mov_b32 v237, 0
v_mov_b32 v238, 0
v_mov_b32 v239, 0
v_mov_b32 v240, 0
v_mov_b32 v241, 0
v_mov_b32 v242, 0
v_mov_b32 v243, 0
v_mov_b32 v244, 0
v_mov_b32 v245, 0
v_mov_b32 v246, 0
v_mov_b32 v247, 0
v_mov_b32 v248, 0
v_mov_b32 v249, 0
v_mov_b32 v250, 0
v_mov_b32 v251, 0
v_mov_b32 v252, 0
v_mov_b32 v253, 0
v_mov_b32 v254, 0
v_mov_b32 v255, 0
v_accvgpr_write_b32 a168, 0
v_accvgpr_write_b32 a169, 0
v_accvgpr_write_b32 a170, 0
v_accvgpr_write_b32 a171, 0
v_accvgpr_write_b32 a172, 0
v_accvgpr_write_b32 a173, 0
v_accvgpr_write_b32 a174, 0
v_accvgpr_write_b32 a175, 0
s_mov_b32 s89, s88
s_mov_b32 s6, 0
L_at_p2A:
s_add_u32 s7, s6, 4096
buffer_load_dwordx4 a[96:99], v1, s[48:51], s6 offen offset:0 sc1
buffer_load_dwordx4 a[100:103], v1, s[48:51], s6 offen offset:1024 sc1
buffer_load_dwordx4 a[104:107], v1, s[48:51], s6 offen offset:2048 sc1
buffer_load_dwordx4 a[108:111], v1, s[48:51], s6 offen offset:3072 sc1
buffer_load_dwordx4 a[112:115], v1, s[48:51], s7 offen offset:0 sc1
buffer_load_dwordx4 a[116:119], v1, s[48:51], s7 offen offset:1024 sc1
buffer_load_dwordx4 a[120:123], v1, s[48:51], s7 offen offset:2048 sc1
buffer_load_dwordx4 a[124:127], v1, s[48:51], s7 offen offset:3072 sc1
s_add_u32 s7, s6, 43008
s_add_u32 s8, s7, 4096
buffer_load_dwordx4 a[128:131], v1, s[48:51], s7 offen offset:0 sc1
buffer_load_dwordx4 a[132:135], v1, s[48:51], s7 offen offset:1024 sc1
buffer_load_dwordx4 a[136:139], v1, s[48:51], s7 offen offset:2048 sc1
buffer_load_dwordx4 a[140:143], v1, s[48:51], s7 offen offset:3072 sc1
buffer_load_dwordx4 a[144:147], v1, s[48:51], s8 offen offset:0 sc1
buffer_load_dwordx4 a[148:151], v1, s[48:51], s8 offen offset:1024 sc1
buffer_load_dwordx4 a[152:155], v1, s[48:51], s8 offen offset:2048 sc1
buffer_load_dwordx4 a[156:159], v1, s[48:51], s8 offen offset:3072 sc1
s_cmp_lg_u32 s89, 1
s_cbranch_scc1 L_at_p2nA
v_cndmask_b32 v112, v112, v11, s[76:77]
v_cndmask_b32 v113, v113, v11, s[78:79]
v_cndmask_b32 v114, v114, v11, s[80:81]
v_cndmask_b32 v115, v115, v11, s[82:83]
v_mov_b32 v116, v11
v_mov_b32 v117, v11
v_mov_b32 v118, v11
v_mov_b32 v119, v11
v_cndmask_b32 v124, v124, v11, s[76:77]
v_cndmask_b32 v125, v125, v11, s[78:79]
v_cndmask_b32 v126, v126, v11, s[80:81]
v_cndmask_b32 v127, v127, v11, s[82:83]
L_at_p2nA:
s_waitcnt vmcnt(15)
v_mfma_f32_16x16x32_bf16 v[48:51], a[96:99], a[64:67], v[112:115]
s_waitcnt vmcnt(14)
v_mfma_f32_16x16x32_bf16 v[48:51], a[100:103], a[68:71], v[48:51]
s_waitcnt vmcnt(13)
v_mfma_f32_16x16x32_bf16 v[48:51], a[104:107], a[72:75], v[48:51]
s_waitcnt vmcnt(12)
v_mfma_f32_16x16x32_bf16 v[48:51], a[108:111], a[76:79], v[48:51]
v_mfma_f32_16x16x32_bf16 v[56:59], a[108:111], a[92:95], v[120:123]
v_mfma_f32_16x16x32_bf16 v[56:59], a[104:107], a[88:91], v[56:59]
v_mfma_f32_16x16x32_bf16 v[56:59], a[100:103], a[84:87], v[56:59]
v_mfma_f32_16x16x32_bf16 v[56:59], a[96:99], a[80:83], v[56:59]
s_waitcnt vmcnt(11)
v_mfma_f32_16x16x32_bf16 v[52:55], a[112:115], a[64:67], v[116:119]
s_waitcnt vmcnt(10)
v_mfma_f32_16x16x32_bf16 v[52:55], a[116:119], a[68:71], v[52:55]
s_waitcnt vmcnt(9)
v_mfma_f32_16x16x32_bf16 v[52:55], a[120:123], a[72:75], v[52:55]
s_waitcnt vmcnt(8)
v_mfma_f32_16x16x32_bf16 v[52:55], a[124:127], a[76:79], v[52:55]
v_mfma_f32_16x16x32_bf16 v[60:63], a[124:127], a[92:95], v[124:127]
v_mfma_f32_16x16x32_bf16 v[60:63], a[120:123], a[88:91], v[60:63]
v_mfma_f32_16x16x32_bf16 v[60:63], a[116:119], a[84:87], v[60:63]
v_mfma_f32_16x16x32_bf16 v[60:63], a[112:115], a[80:83], v[60:63]
s_waitcnt vmcnt(7)
v_exp_f32 v48, v48
v_exp_f32 v49, v49
v_exp_f32 v50, v50
v_exp_f32 v51, v51
v_exp_f32 v52, v52
v_exp_f32 v53, v53
v_exp_f32 v54, v54
v_exp_f32 v55, v55
v_exp_f32 v56, v56
v_exp_f32 v57, v57
v_exp_f32 v58, v58
v_exp_f32 v59, v59
v_exp_f32 v60, v60
v_exp_f32 v61, v61
v_exp_f32 v62, v62
v_exp_f32 v63, v63
v_cvt_pk_bf16_f32 v80, v48, v49
v_cvt_pk_bf16_f32 v81, v50, v51
v_cvt_pk_bf16_f32 v82, v52, v53
v_cvt_pk_bf16_f32 v83, v54, v55
v_cvt_pk_bf16_f32 v84, v56, v57
v_cvt_pk_bf16_f32 v85, v58, v59
v_cvt_pk_bf16_f32 v86, v60, v61
v_cvt_pk_bf16_f32 v87, v62, v63
v_mfma_f32_16x16x32_bf16 v[192:195], a[128:131], v[80:83], v[192:195]
s_nop 0
v_mfma_f32_16x16x32_bf16 v[196:199], a[128:131], v[84:87], v[196:199]
s_waitcnt vmcnt(6)
v_mfma_f32_16x16x32_bf16 v[200:203], a[132:135], v[80:83], v[200:203]
v_mfma_f32_16x16x32_bf16 v[204:207], a[132:135], v[84:87], v[204:207]
s_waitcnt vmcnt(5)
v_mfma_f32_16x16x32_bf16 v[208:211], a[136:139], v[80:83], v[208:211]
v_mfma_f32_16x16x32_bf16 v[212:215], a[136:139], v[84:87], v[212:215]
s_waitcnt vmcnt(4)
v_mfma_f32_16x16x32_bf16 v[216:219], a[140:143], v[80:83], v[216:219]
v_mfma_f32_16x16x32_bf16 v[220:223], a[140:143], v[84:87], v[220:223]
s_waitcnt vmcnt(3)
v_mfma_f32_16x16x32_bf16 v[224:227], a[144:147], v[80:83], v[224:227]
v_mfma_f32_16x16x32_bf16 v[228:231], a[144:147], v[84:87], v[228:231]
s_waitcnt vmcnt(2)
v_mfma_f32_16x16x32_bf16 v[232:235], a[148:151], v[80:83], v[232:235]
v_mfma_f32_16x16x32_bf16 v[236:239], a[148:151], v[84:87], v[236:239]
s_waitcnt vmcnt(1)
v_mfma_f32_16x16x32_bf16 v[240:243], a[152:155], v[80:83], v[240:243]
v_mfma_f32_16x16x32_bf16 v[244:247], a[152:155], v[84:87], v[244:247]
s_waitcnt vmcnt(0)
v_mfma_f32_16x16x32_bf16 v[248:251], a[156:159], v[80:83], v[248:251]
v_mfma_f32_16x16x32_bf16 v[252:255], a[156:159], v[84:87], v[252:255]
v_mfma_f32_16x16x32_bf16 a[168:171], a[176:179], v[80:83], a[168:171]
v_mfma_f32_16x16x32_bf16 a[172:175], a[176:179], v[84:87], a[172:175]
s_add_u32 s6, s6, 17408
s_sub_u32 s89, s89, 1
s_cmp_lg_u32 s89, 0
s_cbranch_scc1 L_at_p2A
s_nop 2
v_accvgpr_read_b32 v6, a168
v_accvgpr_read_b32 v7, a172
v_rcp_f32 v8, v6
v_rcp_f32 v9, v7
v_add_f32 v6, v6, v7
v_cmp_nge_f32 vcc, 0x5d800000, v6
s_add_u32 s6, s96, 0
s_nop 0
s_cmp_lg_u64 vcc, 0
s_cselect_b32 s7, 2, 0
s_or_b32 s97, s97, s7
v_pk_mul_f32 v[192:193], v[192:193], v[8:9] op_sel_hi:[1,0]
v_pk_mul_f32 v[194:195], v[194:195], v[8:9] op_sel_hi:[1,0]
v_pk_mul_f32 v[200:201], v[200:201], v[8:9] op_sel_hi:[1,0]
v_pk_mul_f32 v[202:203], v[202:203], v[8:9] op_sel_hi:[1,0]
v_cvt_pk_bf16_f32 v192, v192, v193
v_cvt_pk_bf16_f32 v193, v194, v195
v_cvt_pk_bf16_f32 v194, v200, v201
v_cvt_pk_bf16_f32 v195, v202, v203
v_pk_mul_f32 v[196:197], v[196:197], v[8:9] op_sel:[0,1]
v_pk_mul_f32 v[198:199], v[198:199], v[8:9] op_sel:[0,1]
v_pk_mul_f32 v[204:205], v[204:205], v[8:9] op_sel:[0,1]
v_pk_mul_f32 v[206:207], v[206:207], v[8:9] op_sel:[0,1]
v_cvt_pk_bf16_f32 v196, v196, v197
v_cvt_pk_bf16_f32 v197, v198, v199
v_cvt_pk_bf16_f32 v198, v204, v205
v_cvt_pk_bf16_f32 v199, v206, v207
buffer_store_dwordx4 v[192:195], v1, s[60:63], s6 offen offset:0 sc1
buffer_store_dwordx4 v[196:199], v1, s[60:63], s6 offen offset:1024 sc1
s_add_u32 s6, s6, 4096
v_pk_mul_f32 v[208:209], v[208:209], v[8:9] op_sel_hi:[1,0]
v_pk_mul_f32 v[210:211], v[210:211], v[8:9] op_sel_hi:[1,0]
v_pk_mul_f32 v[216:217], v[216:217], v[8:9] op_sel_hi:[1,0]
v_pk_mul_f32 v[218:219], v[218:219], v[8:9] op_sel_hi:[1,0]
v_cvt_pk_bf16_f32 v208, v208, v209
v_cvt_pk_bf16_f32 v209, v210, v211
v_cvt_pk_bf16_f32 v210, v216, v217
v_cvt_pk_bf16_f32 v211, v218, v219
v_pk_mul_f32 v[212:213], v[212:213], v[8:9] op_sel:[0,1]
v_pk_mul_f32 v[214:215], v[214:215], v[8:9] op_sel:[0,1]
v_pk_mul_f32 v[220:221], v[220:221], v[8:9] op_sel:[0,1]
v_pk_mul_f32 v[222:223], v[222:223], v[8:9] op_sel:[0,1]
v_cvt_pk_bf16_f32 v212, v212, v213
v_cvt_pk_bf16_f32 v213, v214, v215
v_cvt_pk_bf16_f32 v214, v220, v221
v_cvt_pk_bf16_f32 v215, v222, v223
buffer_store_dwordx4 v[208:211], v1, s[60:63], s6 offen offset:0 sc1
buffer_store_dwordx4 v[212:215], v1, s[60:63], s6 offen offset:1024 sc1
s_add_u32 s6, s6, 4096
v_pk_mul_f32 v[224:225], v[224:225], v[8:9] op_sel_hi:[1,0]
v_pk_mul_f32 v[226:227], v[226:227], v[8:9] op_sel_hi:[1,0]
v_pk_mul_f32 v[232:233], v[232:233], v[8:9] op_sel_hi:[1,0]
v_pk_mul_f32 v[234:235], v[234:235], v[8:9] op_sel_hi:[1,0]
v_cvt_pk_bf16_f32 v224, v224, v225
v_cvt_pk_bf16_f32 v225, v226, v227
v_cvt_pk_bf16_f32 v226, v232, v233
v_cvt_pk_bf16_f32 v227, v234, v235
v_pk_mul_f32 v[228:229], v[228:229], v[8:9] op_sel:[0,1]
v_pk_mul_f32 v[230:231], v[230:231], v[8:9] op_sel:[0,1]
v_pk_mul_f32 v[236:237], v[236:237], v[8:9] op_sel:[0,1]
v_pk_mul_f32 v[238:239], v[238:239], v[8:9] op_sel:[0,1]
v_cvt_pk_bf16_f32 v228, v228, v229
v_cvt_pk_bf16_f32 v229, v230, v231
v_cvt_pk_bf16_f32 v230, v236, v237
v_cvt_pk_bf16_f32 v231, v238, v239
buffer_store_dwordx4 v[224:227], v1, s[60:63], s6 offen offset:0 sc1
buffer_store_dwordx4 v[228:231], v1, s[60:63], s6 offen offset:1024 sc1
s_add_u32 s6, s6, 4096
v_pk_mul_f32 v[240:241], v[240:241], v[8:9] op_sel_hi:[1,0]
v_pk_mul_f32 v[242:243], v[242:243], v[8:9] op_sel_hi:[1,0]
v_pk_mul_f32 v[248:249], v[248:249], v[8:9] op_sel_hi:[1,0]
v_pk_mul_f32 v[250:251], v[250:251], v[8:9] op_sel_hi:[1,0]
v_cvt_pk_bf16_f32 v240, v240, v241
v_cvt_pk_bf16_f32 v241, v242, v243
v_cvt_pk_bf16_f32 v242, v248, v249
v_cvt_pk_bf16_f32 v243, v250, v251
v_pk_mul_f32 v[244:245], v[244:245], v[8:9] op_sel:[0,1]
v_pk_mul_f32 v[246:247], v[246:247], v[8:9] op_sel:[0,1]
v_pk_mul_f32 v[252:253], v[252:253], v[8:9] op_sel:[0,1]
v_pk_mul_f32 v[254:255], v[254:255], v[8:9] op_sel:[0,1]
v_cvt_pk_bf16_f32 v244, v244, v245
v_cvt_pk_bf16_f32 v245, v246, v247
v_cvt_pk_bf16_f32 v246, v252, v253
v_cvt_pk_bf16_f32 v247, v254, v255
buffer_store_dwordx4 v[240:243], v1, s[60:63], s6 offen offset:0 sc1
buffer_store_dwordx4 v[244:247], v1, s[60:63], s6 offen offset:1024 sc1
L_at_sdoneA:
s_add_u32 s43, s43, 4294795264
buffer_load_dwordx4 v[192:195], v1, s[60:63], s43 offen offset:1024 sc1
buffer_load_dwordx4 v[196:199], v1, s[60:63], s43 offen offset:2048 sc1
buffer_load_dwordx4 v[200:203], v1, s[60:63], s43 offen offset:3072 sc1
s_add_u32 s43, s43, 4096
buffer_load_dwordx4 v[204:207], v1, s[60:63], s43 offen offset:0 sc1
buffer_load_dwordx4 v[208:211], v1, s[60:63], s43 offen offset:1024 sc1
buffer_load_dwordx4 v[212:215], v1, s[60:63], s43 offen offset:2048 sc1
buffer_load_dwordx4 v[216:219], v1, s[60:63], s43 offen offset:3072 sc1
s_add_u32 s43, s43, 4096
buffer_load_dwordx4 v[220:223], v1, s[60:63], s43 offen offset:0 sc1
buffer_load_dwordx4 v[224:227], v1, s[60:63], s43 offen offset:1024 sc1
buffer_load_dwordx4 v[228:231], v1, s[60:63], s43 offen offset:2048 sc1
buffer_load_dwordx4 v[232:235], v1, s[60:63], s43 offen offset:3072 sc1
s_add_u32 s43, s43, 4096
buffer_load_dwordx4 v[236:239], v1, s[60:63], s43 offen offset:0 sc1
buffer_load_dwordx4 v[240:243], v1, s[60:63], s43 offen offset:1024 sc1
buffer_load_dwordx4 v[244:247], v1, s[60:63], s43 offen offset:2048 sc1
buffer_load_dwordx4 v[248:251], v1, s[60:63], s43 offen offset:3072 sc1
s_add_u32 s43, s43, 151552
buffer_load_dwordx4 v[252:255], v1, s[60:63], s43 offen offset:1024 sc1
buffer_load_dwordx4 v[112:115], v1, s[60:63], s43 offen offset:2048 sc1
buffer_load_dwordx4 v[116:119], v1, s[60:63], s43 offen offset:3072 sc1
s_add_u32 s43, s43, 4096
buffer_load_dwordx4 v[120:123], v1, s[60:63], s43 offen offset:0 sc1
buffer_load_dwordx4 v[124:127], v1, s[60:63], s43 offen offset:1024 sc1
buffer_load_dwordx4 a[96:99], v1, s[60:63], s43 offen offset:2048 sc1
buffer_load_dwordx4 a[100:103], v1, s[60:63], s43 offen offset:3072 sc1
s_add_u32 s43, s43, 4096
buffer_load_dwordx4 a[104:107], v1, s[60:63], s43 offen offset:0 sc1
buffer_load_dwordx4 a[108:111], v1, s[60:63], s43 offen offset:1024 sc1
s_branch L_at_fin
.section .rodata,"a"
.p2align 6
.amdhsa_kernel adaLN_cond__compressed_kv_cla__dense_activation_squared_relu__prompt_kernel
  .amdhsa_next_free_vgpr 512
  .amdhsa_next_free_sgpr 102
  .amdhsa_accum_offset 256
  .amdhsa_group_segment_fixed_size 0
  .amdhsa_kernarg_size 128
  .amdhsa_user_sgpr_count 2
  .amdhsa_user_sgpr_kernarg_segment_ptr 1
  .amdhsa_system_sgpr_workgroup_id_x 1
  .amdhsa_float_denorm_mode_32 3
.end_amdhsa_kernel
```
